```python
import torch

def _softmax(x, axis=-1):
    return torch.softmax(x, dim=axis)
def _gelu(x):
    return torch.nn.functional.gelu(x, approximate="tanh")
def _silu(x):
    return torch.nn.functional.silu(x)
def _sigmoid(x):
    return torch.sigmoid(x)
def _layernorm(x, axis=-1, eps=1e-5):
    m = x.mean(dim=axis, keepdim=True)
    v = x.var(dim=axis, keepdim=True, unbiased=False)
    return (x - m) / torch.sqrt(v + eps)
def _scatter_add(tgt, idx, src, axis=0):
    return tgt.clone().index_add_(axis, idx, src)
def _segment_sum(src, seg, n):
    out = torch.zeros((n,) + src.shape[1:], dtype=src.dtype)
    return out.index_add_(0, seg, src)
def _pad(x, pw):
    flat = tuple(v for pair in reversed(pw) for v in pair)
    return torch.nn.functional.pad(x, flat)

kernel_name = 'concat_heads__softmax_full_mha__compressed_kv_cla__prompt'

def setup_inputs():

    _w = (lambda a: (lambda t: t.to(torch.bfloat16) if t.is_floating_point() else t)(torch.as_tensor(a)))
    def _A_setup():
        B, S, D = 1, 2048, 576
        return {
            "x": _w((lambda *s: torch.randn(*s, dtype=torch.bfloat16) * 0.2)(B, S, D)),
            "wqkv": _w((lambda *s: torch.randn(*s, dtype=torch.bfloat16) * 0.2)(D, 3 * D)),
            "wo": _w((lambda *s: torch.randn(*s, dtype=torch.bfloat16) * 0.05)(D, D)),
        }
    _A_in = _A_setup()

    def _B_setup():
        B, H, Sq, Sk, D, M = 1, 32, 2048, 2048, 128, 576
        Dc = 4 * D
        return {
            "x": _w((lambda *s: torch.randn(*s, dtype=torch.bfloat16) * 0.4)(B, Sq, M)),
            "c_kv": _w((lambda *s: torch.randn(*s, dtype=torch.bfloat16) * 0.4)(B, Sk, Dc)),
            "w_q": _w((lambda *s: torch.randn(*s, dtype=torch.bfloat16) * 3.2)(M, H, D) * (M ** -0.5)),
            "w_uk": _w((lambda *s: torch.randn(*s, dtype=torch.bfloat16) * 3.2)(Dc, H, D) * (Dc ** -0.5)),
            "w_uv": _w((lambda *s: torch.randn(*s, dtype=torch.bfloat16) * 0.4)(Dc, H, D) * (Dc ** -0.5)),
            "w_o": _w((lambda *s: torch.randn(*s, dtype=torch.bfloat16) * 0.4)(H, D, M) * ((H * D) ** -0.5)),
        }
    _B_in = _B_setup()

    return {
        "A_x": _A_in["x"],
        "A_wqkv": _A_in["wqkv"],
        "A_wo": _A_in["wo"],
        "B_x": _B_in["x"],
        "B_c_kv": _B_in["c_kv"],
        "B_w_q": _B_in["w_q"],
        "B_w_uk": _B_in["w_uk"],
        "B_w_uv": _B_in["w_uv"],
        "B_w_o": _B_in["w_o"],
    }

def reference(A_x, A_wqkv, A_wo, B_x, B_c_kv, B_w_q, B_w_uk, B_w_uv, B_w_o):
    def _A_ref(x, wqkv, wo):
        B, S, D = x.shape
        H = 32; Dh = D // H
        qkv = (lambda x, *d: x.permute(*d))((x @ wqkv).reshape(B, S, 3, H, Dh), 2, 0, 3, 1, 4)
        q, k, v = qkv[0], qkv[1], qkv[2]
        scale = Dh ** -0.5
        scores = torch.einsum("bhqd,bhkd->bhqk", q, k) * scale
        p = _softmax(scores, axis=-1)
        o = torch.einsum("bhqk,bhkd->bhqd", p, v)
        return (lambda x, *d: x.permute(*d))(o, 0, 2, 1, 3).reshape(B, S, D) @ wo

    def _B_ref(x, c_kv, w_q, w_uk, w_uv, w_o):
        B, Sq, M = x.shape[0], x.shape[1], x.shape[2]
        Sk = c_kv.shape[1]
        H, D = w_q.shape[1], w_q.shape[2]
        q = torch.einsum("bqm,mhd->bhqd", x, w_q)
        k = torch.einsum("bkc,chd->bhkd", c_kv, w_uk)
        v = torch.einsum("bkc,chd->bhkd", c_kv, w_uv)
        scores = torch.einsum("bhqd,bhkd->bhqk", q, k) * (D ** -0.5)
        off = Sk - Sq
        qi = torch.arange(Sq)[:, None]
        kj = torch.arange(Sk)[None, :]
        cmask = kj <= (qi + off)
        scores = torch.where(cmask[None, None], scores, -1e9)
        p = _softmax(scores, axis=-1)
        ctx = torch.einsum("bhqk,bhkd->bhqd", p, v)
        return torch.einsum("bhqd,hdm->bqm", ctx, w_o)

    a = _A_ref(A_x, A_wqkv, A_wo)
    b = _B_ref(B_x, B_c_kv, B_w_q, B_w_uk, B_w_uv, B_w_o)
    return torch.concatenate([a, b], axis=-1)
```

```asm
; @launch grid=(256,1,1) block=(256,1,1) lds=163840
.amdgcn_target "amdgcn-amd-amdhsa--gfx950"
.text
.globl concat_heads__softmax_full_mha__compressed_kv_cla__prompt_kernel
.p2align 8
.type concat_heads__softmax_full_mha__compressed_kv_cla__prompt_kernel,@function
concat_heads__softmax_full_mha__compressed_kv_cla__prompt_kernel:
 s_cmp_ge_u32 s2, 256
 s_cbranch_scc1 L_end
 s_load_dwordx16 s[4:19], s[0:1], 0
 s_load_dwordx8 s[20:27], s[0:1], 64
 v_lshrrev_b32 v2, 6, v0
 v_and_b32 v1, 63, v0
 s_mov_b32 s33, s2
 v_readfirstlane_b32 s28, v2
 s_and_b32 s29, s2, 7
 s_lshr_b32 s30, s2, 3
 s_and_b32 s31, s30, 3
 s_lshl_b32 s52, s29, 2
 s_add_u32 s31, s31, s52
 s_lshr_b32 s32, s30, 2
 s_waitcnt lgkmcnt(0)
 s_mov_b32 s36, s26
 s_mov_b32 s37, s27
 s_mov_b32 s38, 0x10000000
 s_mov_b32 s39, 0x20000
 v_and_b32 v2, 31, v1
 v_lshrrev_b32 v3, 5, v1
 v_bfe_u32 v4, v1, 2, 2
 v_bfe_u32 v5, v1, 4, 1
 v_and_b32 v6, 3, v1
 v_lshrrev_b32 v7, 3, v1
 v_lshrrev_b32 v8, 4, v1
 s_mov_b32 s40, s12
 s_mov_b32 s41, s13
 s_mov_b32 s42, 2097152
 s_mov_b32 s43, 0x20000
 s_mov_b32 s44, s16
 s_mov_b32 s45, s17
 s_mov_b32 s46, 4194304
 s_mov_b32 s47, 0x20000
 s_lshl_b32 s54, s28, 4
 s_mov_b32 s53, 8192
 v_lshlrev_b32 v9, 2, v8
 v_and_b32 v26, 15, v1
 v_xor_b32 v9, v9, v26
 v_lshlrev_b32 v9, 4, v9
 s_add_u32 s52, s54, 0
 v_add_u32 v26, s52, v8
 v_mul_lo_u32 v26, v26, s53
 v_add_u32 v26, v26, v9
 s_add_u32 s52, s54, 4
 v_add_u32 v27, s52, v8
 v_mul_lo_u32 v27, v27, s53
 v_add_u32 v27, v27, v9
 v_subrev_u32 v27, 1024, v27
 s_add_u32 s52, s54, 8
 v_add_u32 v28, s52, v8
 v_mul_lo_u32 v28, v28, s53
 v_add_u32 v28, v28, v9
 v_subrev_u32 v28, 2048, v28
 s_add_u32 s52, s54, 12
 v_add_u32 v29, s52, v8
 v_mul_lo_u32 v29, v29, s53
 v_add_u32 v29, v29, v9
 v_subrev_u32 v29, 3072, v29
 s_lshl_b32 s54, s28, 6
 s_mov_b32 s53, 1024
 v_add_u32 v9, 0, v8
 v_and_b32 v9, 7, v9
 v_and_b32 v22, 7, v1
 v_xor_b32 v9, v9, v22
 v_lshlrev_b32 v9, 4, v9
 s_add_u32 s52, s54, 0
 v_add_u32 v22, s52, v7
 v_mul_lo_u32 v22, v22, s53
 v_add_u32 v22, v22, v9
 v_add_u32 v9, 4, v8
 v_and_b32 v9, 7, v9
 v_and_b32 v23, 7, v1
 v_xor_b32 v9, v9, v23
 v_lshlrev_b32 v9, 4, v9
 s_add_u32 s52, s54, 8
 v_add_u32 v23, s52, v7
 v_mul_lo_u32 v23, v23, s53
 v_add_u32 v23, v23, v9
 v_subrev_u32 v23, 1024, v23
 v_add_u32 v9, 0, v8
 v_and_b32 v9, 7, v9
 v_and_b32 v24, 7, v1
 v_xor_b32 v9, v9, v24
 v_lshlrev_b32 v9, 4, v9
 s_add_u32 s52, s54, 16
 v_add_u32 v24, s52, v7
 v_mul_lo_u32 v24, v24, s53
 v_add_u32 v24, v24, v9
 v_subrev_u32 v24, 2048, v24
 v_add_u32 v9, 4, v8
 v_and_b32 v9, 7, v9
 v_and_b32 v25, 7, v1
 v_xor_b32 v9, v9, v25
 v_lshlrev_b32 v9, 4, v9
 s_add_u32 s52, s54, 24
 v_add_u32 v25, s52, v7
 v_mul_lo_u32 v25, v25, s53
 v_add_u32 v25, v25, v9
 v_subrev_u32 v25, 3072, v25
 s_lshl_b32 s56, s28, 13
 s_lshl_b32 s57, s28, 12
 s_lshl_b32 s58, s32, 18
 s_add_u32 s60, s58, 32768
 s_lshl_b32 s59, s31, 8
 s_mov_b32 s61, s59
 s_mov_b32 s62, s59
 s_add_u32 m0, s56, 0
 s_nop 0
 buffer_load_dwordx4 v22, s[40:43], s58 offen lds
 buffer_load_dwordx4 v23, s[40:43], s58 offen offset:1024 lds
 buffer_load_dwordx4 v24, s[40:43], s58 offen offset:2048 lds
 buffer_load_dwordx4 v25, s[40:43], s58 offen offset:3072 lds
 s_add_u32 s58, s58, 128
 s_add_u32 m0, s56, 4096
 s_nop 0
 buffer_load_dwordx4 v22, s[40:43], s60 offen lds
 buffer_load_dwordx4 v23, s[40:43], s60 offen offset:1024 lds
 buffer_load_dwordx4 v24, s[40:43], s60 offen offset:2048 lds
 buffer_load_dwordx4 v25, s[40:43], s60 offen offset:3072 lds
 s_add_u32 s60, s60, 128
 s_add_u32 m0, s57, 98304
 s_nop 0
 buffer_load_dwordx4 v26, s[44:47], s59 offen nt lds
 buffer_load_dwordx4 v27, s[44:47], s59 offen offset:1024 nt lds
 buffer_load_dwordx4 v28, s[44:47], s59 offen offset:2048 nt lds
 buffer_load_dwordx4 v29, s[44:47], s59 offen offset:3072 nt lds
 s_add_u32 s59, s59, 524288
 s_add_u32 m0, s56, 32768
 s_nop 0
 buffer_load_dwordx4 v22, s[40:43], s58 offen lds
 buffer_load_dwordx4 v23, s[40:43], s58 offen offset:1024 lds
 buffer_load_dwordx4 v24, s[40:43], s58 offen offset:2048 lds
 buffer_load_dwordx4 v25, s[40:43], s58 offen offset:3072 lds
 s_add_u32 s58, s58, 128
 s_add_u32 m0, s56, 36864
 s_nop 0
 buffer_load_dwordx4 v22, s[40:43], s60 offen lds
 buffer_load_dwordx4 v23, s[40:43], s60 offen offset:1024 lds
 buffer_load_dwordx4 v24, s[40:43], s60 offen offset:2048 lds
 buffer_load_dwordx4 v25, s[40:43], s60 offen offset:3072 lds
 s_add_u32 s60, s60, 128
 s_add_u32 m0, s57, 65536
 s_nop 0
 buffer_load_dwordx4 v26, s[44:47], s59 offen nt lds
 buffer_load_dwordx4 v27, s[44:47], s59 offen offset:1024 nt lds
 buffer_load_dwordx4 v28, s[44:47], s59 offen offset:2048 nt lds
 buffer_load_dwordx4 v29, s[44:47], s59 offen offset:3072 nt lds
 s_add_u32 s59, s59, 524288
 s_add_u32 m0, s56, 131072
 s_nop 0
 buffer_load_dwordx4 v22, s[40:43], s58 offen lds
 buffer_load_dwordx4 v23, s[40:43], s58 offen offset:1024 lds
 buffer_load_dwordx4 v24, s[40:43], s58 offen offset:2048 lds
 buffer_load_dwordx4 v25, s[40:43], s58 offen offset:3072 lds
 s_add_u32 s58, s58, 128
 s_add_u32 m0, s56, 135168
 s_nop 0
 buffer_load_dwordx4 v22, s[40:43], s60 offen lds
 buffer_load_dwordx4 v23, s[40:43], s60 offen offset:1024 lds
 buffer_load_dwordx4 v24, s[40:43], s60 offen offset:2048 lds
 buffer_load_dwordx4 v25, s[40:43], s60 offen offset:3072 lds
 s_add_u32 s60, s60, 128
 s_add_u32 m0, s57, 81920
 s_nop 0
 buffer_load_dwordx4 v26, s[44:47], s59 offen nt lds
 buffer_load_dwordx4 v27, s[44:47], s59 offen offset:1024 nt lds
 buffer_load_dwordx4 v28, s[44:47], s59 offen offset:2048 nt lds
 buffer_load_dwordx4 v29, s[44:47], s59 offen offset:3072 nt lds
 s_add_u32 s59, s59, 524288
 s_mov_b32 s48, s18
 s_mov_b32 s49, s19
 s_mov_b32 s50, 4194304
 s_mov_b32 s51, 0x20000
 s_lshl_b32 s54, s28, 13
 v_bfe_u32 v9, v2, 1, 3
 v_add_u32 v14, 0, v3
 v_xor_b32 v14, v14, v9
 v_lshlrev_b32 v14, 4, v14
 v_lshl_add_u32 v14, v2, 7, v14
 v_add_u32 v14, s54, v14
 v_add_u32 v10, 0, v14
 v_add_u32 v14, 131072, v14
 v_add_u32 v15, 2, v3
 v_xor_b32 v15, v15, v9
 v_lshlrev_b32 v15, 4, v15
 v_lshl_add_u32 v15, v2, 7, v15
 v_add_u32 v15, s54, v15
 v_add_u32 v11, 0, v15
 v_add_u32 v15, 131072, v15
 v_add_u32 v16, 4, v3
 v_xor_b32 v16, v16, v9
 v_lshlrev_b32 v16, 4, v16
 v_lshl_add_u32 v16, v2, 7, v16
 v_add_u32 v16, s54, v16
 v_add_u32 v12, 0, v16
 v_add_u32 v16, 131072, v16
 v_add_u32 v17, 6, v3
 v_xor_b32 v17, v17, v9
 v_lshlrev_b32 v17, 4, v17
 v_lshl_add_u32 v17, v2, 7, v17
 v_add_u32 v17, s54, v17
 v_add_u32 v13, 0, v17
 v_add_u32 v17, 131072, v17
 v_lshlrev_b32 v9, 3, v3
 v_add_u32 v9, v9, v4
 v_lshlrev_b32 v9, 8, v9
 v_lshl_add_u32 v9, v5, 5, v9
 v_lshl_add_u32 v9, v6, 3, v9
 v_xor_b32 v18, 0, v4
 v_lshl_add_u32 v18, v18, 6, v9
 v_add_u32 v18, 65536, v18
 v_xor_b32 v19, 1, v4
 v_lshl_add_u32 v19, v19, 6, v9
 v_add_u32 v19, 65536, v19
 v_xor_b32 v20, 2, v4
 v_lshl_add_u32 v20, v20, 6, v9
 v_add_u32 v20, 65536, v20
 v_xor_b32 v21, 3, v4
 v_lshl_add_u32 v21, v21, 6, v9
 v_add_u32 v21, 65536, v21
 v_lshlrev_b32 v30, 4, v1
 s_lshl_b32 s63, s31, 19
 s_lshl_b32 s52, s32, 16
 s_add_u32 s63, s63, s52
 s_lshl_b32 s52, s28, 14
 s_add_u32 s63, s63, s52
 s_mul_i32 s52, s30, 9363
 s_lshr_b32 s52, s52, 16
 s_mul_i32 s53, s52, 7
 s_sub_u32 s53, s30, s53
 s_lshr_b32 s68, s29, 1
 s_lshl_b32 s68, s68, 2
 s_and_b32 s54, s52, 3
 s_add_u32 s68, s68, s54
 s_and_b32 s69, s29, 1
 s_mul_i32 s69, s69, 7
 s_add_u32 s69, s69, s53
 s_cmp_ge_u32 s30, 28
 s_cselect_b32 s69, 14, s69
 s_lshl_b32 s65, s28, 12
 s_mul_i32 s66, s68, 147456
 s_lshl_b32 s67, s69, 8
 s_mov_b32 s70, 0x3e0293ee
 v_lshlrev_b32 v9, 10, v1
 s_lshl_b32 s52, s33, 2
 s_add_u32 s52, s52, 71303168
 s_cmp_eq_u32 s28, 0
 v_mov_b32 v31, 0
 s_cselect_b32 s53, 2, 0
 v_cmp_gt_u32 vcc, s53, v1
 v_mov_b32 v8, 0x80000000
 s_nop 0
 v_cndmask_b32 v9, v8, v9, vcc
 buffer_store_dword v31, v9, s[36:39], s52 offen sc1
 v_lshrrev_b32 v8, 4, v1
 s_lshl_b32 s35, s33, 2
 s_add_u32 s35, s35, s28
 v_mov_b32 v0, 0x80000000
L_code_pf:
 s_getpc_b64 s[72:73]
 s_mov_b32 s74, L_code_end-L_code_pf
 s_mov_b32 s75, 0x20000
 s_lshl_b32 s64, s30, 2
 s_add_u32 s64, s64, s28
 s_mul_i32 s64, s64, 1280
 v_cmp_gt_u32 vcc, 10, v1
 v_lshlrev_b32 v9, 7, v1
 s_nop 0
 v_cndmask_b32 v9, v0, v9, vcc
 buffer_load_dword v31, v9, s[72:75], s64 offen
 s_mov_b32 s72, s12
 s_mov_b32 s73, s13
 s_mov_b32 s74, 2097152
 s_mov_b32 s75, 0x20000
 s_mul_i32 s64, s35, 2048
 v_cmp_gt_u32 vcc, 8, v1
 v_lshlrev_b32 v9, 7, v1
 s_nop 0
 v_cndmask_b32 v9, v0, v9, vcc
 buffer_load_dword v31, v9, s[72:75], s64 offen
 s_add_u32 s64, s64, 1024
 buffer_load_dword v31, v9, s[72:75], s64 offen
 s_add_u32 s64, s64, 1024
 s_mov_b32 s72, s18
 s_mov_b32 s73, s19
 s_mov_b32 s74, 4194304
 s_mov_b32 s75, 0x20000
 s_lshl_b32 s64, s32, 2
 s_add_u32 s64, s64, s28
 s_mul_i32 s64, s64, 131072
 s_add_u32 s64, s64, s62
 v_cmp_gt_u32 vcc, 8, v1
 v_lshrrev_b32 v9, 1, v1
 v_lshlrev_b32 v9, 6, v9
 v_and_or_b32 v9, v1, 1, v9
 v_lshlrev_b32 v9, 7, v9
 v_cndmask_b32 v9, v0, v9, vcc
 buffer_load_dword v31, v9, s[72:75], s64 offen
 s_add_u32 s64, s64, 32768
 buffer_load_dword v31, v9, s[72:75], s64 offen
 s_add_u32 s64, s64, 32768
 buffer_load_dword v31, v9, s[72:75], s64 offen
 s_add_u32 s64, s64, 32768
 buffer_load_dword v31, v9, s[72:75], s64 offen
 s_add_u32 s64, s64, 32768
 s_mov_b32 s72, s10
 s_mov_b32 s73, s11
 s_mov_b32 s74, 2359296
 s_mov_b32 s75, 0x20000
 s_mul_i32 s64, s35, 2304
 v_cmp_gt_u32 vcc, 8, v1
 v_lshlrev_b32 v9, 7, v1
 s_nop 0
 v_cndmask_b32 v9, v0, v9, vcc
 buffer_load_dword v31, v9, s[72:75], s64 offen
 s_add_u32 s64, s64, 1024
 buffer_load_dword v31, v9, s[72:75], s64 offen
 s_add_u32 s64, s64, 1024
 buffer_load_dword v31, v9, s[72:75], s64 offen
 s_add_u32 s64, s64, 1024
 s_mov_b32 s72, s14
 s_mov_b32 s73, s15
 s_mov_b32 s74, 4718592
 s_mov_b32 s75, 0x20000
 s_lshl_b32 s64, s32, 2
 s_add_u32 s64, s64, s28
 s_mul_i32 s64, s64, 147456
 s_add_u32 s64, s64, s62
 v_cmp_gt_u32 vcc, 8, v1
 v_lshrrev_b32 v9, 1, v1
 v_lshlrev_b32 v9, 6, v9
 v_and_or_b32 v9, v1, 1, v9
 v_lshlrev_b32 v9, 7, v9
 v_cndmask_b32 v9, v0, v9, vcc
 buffer_load_dword v31, v9, s[72:75], s64 offen
 s_add_u32 s64, s64, 32768
 s_waitcnt vmcnt(36)
 s_barrier
 ds_read_b64_tr_b16 v[32:33], v18 offset:32768
 ds_read_b64_tr_b16 v[34:35], v18 offset:33792
 ds_read_b128 a[0:3], v10
 ds_read_b64_tr_b16 v[36:37], v19 offset:32768
 ds_read_b64_tr_b16 v[38:39], v19 offset:33792
 ds_read_b128 a[4:7], v10 offset:4096
 ds_read_b64_tr_b16 v[40:41], v20 offset:32768
 ds_read_b64_tr_b16 v[42:43], v20 offset:33792
 ds_read_b64_tr_b16 v[44:45], v21 offset:32768
 ds_read_b64_tr_b16 v[46:47], v21 offset:33792
 s_waitcnt lgkmcnt(7)
 v_mfma_f32_32x32x16_bf16 v[64:79], v[32:35], a[0:3], 0
 ds_read_b64_tr_b16 v[48:49], v18 offset:36864
 ds_read_b64_tr_b16 v[50:51], v18 offset:37888
 buffer_load_dword v31, v9, s[72:75], s64 offen
 s_add_u32 s64, s64, 32768
 s_waitcnt lgkmcnt(7)
 v_mfma_f32_32x32x16_bf16 v[80:95], v[36:39], a[0:3], 0
 ds_read_b128 a[8:11], v11
 ds_read_b64_tr_b16 v[52:53], v19 offset:36864
 s_waitcnt lgkmcnt(8)
 v_mfma_f32_32x32x16_bf16 v[144:159], v[36:39], a[4:7], 0
 ds_read_b64_tr_b16 v[54:55], v19 offset:37888
 ds_read_b128 a[12:15], v11 offset:4096
 v_mfma_f32_32x32x16_bf16 v[128:143], v[32:35], a[4:7], 0
 ds_read_b64_tr_b16 v[56:57], v20 offset:36864
 ds_read_b64_tr_b16 v[58:59], v20 offset:37888
 s_waitcnt lgkmcnt(6)
 v_mfma_f32_32x32x16_bf16 v[96:111], v[40:43], a[0:3], 0
 ds_read_b64_tr_b16 v[60:61], v21 offset:36864
 ds_read_b64_tr_b16 v[62:63], v21 offset:37888
 v_mfma_f32_32x32x16_bf16 v[160:175], v[40:43], a[4:7], 0
 v_mfma_f32_32x32x16_bf16 v[112:127], v[44:47], a[0:3], 0
 v_mfma_f32_32x32x16_bf16 v[176:191], v[44:47], a[4:7], 0
 s_waitcnt lgkmcnt(0)
 v_mfma_f32_32x32x16_bf16 v[64:79], v[48:51], a[8:11], v[64:79]
 ds_read_b64_tr_b16 v[32:33], v18 offset:40960
 ds_read_b64_tr_b16 v[34:35], v18 offset:41984
 v_mfma_f32_32x32x16_bf16 v[80:95], v[52:55], a[8:11], v[80:95]
 ds_read_b128 a[16:19], v12
 ds_read_b64_tr_b16 v[36:37], v19 offset:40960
 v_mfma_f32_32x32x16_bf16 v[144:159], v[52:55], a[12:15], v[144:159]
 ds_read_b64_tr_b16 v[38:39], v19 offset:41984
 ds_read_b128 a[20:23], v12 offset:4096
 v_mfma_f32_32x32x16_bf16 v[128:143], v[48:51], a[12:15], v[128:143]
 ds_read_b64_tr_b16 v[40:41], v20 offset:40960
 ds_read_b64_tr_b16 v[42:43], v20 offset:41984
 v_mfma_f32_32x32x16_bf16 v[96:111], v[56:59], a[8:11], v[96:111]
 ds_read_b64_tr_b16 v[44:45], v21 offset:40960
 ds_read_b64_tr_b16 v[46:47], v21 offset:41984
 v_mfma_f32_32x32x16_bf16 v[160:175], v[56:59], a[12:15], v[160:175]
 v_mfma_f32_32x32x16_bf16 v[112:127], v[60:63], a[8:11], v[112:127]
 v_mfma_f32_32x32x16_bf16 v[176:191], v[60:63], a[12:15], v[176:191]
 s_waitcnt lgkmcnt(0)
 v_mfma_f32_32x32x16_bf16 v[64:79], v[32:35], a[16:19], v[64:79]
 ds_read_b64_tr_b16 v[48:49], v18 offset:45056
 ds_read_b64_tr_b16 v[50:51], v18 offset:46080
 v_mfma_f32_32x32x16_bf16 v[80:95], v[36:39], a[16:19], v[80:95]
 ds_read_b128 a[24:27], v13
 ds_read_b64_tr_b16 v[52:53], v19 offset:45056
 v_mfma_f32_32x32x16_bf16 v[144:159], v[36:39], a[20:23], v[144:159]
 ds_read_b64_tr_b16 v[54:55], v19 offset:46080
 ds_read_b128 a[28:31], v13 offset:4096
 v_mfma_f32_32x32x16_bf16 v[128:143], v[32:35], a[20:23], v[128:143]
 ds_read_b64_tr_b16 v[56:57], v20 offset:45056
 ds_read_b64_tr_b16 v[58:59], v20 offset:46080
 v_mfma_f32_32x32x16_bf16 v[96:111], v[40:43], a[16:19], v[96:111]
 ds_read_b64_tr_b16 v[60:61], v21 offset:45056
 ds_read_b64_tr_b16 v[62:63], v21 offset:46080
 v_mfma_f32_32x32x16_bf16 v[160:175], v[40:43], a[20:23], v[160:175]
 v_mfma_f32_32x32x16_bf16 v[112:127], v[44:47], a[16:19], v[112:127]
 v_mfma_f32_32x32x16_bf16 v[176:191], v[44:47], a[20:23], v[176:191]
 s_waitcnt lgkmcnt(0)
 v_mfma_f32_32x32x16_bf16 v[64:79], v[48:51], a[24:27], v[64:79]
 s_waitcnt vmcnt(25)
 s_barrier
 ds_read_b64_tr_b16 v[32:33], v18
 ds_read_b64_tr_b16 v[34:35], v18 offset:1024
 v_mfma_f32_32x32x16_bf16 v[80:95], v[52:55], a[24:27], v[80:95]
 ds_read_b128 a[32:35], v10 offset:32768
 ds_read_b64_tr_b16 v[36:37], v19
 s_add_u32 m0, s56, 0
 s_nop 0
 buffer_load_dwordx4 v22, s[40:43], s58 offen lds
 v_mfma_f32_32x32x16_bf16 v[144:159], v[52:55], a[28:31], v[144:159]
 ds_read_b64_tr_b16 v[38:39], v19 offset:1024
 ds_read_b128 a[36:39], v10 offset:36864
 v_mfma_f32_32x32x16_bf16 v[128:143], v[48:51], a[28:31], v[128:143]
 ds_read_b64_tr_b16 v[40:41], v20
 ds_read_b64_tr_b16 v[42:43], v20 offset:1024
 buffer_load_dwordx4 v23, s[40:43], s58 offen offset:1024 lds
 v_mfma_f32_32x32x16_bf16 v[96:111], v[56:59], a[24:27], v[96:111]
 ds_read_b64_tr_b16 v[44:45], v21
 ds_read_b64_tr_b16 v[46:47], v21 offset:1024
 v_mfma_f32_32x32x16_bf16 v[160:175], v[56:59], a[28:31], v[160:175]
 buffer_load_dwordx4 v24, s[40:43], s58 offen offset:2048 lds
 v_mfma_f32_32x32x16_bf16 v[112:127], v[60:63], a[24:27], v[112:127]
 v_mfma_f32_32x32x16_bf16 v[176:191], v[60:63], a[28:31], v[176:191]
 buffer_load_dwordx4 v25, s[40:43], s58 offen offset:3072 lds
 s_add_u32 s58, s58, 128
 s_waitcnt lgkmcnt(0)
 v_mfma_f32_32x32x16_bf16 v[64:79], v[32:35], a[32:35], v[64:79]
 ds_read_b64_tr_b16 v[48:49], v18 offset:4096
 ds_read_b64_tr_b16 v[50:51], v18 offset:5120
 v_mfma_f32_32x32x16_bf16 v[80:95], v[36:39], a[32:35], v[80:95]
 ds_read_b128 a[40:43], v11 offset:32768
 ds_read_b64_tr_b16 v[52:53], v19 offset:4096
 s_add_u32 m0, s56, 4096
 s_nop 0
 buffer_load_dwordx4 v22, s[40:43], s60 offen lds
 v_mfma_f32_32x32x16_bf16 v[144:159], v[36:39], a[36:39], v[144:159]
 ds_read_b64_tr_b16 v[54:55], v19 offset:5120
 ds_read_b128 a[44:47], v11 offset:36864
 v_mfma_f32_32x32x16_bf16 v[128:143], v[32:35], a[36:39], v[128:143]
 ds_read_b64_tr_b16 v[56:57], v20 offset:4096
 ds_read_b64_tr_b16 v[58:59], v20 offset:5120
 buffer_load_dwordx4 v23, s[40:43], s60 offen offset:1024 lds
 v_mfma_f32_32x32x16_bf16 v[96:111], v[40:43], a[32:35], v[96:111]
 ds_read_b64_tr_b16 v[60:61], v21 offset:4096
 ds_read_b64_tr_b16 v[62:63], v21 offset:5120
 v_mfma_f32_32x32x16_bf16 v[160:175], v[40:43], a[36:39], v[160:175]
 buffer_load_dwordx4 v24, s[40:43], s60 offen offset:2048 lds
 v_mfma_f32_32x32x16_bf16 v[112:127], v[44:47], a[32:35], v[112:127]
 v_mfma_f32_32x32x16_bf16 v[176:191], v[44:47], a[36:39], v[176:191]
 buffer_load_dwordx4 v25, s[40:43], s60 offen offset:3072 lds
 s_add_u32 s60, s60, 128
 s_waitcnt lgkmcnt(0)
 v_mfma_f32_32x32x16_bf16 v[64:79], v[48:51], a[40:43], v[64:79]
 ds_read_b64_tr_b16 v[32:33], v18 offset:8192
 ds_read_b64_tr_b16 v[34:35], v18 offset:9216
 v_mfma_f32_32x32x16_bf16 v[80:95], v[52:55], a[40:43], v[80:95]
 ds_read_b128 a[48:51], v12 offset:32768
 ds_read_b64_tr_b16 v[36:37], v19 offset:8192
 s_add_u32 m0, s57, 98304
 s_nop 0
 buffer_load_dwordx4 v26, s[44:47], s59 offen nt lds
 v_mfma_f32_32x32x16_bf16 v[144:159], v[52:55], a[44:47], v[144:159]
 ds_read_b64_tr_b16 v[38:39], v19 offset:9216
 ds_read_b128 a[52:55], v12 offset:36864
 v_mfma_f32_32x32x16_bf16 v[128:143], v[48:51], a[44:47], v[128:143]
 ds_read_b64_tr_b16 v[40:41], v20 offset:8192
 ds_read_b64_tr_b16 v[42:43], v20 offset:9216
 buffer_load_dwordx4 v27, s[44:47], s59 offen offset:1024 nt lds
 v_mfma_f32_32x32x16_bf16 v[96:111], v[56:59], a[40:43], v[96:111]
 ds_read_b64_tr_b16 v[44:45], v21 offset:8192
 ds_read_b64_tr_b16 v[46:47], v21 offset:9216
 v_mfma_f32_32x32x16_bf16 v[160:175], v[56:59], a[44:47], v[160:175]
 buffer_load_dwordx4 v28, s[44:47], s59 offen offset:2048 nt lds
 v_mfma_f32_32x32x16_bf16 v[112:127], v[60:63], a[40:43], v[112:127]
 v_mfma_f32_32x32x16_bf16 v[176:191], v[60:63], a[44:47], v[176:191]
 buffer_load_dwordx4 v29, s[44:47], s59 offen offset:3072 nt lds
 s_add_u32 s59, s59, 524288
 s_waitcnt lgkmcnt(0)
 v_mfma_f32_32x32x16_bf16 v[64:79], v[32:35], a[48:51], v[64:79]
 ds_read_b64_tr_b16 v[48:49], v18 offset:12288
 ds_read_b64_tr_b16 v[50:51], v18 offset:13312
 v_mfma_f32_32x32x16_bf16 v[80:95], v[36:39], a[48:51], v[80:95]
 ds_read_b128 a[56:59], v13 offset:32768
 ds_read_b64_tr_b16 v[52:53], v19 offset:12288
 buffer_load_dword v31, v9, s[72:75], s64 offen
 s_add_u32 s64, s64, 32768
 v_mfma_f32_32x32x16_bf16 v[144:159], v[36:39], a[52:55], v[144:159]
 ds_read_b64_tr_b16 v[54:55], v19 offset:13312
 ds_read_b128 a[60:63], v13 offset:36864
 v_mfma_f32_32x32x16_bf16 v[128:143], v[32:35], a[52:55], v[128:143]
 ds_read_b64_tr_b16 v[56:57], v20 offset:12288
 ds_read_b64_tr_b16 v[58:59], v20 offset:13312
 buffer_load_dword v31, v9, s[72:75], s64 offen
 s_add_u32 s64, s64, 32768
 v_mfma_f32_32x32x16_bf16 v[96:111], v[40:43], a[48:51], v[96:111]
 ds_read_b64_tr_b16 v[60:61], v21 offset:12288
 ds_read_b64_tr_b16 v[62:63], v21 offset:13312
 v_mfma_f32_32x32x16_bf16 v[160:175], v[40:43], a[52:55], v[160:175]
 v_mfma_f32_32x32x16_bf16 v[112:127], v[44:47], a[48:51], v[112:127]
 v_mfma_f32_32x32x16_bf16 v[176:191], v[44:47], a[52:55], v[176:191]
 s_waitcnt lgkmcnt(0)
 v_mfma_f32_32x32x16_bf16 v[64:79], v[48:51], a[56:59], v[64:79]
 s_waitcnt vmcnt(27)
 s_barrier
 ds_read_b64_tr_b16 v[32:33], v18 offset:16384
 ds_read_b64_tr_b16 v[34:35], v18 offset:17408
 v_mfma_f32_32x32x16_bf16 v[80:95], v[52:55], a[56:59], v[80:95]
 ds_read_b128 a[64:67], v14
 ds_read_b64_tr_b16 v[36:37], v19 offset:16384
 s_add_u32 m0, s56, 32768
 s_nop 0
 buffer_load_dwordx4 v22, s[40:43], s58 offen lds
 v_mfma_f32_32x32x16_bf16 v[144:159], v[52:55], a[60:63], v[144:159]
 ds_read_b64_tr_b16 v[38:39], v19 offset:17408
 ds_read_b128 a[68:71], v14 offset:4096
 v_mfma_f32_32x32x16_bf16 v[128:143], v[48:51], a[60:63], v[128:143]
 ds_read_b64_tr_b16 v[40:41], v20 offset:16384
 ds_read_b64_tr_b16 v[42:43], v20 offset:17408
 buffer_load_dwordx4 v23, s[40:43], s58 offen offset:1024 lds
 v_mfma_f32_32x32x16_bf16 v[96:111], v[56:59], a[56:59], v[96:111]
 ds_read_b64_tr_b16 v[44:45], v21 offset:16384
 ds_read_b64_tr_b16 v[46:47], v21 offset:17408
 v_mfma_f32_32x32x16_bf16 v[160:175], v[56:59], a[60:63], v[160:175]
 buffer_load_dwordx4 v24, s[40:43], s58 offen offset:2048 lds
 v_mfma_f32_32x32x16_bf16 v[112:127], v[60:63], a[56:59], v[112:127]
 v_mfma_f32_32x32x16_bf16 v[176:191], v[60:63], a[60:63], v[176:191]
 buffer_load_dwordx4 v25, s[40:43], s58 offen offset:3072 lds
 s_add_u32 s58, s58, 128
 s_waitcnt lgkmcnt(0)
 v_mfma_f32_32x32x16_bf16 v[64:79], v[32:35], a[64:67], v[64:79]
 ds_read_b64_tr_b16 v[48:49], v18 offset:20480
 ds_read_b64_tr_b16 v[50:51], v18 offset:21504
 v_mfma_f32_32x32x16_bf16 v[80:95], v[36:39], a[64:67], v[80:95]
 ds_read_b128 a[72:75], v15
 ds_read_b64_tr_b16 v[52:53], v19 offset:20480
 s_add_u32 m0, s56, 36864
 s_nop 0
 buffer_load_dwordx4 v22, s[40:43], s60 offen lds
 v_mfma_f32_32x32x16_bf16 v[144:159], v[36:39], a[68:71], v[144:159]
 ds_read_b64_tr_b16 v[54:55], v19 offset:21504
 ds_read_b128 a[76:79], v15 offset:4096
 v_mfma_f32_32x32x16_bf16 v[128:143], v[32:35], a[68:71], v[128:143]
 ds_read_b64_tr_b16 v[56:57], v20 offset:20480
 ds_read_b64_tr_b16 v[58:59], v20 offset:21504
 buffer_load_dwordx4 v23, s[40:43], s60 offen offset:1024 lds
 v_mfma_f32_32x32x16_bf16 v[96:111], v[40:43], a[64:67], v[96:111]
 ds_read_b64_tr_b16 v[60:61], v21 offset:20480
 ds_read_b64_tr_b16 v[62:63], v21 offset:21504
 v_mfma_f32_32x32x16_bf16 v[160:175], v[40:43], a[68:71], v[160:175]
 buffer_load_dwordx4 v24, s[40:43], s60 offen offset:2048 lds
 v_mfma_f32_32x32x16_bf16 v[112:127], v[44:47], a[64:67], v[112:127]
 v_mfma_f32_32x32x16_bf16 v[176:191], v[44:47], a[68:71], v[176:191]
 buffer_load_dwordx4 v25, s[40:43], s60 offen offset:3072 lds
 s_add_u32 s60, s60, 128
 s_waitcnt lgkmcnt(0)
 v_mfma_f32_32x32x16_bf16 v[64:79], v[48:51], a[72:75], v[64:79]
 ds_read_b64_tr_b16 v[32:33], v18 offset:24576
 ds_read_b64_tr_b16 v[34:35], v18 offset:25600
 v_mfma_f32_32x32x16_bf16 v[80:95], v[52:55], a[72:75], v[80:95]
 ds_read_b128 a[80:83], v16
 ds_read_b64_tr_b16 v[36:37], v19 offset:24576
 s_add_u32 m0, s57, 65536
 s_nop 0
 buffer_load_dwordx4 v26, s[44:47], s59 offen nt lds
 v_mfma_f32_32x32x16_bf16 v[144:159], v[52:55], a[76:79], v[144:159]
 ds_read_b64_tr_b16 v[38:39], v19 offset:25600
 ds_read_b128 a[84:87], v16 offset:4096
 v_mfma_f32_32x32x16_bf16 v[128:143], v[48:51], a[76:79], v[128:143]
 ds_read_b64_tr_b16 v[40:41], v20 offset:24576
 ds_read_b64_tr_b16 v[42:43], v20 offset:25600
 buffer_load_dwordx4 v27, s[44:47], s59 offen offset:1024 nt lds
 v_mfma_f32_32x32x16_bf16 v[96:111], v[56:59], a[72:75], v[96:111]
 ds_read_b64_tr_b16 v[44:45], v21 offset:24576
 ds_read_b64_tr_b16 v[46:47], v21 offset:25600
 v_mfma_f32_32x32x16_bf16 v[160:175], v[56:59], a[76:79], v[160:175]
 buffer_load_dwordx4 v28, s[44:47], s59 offen offset:2048 nt lds
 v_mfma_f32_32x32x16_bf16 v[112:127], v[60:63], a[72:75], v[112:127]
 v_mfma_f32_32x32x16_bf16 v[176:191], v[60:63], a[76:79], v[176:191]
 buffer_load_dwordx4 v29, s[44:47], s59 offen offset:3072 nt lds
 s_add_u32 s59, s59, 524288
 s_waitcnt lgkmcnt(0)
 v_mfma_f32_32x32x16_bf16 v[64:79], v[32:35], a[80:83], v[64:79]
 ds_read_b64_tr_b16 v[48:49], v18 offset:28672
 ds_read_b64_tr_b16 v[50:51], v18 offset:29696
 v_mfma_f32_32x32x16_bf16 v[80:95], v[36:39], a[80:83], v[80:95]
 ds_read_b128 a[88:91], v17
 ds_read_b64_tr_b16 v[52:53], v19 offset:28672
 buffer_load_dword v31, v9, s[72:75], s64 offen
 s_add_u32 s64, s64, 32768
 v_mfma_f32_32x32x16_bf16 v[144:159], v[36:39], a[84:87], v[144:159]
 ds_read_b64_tr_b16 v[54:55], v19 offset:29696
 ds_read_b128 a[92:95], v17 offset:4096
 v_mfma_f32_32x32x16_bf16 v[128:143], v[32:35], a[84:87], v[128:143]
 ds_read_b64_tr_b16 v[56:57], v20 offset:28672
 ds_read_b64_tr_b16 v[58:59], v20 offset:29696
 v_mfma_f32_32x32x16_bf16 v[96:111], v[40:43], a[80:83], v[96:111]
 ds_read_b64_tr_b16 v[60:61], v21 offset:28672
 ds_read_b64_tr_b16 v[62:63], v21 offset:29696
 v_mfma_f32_32x32x16_bf16 v[160:175], v[40:43], a[84:87], v[160:175]
 v_mfma_f32_32x32x16_bf16 v[112:127], v[44:47], a[80:83], v[112:127]
 v_mfma_f32_32x32x16_bf16 v[176:191], v[44:47], a[84:87], v[176:191]
 s_waitcnt lgkmcnt(0)
 v_mfma_f32_32x32x16_bf16 v[64:79], v[48:51], a[88:91], v[64:79]
 s_waitcnt vmcnt(15)
 s_barrier
 ds_read_b64_tr_b16 v[32:33], v18 offset:32768
 ds_read_b64_tr_b16 v[34:35], v18 offset:33792
 v_mfma_f32_32x32x16_bf16 v[80:95], v[52:55], a[88:91], v[80:95]
 ds_read_b128 a[96:99], v10
 ds_read_b64_tr_b16 v[36:37], v19 offset:32768
 s_add_u32 m0, s56, 131072
 s_nop 0
 buffer_load_dwordx4 v22, s[40:43], s58 offen lds
 v_mfma_f32_32x32x16_bf16 v[144:159], v[52:55], a[92:95], v[144:159]
 ds_read_b64_tr_b16 v[38:39], v19 offset:33792
 ds_read_b128 a[100:103], v10 offset:4096
 v_mfma_f32_32x32x16_bf16 v[128:143], v[48:51], a[92:95], v[128:143]
 ds_read_b64_tr_b16 v[40:41], v20 offset:32768
 ds_read_b64_tr_b16 v[42:43], v20 offset:33792
 buffer_load_dwordx4 v23, s[40:43], s58 offen offset:1024 lds
 v_mfma_f32_32x32x16_bf16 v[96:111], v[56:59], a[88:91], v[96:111]
 ds_read_b64_tr_b16 v[44:45], v21 offset:32768
 ds_read_b64_tr_b16 v[46:47], v21 offset:33792
 v_mfma_f32_32x32x16_bf16 v[160:175], v[56:59], a[92:95], v[160:175]
 buffer_load_dwordx4 v24, s[40:43], s58 offen offset:2048 lds
 v_mfma_f32_32x32x16_bf16 v[112:127], v[60:63], a[88:91], v[112:127]
 v_mfma_f32_32x32x16_bf16 v[176:191], v[60:63], a[92:95], v[176:191]
 buffer_load_dwordx4 v25, s[40:43], s58 offen offset:3072 lds
 s_add_u32 s58, s58, 128
 s_waitcnt lgkmcnt(0)
 v_mfma_f32_32x32x16_bf16 v[64:79], v[32:35], a[96:99], v[64:79]
 ds_read_b64_tr_b16 v[48:49], v18 offset:36864
 ds_read_b64_tr_b16 v[50:51], v18 offset:37888
 s_mov_b32 s72, s4
 s_mov_b32 s73, s5
 s_mov_b32 s74, 2359296
 v_mfma_f32_32x32x16_bf16 v[80:95], v[36:39], a[96:99], v[80:95]
 ds_read_b128 a[104:107], v11
 ds_read_b64_tr_b16 v[52:53], v19 offset:36864
 s_add_u32 m0, s56, 135168
 s_nop 0
 buffer_load_dwordx4 v22, s[40:43], s60 offen lds
 v_mfma_f32_32x32x16_bf16 v[144:159], v[36:39], a[100:103], v[144:159]
 ds_read_b64_tr_b16 v[54:55], v19 offset:37888
 ds_read_b128 a[108:111], v11 offset:4096
 s_mov_b32 s75, 0x20000
 s_mul_i32 s64, s35, 2304
 v_cmp_gt_u32 vcc, 8, v1
 v_mfma_f32_32x32x16_bf16 v[128:143], v[32:35], a[100:103], v[128:143]
 ds_read_b64_tr_b16 v[56:57], v20 offset:36864
 ds_read_b64_tr_b16 v[58:59], v20 offset:37888
 buffer_load_dwordx4 v23, s[40:43], s60 offen offset:1024 lds
 v_lshlrev_b32 v9, 7, v1
 v_mfma_f32_32x32x16_bf16 v[96:111], v[40:43], a[96:99], v[96:111]
 ds_read_b64_tr_b16 v[60:61], v21 offset:36864
 ds_read_b64_tr_b16 v[62:63], v21 offset:37888
 s_nop 0
 v_cndmask_b32 v9, v0, v9, vcc
 v_mfma_f32_32x32x16_bf16 v[160:175], v[40:43], a[100:103], v[160:175]
 buffer_load_dwordx4 v24, s[40:43], s60 offen offset:2048 lds
 v_mfma_f32_32x32x16_bf16 v[112:127], v[44:47], a[96:99], v[112:127]
 v_mfma_f32_32x32x16_bf16 v[176:191], v[44:47], a[100:103], v[176:191]
 buffer_load_dwordx4 v25, s[40:43], s60 offen offset:3072 lds
 s_add_u32 s60, s60, 128
 s_waitcnt lgkmcnt(0)
 v_mfma_f32_32x32x16_bf16 v[64:79], v[48:51], a[104:107], v[64:79]
 ds_read_b64_tr_b16 v[32:33], v18 offset:40960
 ds_read_b64_tr_b16 v[34:35], v18 offset:41984
 v_mfma_f32_32x32x16_bf16 v[80:95], v[52:55], a[104:107], v[80:95]
 ds_read_b128 a[112:115], v12
 ds_read_b64_tr_b16 v[36:37], v19 offset:40960
 s_add_u32 m0, s57, 81920
 s_nop 0
 buffer_load_dwordx4 v26, s[44:47], s59 offen nt lds
 v_mfma_f32_32x32x16_bf16 v[144:159], v[52:55], a[108:111], v[144:159]
 ds_read_b64_tr_b16 v[38:39], v19 offset:41984
 ds_read_b128 a[116:119], v12 offset:4096
 v_mfma_f32_32x32x16_bf16 v[128:143], v[48:51], a[108:111], v[128:143]
 ds_read_b64_tr_b16 v[40:41], v20 offset:40960
 ds_read_b64_tr_b16 v[42:43], v20 offset:41984
 buffer_load_dwordx4 v27, s[44:47], s59 offen offset:1024 nt lds
 v_mfma_f32_32x32x16_bf16 v[96:111], v[56:59], a[104:107], v[96:111]
 ds_read_b64_tr_b16 v[44:45], v21 offset:40960
 ds_read_b64_tr_b16 v[46:47], v21 offset:41984
 v_mfma_f32_32x32x16_bf16 v[160:175], v[56:59], a[108:111], v[160:175]
 buffer_load_dwordx4 v28, s[44:47], s59 offen offset:2048 nt lds
 v_mfma_f32_32x32x16_bf16 v[112:127], v[60:63], a[104:107], v[112:127]
 v_mfma_f32_32x32x16_bf16 v[176:191], v[60:63], a[108:111], v[176:191]
 buffer_load_dwordx4 v29, s[44:47], s59 offen offset:3072 nt lds
 s_add_u32 s59, s59, 524288
 s_waitcnt lgkmcnt(0)
 v_mfma_f32_32x32x16_bf16 v[64:79], v[32:35], a[112:115], v[64:79]
 ds_read_b64_tr_b16 v[48:49], v18 offset:45056
 ds_read_b64_tr_b16 v[50:51], v18 offset:46080
 v_mfma_f32_32x32x16_bf16 v[80:95], v[36:39], a[112:115], v[80:95]
 ds_read_b128 a[120:123], v13
 ds_read_b64_tr_b16 v[52:53], v19 offset:45056
 buffer_load_dword v31, v9, s[72:75], s64 offen
 s_add_u32 s64, s64, 1024
 v_mfma_f32_32x32x16_bf16 v[144:159], v[36:39], a[116:119], v[144:159]
 ds_read_b64_tr_b16 v[54:55], v19 offset:46080
 ds_read_b128 a[124:127], v13 offset:4096
 v_mfma_f32_32x32x16_bf16 v[128:143], v[32:35], a[116:119], v[128:143]
 ds_read_b64_tr_b16 v[56:57], v20 offset:45056
 ds_read_b64_tr_b16 v[58:59], v20 offset:46080
 v_mfma_f32_32x32x16_bf16 v[96:111], v[40:43], a[112:115], v[96:111]
 ds_read_b64_tr_b16 v[60:61], v21 offset:45056
 ds_read_b64_tr_b16 v[62:63], v21 offset:46080
 v_mfma_f32_32x32x16_bf16 v[160:175], v[40:43], a[116:119], v[160:175]
 v_mfma_f32_32x32x16_bf16 v[112:127], v[44:47], a[112:115], v[112:127]
 v_mfma_f32_32x32x16_bf16 v[176:191], v[44:47], a[116:119], v[176:191]
 s_waitcnt lgkmcnt(0)
 v_mfma_f32_32x32x16_bf16 v[64:79], v[48:51], a[120:123], v[64:79]
 s_waitcnt vmcnt(14)
 s_barrier
 ds_read_b64_tr_b16 v[32:33], v18
 ds_read_b64_tr_b16 v[34:35], v18 offset:1024
 v_mfma_f32_32x32x16_bf16 v[80:95], v[52:55], a[120:123], v[80:95]
 ds_read_b128 a[128:131], v10 offset:32768
 ds_read_b64_tr_b16 v[36:37], v19
 s_add_u32 m0, s56, 0
 s_nop 0
 buffer_load_dwordx4 v22, s[40:43], s58 offen lds
 v_mfma_f32_32x32x16_bf16 v[144:159], v[52:55], a[124:127], v[144:159]
 ds_read_b64_tr_b16 v[38:39], v19 offset:1024
 ds_read_b128 a[132:135], v10 offset:36864
 v_mfma_f32_32x32x16_bf16 v[128:143], v[48:51], a[124:127], v[128:143]
 ds_read_b64_tr_b16 v[40:41], v20
 ds_read_b64_tr_b16 v[42:43], v20 offset:1024
 buffer_load_dwordx4 v23, s[40:43], s58 offen offset:1024 lds
 v_mfma_f32_32x32x16_bf16 v[96:111], v[56:59], a[120:123], v[96:111]
 ds_read_b64_tr_b16 v[44:45], v21
 ds_read_b64_tr_b16 v[46:47], v21 offset:1024
 v_mfma_f32_32x32x16_bf16 v[160:175], v[56:59], a[124:127], v[160:175]
 buffer_load_dwordx4 v24, s[40:43], s58 offen offset:2048 lds
 v_mfma_f32_32x32x16_bf16 v[112:127], v[60:63], a[120:123], v[112:127]
 v_mfma_f32_32x32x16_bf16 v[176:191], v[60:63], a[124:127], v[176:191]
 buffer_load_dwordx4 v25, s[40:43], s58 offen offset:3072 lds
 s_add_u32 s58, s58, 128
 s_waitcnt lgkmcnt(0)
 v_mfma_f32_32x32x16_bf16 v[64:79], v[32:35], a[128:131], v[64:79]
 ds_read_b64_tr_b16 v[48:49], v18 offset:4096
 ds_read_b64_tr_b16 v[50:51], v18 offset:5120
 v_mfma_f32_32x32x16_bf16 v[80:95], v[36:39], a[128:131], v[80:95]
 ds_read_b128 a[136:139], v11 offset:32768
 ds_read_b64_tr_b16 v[52:53], v19 offset:4096
 s_add_u32 m0, s56, 4096
 s_nop 0
 buffer_load_dwordx4 v22, s[40:43], s60 offen lds
 v_mfma_f32_32x32x16_bf16 v[144:159], v[36:39], a[132:135], v[144:159]
 ds_read_b64_tr_b16 v[54:55], v19 offset:5120
 ds_read_b128 a[140:143], v11 offset:36864
 v_mfma_f32_32x32x16_bf16 v[128:143], v[32:35], a[132:135], v[128:143]
 ds_read_b64_tr_b16 v[56:57], v20 offset:4096
 ds_read_b64_tr_b16 v[58:59], v20 offset:5120
 buffer_load_dwordx4 v23, s[40:43], s60 offen offset:1024 lds
 v_mfma_f32_32x32x16_bf16 v[96:111], v[40:43], a[128:131], v[96:111]
 ds_read_b64_tr_b16 v[60:61], v21 offset:4096
 ds_read_b64_tr_b16 v[62:63], v21 offset:5120
 v_mfma_f32_32x32x16_bf16 v[160:175], v[40:43], a[132:135], v[160:175]
 buffer_load_dwordx4 v24, s[40:43], s60 offen offset:2048 lds
 v_mfma_f32_32x32x16_bf16 v[112:127], v[44:47], a[128:131], v[112:127]
 v_mfma_f32_32x32x16_bf16 v[176:191], v[44:47], a[132:135], v[176:191]
 buffer_load_dwordx4 v25, s[40:43], s60 offen offset:3072 lds
 s_add_u32 s60, s60, 128
 s_waitcnt lgkmcnt(0)
 v_mfma_f32_32x32x16_bf16 v[64:79], v[48:51], a[136:139], v[64:79]
 ds_read_b64_tr_b16 v[32:33], v18 offset:8192
 ds_read_b64_tr_b16 v[34:35], v18 offset:9216
 v_mfma_f32_32x32x16_bf16 v[80:95], v[52:55], a[136:139], v[80:95]
 ds_read_b128 a[144:147], v12 offset:32768
 ds_read_b64_tr_b16 v[36:37], v19 offset:8192
 s_add_u32 m0, s57, 98304
 s_nop 0
 buffer_load_dwordx4 v26, s[44:47], s59 offen nt lds
 v_mfma_f32_32x32x16_bf16 v[144:159], v[52:55], a[140:143], v[144:159]
 ds_read_b64_tr_b16 v[38:39], v19 offset:9216
 ds_read_b128 a[148:151], v12 offset:36864
 v_mfma_f32_32x32x16_bf16 v[128:143], v[48:51], a[140:143], v[128:143]
 ds_read_b64_tr_b16 v[40:41], v20 offset:8192
 ds_read_b64_tr_b16 v[42:43], v20 offset:9216
 buffer_load_dwordx4 v27, s[44:47], s59 offen offset:1024 nt lds
 v_mfma_f32_32x32x16_bf16 v[96:111], v[56:59], a[136:139], v[96:111]
 ds_read_b64_tr_b16 v[44:45], v21 offset:8192
 ds_read_b64_tr_b16 v[46:47], v21 offset:9216
 v_mfma_f32_32x32x16_bf16 v[160:175], v[56:59], a[140:143], v[160:175]
 buffer_load_dwordx4 v28, s[44:47], s59 offen offset:2048 nt lds
 v_mfma_f32_32x32x16_bf16 v[112:127], v[60:63], a[136:139], v[112:127]
 v_mfma_f32_32x32x16_bf16 v[176:191], v[60:63], a[140:143], v[176:191]
 buffer_load_dwordx4 v29, s[44:47], s59 offen offset:3072 nt lds
 s_add_u32 s59, s59, 524288
 s_waitcnt lgkmcnt(0)
 v_mfma_f32_32x32x16_bf16 v[64:79], v[32:35], a[144:147], v[64:79]
 ds_read_b64_tr_b16 v[48:49], v18 offset:12288
 ds_read_b64_tr_b16 v[50:51], v18 offset:13312
 v_mfma_f32_32x32x16_bf16 v[80:95], v[36:39], a[144:147], v[80:95]
 ds_read_b128 a[152:155], v13 offset:32768
 ds_read_b64_tr_b16 v[52:53], v19 offset:12288
 buffer_load_dword v31, v9, s[72:75], s64 offen
 s_add_u32 s64, s64, 1024
 v_mfma_f32_32x32x16_bf16 v[144:159], v[36:39], a[148:151], v[144:159]
 ds_read_b64_tr_b16 v[54:55], v19 offset:13312
 ds_read_b128 a[156:159], v13 offset:36864
 v_mfma_f32_32x32x16_bf16 v[128:143], v[32:35], a[148:151], v[128:143]
 ds_read_b64_tr_b16 v[56:57], v20 offset:12288
 ds_read_b64_tr_b16 v[58:59], v20 offset:13312
 buffer_load_dword v31, v9, s[72:75], s64 offen
 s_add_u32 s64, s64, 1024
 v_mfma_f32_32x32x16_bf16 v[96:111], v[40:43], a[144:147], v[96:111]
 ds_read_b64_tr_b16 v[60:61], v21 offset:12288
 ds_read_b64_tr_b16 v[62:63], v21 offset:13312
 v_mfma_f32_32x32x16_bf16 v[160:175], v[40:43], a[148:151], v[160:175]
 v_mfma_f32_32x32x16_bf16 v[112:127], v[44:47], a[144:147], v[112:127]
 v_mfma_f32_32x32x16_bf16 v[176:191], v[44:47], a[148:151], v[176:191]
 s_waitcnt lgkmcnt(0)
 v_mfma_f32_32x32x16_bf16 v[64:79], v[48:51], a[152:155], v[64:79]
 s_waitcnt vmcnt(15)
 s_barrier
 ds_read_b64_tr_b16 v[32:33], v18 offset:16384
 ds_read_b64_tr_b16 v[34:35], v18 offset:17408
 v_mfma_f32_32x32x16_bf16 v[80:95], v[52:55], a[152:155], v[80:95]
 ds_read_b128 a[160:163], v14
 ds_read_b64_tr_b16 v[36:37], v19 offset:16384
 s_add_u32 m0, s56, 32768
 s_nop 0
 buffer_load_dwordx4 v22, s[40:43], s58 offen lds
 v_mfma_f32_32x32x16_bf16 v[144:159], v[52:55], a[156:159], v[144:159]
 ds_read_b64_tr_b16 v[38:39], v19 offset:17408
 ds_read_b128 a[164:167], v14 offset:4096
 v_mfma_f32_32x32x16_bf16 v[128:143], v[48:51], a[156:159], v[128:143]
 ds_read_b64_tr_b16 v[40:41], v20 offset:16384
 ds_read_b64_tr_b16 v[42:43], v20 offset:17408
 buffer_load_dwordx4 v23, s[40:43], s58 offen offset:1024 lds
 v_mfma_f32_32x32x16_bf16 v[96:111], v[56:59], a[152:155], v[96:111]
 ds_read_b64_tr_b16 v[44:45], v21 offset:16384
 ds_read_b64_tr_b16 v[46:47], v21 offset:17408
 v_mfma_f32_32x32x16_bf16 v[160:175], v[56:59], a[156:159], v[160:175]
 buffer_load_dwordx4 v24, s[40:43], s58 offen offset:2048 lds
 v_mfma_f32_32x32x16_bf16 v[112:127], v[60:63], a[152:155], v[112:127]
 v_mfma_f32_32x32x16_bf16 v[176:191], v[60:63], a[156:159], v[176:191]
 buffer_load_dwordx4 v25, s[40:43], s58 offen offset:3072 lds
 s_add_u32 s58, s58, 128
 s_waitcnt lgkmcnt(0)
 v_mfma_f32_32x32x16_bf16 v[64:79], v[32:35], a[160:163], v[64:79]
 ds_read_b64_tr_b16 v[48:49], v18 offset:20480
 ds_read_b64_tr_b16 v[50:51], v18 offset:21504
 v_mfma_f32_32x32x16_bf16 v[80:95], v[36:39], a[160:163], v[80:95]
 ds_read_b128 a[168:171], v15
 ds_read_b64_tr_b16 v[52:53], v19 offset:20480
 s_add_u32 m0, s56, 36864
 s_nop 0
 buffer_load_dwordx4 v22, s[40:43], s60 offen lds
 v_mfma_f32_32x32x16_bf16 v[144:159], v[36:39], a[164:167], v[144:159]
 ds_read_b64_tr_b16 v[54:55], v19 offset:21504
 ds_read_b128 a[172:175], v15 offset:4096
 v_mfma_f32_32x32x16_bf16 v[128:143], v[32:35], a[164:167], v[128:143]
 ds_read_b64_tr_b16 v[56:57], v20 offset:20480
 ds_read_b64_tr_b16 v[58:59], v20 offset:21504
 buffer_load_dwordx4 v23, s[40:43], s60 offen offset:1024 lds
 v_mfma_f32_32x32x16_bf16 v[96:111], v[40:43], a[160:163], v[96:111]
 ds_read_b64_tr_b16 v[60:61], v21 offset:20480
 ds_read_b64_tr_b16 v[62:63], v21 offset:21504
 v_mfma_f32_32x32x16_bf16 v[160:175], v[40:43], a[164:167], v[160:175]
 buffer_load_dwordx4 v24, s[40:43], s60 offen offset:2048 lds
 v_mfma_f32_32x32x16_bf16 v[112:127], v[44:47], a[160:163], v[112:127]
 v_mfma_f32_32x32x16_bf16 v[176:191], v[44:47], a[164:167], v[176:191]
 buffer_load_dwordx4 v25, s[40:43], s60 offen offset:3072 lds
 s_add_u32 s60, s60, 128
 s_waitcnt lgkmcnt(0)
 v_mfma_f32_32x32x16_bf16 v[64:79], v[48:51], a[168:171], v[64:79]
 ds_read_b64_tr_b16 v[32:33], v18 offset:24576
 ds_read_b64_tr_b16 v[34:35], v18 offset:25600
 s_mov_b32 s72, s6
 s_mov_b32 s73, s7
 s_mov_b32 s74, 1990656
 v_mfma_f32_32x32x16_bf16 v[80:95], v[52:55], a[168:171], v[80:95]
 ds_read_b128 a[176:179], v16
 ds_read_b64_tr_b16 v[36:37], v19 offset:24576
 s_add_u32 m0, s57, 65536
 s_nop 0
 buffer_load_dwordx4 v26, s[44:47], s59 offen nt lds
 v_mfma_f32_32x32x16_bf16 v[144:159], v[52:55], a[172:175], v[144:159]
 ds_read_b64_tr_b16 v[38:39], v19 offset:25600
 ds_read_b128 a[180:183], v16 offset:4096
 s_mov_b32 s75, 0x20000
 s_mul_i32 s64, s35, 2048
 v_cmp_gt_u32 vcc, 8, v1
 v_mfma_f32_32x32x16_bf16 v[128:143], v[48:51], a[172:175], v[128:143]
 ds_read_b64_tr_b16 v[40:41], v20 offset:24576
 ds_read_b64_tr_b16 v[42:43], v20 offset:25600
 buffer_load_dwordx4 v27, s[44:47], s59 offen offset:1024 nt lds
 v_lshlrev_b32 v9, 7, v1
 v_mfma_f32_32x32x16_bf16 v[96:111], v[56:59], a[168:171], v[96:111]
 ds_read_b64_tr_b16 v[44:45], v21 offset:24576
 ds_read_b64_tr_b16 v[46:47], v21 offset:25600
 s_nop 0
 v_cndmask_b32 v9, v0, v9, vcc
 v_mfma_f32_32x32x16_bf16 v[160:175], v[56:59], a[172:175], v[160:175]
 buffer_load_dwordx4 v28, s[44:47], s59 offen offset:2048 nt lds
 v_mfma_f32_32x32x16_bf16 v[112:127], v[60:63], a[168:171], v[112:127]
 v_mfma_f32_32x32x16_bf16 v[176:191], v[60:63], a[172:175], v[176:191]
 buffer_load_dwordx4 v29, s[44:47], s59 offen offset:3072 nt lds
 s_add_u32 s59, s59, 524288
 s_waitcnt lgkmcnt(0)
 v_mfma_f32_32x32x16_bf16 v[64:79], v[32:35], a[176:179], v[64:79]
 ds_read_b64_tr_b16 v[48:49], v18 offset:28672
 ds_read_b64_tr_b16 v[50:51], v18 offset:29696
 v_mfma_f32_32x32x16_bf16 v[80:95], v[36:39], a[176:179], v[80:95]
 ds_read_b128 a[184:187], v17
 ds_read_b64_tr_b16 v[52:53], v19 offset:28672
 buffer_load_dword v31, v9, s[72:75], s64 offen
 s_add_u32 s64, s64, 1024
 v_mfma_f32_32x32x16_bf16 v[144:159], v[36:39], a[180:183], v[144:159]
 ds_read_b64_tr_b16 v[54:55], v19 offset:29696
 ds_read_b128 a[188:191], v17 offset:4096
 v_mfma_f32_32x32x16_bf16 v[128:143], v[32:35], a[180:183], v[128:143]
 ds_read_b64_tr_b16 v[56:57], v20 offset:28672
 ds_read_b64_tr_b16 v[58:59], v20 offset:29696
 v_mfma_f32_32x32x16_bf16 v[96:111], v[40:43], a[176:179], v[96:111]
 ds_read_b64_tr_b16 v[60:61], v21 offset:28672
 ds_read_b64_tr_b16 v[62:63], v21 offset:29696
 v_mfma_f32_32x32x16_bf16 v[160:175], v[40:43], a[180:183], v[160:175]
 v_mfma_f32_32x32x16_bf16 v[112:127], v[44:47], a[176:179], v[112:127]
 v_mfma_f32_32x32x16_bf16 v[176:191], v[44:47], a[180:183], v[176:191]
 s_waitcnt lgkmcnt(0)
 v_mfma_f32_32x32x16_bf16 v[64:79], v[48:51], a[184:187], v[64:79]
 s_waitcnt vmcnt(15)
 s_barrier
 ds_read_b64_tr_b16 v[32:33], v18 offset:32768
 ds_read_b64_tr_b16 v[34:35], v18 offset:33792
 v_mfma_f32_32x32x16_bf16 v[80:95], v[52:55], a[184:187], v[80:95]
 ds_read_b128 a[192:195], v10
 ds_read_b64_tr_b16 v[36:37], v19 offset:32768
 s_add_u32 m0, s57, 81920
 s_nop 0
 buffer_load_dwordx4 v26, s[48:51], s61 offen lds
 v_mfma_f32_32x32x16_bf16 v[144:159], v[52:55], a[188:191], v[144:159]
 ds_read_b64_tr_b16 v[38:39], v19 offset:33792
 ds_read_b128 a[196:199], v10 offset:4096
 v_mfma_f32_32x32x16_bf16 v[128:143], v[48:51], a[188:191], v[128:143]
 ds_read_b64_tr_b16 v[40:41], v20 offset:32768
 ds_read_b64_tr_b16 v[42:43], v20 offset:33792
 buffer_load_dwordx4 v27, s[48:51], s61 offen offset:1024 lds
 v_mfma_f32_32x32x16_bf16 v[96:111], v[56:59], a[184:187], v[96:111]
 ds_read_b64_tr_b16 v[44:45], v21 offset:32768
 ds_read_b64_tr_b16 v[46:47], v21 offset:33792
 v_mfma_f32_32x32x16_bf16 v[160:175], v[56:59], a[188:191], v[160:175]
 buffer_load_dwordx4 v28, s[48:51], s61 offen offset:2048 lds
 v_mfma_f32_32x32x16_bf16 v[112:127], v[60:63], a[184:187], v[112:127]
 v_mfma_f32_32x32x16_bf16 v[176:191], v[60:63], a[188:191], v[176:191]
 buffer_load_dwordx4 v29, s[48:51], s61 offen offset:3072 lds
 s_add_u32 s61, s61, 524288
 s_waitcnt lgkmcnt(0)
 v_mfma_f32_32x32x16_bf16 v[64:79], v[32:35], a[192:195], v[64:79]
 ds_read_b64_tr_b16 v[48:49], v18 offset:36864
 ds_read_b64_tr_b16 v[50:51], v18 offset:37888
 v_mfma_f32_32x32x16_bf16 v[80:95], v[36:39], a[192:195], v[80:95]
 ds_read_b128 a[200:203], v11
 ds_read_b64_tr_b16 v[52:53], v19 offset:36864
 buffer_load_dword v31, v9, s[72:75], s64 offen
 s_add_u32 s64, s64, 1024
 v_mfma_f32_32x32x16_bf16 v[144:159], v[36:39], a[196:199], v[144:159]
 ds_read_b64_tr_b16 v[54:55], v19 offset:37888
 ds_read_b128 a[204:207], v11 offset:4096
 v_mfma_f32_32x32x16_bf16 v[128:143], v[32:35], a[196:199], v[128:143]
 ds_read_b64_tr_b16 v[56:57], v20 offset:36864
 ds_read_b64_tr_b16 v[58:59], v20 offset:37888
 v_mfma_f32_32x32x16_bf16 v[96:111], v[40:43], a[192:195], v[96:111]
 ds_read_b64_tr_b16 v[60:61], v21 offset:36864
 ds_read_b64_tr_b16 v[62:63], v21 offset:37888
 v_mfma_f32_32x32x16_bf16 v[160:175], v[40:43], a[196:199], v[160:175]
 v_mfma_f32_32x32x16_bf16 v[112:127], v[44:47], a[192:195], v[112:127]
 v_mfma_f32_32x32x16_bf16 v[176:191], v[44:47], a[196:199], v[176:191]
 s_waitcnt lgkmcnt(0)
 v_mfma_f32_32x32x16_bf16 v[64:79], v[48:51], a[200:203], v[64:79]
 ds_read_b64_tr_b16 v[32:33], v18 offset:40960
 ds_read_b64_tr_b16 v[34:35], v18 offset:41984
 v_mfma_f32_32x32x16_bf16 v[80:95], v[52:55], a[200:203], v[80:95]
 ds_read_b128 a[208:211], v12
 ds_read_b64_tr_b16 v[36:37], v19 offset:40960
 v_mfma_f32_32x32x16_bf16 v[144:159], v[52:55], a[204:207], v[144:159]
 ds_read_b64_tr_b16 v[38:39], v19 offset:41984
 ds_read_b128 a[212:215], v12 offset:4096
 v_mfma_f32_32x32x16_bf16 v[128:143], v[48:51], a[204:207], v[128:143]
 ds_read_b64_tr_b16 v[40:41], v20 offset:40960
 ds_read_b64_tr_b16 v[42:43], v20 offset:41984
 v_mfma_f32_32x32x16_bf16 v[96:111], v[56:59], a[200:203], v[96:111]
 ds_read_b64_tr_b16 v[44:45], v21 offset:40960
 ds_read_b64_tr_b16 v[46:47], v21 offset:41984
 v_mfma_f32_32x32x16_bf16 v[160:175], v[56:59], a[204:207], v[160:175]
 v_mfma_f32_32x32x16_bf16 v[112:127], v[60:63], a[200:203], v[112:127]
 v_mfma_f32_32x32x16_bf16 v[176:191], v[60:63], a[204:207], v[176:191]
 s_waitcnt lgkmcnt(0)
 v_mfma_f32_32x32x16_bf16 v[64:79], v[32:35], a[208:211], v[64:79]
 ds_read_b64_tr_b16 v[48:49], v18 offset:45056
 ds_read_b64_tr_b16 v[50:51], v18 offset:46080
 v_mfma_f32_32x32x16_bf16 v[80:95], v[36:39], a[208:211], v[80:95]
 ds_read_b128 a[216:219], v13
 ds_read_b64_tr_b16 v[52:53], v19 offset:45056
 v_mfma_f32_32x32x16_bf16 v[144:159], v[36:39], a[212:215], v[144:159]
 ds_read_b64_tr_b16 v[54:55], v19 offset:46080
 ds_read_b128 a[220:223], v13 offset:4096
 v_mfma_f32_32x32x16_bf16 v[128:143], v[32:35], a[212:215], v[128:143]
 ds_read_b64_tr_b16 v[56:57], v20 offset:45056
 ds_read_b64_tr_b16 v[58:59], v20 offset:46080
 v_mfma_f32_32x32x16_bf16 v[96:111], v[40:43], a[208:211], v[96:111]
 ds_read_b64_tr_b16 v[60:61], v21 offset:45056
 ds_read_b64_tr_b16 v[62:63], v21 offset:46080
 v_mfma_f32_32x32x16_bf16 v[160:175], v[40:43], a[212:215], v[160:175]
 v_mfma_f32_32x32x16_bf16 v[112:127], v[44:47], a[208:211], v[112:127]
 v_mfma_f32_32x32x16_bf16 v[176:191], v[44:47], a[212:215], v[176:191]
 s_waitcnt lgkmcnt(0)
 v_mfma_f32_32x32x16_bf16 v[64:79], v[48:51], a[216:219], v[64:79]
 s_waitcnt vmcnt(6)
 s_barrier
 ds_read_b64_tr_b16 v[32:33], v18
 ds_read_b64_tr_b16 v[34:35], v18 offset:1024
 s_mov_b32 s72, s8
 v_mfma_f32_32x32x16_bf16 v[80:95], v[52:55], a[216:219], v[80:95]
 ds_read_b128 a[224:227], v10 offset:32768
 ds_read_b64_tr_b16 v[36:37], v19
 s_add_u32 m0, s57, 98304
 s_nop 0
 buffer_load_dwordx4 v26, s[48:51], s61 offen lds
 v_mfma_f32_32x32x16_bf16 v[144:159], v[52:55], a[220:223], v[144:159]
 ds_read_b64_tr_b16 v[38:39], v19 offset:1024
 ds_read_b128 a[228:231], v10 offset:36864
 s_mov_b32 s73, s9
 s_mov_b32 s74, 663552
 s_mov_b32 s75, 0x20000
 v_mfma_f32_32x32x16_bf16 v[128:143], v[48:51], a[220:223], v[128:143]
 ds_read_b64_tr_b16 v[40:41], v20
 ds_read_b64_tr_b16 v[42:43], v20 offset:1024
 buffer_load_dwordx4 v27, s[48:51], s61 offen offset:1024 lds
 s_mul_i32 s64, s35, 768
 v_mfma_f32_32x32x16_bf16 v[96:111], v[56:59], a[216:219], v[96:111]
 ds_read_b64_tr_b16 v[44:45], v21
 ds_read_b64_tr_b16 v[46:47], v21 offset:1024
 v_cmp_gt_u32 vcc, 8, v1
 v_lshlrev_b32 v9, 7, v1
 s_nop 0
 v_mfma_f32_32x32x16_bf16 v[160:175], v[56:59], a[220:223], v[160:175]
 buffer_load_dwordx4 v28, s[48:51], s61 offen offset:2048 lds
 v_cndmask_b32 v9, v0, v9, vcc
 v_mfma_f32_32x32x16_bf16 v[112:127], v[60:63], a[216:219], v[112:127]
 v_mfma_f32_32x32x16_bf16 v[176:191], v[60:63], a[220:223], v[176:191]
 buffer_load_dwordx4 v29, s[48:51], s61 offen offset:3072 lds
 s_add_u32 s61, s61, 524288
 s_waitcnt lgkmcnt(0)
 v_mfma_f32_32x32x16_bf16 v[64:79], v[32:35], a[224:227], v[64:79]
 ds_read_b64_tr_b16 v[48:49], v18 offset:4096
 ds_read_b64_tr_b16 v[50:51], v18 offset:5120
 v_mfma_f32_32x32x16_bf16 v[80:95], v[36:39], a[224:227], v[80:95]
 ds_read_b128 a[232:235], v11 offset:32768
 ds_read_b64_tr_b16 v[52:53], v19 offset:4096
 buffer_load_dword v31, v9, s[72:75], s64 offen
 s_add_u32 s64, s64, 1024
 v_mfma_f32_32x32x16_bf16 v[144:159], v[36:39], a[228:231], v[144:159]
 ds_read_b64_tr_b16 v[54:55], v19 offset:5120
 ds_read_b128 a[236:239], v11 offset:36864
 v_mfma_f32_32x32x16_bf16 v[128:143], v[32:35], a[228:231], v[128:143]
 ds_read_b64_tr_b16 v[56:57], v20 offset:4096
 ds_read_b64_tr_b16 v[58:59], v20 offset:5120
 v_mfma_f32_32x32x16_bf16 v[96:111], v[40:43], a[224:227], v[96:111]
 ds_read_b64_tr_b16 v[60:61], v21 offset:4096
 ds_read_b64_tr_b16 v[62:63], v21 offset:5120
 v_mfma_f32_32x32x16_bf16 v[160:175], v[40:43], a[228:231], v[160:175]
 v_mfma_f32_32x32x16_bf16 v[112:127], v[44:47], a[224:227], v[112:127]
 v_mfma_f32_32x32x16_bf16 v[176:191], v[44:47], a[228:231], v[176:191]
 s_waitcnt lgkmcnt(0)
 v_mfma_f32_32x32x16_bf16 v[64:79], v[48:51], a[232:235], v[64:79]
 ds_read_b64_tr_b16 v[32:33], v18 offset:8192
 ds_read_b64_tr_b16 v[34:35], v18 offset:9216
 v_mfma_f32_32x32x16_bf16 v[80:95], v[52:55], a[232:235], v[80:95]
 ds_read_b128 a[240:243], v12 offset:32768
 ds_read_b64_tr_b16 v[36:37], v19 offset:8192
 v_mfma_f32_32x32x16_bf16 v[144:159], v[52:55], a[236:239], v[144:159]
 ds_read_b64_tr_b16 v[38:39], v19 offset:9216
 ds_read_b128 a[244:247], v12 offset:36864
 v_mfma_f32_32x32x16_bf16 v[128:143], v[48:51], a[236:239], v[128:143]
 ds_read_b64_tr_b16 v[40:41], v20 offset:8192
 ds_read_b64_tr_b16 v[42:43], v20 offset:9216
 v_mfma_f32_32x32x16_bf16 v[96:111], v[56:59], a[232:235], v[96:111]
 ds_read_b64_tr_b16 v[44:45], v21 offset:8192
 ds_read_b64_tr_b16 v[46:47], v21 offset:9216
 v_mfma_f32_32x32x16_bf16 v[160:175], v[56:59], a[236:239], v[160:175]
 v_mfma_f32_32x32x16_bf16 v[112:127], v[60:63], a[232:235], v[112:127]
 v_mfma_f32_32x32x16_bf16 v[176:191], v[60:63], a[236:239], v[176:191]
 s_waitcnt lgkmcnt(0)
 v_mfma_f32_32x32x16_bf16 v[64:79], v[32:35], a[240:243], v[64:79]
 ds_read_b64_tr_b16 v[48:49], v18 offset:12288
 ds_read_b64_tr_b16 v[50:51], v18 offset:13312
 v_mfma_f32_32x32x16_bf16 v[80:95], v[36:39], a[240:243], v[80:95]
 ds_read_b128 a[248:251], v13 offset:32768
 ds_read_b64_tr_b16 v[52:53], v19 offset:12288
 v_mfma_f32_32x32x16_bf16 v[144:159], v[36:39], a[244:247], v[144:159]
 ds_read_b64_tr_b16 v[54:55], v19 offset:13312
 ds_read_b128 a[252:255], v13 offset:36864
 v_mfma_f32_32x32x16_bf16 v[128:143], v[32:35], a[244:247], v[128:143]
 ds_read_b64_tr_b16 v[56:57], v20 offset:12288
 ds_read_b64_tr_b16 v[58:59], v20 offset:13312
 v_mfma_f32_32x32x16_bf16 v[96:111], v[40:43], a[240:243], v[96:111]
 ds_read_b64_tr_b16 v[60:61], v21 offset:12288
 ds_read_b64_tr_b16 v[62:63], v21 offset:13312
 v_mfma_f32_32x32x16_bf16 v[160:175], v[40:43], a[244:247], v[160:175]
 v_mfma_f32_32x32x16_bf16 v[112:127], v[44:47], a[240:243], v[112:127]
 v_mfma_f32_32x32x16_bf16 v[176:191], v[44:47], a[244:247], v[176:191]
 s_waitcnt lgkmcnt(0)
 v_mfma_f32_32x32x16_bf16 v[64:79], v[48:51], a[248:251], v[64:79]
 s_waitcnt vmcnt(6)
 s_barrier
 ds_read_b64_tr_b16 v[32:33], v18 offset:16384
 ds_read_b64_tr_b16 v[34:35], v18 offset:17408
 v_mfma_f32_32x32x16_bf16 v[80:95], v[52:55], a[248:251], v[80:95]
 ds_read_b64_tr_b16 v[36:37], v19 offset:16384
 ds_read_b64_tr_b16 v[38:39], v19 offset:17408
 s_add_u32 m0, s57, 65536
 s_nop 0
 buffer_load_dwordx4 v26, s[48:51], s61 offen lds
 v_mfma_f32_32x32x16_bf16 v[144:159], v[52:55], a[252:255], v[144:159]
 ds_read_b64_tr_b16 v[40:41], v20 offset:16384
 ds_read_b64_tr_b16 v[42:43], v20 offset:17408
 v_mfma_f32_32x32x16_bf16 v[128:143], v[48:51], a[252:255], v[128:143]
 ds_read_b64_tr_b16 v[44:45], v21 offset:16384
 ds_read_b64_tr_b16 v[46:47], v21 offset:17408
 buffer_load_dwordx4 v27, s[48:51], s61 offen offset:1024 lds
 v_mfma_f32_32x32x16_bf16 v[96:111], v[56:59], a[248:251], v[96:111]
 v_mfma_f32_32x32x16_bf16 v[160:175], v[56:59], a[252:255], v[160:175]
 buffer_load_dwordx4 v28, s[48:51], s61 offen offset:2048 lds
 v_mfma_f32_32x32x16_bf16 v[112:127], v[60:63], a[248:251], v[112:127]
 v_mfma_f32_32x32x16_bf16 v[176:191], v[60:63], a[252:255], v[176:191]
 buffer_load_dwordx4 v29, s[48:51], s61 offen offset:3072 lds
 s_add_u32 s61, s61, 524288
 s_nop 3
 v_cvt_pk_bf16_f32 v192, v64, v65
 v_cvt_pk_bf16_f32 v193, v66, v67
 v_cvt_pk_bf16_f32 v194, v68, v69
 v_cvt_pk_bf16_f32 v195, v70, v71
 v_cvt_pk_bf16_f32 v196, v72, v73
 v_cvt_pk_bf16_f32 v197, v74, v75
 v_cvt_pk_bf16_f32 v198, v76, v77
 v_cvt_pk_bf16_f32 v199, v78, v79
 s_nop 0
 s_waitcnt lgkmcnt(0)
 v_mfma_f32_32x32x16_bf16 v[64:79], a[0:3], v[32:35], 0
 ds_read_b64_tr_b16 v[48:49], v18 offset:20480
 ds_read_b64_tr_b16 v[50:51], v18 offset:21504
 v_cvt_pk_bf16_f32 v200, v80, v81
 v_cvt_pk_bf16_f32 v201, v82, v83
 v_cvt_pk_bf16_f32 v202, v84, v85
 v_cvt_pk_bf16_f32 v203, v86, v87
 v_cvt_pk_bf16_f32 v204, v88, v89
 v_cvt_pk_bf16_f32 v205, v90, v91
 v_cvt_pk_bf16_f32 v206, v92, v93
 v_cvt_pk_bf16_f32 v207, v94, v95
 s_nop 0
 v_mfma_f32_32x32x16_bf16 v[80:95], a[0:3], v[36:39], 0
 ds_read_b64_tr_b16 v[52:53], v19 offset:20480
 ds_read_b64_tr_b16 v[54:55], v19 offset:21504
 v_cvt_pk_bf16_f32 v232, v144, v145
 v_cvt_pk_bf16_f32 v233, v146, v147
 v_cvt_pk_bf16_f32 v234, v148, v149
 v_cvt_pk_bf16_f32 v235, v150, v151
 v_cvt_pk_bf16_f32 v236, v152, v153
 v_cvt_pk_bf16_f32 v237, v154, v155
 v_cvt_pk_bf16_f32 v238, v156, v157
 v_cvt_pk_bf16_f32 v239, v158, v159
 s_nop 0
 v_mfma_f32_32x32x16_bf16 v[144:159], a[4:7], v[36:39], 0
 ds_read_b64_tr_b16 v[56:57], v20 offset:20480
 ds_read_b64_tr_b16 v[58:59], v20 offset:21504
 v_cvt_pk_bf16_f32 v224, v128, v129
 v_cvt_pk_bf16_f32 v225, v130, v131
 v_cvt_pk_bf16_f32 v226, v132, v133
 v_cvt_pk_bf16_f32 v227, v134, v135
 v_cvt_pk_bf16_f32 v228, v136, v137
 v_cvt_pk_bf16_f32 v229, v138, v139
 v_cvt_pk_bf16_f32 v230, v140, v141
 v_cvt_pk_bf16_f32 v231, v142, v143
 s_nop 0
 v_mfma_f32_32x32x16_bf16 v[128:143], a[4:7], v[32:35], 0
 ds_read_b64_tr_b16 v[60:61], v21 offset:20480
 ds_read_b64_tr_b16 v[62:63], v21 offset:21504
 v_cvt_pk_bf16_f32 v208, v96, v97
 v_cvt_pk_bf16_f32 v209, v98, v99
 v_cvt_pk_bf16_f32 v210, v100, v101
 v_cvt_pk_bf16_f32 v211, v102, v103
 v_cvt_pk_bf16_f32 v212, v104, v105
 v_cvt_pk_bf16_f32 v213, v106, v107
 v_cvt_pk_bf16_f32 v214, v108, v109
 v_cvt_pk_bf16_f32 v215, v110, v111
 s_nop 0
 v_mfma_f32_32x32x16_bf16 v[96:111], a[0:3], v[40:43], 0
 v_cvt_pk_bf16_f32 v240, v160, v161
 v_cvt_pk_bf16_f32 v241, v162, v163
 v_cvt_pk_bf16_f32 v242, v164, v165
 v_cvt_pk_bf16_f32 v243, v166, v167
 v_cvt_pk_bf16_f32 v244, v168, v169
 v_cvt_pk_bf16_f32 v245, v170, v171
 v_cvt_pk_bf16_f32 v246, v172, v173
 v_cvt_pk_bf16_f32 v247, v174, v175
 s_nop 0
 v_mfma_f32_32x32x16_bf16 v[160:175], a[4:7], v[40:43], 0
 v_cvt_pk_bf16_f32 v216, v112, v113
 v_cvt_pk_bf16_f32 v217, v114, v115
 v_cvt_pk_bf16_f32 v218, v116, v117
 v_cvt_pk_bf16_f32 v219, v118, v119
 v_cvt_pk_bf16_f32 v220, v120, v121
 v_cvt_pk_bf16_f32 v221, v122, v123
 v_cvt_pk_bf16_f32 v222, v124, v125
 v_cvt_pk_bf16_f32 v223, v126, v127
 s_nop 0
 v_mfma_f32_32x32x16_bf16 v[112:127], a[0:3], v[44:47], 0
 v_cvt_pk_bf16_f32 v248, v176, v177
 v_cvt_pk_bf16_f32 v249, v178, v179
 v_cvt_pk_bf16_f32 v250, v180, v181
 v_cvt_pk_bf16_f32 v251, v182, v183
 v_cvt_pk_bf16_f32 v252, v184, v185
 v_cvt_pk_bf16_f32 v253, v186, v187
 v_cvt_pk_bf16_f32 v254, v188, v189
 v_cvt_pk_bf16_f32 v255, v190, v191
 s_nop 0
 v_mfma_f32_32x32x16_bf16 v[176:191], a[4:7], v[44:47], 0
 s_waitcnt lgkmcnt(0)
 v_mfma_f32_32x32x16_bf16 v[64:79], a[8:11], v[48:51], v[64:79]
 ds_read_b64_tr_b16 v[32:33], v18 offset:24576
 ds_read_b64_tr_b16 v[34:35], v18 offset:25600
 s_mov_b32 s40, s10
 s_mov_b32 s41, s11
 s_mov_b32 s42, 2359296
 v_mfma_f32_32x32x16_bf16 v[80:95], a[8:11], v[52:55], v[80:95]
 ds_read_b64_tr_b16 v[36:37], v19 offset:24576
 ds_read_b64_tr_b16 v[38:39], v19 offset:25600
 s_mov_b32 s43, 0x20000
 s_mov_b32 s44, s14
 s_mov_b32 s45, s15
 v_mfma_f32_32x32x16_bf16 v[144:159], a[12:15], v[52:55], v[144:159]
 ds_read_b64_tr_b16 v[40:41], v20 offset:24576
 ds_read_b64_tr_b16 v[42:43], v20 offset:25600
 s_mov_b32 s46, 4718592
 s_mov_b32 s47, 0x20000
 s_mov_b32 s54, 0
 v_mfma_f32_32x32x16_bf16 v[128:143], a[12:15], v[48:51], v[128:143]
 ds_read_b64_tr_b16 v[44:45], v21 offset:24576
 ds_read_b64_tr_b16 v[46:47], v21 offset:25600
 s_mov_b32 s53, 1152
 v_add_u32 v9, 0, v8
 v_and_b32 v9, 7, v9
 v_mfma_f32_32x32x16_bf16 v[96:111], a[8:11], v[56:59], v[96:111]
 s_add_u32 s71, s63, 0
 buffer_store_dwordx4 v[192:195], v30, s[36:39], s71 offen sc1
 buffer_store_dwordx4 v[196:199], v30, s[36:39], s71 offen offset:1024 sc1
 v_mfma_f32_32x32x16_bf16 v[160:175], a[12:15], v[56:59], v[160:175]
 v_and_b32 v22, 7, v1
 v_xor_b32 v9, v9, v22
 v_lshlrev_b32 v9, 4, v9
 s_add_u32 s52, s54, 0
 v_add_u32 v22, s52, v7
 v_mfma_f32_32x32x16_bf16 v[112:127], a[8:11], v[60:63], v[112:127]
 v_mul_lo_u32 v22, v22, s53
 v_add_u32 v22, v22, v9
 v_add_u32 v9, 4, v8
 v_and_b32 v9, 7, v9
 v_and_b32 v23, 7, v1
 v_mfma_f32_32x32x16_bf16 v[176:191], a[12:15], v[60:63], v[176:191]
 v_xor_b32 v9, v9, v23
 v_lshlrev_b32 v9, 4, v9
 s_add_u32 s52, s54, 8
 v_add_u32 v23, s52, v7
 v_mul_lo_u32 v23, v23, s53
 s_waitcnt lgkmcnt(0)
 v_mfma_f32_32x32x16_bf16 v[64:79], a[16:19], v[32:35], v[64:79]
 ds_read_b64_tr_b16 v[48:49], v18 offset:28672
 ds_read_b64_tr_b16 v[50:51], v18 offset:29696
 v_add_u32 v23, v23, v9
 v_subrev_u32 v23, 1024, v23
 v_add_u32 v9, 0, v8
 v_mfma_f32_32x32x16_bf16 v[80:95], a[16:19], v[36:39], v[80:95]
 ds_read_b64_tr_b16 v[52:53], v19 offset:28672
 ds_read_b64_tr_b16 v[54:55], v19 offset:29696
 v_and_b32 v9, 7, v9
 v_and_b32 v24, 7, v1
 v_xor_b32 v9, v9, v24
 v_mfma_f32_32x32x16_bf16 v[144:159], a[20:23], v[36:39], v[144:159]
 ds_read_b64_tr_b16 v[56:57], v20 offset:28672
 ds_read_b64_tr_b16 v[58:59], v20 offset:29696
 v_lshlrev_b32 v9, 4, v9
 s_add_u32 s52, s54, 16
 v_add_u32 v24, s52, v7
 v_mfma_f32_32x32x16_bf16 v[128:143], a[20:23], v[32:35], v[128:143]
 ds_read_b64_tr_b16 v[60:61], v21 offset:28672
 ds_read_b64_tr_b16 v[62:63], v21 offset:29696
 v_mul_lo_u32 v24, v24, s53
 v_add_u32 v24, v24, v9
 v_subrev_u32 v24, 2048, v24
 v_mfma_f32_32x32x16_bf16 v[96:111], a[16:19], v[40:43], v[96:111]
 v_add_u32 v9, 4, v8
 v_and_b32 v9, 7, v9
 v_and_b32 v25, 7, v1
 v_xor_b32 v9, v9, v25
 v_lshlrev_b32 v9, 4, v9
 v_mfma_f32_32x32x16_bf16 v[160:175], a[20:23], v[40:43], v[160:175]
 s_add_u32 s52, s54, 24
 v_add_u32 v25, s52, v7
 v_mul_lo_u32 v25, v25, s53
 v_add_u32 v25, v25, v9
 v_subrev_u32 v25, 3072, v25
 v_mfma_f32_32x32x16_bf16 v[112:127], a[16:19], v[44:47], v[112:127]
 s_lshl_b32 s52, s32, 2
 s_add_u32 s52, s52, s28
 s_mul_i32 s58, s52, 36864
 s_sub_u32 s52, 15, s32
 s_lshl_b32 s52, s52, 2
 v_mfma_f32_32x32x16_bf16 v[176:191], a[20:23], v[44:47], v[176:191]
 s_add_u32 s52, s52, s28
 s_mul_i32 s60, s52, 36864
 s_waitcnt lgkmcnt(0)
 v_mfma_f32_32x32x16_bf16 v[64:79], a[24:27], v[48:51], v[64:79]
 s_waitcnt vmcnt(7)
 s_barrier
 ds_read_b64_tr_b16 v[32:33], v18 offset:32768
 ds_read_b64_tr_b16 v[34:35], v18 offset:33792
 v_mfma_f32_32x32x16_bf16 v[80:95], a[24:27], v[52:55], v[80:95]
 ds_read_b64_tr_b16 v[36:37], v19 offset:32768
 ds_read_b64_tr_b16 v[38:39], v19 offset:33792
 s_add_u32 m0, s57, 81920
 s_nop 0
 buffer_load_dwordx4 v26, s[48:51], s61 offen lds
 v_mfma_f32_32x32x16_bf16 v[144:159], a[28:31], v[52:55], v[144:159]
 ds_read_b64_tr_b16 v[40:41], v20 offset:32768
 ds_read_b64_tr_b16 v[42:43], v20 offset:33792
 v_mfma_f32_32x32x16_bf16 v[128:143], a[28:31], v[48:51], v[128:143]
 ds_read_b64_tr_b16 v[44:45], v21 offset:32768
 ds_read_b64_tr_b16 v[46:47], v21 offset:33792
 buffer_load_dwordx4 v27, s[48:51], s61 offen offset:1024 lds
 v_mfma_f32_32x32x16_bf16 v[96:111], a[24:27], v[56:59], v[96:111]
 v_mfma_f32_32x32x16_bf16 v[160:175], a[28:31], v[56:59], v[160:175]
 buffer_load_dwordx4 v28, s[48:51], s61 offen offset:2048 lds
 v_mfma_f32_32x32x16_bf16 v[112:127], a[24:27], v[60:63], v[112:127]
 v_mfma_f32_32x32x16_bf16 v[176:191], a[28:31], v[60:63], v[176:191]
 buffer_load_dwordx4 v29, s[48:51], s61 offen offset:3072 lds
 s_add_u32 s61, s61, 524288
 s_waitcnt lgkmcnt(0)
 v_mfma_f32_32x32x16_bf16 v[64:79], a[32:35], v[32:35], v[64:79]
 ds_read_b64_tr_b16 v[48:49], v18 offset:36864
 ds_read_b64_tr_b16 v[50:51], v18 offset:37888
 v_mfma_f32_32x32x16_bf16 v[80:95], a[32:35], v[36:39], v[80:95]
 ds_read_b64_tr_b16 v[52:53], v19 offset:36864
 ds_read_b64_tr_b16 v[54:55], v19 offset:37888
 buffer_store_dwordx4 v[200:203], v30, s[36:39], s71 offen offset:2048 sc1
 buffer_store_dwordx4 v[204:207], v30, s[36:39], s71 offen offset:3072 sc1
 v_mfma_f32_32x32x16_bf16 v[144:159], a[36:39], v[36:39], v[144:159]
 ds_read_b64_tr_b16 v[56:57], v20 offset:36864
 ds_read_b64_tr_b16 v[58:59], v20 offset:37888
 v_mfma_f32_32x32x16_bf16 v[128:143], a[36:39], v[32:35], v[128:143]
 ds_read_b64_tr_b16 v[60:61], v21 offset:36864
 ds_read_b64_tr_b16 v[62:63], v21 offset:37888
 v_mfma_f32_32x32x16_bf16 v[96:111], a[32:35], v[40:43], v[96:111]
 v_mfma_f32_32x32x16_bf16 v[160:175], a[36:39], v[40:43], v[160:175]
 v_mfma_f32_32x32x16_bf16 v[112:127], a[32:35], v[44:47], v[112:127]
 v_mfma_f32_32x32x16_bf16 v[176:191], a[36:39], v[44:47], v[176:191]
 s_waitcnt lgkmcnt(0)
 v_mfma_f32_32x32x16_bf16 v[64:79], a[40:43], v[48:51], v[64:79]
 ds_read_b64_tr_b16 v[32:33], v18 offset:40960
 ds_read_b64_tr_b16 v[34:35], v18 offset:41984
 v_mfma_f32_32x32x16_bf16 v[80:95], a[40:43], v[52:55], v[80:95]
 ds_read_b64_tr_b16 v[36:37], v19 offset:40960
 ds_read_b64_tr_b16 v[38:39], v19 offset:41984
 v_mfma_f32_32x32x16_bf16 v[144:159], a[44:47], v[52:55], v[144:159]
 ds_read_b64_tr_b16 v[40:41], v20 offset:40960
 ds_read_b64_tr_b16 v[42:43], v20 offset:41984
 v_mfma_f32_32x32x16_bf16 v[128:143], a[44:47], v[48:51], v[128:143]
 ds_read_b64_tr_b16 v[44:45], v21 offset:40960
 ds_read_b64_tr_b16 v[46:47], v21 offset:41984
 v_mfma_f32_32x32x16_bf16 v[96:111], a[40:43], v[56:59], v[96:111]
 v_mfma_f32_32x32x16_bf16 v[160:175], a[44:47], v[56:59], v[160:175]
 v_mfma_f32_32x32x16_bf16 v[112:127], a[40:43], v[60:63], v[112:127]
 v_mfma_f32_32x32x16_bf16 v[176:191], a[44:47], v[60:63], v[176:191]
 s_waitcnt lgkmcnt(0)
 v_mfma_f32_32x32x16_bf16 v[64:79], a[48:51], v[32:35], v[64:79]
 ds_read_b64_tr_b16 v[48:49], v18 offset:45056
 ds_read_b64_tr_b16 v[50:51], v18 offset:46080
 v_mfma_f32_32x32x16_bf16 v[80:95], a[48:51], v[36:39], v[80:95]
 ds_read_b64_tr_b16 v[52:53], v19 offset:45056
 ds_read_b64_tr_b16 v[54:55], v19 offset:46080
 v_mfma_f32_32x32x16_bf16 v[144:159], a[52:55], v[36:39], v[144:159]
 ds_read_b64_tr_b16 v[56:57], v20 offset:45056
 ds_read_b64_tr_b16 v[58:59], v20 offset:46080
 v_mfma_f32_32x32x16_bf16 v[128:143], a[52:55], v[32:35], v[128:143]
 ds_read_b64_tr_b16 v[60:61], v21 offset:45056
 ds_read_b64_tr_b16 v[62:63], v21 offset:46080
 v_mfma_f32_32x32x16_bf16 v[96:111], a[48:51], v[40:43], v[96:111]
 v_mfma_f32_32x32x16_bf16 v[160:175], a[52:55], v[40:43], v[160:175]
 v_mfma_f32_32x32x16_bf16 v[112:127], a[48:51], v[44:47], v[112:127]
 v_mfma_f32_32x32x16_bf16 v[176:191], a[52:55], v[44:47], v[176:191]
 s_waitcnt lgkmcnt(0)
 v_mfma_f32_32x32x16_bf16 v[64:79], a[56:59], v[48:51], v[64:79]
 s_waitcnt vmcnt(8)
 s_barrier
 ds_read_b64_tr_b16 v[32:33], v18
 ds_read_b64_tr_b16 v[34:35], v18 offset:1024
 v_mfma_f32_32x32x16_bf16 v[80:95], a[56:59], v[52:55], v[80:95]
 ds_read_b64_tr_b16 v[36:37], v19
 ds_read_b64_tr_b16 v[38:39], v19 offset:1024
 s_add_u32 m0, s57, 98304
 s_nop 0
 buffer_load_dwordx4 v26, s[48:51], s61 offen lds
 v_mfma_f32_32x32x16_bf16 v[144:159], a[60:63], v[52:55], v[144:159]
 ds_read_b64_tr_b16 v[40:41], v20
 ds_read_b64_tr_b16 v[42:43], v20 offset:1024
 v_mfma_f32_32x32x16_bf16 v[128:143], a[60:63], v[48:51], v[128:143]
 ds_read_b64_tr_b16 v[44:45], v21
 ds_read_b64_tr_b16 v[46:47], v21 offset:1024
 buffer_load_dwordx4 v27, s[48:51], s61 offen offset:1024 lds
 v_mfma_f32_32x32x16_bf16 v[96:111], a[56:59], v[56:59], v[96:111]
 v_mfma_f32_32x32x16_bf16 v[160:175], a[60:63], v[56:59], v[160:175]
 buffer_load_dwordx4 v28, s[48:51], s61 offen offset:2048 lds
 v_mfma_f32_32x32x16_bf16 v[112:127], a[56:59], v[60:63], v[112:127]
 v_mfma_f32_32x32x16_bf16 v[176:191], a[60:63], v[60:63], v[176:191]
 buffer_load_dwordx4 v29, s[48:51], s61 offen offset:3072 lds
 s_add_u32 s61, s61, 524288
 s_waitcnt lgkmcnt(0)
 v_mfma_f32_32x32x16_bf16 v[64:79], a[64:67], v[32:35], v[64:79]
 ds_read_b64_tr_b16 v[48:49], v18 offset:4096
 ds_read_b64_tr_b16 v[50:51], v18 offset:5120
 v_mfma_f32_32x32x16_bf16 v[80:95], a[64:67], v[36:39], v[80:95]
 ds_read_b64_tr_b16 v[52:53], v19 offset:4096
 ds_read_b64_tr_b16 v[54:55], v19 offset:5120
 v_mfma_f32_32x32x16_bf16 v[144:159], a[68:71], v[36:39], v[144:159]
 ds_read_b64_tr_b16 v[56:57], v20 offset:4096
 ds_read_b64_tr_b16 v[58:59], v20 offset:5120
 v_mfma_f32_32x32x16_bf16 v[128:143], a[68:71], v[32:35], v[128:143]
 ds_read_b64_tr_b16 v[60:61], v21 offset:4096
 ds_read_b64_tr_b16 v[62:63], v21 offset:5120
 v_mfma_f32_32x32x16_bf16 v[96:111], a[64:67], v[40:43], v[96:111]
 s_add_u32 s71, s63, 4096
 buffer_store_dwordx4 v[208:211], v30, s[36:39], s71 offen sc1
 buffer_store_dwordx4 v[212:215], v30, s[36:39], s71 offen offset:1024 sc1
 v_mfma_f32_32x32x16_bf16 v[160:175], a[68:71], v[40:43], v[160:175]
 v_mfma_f32_32x32x16_bf16 v[112:127], a[64:67], v[44:47], v[112:127]
 v_mfma_f32_32x32x16_bf16 v[176:191], a[68:71], v[44:47], v[176:191]
 s_waitcnt lgkmcnt(0)
 v_mfma_f32_32x32x16_bf16 v[64:79], a[72:75], v[48:51], v[64:79]
 ds_read_b64_tr_b16 v[32:33], v18 offset:8192
 ds_read_b64_tr_b16 v[34:35], v18 offset:9216
 v_mfma_f32_32x32x16_bf16 v[80:95], a[72:75], v[52:55], v[80:95]
 ds_read_b64_tr_b16 v[36:37], v19 offset:8192
 ds_read_b64_tr_b16 v[38:39], v19 offset:9216
 v_mfma_f32_32x32x16_bf16 v[144:159], a[76:79], v[52:55], v[144:159]
 ds_read_b64_tr_b16 v[40:41], v20 offset:8192
 ds_read_b64_tr_b16 v[42:43], v20 offset:9216
 v_mfma_f32_32x32x16_bf16 v[128:143], a[76:79], v[48:51], v[128:143]
 ds_read_b64_tr_b16 v[44:45], v21 offset:8192
 ds_read_b64_tr_b16 v[46:47], v21 offset:9216
 v_mfma_f32_32x32x16_bf16 v[96:111], a[72:75], v[56:59], v[96:111]
 v_mfma_f32_32x32x16_bf16 v[160:175], a[76:79], v[56:59], v[160:175]
 v_mfma_f32_32x32x16_bf16 v[112:127], a[72:75], v[60:63], v[112:127]
 v_mfma_f32_32x32x16_bf16 v[176:191], a[76:79], v[60:63], v[176:191]
 s_waitcnt lgkmcnt(0)
 v_mfma_f32_32x32x16_bf16 v[64:79], a[80:83], v[32:35], v[64:79]
 ds_read_b64_tr_b16 v[48:49], v18 offset:12288
 ds_read_b64_tr_b16 v[50:51], v18 offset:13312
 buffer_store_dwordx4 v[216:219], v30, s[36:39], s71 offen offset:2048 sc1
 buffer_store_dwordx4 v[220:223], v30, s[36:39], s71 offen offset:3072 sc1
 v_mfma_f32_32x32x16_bf16 v[80:95], a[80:83], v[36:39], v[80:95]
 ds_read_b64_tr_b16 v[52:53], v19 offset:12288
 ds_read_b64_tr_b16 v[54:55], v19 offset:13312
 v_mfma_f32_32x32x16_bf16 v[144:159], a[84:87], v[36:39], v[144:159]
 ds_read_b64_tr_b16 v[56:57], v20 offset:12288
 ds_read_b64_tr_b16 v[58:59], v20 offset:13312
 v_mfma_f32_32x32x16_bf16 v[128:143], a[84:87], v[32:35], v[128:143]
 ds_read_b64_tr_b16 v[60:61], v21 offset:12288
 ds_read_b64_tr_b16 v[62:63], v21 offset:13312
 v_mfma_f32_32x32x16_bf16 v[96:111], a[80:83], v[40:43], v[96:111]
 v_mfma_f32_32x32x16_bf16 v[160:175], a[84:87], v[40:43], v[160:175]
 v_mfma_f32_32x32x16_bf16 v[112:127], a[80:83], v[44:47], v[112:127]
 v_mfma_f32_32x32x16_bf16 v[176:191], a[84:87], v[44:47], v[176:191]
 s_waitcnt lgkmcnt(0)
 v_mfma_f32_32x32x16_bf16 v[64:79], a[88:91], v[48:51], v[64:79]
 s_waitcnt vmcnt(10)
 s_barrier
 ds_read_b64_tr_b16 v[32:33], v18 offset:16384
 ds_read_b64_tr_b16 v[34:35], v18 offset:17408
 v_mfma_f32_32x32x16_bf16 v[80:95], a[88:91], v[52:55], v[80:95]
 ds_read_b64_tr_b16 v[36:37], v19 offset:16384
 ds_read_b64_tr_b16 v[38:39], v19 offset:17408
 s_add_u32 m0, s57, 65536
 s_nop 0
 buffer_load_dwordx4 v26, s[48:51], s61 offen lds
 v_mfma_f32_32x32x16_bf16 v[144:159], a[92:95], v[52:55], v[144:159]
 ds_read_b64_tr_b16 v[40:41], v20 offset:16384
 ds_read_b64_tr_b16 v[42:43], v20 offset:17408
 v_mfma_f32_32x32x16_bf16 v[128:143], a[92:95], v[48:51], v[128:143]
 ds_read_b64_tr_b16 v[44:45], v21 offset:16384
 ds_read_b64_tr_b16 v[46:47], v21 offset:17408
 buffer_load_dwordx4 v27, s[48:51], s61 offen offset:1024 lds
 v_mfma_f32_32x32x16_bf16 v[96:111], a[88:91], v[56:59], v[96:111]
 v_mfma_f32_32x32x16_bf16 v[160:175], a[92:95], v[56:59], v[160:175]
 buffer_load_dwordx4 v28, s[48:51], s61 offen offset:2048 lds
 v_mfma_f32_32x32x16_bf16 v[112:127], a[88:91], v[60:63], v[112:127]
 v_mfma_f32_32x32x16_bf16 v[176:191], a[92:95], v[60:63], v[176:191]
 buffer_load_dwordx4 v29, s[48:51], s61 offen offset:3072 lds
 s_add_u32 s61, s61, 524288
 s_waitcnt lgkmcnt(0)
 v_mfma_f32_32x32x16_bf16 v[64:79], a[96:99], v[32:35], v[64:79]
 ds_read_b64_tr_b16 v[48:49], v18 offset:20480
 ds_read_b64_tr_b16 v[50:51], v18 offset:21504
 v_mfma_f32_32x32x16_bf16 v[80:95], a[96:99], v[36:39], v[80:95]
 ds_read_b64_tr_b16 v[52:53], v19 offset:20480
 ds_read_b64_tr_b16 v[54:55], v19 offset:21504
 v_mfma_f32_32x32x16_bf16 v[144:159], a[100:103], v[36:39], v[144:159]
 ds_read_b64_tr_b16 v[56:57], v20 offset:20480
 ds_read_b64_tr_b16 v[58:59], v20 offset:21504
 v_mfma_f32_32x32x16_bf16 v[128:143], a[100:103], v[32:35], v[128:143]
 ds_read_b64_tr_b16 v[60:61], v21 offset:20480
 ds_read_b64_tr_b16 v[62:63], v21 offset:21504
 v_mfma_f32_32x32x16_bf16 v[96:111], a[96:99], v[40:43], v[96:111]
 v_mfma_f32_32x32x16_bf16 v[160:175], a[100:103], v[40:43], v[160:175]
 v_mfma_f32_32x32x16_bf16 v[112:127], a[96:99], v[44:47], v[112:127]
 v_mfma_f32_32x32x16_bf16 v[176:191], a[100:103], v[44:47], v[176:191]
 s_waitcnt lgkmcnt(0)
 v_mfma_f32_32x32x16_bf16 v[64:79], a[104:107], v[48:51], v[64:79]
 ds_read_b64_tr_b16 v[32:33], v18 offset:24576
 ds_read_b64_tr_b16 v[34:35], v18 offset:25600
 v_mfma_f32_32x32x16_bf16 v[80:95], a[104:107], v[52:55], v[80:95]
 ds_read_b64_tr_b16 v[36:37], v19 offset:24576
 ds_read_b64_tr_b16 v[38:39], v19 offset:25600
 v_mfma_f32_32x32x16_bf16 v[144:159], a[108:111], v[52:55], v[144:159]
 ds_read_b64_tr_b16 v[40:41], v20 offset:24576
 ds_read_b64_tr_b16 v[42:43], v20 offset:25600
 v_mfma_f32_32x32x16_bf16 v[128:143], a[108:111], v[48:51], v[128:143]
 ds_read_b64_tr_b16 v[44:45], v21 offset:24576
 ds_read_b64_tr_b16 v[46:47], v21 offset:25600
 v_mfma_f32_32x32x16_bf16 v[96:111], a[104:107], v[56:59], v[96:111]
 s_add_u32 s71, s63, 8192
 buffer_store_dwordx4 v[224:227], v30, s[36:39], s71 offen sc1
 buffer_store_dwordx4 v[228:231], v30, s[36:39], s71 offen offset:1024 sc1
 v_mfma_f32_32x32x16_bf16 v[160:175], a[108:111], v[56:59], v[160:175]
 v_mfma_f32_32x32x16_bf16 v[112:127], a[104:107], v[60:63], v[112:127]
 v_mfma_f32_32x32x16_bf16 v[176:191], a[108:111], v[60:63], v[176:191]
 s_waitcnt lgkmcnt(0)
 v_mfma_f32_32x32x16_bf16 v[64:79], a[112:115], v[32:35], v[64:79]
 ds_read_b64_tr_b16 v[48:49], v18 offset:28672
 ds_read_b64_tr_b16 v[50:51], v18 offset:29696
 v_mfma_f32_32x32x16_bf16 v[80:95], a[112:115], v[36:39], v[80:95]
 ds_read_b64_tr_b16 v[52:53], v19 offset:28672
 ds_read_b64_tr_b16 v[54:55], v19 offset:29696
 v_mfma_f32_32x32x16_bf16 v[144:159], a[116:119], v[36:39], v[144:159]
 ds_read_b64_tr_b16 v[56:57], v20 offset:28672
 ds_read_b64_tr_b16 v[58:59], v20 offset:29696
 v_mfma_f32_32x32x16_bf16 v[128:143], a[116:119], v[32:35], v[128:143]
 ds_read_b64_tr_b16 v[60:61], v21 offset:28672
 ds_read_b64_tr_b16 v[62:63], v21 offset:29696
 v_mfma_f32_32x32x16_bf16 v[96:111], a[112:115], v[40:43], v[96:111]
 v_mfma_f32_32x32x16_bf16 v[160:175], a[116:119], v[40:43], v[160:175]
 v_mfma_f32_32x32x16_bf16 v[112:127], a[112:115], v[44:47], v[112:127]
 v_mfma_f32_32x32x16_bf16 v[176:191], a[116:119], v[44:47], v[176:191]
 s_waitcnt lgkmcnt(0)
 v_mfma_f32_32x32x16_bf16 v[64:79], a[120:123], v[48:51], v[64:79]
 s_waitcnt vmcnt(10)
 s_barrier
 ds_read_b64_tr_b16 v[32:33], v18 offset:32768
 ds_read_b64_tr_b16 v[34:35], v18 offset:33792
 v_mfma_f32_32x32x16_bf16 v[80:95], a[120:123], v[52:55], v[80:95]
 ds_read_b64_tr_b16 v[36:37], v19 offset:32768
 ds_read_b64_tr_b16 v[38:39], v19 offset:33792
 s_add_u32 m0, s57, 81920
 s_nop 0
 buffer_load_dwordx4 v26, s[48:51], s61 offen lds
 v_mfma_f32_32x32x16_bf16 v[144:159], a[124:127], v[52:55], v[144:159]
 ds_read_b64_tr_b16 v[40:41], v20 offset:32768
 ds_read_b64_tr_b16 v[42:43], v20 offset:33792
 v_mfma_f32_32x32x16_bf16 v[128:143], a[124:127], v[48:51], v[128:143]
 ds_read_b64_tr_b16 v[44:45], v21 offset:32768
 ds_read_b64_tr_b16 v[46:47], v21 offset:33792
 buffer_load_dwordx4 v27, s[48:51], s61 offen offset:1024 lds
 v_mfma_f32_32x32x16_bf16 v[96:111], a[120:123], v[56:59], v[96:111]
 v_mfma_f32_32x32x16_bf16 v[160:175], a[124:127], v[56:59], v[160:175]
 buffer_load_dwordx4 v28, s[48:51], s61 offen offset:2048 lds
 v_mfma_f32_32x32x16_bf16 v[112:127], a[120:123], v[60:63], v[112:127]
 v_mfma_f32_32x32x16_bf16 v[176:191], a[124:127], v[60:63], v[176:191]
 buffer_load_dwordx4 v29, s[48:51], s61 offen offset:3072 lds
 s_add_u32 s61, s61, 524288
 s_waitcnt lgkmcnt(0)
 v_mfma_f32_32x32x16_bf16 v[64:79], a[128:131], v[32:35], v[64:79]
 ds_read_b64_tr_b16 v[48:49], v18 offset:36864
 ds_read_b64_tr_b16 v[50:51], v18 offset:37888
 v_mfma_f32_32x32x16_bf16 v[80:95], a[128:131], v[36:39], v[80:95]
 ds_read_b64_tr_b16 v[52:53], v19 offset:36864
 ds_read_b64_tr_b16 v[54:55], v19 offset:37888
 buffer_store_dwordx4 v[232:235], v30, s[36:39], s71 offen offset:2048 sc1
 buffer_store_dwordx4 v[236:239], v30, s[36:39], s71 offen offset:3072 sc1
 v_mfma_f32_32x32x16_bf16 v[144:159], a[132:135], v[36:39], v[144:159]
 ds_read_b64_tr_b16 v[56:57], v20 offset:36864
 ds_read_b64_tr_b16 v[58:59], v20 offset:37888
 v_mfma_f32_32x32x16_bf16 v[128:143], a[132:135], v[32:35], v[128:143]
 ds_read_b64_tr_b16 v[60:61], v21 offset:36864
 ds_read_b64_tr_b16 v[62:63], v21 offset:37888
 v_mfma_f32_32x32x16_bf16 v[96:111], a[128:131], v[40:43], v[96:111]
 v_mfma_f32_32x32x16_bf16 v[160:175], a[132:135], v[40:43], v[160:175]
 v_mfma_f32_32x32x16_bf16 v[112:127], a[128:131], v[44:47], v[112:127]
 v_mfma_f32_32x32x16_bf16 v[176:191], a[132:135], v[44:47], v[176:191]
 s_waitcnt lgkmcnt(0)
 v_mfma_f32_32x32x16_bf16 v[64:79], a[136:139], v[48:51], v[64:79]
 ds_read_b64_tr_b16 v[32:33], v18 offset:40960
 ds_read_b64_tr_b16 v[34:35], v18 offset:41984
 v_mfma_f32_32x32x16_bf16 v[80:95], a[136:139], v[52:55], v[80:95]
 ds_read_b64_tr_b16 v[36:37], v19 offset:40960
 ds_read_b64_tr_b16 v[38:39], v19 offset:41984
 v_mfma_f32_32x32x16_bf16 v[144:159], a[140:143], v[52:55], v[144:159]
 ds_read_b64_tr_b16 v[40:41], v20 offset:40960
 ds_read_b64_tr_b16 v[42:43], v20 offset:41984
 v_mfma_f32_32x32x16_bf16 v[128:143], a[140:143], v[48:51], v[128:143]
 ds_read_b64_tr_b16 v[44:45], v21 offset:40960
 ds_read_b64_tr_b16 v[46:47], v21 offset:41984
 v_mfma_f32_32x32x16_bf16 v[96:111], a[136:139], v[56:59], v[96:111]
 v_mfma_f32_32x32x16_bf16 v[160:175], a[140:143], v[56:59], v[160:175]
 v_mfma_f32_32x32x16_bf16 v[112:127], a[136:139], v[60:63], v[112:127]
 v_mfma_f32_32x32x16_bf16 v[176:191], a[140:143], v[60:63], v[176:191]
 s_waitcnt lgkmcnt(0)
 v_mfma_f32_32x32x16_bf16 v[64:79], a[144:147], v[32:35], v[64:79]
 ds_read_b64_tr_b16 v[48:49], v18 offset:45056
 ds_read_b64_tr_b16 v[50:51], v18 offset:46080
 v_mfma_f32_32x32x16_bf16 v[80:95], a[144:147], v[36:39], v[80:95]
 ds_read_b64_tr_b16 v[52:53], v19 offset:45056
 ds_read_b64_tr_b16 v[54:55], v19 offset:46080
 v_mfma_f32_32x32x16_bf16 v[144:159], a[148:151], v[36:39], v[144:159]
 ds_read_b64_tr_b16 v[56:57], v20 offset:45056
 ds_read_b64_tr_b16 v[58:59], v20 offset:46080
 v_mfma_f32_32x32x16_bf16 v[128:143], a[148:151], v[32:35], v[128:143]
 ds_read_b64_tr_b16 v[60:61], v21 offset:45056
 ds_read_b64_tr_b16 v[62:63], v21 offset:46080
 v_mfma_f32_32x32x16_bf16 v[96:111], a[144:147], v[40:43], v[96:111]
 v_mfma_f32_32x32x16_bf16 v[160:175], a[148:151], v[40:43], v[160:175]
 v_mfma_f32_32x32x16_bf16 v[112:127], a[144:147], v[44:47], v[112:127]
 v_mfma_f32_32x32x16_bf16 v[176:191], a[148:151], v[44:47], v[176:191]
 s_waitcnt lgkmcnt(0)
 v_mfma_f32_32x32x16_bf16 v[64:79], a[152:155], v[48:51], v[64:79]
 s_waitcnt vmcnt(8)
 s_barrier
 ds_read_b64_tr_b16 v[32:33], v18
 ds_read_b64_tr_b16 v[34:35], v18 offset:1024
 v_mfma_f32_32x32x16_bf16 v[80:95], a[152:155], v[52:55], v[80:95]
 ds_read_b64_tr_b16 v[36:37], v19
 ds_read_b64_tr_b16 v[38:39], v19 offset:1024
 s_add_u32 m0, s57, 98304
 s_nop 0
 buffer_load_dwordx4 v26, s[48:51], s61 offen lds
 v_mfma_f32_32x32x16_bf16 v[144:159], a[156:159], v[52:55], v[144:159]
 ds_read_b64_tr_b16 v[40:41], v20
 ds_read_b64_tr_b16 v[42:43], v20 offset:1024
 v_mfma_f32_32x32x16_bf16 v[128:143], a[156:159], v[48:51], v[128:143]
 ds_read_b64_tr_b16 v[44:45], v21
 ds_read_b64_tr_b16 v[46:47], v21 offset:1024
 buffer_load_dwordx4 v27, s[48:51], s61 offen offset:1024 lds
 v_mfma_f32_32x32x16_bf16 v[96:111], a[152:155], v[56:59], v[96:111]
 v_mfma_f32_32x32x16_bf16 v[160:175], a[156:159], v[56:59], v[160:175]
 buffer_load_dwordx4 v28, s[48:51], s61 offen offset:2048 lds
 v_mfma_f32_32x32x16_bf16 v[112:127], a[152:155], v[60:63], v[112:127]
 v_mfma_f32_32x32x16_bf16 v[176:191], a[156:159], v[60:63], v[176:191]
 buffer_load_dwordx4 v29, s[48:51], s61 offen offset:3072 lds
 s_add_u32 s61, s61, 524288
 s_waitcnt lgkmcnt(0)
 v_mfma_f32_32x32x16_bf16 v[64:79], a[160:163], v[32:35], v[64:79]
 ds_read_b64_tr_b16 v[48:49], v18 offset:4096
 ds_read_b64_tr_b16 v[50:51], v18 offset:5120
 v_mfma_f32_32x32x16_bf16 v[80:95], a[160:163], v[36:39], v[80:95]
 ds_read_b64_tr_b16 v[52:53], v19 offset:4096
 ds_read_b64_tr_b16 v[54:55], v19 offset:5120
 v_mfma_f32_32x32x16_bf16 v[144:159], a[164:167], v[36:39], v[144:159]
 ds_read_b64_tr_b16 v[56:57], v20 offset:4096
 ds_read_b64_tr_b16 v[58:59], v20 offset:5120
 v_mfma_f32_32x32x16_bf16 v[128:143], a[164:167], v[32:35], v[128:143]
 ds_read_b64_tr_b16 v[60:61], v21 offset:4096
 ds_read_b64_tr_b16 v[62:63], v21 offset:5120
 v_mfma_f32_32x32x16_bf16 v[96:111], a[160:163], v[40:43], v[96:111]
 s_add_u32 s71, s63, 12288
 buffer_store_dwordx4 v[240:243], v30, s[36:39], s71 offen sc1
 buffer_store_dwordx4 v[244:247], v30, s[36:39], s71 offen offset:1024 sc1
 v_mfma_f32_32x32x16_bf16 v[160:175], a[164:167], v[40:43], v[160:175]
 v_mfma_f32_32x32x16_bf16 v[112:127], a[160:163], v[44:47], v[112:127]
 v_mfma_f32_32x32x16_bf16 v[176:191], a[164:167], v[44:47], v[176:191]
 s_waitcnt lgkmcnt(0)
 v_mfma_f32_32x32x16_bf16 v[64:79], a[168:171], v[48:51], v[64:79]
 ds_read_b64_tr_b16 v[32:33], v18 offset:8192
 ds_read_b64_tr_b16 v[34:35], v18 offset:9216
 v_mfma_f32_32x32x16_bf16 v[80:95], a[168:171], v[52:55], v[80:95]
 ds_read_b64_tr_b16 v[36:37], v19 offset:8192
 ds_read_b64_tr_b16 v[38:39], v19 offset:9216
 v_mfma_f32_32x32x16_bf16 v[144:159], a[172:175], v[52:55], v[144:159]
 ds_read_b64_tr_b16 v[40:41], v20 offset:8192
 ds_read_b64_tr_b16 v[42:43], v20 offset:9216
 v_mfma_f32_32x32x16_bf16 v[128:143], a[172:175], v[48:51], v[128:143]
 ds_read_b64_tr_b16 v[44:45], v21 offset:8192
 ds_read_b64_tr_b16 v[46:47], v21 offset:9216
 v_mfma_f32_32x32x16_bf16 v[96:111], a[168:171], v[56:59], v[96:111]
 v_mfma_f32_32x32x16_bf16 v[160:175], a[172:175], v[56:59], v[160:175]
 v_mfma_f32_32x32x16_bf16 v[112:127], a[168:171], v[60:63], v[112:127]
 v_mfma_f32_32x32x16_bf16 v[176:191], a[172:175], v[60:63], v[176:191]
 s_waitcnt lgkmcnt(0)
 v_mfma_f32_32x32x16_bf16 v[64:79], a[176:179], v[32:35], v[64:79]
 ds_read_b64_tr_b16 v[48:49], v18 offset:12288
 ds_read_b64_tr_b16 v[50:51], v18 offset:13312
 buffer_store_dwordx4 v[248:251], v30, s[36:39], s71 offen offset:2048 sc1
 buffer_store_dwordx4 v[252:255], v30, s[36:39], s71 offen offset:3072 sc1
 v_mfma_f32_32x32x16_bf16 v[80:95], a[176:179], v[36:39], v[80:95]
 ds_read_b64_tr_b16 v[52:53], v19 offset:12288
 ds_read_b64_tr_b16 v[54:55], v19 offset:13312
 v_mfma_f32_32x32x16_bf16 v[144:159], a[180:183], v[36:39], v[144:159]
 ds_read_b64_tr_b16 v[56:57], v20 offset:12288
 ds_read_b64_tr_b16 v[58:59], v20 offset:13312
 v_mfma_f32_32x32x16_bf16 v[128:143], a[180:183], v[32:35], v[128:143]
 ds_read_b64_tr_b16 v[60:61], v21 offset:12288
 ds_read_b64_tr_b16 v[62:63], v21 offset:13312
 v_mfma_f32_32x32x16_bf16 v[96:111], a[176:179], v[40:43], v[96:111]
 v_mfma_f32_32x32x16_bf16 v[160:175], a[180:183], v[40:43], v[160:175]
 v_mfma_f32_32x32x16_bf16 v[112:127], a[176:179], v[44:47], v[112:127]
 v_mfma_f32_32x32x16_bf16 v[176:191], a[180:183], v[44:47], v[176:191]
 s_waitcnt lgkmcnt(0)
 v_mfma_f32_32x32x16_bf16 v[64:79], a[184:187], v[48:51], v[64:79]
 s_waitcnt vmcnt(10)
 s_barrier
 ds_read_b64_tr_b16 v[32:33], v18 offset:16384
 ds_read_b64_tr_b16 v[34:35], v18 offset:17408
 v_mfma_f32_32x32x16_bf16 v[80:95], a[184:187], v[52:55], v[80:95]
 ds_read_b64_tr_b16 v[36:37], v19 offset:16384
 ds_read_b64_tr_b16 v[38:39], v19 offset:17408
 s_add_u32 m0, s56, 0
 s_nop 0
 buffer_load_dwordx4 v22, s[40:43], s58 offen lds
 v_mfma_f32_32x32x16_bf16 v[144:159], a[188:191], v[52:55], v[144:159]
 ds_read_b64_tr_b16 v[40:41], v20 offset:16384
 ds_read_b64_tr_b16 v[42:43], v20 offset:17408
 v_mfma_f32_32x32x16_bf16 v[128:143], a[188:191], v[48:51], v[128:143]
 ds_read_b64_tr_b16 v[44:45], v21 offset:16384
 ds_read_b64_tr_b16 v[46:47], v21 offset:17408
 buffer_load_dwordx4 v23, s[40:43], s58 offen offset:1024 lds
 v_mfma_f32_32x32x16_bf16 v[96:111], a[184:187], v[56:59], v[96:111]
 v_mfma_f32_32x32x16_bf16 v[160:175], a[188:191], v[56:59], v[160:175]
 buffer_load_dwordx4 v24, s[40:43], s58 offen offset:2048 lds
 v_mfma_f32_32x32x16_bf16 v[112:127], a[184:187], v[60:63], v[112:127]
 v_mfma_f32_32x32x16_bf16 v[176:191], a[188:191], v[60:63], v[176:191]
 buffer_load_dwordx4 v25, s[40:43], s58 offen offset:3072 lds
 s_add_u32 s58, s58, 128
 s_waitcnt lgkmcnt(0)
 v_mfma_f32_32x32x16_bf16 v[64:79], a[192:195], v[32:35], v[64:79]
 ds_read_b64_tr_b16 v[48:49], v18 offset:20480
 ds_read_b64_tr_b16 v[50:51], v18 offset:21504
 v_mfma_f32_32x32x16_bf16 v[80:95], a[192:195], v[36:39], v[80:95]
 ds_read_b64_tr_b16 v[52:53], v19 offset:20480
 ds_read_b64_tr_b16 v[54:55], v19 offset:21504
 s_add_u32 m0, s56, 4096
 s_nop 0
 buffer_load_dwordx4 v22, s[40:43], s60 offen lds
 v_mfma_f32_32x32x16_bf16 v[144:159], a[196:199], v[36:39], v[144:159]
 ds_read_b64_tr_b16 v[56:57], v20 offset:20480
 ds_read_b64_tr_b16 v[58:59], v20 offset:21504
 v_mfma_f32_32x32x16_bf16 v[128:143], a[196:199], v[32:35], v[128:143]
 ds_read_b64_tr_b16 v[60:61], v21 offset:20480
 ds_read_b64_tr_b16 v[62:63], v21 offset:21504
 buffer_load_dwordx4 v23, s[40:43], s60 offen offset:1024 lds
 v_mfma_f32_32x32x16_bf16 v[96:111], a[192:195], v[40:43], v[96:111]
 v_mfma_f32_32x32x16_bf16 v[160:175], a[196:199], v[40:43], v[160:175]
 buffer_load_dwordx4 v24, s[40:43], s60 offen offset:2048 lds
 v_mfma_f32_32x32x16_bf16 v[112:127], a[192:195], v[44:47], v[112:127]
 v_mfma_f32_32x32x16_bf16 v[176:191], a[196:199], v[44:47], v[176:191]
 buffer_load_dwordx4 v25, s[40:43], s60 offen offset:3072 lds
 s_add_u32 s60, s60, 128
 s_waitcnt lgkmcnt(0)
 v_mfma_f32_32x32x16_bf16 v[64:79], a[200:203], v[48:51], v[64:79]
 ds_read_b64_tr_b16 v[32:33], v18 offset:24576
 ds_read_b64_tr_b16 v[34:35], v18 offset:25600
 v_mfma_f32_32x32x16_bf16 v[80:95], a[200:203], v[52:55], v[80:95]
 ds_read_b64_tr_b16 v[36:37], v19 offset:24576
 ds_read_b64_tr_b16 v[38:39], v19 offset:25600
 s_add_u32 m0, s57, 65536
 s_nop 0
 buffer_load_dwordx4 v26, s[44:47], s62 offen lds
 v_mfma_f32_32x32x16_bf16 v[144:159], a[204:207], v[52:55], v[144:159]
 ds_read_b64_tr_b16 v[40:41], v20 offset:24576
 ds_read_b64_tr_b16 v[42:43], v20 offset:25600
 v_mfma_f32_32x32x16_bf16 v[128:143], a[204:207], v[48:51], v[128:143]
 ds_read_b64_tr_b16 v[44:45], v21 offset:24576
 ds_read_b64_tr_b16 v[46:47], v21 offset:25600
 buffer_load_dwordx4 v27, s[44:47], s62 offen offset:1024 lds
 v_mfma_f32_32x32x16_bf16 v[96:111], a[200:203], v[56:59], v[96:111]
 v_mfma_f32_32x32x16_bf16 v[160:175], a[204:207], v[56:59], v[160:175]
 buffer_load_dwordx4 v28, s[44:47], s62 offen offset:2048 lds
 v_mfma_f32_32x32x16_bf16 v[112:127], a[200:203], v[60:63], v[112:127]
 v_mfma_f32_32x32x16_bf16 v[176:191], a[204:207], v[60:63], v[176:191]
 buffer_load_dwordx4 v29, s[44:47], s62 offen offset:3072 lds
 s_add_u32 s62, s62, 524288
 s_waitcnt lgkmcnt(0)
 v_mfma_f32_32x32x16_bf16 v[64:79], a[208:211], v[32:35], v[64:79]
 ds_read_b64_tr_b16 v[48:49], v18 offset:28672
 ds_read_b64_tr_b16 v[50:51], v18 offset:29696
 v_mfma_f32_32x32x16_bf16 v[80:95], a[208:211], v[36:39], v[80:95]
 ds_read_b64_tr_b16 v[52:53], v19 offset:28672
 ds_read_b64_tr_b16 v[54:55], v19 offset:29696
 v_mfma_f32_32x32x16_bf16 v[144:159], a[212:215], v[36:39], v[144:159]
 ds_read_b64_tr_b16 v[56:57], v20 offset:28672
 ds_read_b64_tr_b16 v[58:59], v20 offset:29696
 v_mfma_f32_32x32x16_bf16 v[128:143], a[212:215], v[32:35], v[128:143]
 ds_read_b64_tr_b16 v[60:61], v21 offset:28672
 ds_read_b64_tr_b16 v[62:63], v21 offset:29696
 v_mfma_f32_32x32x16_bf16 v[96:111], a[208:211], v[40:43], v[96:111]
 v_mfma_f32_32x32x16_bf16 v[160:175], a[212:215], v[40:43], v[160:175]
 v_mfma_f32_32x32x16_bf16 v[112:127], a[208:211], v[44:47], v[112:127]
 v_mfma_f32_32x32x16_bf16 v[176:191], a[212:215], v[44:47], v[176:191]
 s_waitcnt lgkmcnt(0)
 v_mfma_f32_32x32x16_bf16 v[64:79], a[216:219], v[48:51], v[64:79]
 s_waitcnt vmcnt(16)
 s_barrier
 ds_read_b64_tr_b16 v[32:33], v18 offset:32768
 ds_read_b64_tr_b16 v[34:35], v18 offset:33792
 v_mfma_f32_32x32x16_bf16 v[80:95], a[216:219], v[52:55], v[80:95]
 ds_read_b64_tr_b16 v[36:37], v19 offset:32768
 ds_read_b64_tr_b16 v[38:39], v19 offset:33792
 s_add_u32 m0, s56, 32768
 s_nop 0
 buffer_load_dwordx4 v22, s[40:43], s58 offen lds
 v_mfma_f32_32x32x16_bf16 v[144:159], a[220:223], v[52:55], v[144:159]
 ds_read_b64_tr_b16 v[40:41], v20 offset:32768
 ds_read_b64_tr_b16 v[42:43], v20 offset:33792
 v_mfma_f32_32x32x16_bf16 v[128:143], a[220:223], v[48:51], v[128:143]
 ds_read_b64_tr_b16 v[44:45], v21 offset:32768
 ds_read_b64_tr_b16 v[46:47], v21 offset:33792
 buffer_load_dwordx4 v23, s[40:43], s58 offen offset:1024 lds
 v_mfma_f32_32x32x16_bf16 v[96:111], a[216:219], v[56:59], v[96:111]
 v_mfma_f32_32x32x16_bf16 v[160:175], a[220:223], v[56:59], v[160:175]
 buffer_load_dwordx4 v24, s[40:43], s58 offen offset:2048 lds
 v_mfma_f32_32x32x16_bf16 v[112:127], a[216:219], v[60:63], v[112:127]
 v_mfma_f32_32x32x16_bf16 v[176:191], a[220:223], v[60:63], v[176:191]
 buffer_load_dwordx4 v25, s[40:43], s58 offen offset:3072 lds
 s_add_u32 s58, s58, 128
 s_waitcnt lgkmcnt(0)
 v_mfma_f32_32x32x16_bf16 v[64:79], a[224:227], v[32:35], v[64:79]
 ds_read_b64_tr_b16 v[48:49], v18 offset:36864
 ds_read_b64_tr_b16 v[50:51], v18 offset:37888
 s_mov_b32 s72, s24
 s_mov_b32 s73, s25
 s_mov_b32 s74, 256
 v_mfma_f32_32x32x16_bf16 v[80:95], a[224:227], v[36:39], v[80:95]
 ds_read_b64_tr_b16 v[52:53], v19 offset:36864
 ds_read_b64_tr_b16 v[54:55], v19 offset:37888
 s_add_u32 m0, s56, 36864
 s_nop 0
 buffer_load_dwordx4 v22, s[40:43], s60 offen lds
 v_mfma_f32_32x32x16_bf16 v[144:159], a[228:231], v[36:39], v[144:159]
 ds_read_b64_tr_b16 v[56:57], v20 offset:36864
 ds_read_b64_tr_b16 v[58:59], v20 offset:37888
 s_mov_b32 s75, 0x20000
 v_mfma_f32_32x32x16_bf16 v[128:143], a[228:231], v[32:35], v[128:143]
 ds_read_b64_tr_b16 v[60:61], v21 offset:36864
 ds_read_b64_tr_b16 v[62:63], v21 offset:37888
 buffer_load_dwordx4 v23, s[40:43], s60 offen offset:1024 lds
 v_mfma_f32_32x32x16_bf16 v[96:111], a[224:227], v[40:43], v[96:111]
 v_mfma_f32_32x32x16_bf16 v[160:175], a[228:231], v[40:43], v[160:175]
 buffer_load_dwordx4 v24, s[40:43], s60 offen offset:2048 lds
 v_mfma_f32_32x32x16_bf16 v[112:127], a[224:227], v[44:47], v[112:127]
 v_mfma_f32_32x32x16_bf16 v[176:191], a[228:231], v[44:47], v[176:191]
 buffer_load_dwordx4 v25, s[40:43], s60 offen offset:3072 lds
 s_add_u32 s60, s60, 128
 s_waitcnt lgkmcnt(0)
 v_mfma_f32_32x32x16_bf16 v[64:79], a[232:235], v[48:51], v[64:79]
 ds_read_b64_tr_b16 v[32:33], v18 offset:40960
 ds_read_b64_tr_b16 v[34:35], v18 offset:41984
 v_mfma_f32_32x32x16_bf16 v[80:95], a[232:235], v[52:55], v[80:95]
 ds_read_b64_tr_b16 v[36:37], v19 offset:40960
 ds_read_b64_tr_b16 v[38:39], v19 offset:41984
 s_add_u32 m0, s57, 81920
 s_nop 0
 buffer_load_dwordx4 v26, s[44:47], s62 offen lds
 v_mfma_f32_32x32x16_bf16 v[144:159], a[236:239], v[52:55], v[144:159]
 ds_read_b64_tr_b16 v[40:41], v20 offset:40960
 ds_read_b64_tr_b16 v[42:43], v20 offset:41984
 v_mfma_f32_32x32x16_bf16 v[128:143], a[236:239], v[48:51], v[128:143]
 ds_read_b64_tr_b16 v[44:45], v21 offset:40960
 ds_read_b64_tr_b16 v[46:47], v21 offset:41984
 buffer_load_dwordx4 v27, s[44:47], s62 offen offset:1024 lds
 v_mfma_f32_32x32x16_bf16 v[96:111], a[232:235], v[56:59], v[96:111]
 v_mfma_f32_32x32x16_bf16 v[160:175], a[236:239], v[56:59], v[160:175]
 buffer_load_dwordx4 v28, s[44:47], s62 offen offset:2048 lds
 v_mfma_f32_32x32x16_bf16 v[112:127], a[232:235], v[60:63], v[112:127]
 v_mfma_f32_32x32x16_bf16 v[176:191], a[236:239], v[60:63], v[176:191]
 buffer_load_dwordx4 v29, s[44:47], s62 offen offset:3072 lds
 s_add_u32 s62, s62, 524288
 s_waitcnt lgkmcnt(0)
 v_mfma_f32_32x32x16_bf16 v[64:79], a[240:243], v[32:35], v[64:79]
 ds_read_b64_tr_b16 v[48:49], v18 offset:45056
 ds_read_b64_tr_b16 v[50:51], v18 offset:46080
 v_mfma_f32_32x32x16_bf16 v[80:95], a[240:243], v[36:39], v[80:95]
 ds_read_b64_tr_b16 v[52:53], v19 offset:45056
 ds_read_b64_tr_b16 v[54:55], v19 offset:46080
 v_mfma_f32_32x32x16_bf16 v[144:159], a[244:247], v[36:39], v[144:159]
 ds_read_b64_tr_b16 v[56:57], v20 offset:45056
 ds_read_b64_tr_b16 v[58:59], v20 offset:46080
 v_mfma_f32_32x32x16_bf16 v[128:143], a[244:247], v[32:35], v[128:143]
 ds_read_b64_tr_b16 v[60:61], v21 offset:45056
 ds_read_b64_tr_b16 v[62:63], v21 offset:46080
 v_mfma_f32_32x32x16_bf16 v[96:111], a[240:243], v[40:43], v[96:111]
 v_mfma_f32_32x32x16_bf16 v[160:175], a[244:247], v[40:43], v[160:175]
 v_mfma_f32_32x32x16_bf16 v[112:127], a[240:243], v[44:47], v[112:127]
 v_mfma_f32_32x32x16_bf16 v[176:191], a[244:247], v[44:47], v[176:191]
 s_waitcnt lgkmcnt(0)
 v_mfma_f32_32x32x16_bf16 v[64:79], a[248:251], v[48:51], v[64:79]
 s_waitcnt vmcnt(12)
 s_barrier
 ds_read_b64_tr_b16 v[32:33], v18
 ds_read_b64_tr_b16 v[34:35], v18 offset:1024
 v_mfma_f32_32x32x16_bf16 v[80:95], a[248:251], v[52:55], v[80:95]
 ds_read_b128 a[0:3], v10
 ds_read_b64_tr_b16 v[36:37], v19
 s_add_u32 m0, s56, 131072
 s_nop 0
 buffer_load_dwordx4 v22, s[40:43], s58 offen lds
 v_mfma_f32_32x32x16_bf16 v[144:159], a[252:255], v[52:55], v[144:159]
 ds_read_b64_tr_b16 v[38:39], v19 offset:1024
 ds_read_b128 a[4:7], v10 offset:4096
 v_mfma_f32_32x32x16_bf16 v[128:143], a[252:255], v[48:51], v[128:143]
 ds_read_b64_tr_b16 v[40:41], v20
 ds_read_b64_tr_b16 v[42:43], v20 offset:1024
 buffer_load_dwordx4 v23, s[40:43], s58 offen offset:1024 lds
 v_mfma_f32_32x32x16_bf16 v[96:111], a[248:251], v[56:59], v[96:111]
 ds_read_b64_tr_b16 v[44:45], v21
 ds_read_b64_tr_b16 v[46:47], v21 offset:1024
 v_mfma_f32_32x32x16_bf16 v[160:175], a[252:255], v[56:59], v[160:175]
 buffer_load_dwordx4 v24, s[40:43], s58 offen offset:2048 lds
 v_mfma_f32_32x32x16_bf16 v[112:127], a[248:251], v[60:63], v[112:127]
 v_mfma_f32_32x32x16_bf16 v[176:191], a[252:255], v[60:63], v[176:191]
 buffer_load_dwordx4 v25, s[40:43], s58 offen offset:3072 lds
 s_add_u32 s58, s58, 128
 s_nop 3
 v_cvt_pk_bf16_f32 v192, v64, v65
 v_cvt_pk_bf16_f32 v193, v66, v67
 v_cvt_pk_bf16_f32 v194, v68, v69
 v_cvt_pk_bf16_f32 v195, v70, v71
 v_cvt_pk_bf16_f32 v196, v72, v73
 v_cvt_pk_bf16_f32 v197, v74, v75
 v_cvt_pk_bf16_f32 v198, v76, v77
 v_cvt_pk_bf16_f32 v199, v78, v79
 s_nop 0
 s_waitcnt lgkmcnt(0)
 v_mfma_f32_32x32x16_bf16 v[64:79], v[32:35], a[0:3], 0
 ds_read_b64_tr_b16 v[48:49], v18 offset:4096
 ds_read_b64_tr_b16 v[50:51], v18 offset:5120
 v_cvt_pk_bf16_f32 v200, v80, v81
 v_cvt_pk_bf16_f32 v201, v82, v83
 v_cvt_pk_bf16_f32 v202, v84, v85
 v_cvt_pk_bf16_f32 v203, v86, v87
 v_cvt_pk_bf16_f32 v204, v88, v89
 v_cvt_pk_bf16_f32 v205, v90, v91
 v_cvt_pk_bf16_f32 v206, v92, v93
 v_cvt_pk_bf16_f32 v207, v94, v95
 s_nop 0
 v_mfma_f32_32x32x16_bf16 v[80:95], v[36:39], a[0:3], 0
 ds_read_b128 a[8:11], v11
 ds_read_b64_tr_b16 v[52:53], v19 offset:4096
 s_add_u32 m0, s56, 135168
 s_nop 0
 buffer_load_dwordx4 v22, s[40:43], s60 offen lds
 v_cvt_pk_bf16_f32 v232, v144, v145
 v_cvt_pk_bf16_f32 v233, v146, v147
 v_cvt_pk_bf16_f32 v234, v148, v149
 v_cvt_pk_bf16_f32 v235, v150, v151
 v_cvt_pk_bf16_f32 v236, v152, v153
 v_cvt_pk_bf16_f32 v237, v154, v155
 v_cvt_pk_bf16_f32 v238, v156, v157
 v_cvt_pk_bf16_f32 v239, v158, v159
 s_nop 0
 v_mfma_f32_32x32x16_bf16 v[144:159], v[36:39], a[4:7], 0
 ds_read_b64_tr_b16 v[54:55], v19 offset:5120
 ds_read_b128 a[12:15], v11 offset:4096
 v_cvt_pk_bf16_f32 v224, v128, v129
 v_cvt_pk_bf16_f32 v225, v130, v131
 v_cvt_pk_bf16_f32 v226, v132, v133
 v_cvt_pk_bf16_f32 v227, v134, v135
 v_cvt_pk_bf16_f32 v228, v136, v137
 v_cvt_pk_bf16_f32 v229, v138, v139
 v_cvt_pk_bf16_f32 v230, v140, v141
 v_cvt_pk_bf16_f32 v231, v142, v143
 s_nop 0
 v_mfma_f32_32x32x16_bf16 v[128:143], v[32:35], a[4:7], 0
 ds_read_b64_tr_b16 v[56:57], v20 offset:4096
 ds_read_b64_tr_b16 v[58:59], v20 offset:5120
 buffer_load_dwordx4 v23, s[40:43], s60 offen offset:1024 lds
 v_cvt_pk_bf16_f32 v208, v96, v97
 v_cvt_pk_bf16_f32 v209, v98, v99
 v_cvt_pk_bf16_f32 v210, v100, v101
 v_cvt_pk_bf16_f32 v211, v102, v103
 v_cvt_pk_bf16_f32 v212, v104, v105
 v_cvt_pk_bf16_f32 v213, v106, v107
 v_cvt_pk_bf16_f32 v214, v108, v109
 v_cvt_pk_bf16_f32 v215, v110, v111
 s_nop 0
 v_mfma_f32_32x32x16_bf16 v[96:111], v[40:43], a[0:3], 0
 ds_read_b64_tr_b16 v[60:61], v21 offset:4096
 ds_read_b64_tr_b16 v[62:63], v21 offset:5120
 v_cvt_pk_bf16_f32 v240, v160, v161
 v_cvt_pk_bf16_f32 v241, v162, v163
 v_cvt_pk_bf16_f32 v242, v164, v165
 v_cvt_pk_bf16_f32 v243, v166, v167
 v_cvt_pk_bf16_f32 v244, v168, v169
 v_cvt_pk_bf16_f32 v245, v170, v171
 v_cvt_pk_bf16_f32 v246, v172, v173
 v_cvt_pk_bf16_f32 v247, v174, v175
 s_nop 0
 v_mfma_f32_32x32x16_bf16 v[160:175], v[40:43], a[4:7], 0
 buffer_load_dwordx4 v24, s[40:43], s60 offen offset:2048 lds
 v_cvt_pk_bf16_f32 v216, v112, v113
 v_cvt_pk_bf16_f32 v217, v114, v115
 v_cvt_pk_bf16_f32 v218, v116, v117
 v_cvt_pk_bf16_f32 v219, v118, v119
 v_cvt_pk_bf16_f32 v220, v120, v121
 v_cvt_pk_bf16_f32 v221, v122, v123
 v_cvt_pk_bf16_f32 v222, v124, v125
 v_cvt_pk_bf16_f32 v223, v126, v127
 s_nop 0
 v_mfma_f32_32x32x16_bf16 v[112:127], v[44:47], a[0:3], 0
 v_cvt_pk_bf16_f32 v248, v176, v177
 v_cvt_pk_bf16_f32 v249, v178, v179
 v_cvt_pk_bf16_f32 v250, v180, v181
 v_cvt_pk_bf16_f32 v251, v182, v183
 v_cvt_pk_bf16_f32 v252, v184, v185
 v_cvt_pk_bf16_f32 v253, v186, v187
 v_cvt_pk_bf16_f32 v254, v188, v189
 v_cvt_pk_bf16_f32 v255, v190, v191
 s_nop 0
 v_mfma_f32_32x32x16_bf16 v[176:191], v[44:47], a[4:7], 0
 buffer_load_dwordx4 v25, s[40:43], s60 offen offset:3072 lds
 s_add_u32 s60, s60, 128
 s_waitcnt lgkmcnt(0)
 v_mfma_f32_32x32x16_bf16 v[64:79], v[48:51], a[8:11], v[64:79]
 ds_read_b64_tr_b16 v[32:33], v18 offset:8192
 ds_read_b64_tr_b16 v[34:35], v18 offset:9216
 v_lshlrev_b32 v8, 2, v3
 v_sub_u32 v8, v2, v8
 v_mov_b32 v31, 0xf149f2ca
 v_mfma_f32_32x32x16_bf16 v[80:95], v[52:55], a[8:11], v[80:95]
 ds_read_b128 a[0:3], v12
 ds_read_b64_tr_b16 v[36:37], v19 offset:8192
 s_add_u32 m0, s57, 98304
 s_nop 0
 buffer_load_dwordx4 v26, s[44:47], s62 offen lds
 v_mfma_f32_32x32x16_bf16 v[144:159], v[52:55], a[12:15], v[144:159]
 ds_read_b64_tr_b16 v[38:39], v19 offset:9216
 ds_read_b128 a[4:7], v12 offset:4096
 v_cmp_gt_i32 vcc, 0, v8
 v_cmp_gt_i32 s[52:53], 1, v8
 v_cmp_gt_i32 s[54:55], 2, v8
 v_mfma_f32_32x32x16_bf16 v[128:143], v[48:51], a[12:15], v[128:143]
 ds_read_b64_tr_b16 v[40:41], v20 offset:8192
 ds_read_b64_tr_b16 v[42:43], v20 offset:9216
 buffer_load_dwordx4 v27, s[44:47], s62 offen offset:1024 lds
 v_cndmask_b32 v9, 0, v31, vcc
 v_mfma_f32_32x32x16_bf16 v[96:111], v[56:59], a[8:11], v[96:111]
 ds_read_b64_tr_b16 v[44:45], v21 offset:8192
 ds_read_b64_tr_b16 v[46:47], v21 offset:9216
 v_accvgpr_write_b32 a152, v9
 v_cmp_gt_i32 vcc, 3, v8
 v_cndmask_b32 v0, 0, v31, s[52:53]
 v_mfma_f32_32x32x16_bf16 v[160:175], v[56:59], a[12:15], v[160:175]
 buffer_load_dwordx4 v28, s[44:47], s62 offen offset:2048 lds
 v_accvgpr_write_b32 a153, v0
 v_cmp_gt_i32 s[52:53], 8, v8
 v_cndmask_b32 v9, 0, v31, s[54:55]
 v_mfma_f32_32x32x16_bf16 v[112:127], v[60:63], a[8:11], v[112:127]
 v_accvgpr_write_b32 a154, v9
 v_cmp_gt_i32 s[54:55], 9, v8
 v_cndmask_b32 v0, 0, v31, vcc
 v_accvgpr_write_b32 a155, v0
 v_cmp_gt_i32 vcc, 10, v8
 v_mfma_f32_32x32x16_bf16 v[176:191], v[60:63], a[12:15], v[176:191]
 buffer_load_dwordx4 v29, s[44:47], s62 offen offset:3072 lds
 s_add_u32 s62, s62, 524288
 v_cndmask_b32 v9, 0, v31, s[52:53]
 v_accvgpr_write_b32 a156, v9
 s_waitcnt lgkmcnt(0)
 v_mfma_f32_32x32x16_bf16 v[64:79], v[32:35], a[0:3], v[64:79]
 ds_read_b64_tr_b16 v[48:49], v18 offset:12288
 ds_read_b64_tr_b16 v[50:51], v18 offset:13312
 v_cmp_gt_i32 s[52:53], 11, v8
 v_cndmask_b32 v0, 0, v31, s[54:55]
 v_accvgpr_write_b32 a157, v0
 v_mfma_f32_32x32x16_bf16 v[80:95], v[36:39], a[0:3], v[80:95]
 ds_read_b128 a[8:11], v13
 ds_read_b64_tr_b16 v[52:53], v19 offset:12288
 v_cmp_gt_i32 s[54:55], 16, v8
 v_cndmask_b32 v9, 0, v31, vcc
 v_accvgpr_write_b32 a158, v9
 v_mfma_f32_32x32x16_bf16 v[144:159], v[36:39], a[4:7], v[144:159]
 ds_read_b64_tr_b16 v[54:55], v19 offset:13312
 ds_read_b128 a[12:15], v13 offset:4096
 v_cmp_gt_i32 vcc, 17, v8
 v_cndmask_b32 v0, 0, v31, s[52:53]
 v_accvgpr_write_b32 a159, v0
 v_mfma_f32_32x32x16_bf16 v[128:143], v[32:35], a[4:7], v[128:143]
 ds_read_b64_tr_b16 v[56:57], v20 offset:12288
 ds_read_b64_tr_b16 v[58:59], v20 offset:13312
 v_cmp_gt_i32 s[52:53], 18, v8
 v_cndmask_b32 v9, 0, v31, s[54:55]
 v_accvgpr_write_b32 a160, v9
 v_mfma_f32_32x32x16_bf16 v[96:111], v[40:43], a[0:3], v[96:111]
 ds_read_b64_tr_b16 v[60:61], v21 offset:12288
 ds_read_b64_tr_b16 v[62:63], v21 offset:13312
 v_cmp_gt_i32 s[54:55], 19, v8
 v_cndmask_b32 v0, 0, v31, vcc
 v_accvgpr_write_b32 a161, v0
 v_mfma_f32_32x32x16_bf16 v[160:175], v[40:43], a[4:7], v[160:175]
 s_add_u32 s64, s63, 16785408
 buffer_store_dwordx4 v[224:227], v30, s[36:39], s64 offen sc1
 buffer_store_dwordx4 v[232:235], v30, s[36:39], s64 offen offset:1024 sc1
 v_mfma_f32_32x32x16_bf16 v[112:127], v[44:47], a[0:3], v[112:127]
 v_cmp_gt_i32 vcc, 24, v8
 v_cndmask_b32 v9, 0, v31, s[52:53]
 v_accvgpr_write_b32 a162, v9
 v_cmp_gt_i32 s[52:53], 25, v8
 v_cndmask_b32 v0, 0, v31, s[54:55]
 v_mfma_f32_32x32x16_bf16 v[176:191], v[44:47], a[4:7], v[176:191]
 v_accvgpr_write_b32 a163, v0
 v_cmp_gt_i32 s[54:55], 26, v8
 v_cndmask_b32 v9, 0, v31, vcc
 v_accvgpr_write_b32 a164, v9
 v_cmp_gt_i32 vcc, 27, v8
 s_waitcnt lgkmcnt(0)
 v_mfma_f32_32x32x16_bf16 v[64:79], v[48:51], a[8:11], v[64:79]
 s_waitcnt vmcnt(14)
 s_barrier
 ds_read_b64_tr_b16 v[32:33], v18 offset:16384
 ds_read_b64_tr_b16 v[34:35], v18 offset:17408
 v_cndmask_b32 v0, 0, v31, s[52:53]
 v_mfma_f32_32x32x16_bf16 v[80:95], v[52:55], a[8:11], v[80:95]
 ds_read_b128 a[0:3], v10 offset:32768
 ds_read_b64_tr_b16 v[36:37], v19 offset:16384
 s_add_u32 m0, s56, 0
 s_nop 0
 buffer_load_dwordx4 v22, s[40:43], s58 offen lds
 v_mfma_f32_32x32x16_bf16 v[144:159], v[52:55], a[12:15], v[144:159]
 ds_read_b64_tr_b16 v[38:39], v19 offset:17408
 ds_read_b128 a[4:7], v10 offset:36864
 v_accvgpr_write_b32 a165, v0
 s_nop 0
 v_cndmask_b32 v9, 0, v31, s[54:55]
 v_mfma_f32_32x32x16_bf16 v[128:143], v[48:51], a[12:15], v[128:143]
 ds_read_b64_tr_b16 v[40:41], v20 offset:16384
 ds_read_b64_tr_b16 v[42:43], v20 offset:17408
 buffer_load_dwordx4 v23, s[40:43], s58 offen offset:1024 lds
 v_accvgpr_write_b32 a166, v9
 v_mfma_f32_32x32x16_bf16 v[96:111], v[56:59], a[8:11], v[96:111]
 ds_read_b64_tr_b16 v[44:45], v21 offset:16384
 ds_read_b64_tr_b16 v[46:47], v21 offset:17408
 s_nop 0
 v_cndmask_b32 v0, 0, v31, vcc
 v_accvgpr_write_b32 a167, v0
 v_mfma_f32_32x32x16_bf16 v[160:175], v[56:59], a[12:15], v[160:175]
 buffer_load_dwordx4 v24, s[40:43], s58 offen offset:2048 lds
 s_mov_b32 s55, 3277
 v_add_u32 v9, 0, v1
 v_mul_lo_u32 v8, v9, s55
 v_mfma_f32_32x32x16_bf16 v[112:127], v[60:63], a[8:11], v[112:127]
 v_lshrrev_b32 v8, 16, v8
 v_mul_u32_u24 v0, 20, v8
 v_sub_u32 v9, v9, v0
 v_mul_u32_u24 v8, 1152, v8
 v_lshl_add_u32 v0, v9, 4, v8
 v_mfma_f32_32x32x16_bf16 v[176:191], v[60:63], a[12:15], v[176:191]
 buffer_load_dwordx4 v25, s[40:43], s58 offen offset:3072 lds
 s_add_u32 s58, s58, 128
 v_accvgpr_write_b32 a147, v0
 v_add_u32 v9, 64, v1
 s_waitcnt lgkmcnt(0)
 v_mfma_f32_32x32x16_bf16 v[64:79], v[32:35], a[0:3], v[64:79]
 ds_read_b64_tr_b16 v[48:49], v18 offset:20480
 ds_read_b64_tr_b16 v[50:51], v18 offset:21504
 v_mul_lo_u32 v8, v9, s55
 v_lshrrev_b32 v8, 16, v8
 v_mul_u32_u24 v0, 20, v8
 v_mfma_f32_32x32x16_bf16 v[80:95], v[36:39], a[0:3], v[80:95]
 ds_read_b128 a[8:11], v11 offset:32768
 ds_read_b64_tr_b16 v[52:53], v19 offset:20480
 s_add_u32 m0, s56, 4096
 s_nop 0
 buffer_load_dwordx4 v22, s[40:43], s60 offen lds
 v_mfma_f32_32x32x16_bf16 v[144:159], v[36:39], a[4:7], v[144:159]
 ds_read_b64_tr_b16 v[54:55], v19 offset:21504
 ds_read_b128 a[12:15], v11 offset:36864
 v_sub_u32 v9, v9, v0
 v_mul_u32_u24 v8, 1152, v8
 v_lshl_add_u32 v0, v9, 4, v8
 v_mfma_f32_32x32x16_bf16 v[128:143], v[32:35], a[4:7], v[128:143]
 ds_read_b64_tr_b16 v[56:57], v20 offset:20480
 ds_read_b64_tr_b16 v[58:59], v20 offset:21504
 buffer_load_dwordx4 v23, s[40:43], s60 offen offset:1024 lds
 v_subrev_u32 v0, 1024, v0
 v_mfma_f32_32x32x16_bf16 v[96:111], v[40:43], a[0:3], v[96:111]
 ds_read_b64_tr_b16 v[60:61], v21 offset:20480
 ds_read_b64_tr_b16 v[62:63], v21 offset:21504
 v_accvgpr_write_b32 a148, v0
 v_add_u32 v9, 128, v1
 v_mul_lo_u32 v8, v9, s55
 v_mfma_f32_32x32x16_bf16 v[160:175], v[40:43], a[4:7], v[160:175]
 buffer_load_dwordx4 v24, s[40:43], s60 offen offset:2048 lds
 v_lshrrev_b32 v8, 16, v8
 v_mul_u32_u24 v0, 20, v8
 v_sub_u32 v9, v9, v0
 v_mfma_f32_32x32x16_bf16 v[112:127], v[44:47], a[0:3], v[112:127]
 v_mul_u32_u24 v8, 1152, v8
 v_lshl_add_u32 v0, v9, 4, v8
 v_subrev_u32 v0, 2048, v0
 v_accvgpr_write_b32 a149, v0
 v_add_u32 v9, 192, v1
 v_mfma_f32_32x32x16_bf16 v[176:191], v[44:47], a[4:7], v[176:191]
 buffer_load_dwordx4 v25, s[40:43], s60 offen offset:3072 lds
 s_add_u32 s60, s60, 128
 v_mul_lo_u32 v8, v9, s55
 v_lshrrev_b32 v8, 16, v8
 s_waitcnt lgkmcnt(0)
 v_mfma_f32_32x32x16_bf16 v[64:79], v[48:51], a[8:11], v[64:79]
 ds_read_b64_tr_b16 v[32:33], v18 offset:24576
 ds_read_b64_tr_b16 v[34:35], v18 offset:25600
 v_mul_u32_u24 v0, 20, v8
 v_sub_u32 v9, v9, v0
 v_mul_u32_u24 v8, 1152, v8
 v_mfma_f32_32x32x16_bf16 v[80:95], v[52:55], a[8:11], v[80:95]
 ds_read_b128 a[0:3], v12 offset:32768
 ds_read_b64_tr_b16 v[36:37], v19 offset:24576
 s_add_u32 m0, s57, 65536
 s_nop 0
 buffer_load_dwordx4 v26, s[44:47], s62 offen lds
 v_mfma_f32_32x32x16_bf16 v[144:159], v[52:55], a[12:15], v[144:159]
 ds_read_b64_tr_b16 v[38:39], v19 offset:25600
 ds_read_b128 a[4:7], v12 offset:36864
 v_lshl_add_u32 v0, v9, 4, v8
 v_subrev_u32 v0, 3072, v0
 v_accvgpr_write_b32 a150, v0
 v_mfma_f32_32x32x16_bf16 v[128:143], v[48:51], a[12:15], v[128:143]
 ds_read_b64_tr_b16 v[40:41], v20 offset:24576
 ds_read_b64_tr_b16 v[42:43], v20 offset:25600
 buffer_load_dwordx4 v27, s[44:47], s62 offen offset:1024 lds
 v_add_u32 v9, 256, v1
 v_mfma_f32_32x32x16_bf16 v[96:111], v[56:59], a[8:11], v[96:111]
 ds_read_b64_tr_b16 v[44:45], v21 offset:24576
 ds_read_b64_tr_b16 v[46:47], v21 offset:25600
 v_mul_lo_u32 v8, v9, s55
 v_lshrrev_b32 v8, 16, v8
 v_mul_u32_u24 v0, 20, v8
 v_mfma_f32_32x32x16_bf16 v[160:175], v[56:59], a[12:15], v[160:175]
 buffer_load_dwordx4 v28, s[44:47], s62 offen offset:2048 lds
 v_sub_u32 v9, v9, v0
 v_mul_u32_u24 v8, 1152, v8
 v_lshl_add_u32 v0, v9, 4, v8
 v_mfma_f32_32x32x16_bf16 v[112:127], v[60:63], a[8:11], v[112:127]
 v_accvgpr_write_b32 a151, v0
 v_lshrrev_b32 v8, 4, v1
 s_lshl_b32 s55, s31, 2
 s_cmp_eq_u32 s28, 0
 s_cselect_b32 s55, s55, 0x80000000
 v_mfma_f32_32x32x16_bf16 v[176:191], v[60:63], a[12:15], v[176:191]
 buffer_load_dwordx4 v29, s[44:47], s62 offen offset:3072 lds
 s_add_u32 s62, s62, 524288
 v_mov_b32 v0, s55
 v_mov_b32 v31, 1
 s_waitcnt lgkmcnt(0)
 v_mfma_f32_32x32x16_bf16 v[64:79], v[32:35], a[0:3], v[64:79]
 ds_read_b64_tr_b16 v[48:49], v18 offset:28672
 ds_read_b64_tr_b16 v[50:51], v18 offset:29696
 v_mfma_f32_32x32x16_bf16 v[80:95], v[36:39], a[0:3], v[80:95]
 ds_read_b128 a[8:11], v13 offset:32768
 ds_read_b64_tr_b16 v[52:53], v19 offset:28672
 buffer_store_dwordx4 v[240:243], v30, s[36:39], s64 offen offset:2048 sc1
 buffer_store_dwordx4 v[248:251], v30, s[36:39], s64 offen offset:3072 sc1
 v_mfma_f32_32x32x16_bf16 v[144:159], v[36:39], a[4:7], v[144:159]
 ds_read_b64_tr_b16 v[54:55], v19 offset:29696
 ds_read_b128 a[12:15], v13 offset:36864
 v_mfma_f32_32x32x16_bf16 v[128:143], v[32:35], a[4:7], v[128:143]
 ds_read_b64_tr_b16 v[56:57], v20 offset:28672
 ds_read_b64_tr_b16 v[58:59], v20 offset:29696
 v_mfma_f32_32x32x16_bf16 v[96:111], v[40:43], a[0:3], v[96:111]
 ds_read_b64_tr_b16 v[60:61], v21 offset:28672
 ds_read_b64_tr_b16 v[62:63], v21 offset:29696
 v_mfma_f32_32x32x16_bf16 v[160:175], v[40:43], a[4:7], v[160:175]
 v_mfma_f32_32x32x16_bf16 v[112:127], v[44:47], a[0:3], v[112:127]
 v_mfma_f32_32x32x16_bf16 v[176:191], v[44:47], a[4:7], v[176:191]
 s_waitcnt lgkmcnt(0)
 v_mfma_f32_32x32x16_bf16 v[64:79], v[48:51], a[8:11], v[64:79]
 s_waitcnt vmcnt(16)
 s_barrier
 ds_read_b64_tr_b16 v[32:33], v18 offset:32768
 ds_read_b64_tr_b16 v[34:35], v18 offset:33792
 v_mfma_f32_32x32x16_bf16 v[80:95], v[52:55], a[8:11], v[80:95]
 ds_read_b128 a[0:3], v14
 ds_read_b64_tr_b16 v[36:37], v19 offset:32768
 s_add_u32 m0, s56, 32768
 s_nop 0
 buffer_load_dwordx4 v22, s[40:43], s58 offen lds
 v_mfma_f32_32x32x16_bf16 v[144:159], v[52:55], a[12:15], v[144:159]
 ds_read_b64_tr_b16 v[38:39], v19 offset:33792
 ds_read_b128 a[4:7], v14 offset:4096
 v_mfma_f32_32x32x16_bf16 v[128:143], v[48:51], a[12:15], v[128:143]
 ds_read_b64_tr_b16 v[40:41], v20 offset:32768
 ds_read_b64_tr_b16 v[42:43], v20 offset:33792
 buffer_load_dwordx4 v23, s[40:43], s58 offen offset:1024 lds
 v_mfma_f32_32x32x16_bf16 v[96:111], v[56:59], a[8:11], v[96:111]
 ds_read_b64_tr_b16 v[44:45], v21 offset:32768
 ds_read_b64_tr_b16 v[46:47], v21 offset:33792
 v_mfma_f32_32x32x16_bf16 v[160:175], v[56:59], a[12:15], v[160:175]
 buffer_load_dwordx4 v24, s[40:43], s58 offen offset:2048 lds
 v_mfma_f32_32x32x16_bf16 v[112:127], v[60:63], a[8:11], v[112:127]
 v_mfma_f32_32x32x16_bf16 v[176:191], v[60:63], a[12:15], v[176:191]
 buffer_load_dwordx4 v25, s[40:43], s58 offen offset:3072 lds
 s_add_u32 s58, s58, 128
 s_waitcnt lgkmcnt(0)
 v_mfma_f32_32x32x16_bf16 v[64:79], v[32:35], a[0:3], v[64:79]
 ds_read_b64_tr_b16 v[48:49], v18 offset:36864
 ds_read_b64_tr_b16 v[50:51], v18 offset:37888
 v_mfma_f32_32x32x16_bf16 v[80:95], v[36:39], a[0:3], v[80:95]
 ds_read_b128 a[8:11], v15
 ds_read_b64_tr_b16 v[52:53], v19 offset:36864
 s_add_u32 m0, s56, 36864
 s_nop 0
 buffer_load_dwordx4 v22, s[40:43], s60 offen lds
 v_mfma_f32_32x32x16_bf16 v[144:159], v[36:39], a[4:7], v[144:159]
 ds_read_b64_tr_b16 v[54:55], v19 offset:37888
 ds_read_b128 a[12:15], v15 offset:4096
 v_mfma_f32_32x32x16_bf16 v[128:143], v[32:35], a[4:7], v[128:143]
 ds_read_b64_tr_b16 v[56:57], v20 offset:36864
 ds_read_b64_tr_b16 v[58:59], v20 offset:37888
 buffer_load_dwordx4 v23, s[40:43], s60 offen offset:1024 lds
 v_mfma_f32_32x32x16_bf16 v[96:111], v[40:43], a[0:3], v[96:111]
 ds_read_b64_tr_b16 v[60:61], v21 offset:36864
 ds_read_b64_tr_b16 v[62:63], v21 offset:37888
 v_mfma_f32_32x32x16_bf16 v[160:175], v[40:43], a[4:7], v[160:175]
 buffer_load_dwordx4 v24, s[40:43], s60 offen offset:2048 lds
 v_mfma_f32_32x32x16_bf16 v[112:127], v[44:47], a[0:3], v[112:127]
 v_mfma_f32_32x32x16_bf16 v[176:191], v[44:47], a[4:7], v[176:191]
 buffer_load_dwordx4 v25, s[40:43], s60 offen offset:3072 lds
 s_add_u32 s60, s60, 128
 s_waitcnt lgkmcnt(0)
 v_mfma_f32_32x32x16_bf16 v[64:79], v[48:51], a[8:11], v[64:79]
 ds_read_b64_tr_b16 v[32:33], v18 offset:40960
 ds_read_b64_tr_b16 v[34:35], v18 offset:41984
 v_mfma_f32_32x32x16_bf16 v[80:95], v[52:55], a[8:11], v[80:95]
 ds_read_b128 a[0:3], v16
 ds_read_b64_tr_b16 v[36:37], v19 offset:40960
 s_add_u32 m0, s57, 81920
 s_nop 0
 buffer_load_dwordx4 v26, s[44:47], s62 offen lds
 v_mfma_f32_32x32x16_bf16 v[144:159], v[52:55], a[12:15], v[144:159]
 ds_read_b64_tr_b16 v[38:39], v19 offset:41984
 ds_read_b128 a[4:7], v16 offset:4096
 v_mfma_f32_32x32x16_bf16 v[128:143], v[48:51], a[12:15], v[128:143]
 ds_read_b64_tr_b16 v[40:41], v20 offset:40960
 ds_read_b64_tr_b16 v[42:43], v20 offset:41984
 buffer_load_dwordx4 v27, s[44:47], s62 offen offset:1024 lds
 v_mfma_f32_32x32x16_bf16 v[96:111], v[56:59], a[8:11], v[96:111]
 ds_read_b64_tr_b16 v[44:45], v21 offset:40960
 ds_read_b64_tr_b16 v[46:47], v21 offset:41984
 v_mfma_f32_32x32x16_bf16 v[160:175], v[56:59], a[12:15], v[160:175]
 buffer_load_dwordx4 v28, s[44:47], s62 offen offset:2048 lds
 v_mfma_f32_32x32x16_bf16 v[112:127], v[60:63], a[8:11], v[112:127]
 v_mfma_f32_32x32x16_bf16 v[176:191], v[60:63], a[12:15], v[176:191]
 buffer_load_dwordx4 v29, s[44:47], s62 offen offset:3072 lds
 s_add_u32 s62, s62, 524288
 s_waitcnt lgkmcnt(0)
 v_mfma_f32_32x32x16_bf16 v[64:79], v[32:35], a[0:3], v[64:79]
 ds_read_b64_tr_b16 v[48:49], v18 offset:45056
 ds_read_b64_tr_b16 v[50:51], v18 offset:46080
 v_mfma_f32_32x32x16_bf16 v[80:95], v[36:39], a[0:3], v[80:95]
 ds_read_b128 a[8:11], v17
 ds_read_b64_tr_b16 v[52:53], v19 offset:45056
 v_mfma_f32_32x32x16_bf16 v[144:159], v[36:39], a[4:7], v[144:159]
 ds_read_b64_tr_b16 v[54:55], v19 offset:46080
 ds_read_b128 a[12:15], v17 offset:4096
 v_mfma_f32_32x32x16_bf16 v[128:143], v[32:35], a[4:7], v[128:143]
 ds_read_b64_tr_b16 v[56:57], v20 offset:45056
 ds_read_b64_tr_b16 v[58:59], v20 offset:46080
 v_mfma_f32_32x32x16_bf16 v[96:111], v[40:43], a[0:3], v[96:111]
 ds_read_b64_tr_b16 v[60:61], v21 offset:45056
 ds_read_b64_tr_b16 v[62:63], v21 offset:46080
 v_mfma_f32_32x32x16_bf16 v[160:175], v[40:43], a[4:7], v[160:175]
 s_add_u32 s64, s63, 16789504
 buffer_store_dwordx4 v[228:231], v30, s[36:39], s64 offen sc1
 buffer_store_dwordx4 v[236:239], v30, s[36:39], s64 offen offset:1024 sc1
 v_mfma_f32_32x32x16_bf16 v[112:127], v[44:47], a[0:3], v[112:127]
 v_mfma_f32_32x32x16_bf16 v[176:191], v[44:47], a[4:7], v[176:191]
 buffer_store_dwordx4 v[244:247], v30, s[36:39], s64 offen offset:2048 sc1
 buffer_store_dwordx4 v[252:255], v30, s[36:39], s64 offen offset:3072 sc1
 s_waitcnt lgkmcnt(0)
 v_mfma_f32_32x32x16_bf16 v[64:79], v[48:51], a[8:11], v[64:79]
 s_waitcnt vmcnt(18)
 s_barrier
 ds_read_b64_tr_b16 v[32:33], v18
 ds_read_b64_tr_b16 v[34:35], v18 offset:1024
 v_mfma_f32_32x32x16_bf16 v[80:95], v[52:55], a[8:11], v[80:95]
 ds_read_b128 a[0:3], v10
 ds_read_b64_tr_b16 v[36:37], v19
 s_add_u32 m0, s56, 131072
 s_nop 0
 buffer_load_dwordx4 v22, s[40:43], s58 offen lds
 v_mfma_f32_32x32x16_bf16 v[144:159], v[52:55], a[12:15], v[144:159]
 ds_read_b64_tr_b16 v[38:39], v19 offset:1024
 ds_read_b128 a[4:7], v10 offset:4096
 v_mfma_f32_32x32x16_bf16 v[128:143], v[48:51], a[12:15], v[128:143]
 ds_read_b64_tr_b16 v[40:41], v20
 ds_read_b64_tr_b16 v[42:43], v20 offset:1024
 buffer_load_dwordx4 v23, s[40:43], s58 offen offset:1024 lds
 v_mfma_f32_32x32x16_bf16 v[96:111], v[56:59], a[8:11], v[96:111]
 ds_read_b64_tr_b16 v[44:45], v21
 ds_read_b64_tr_b16 v[46:47], v21 offset:1024
 v_mfma_f32_32x32x16_bf16 v[160:175], v[56:59], a[12:15], v[160:175]
 buffer_load_dwordx4 v24, s[40:43], s58 offen offset:2048 lds
 v_mfma_f32_32x32x16_bf16 v[112:127], v[60:63], a[8:11], v[112:127]
 v_mfma_f32_32x32x16_bf16 v[176:191], v[60:63], a[12:15], v[176:191]
 buffer_load_dwordx4 v25, s[40:43], s58 offen offset:3072 lds
 s_add_u32 s58, s58, 128
 s_waitcnt lgkmcnt(0)
 v_mfma_f32_32x32x16_bf16 v[64:79], v[32:35], a[0:3], v[64:79]
 ds_read_b64_tr_b16 v[48:49], v18 offset:4096
 ds_read_b64_tr_b16 v[50:51], v18 offset:5120
 v_mfma_f32_32x32x16_bf16 v[80:95], v[36:39], a[0:3], v[80:95]
 ds_read_b128 a[8:11], v11
 ds_read_b64_tr_b16 v[52:53], v19 offset:4096
 s_add_u32 m0, s56, 135168
 s_nop 0
 buffer_load_dwordx4 v22, s[40:43], s60 offen lds
 v_mfma_f32_32x32x16_bf16 v[144:159], v[36:39], a[4:7], v[144:159]
 ds_read_b64_tr_b16 v[54:55], v19 offset:5120
 ds_read_b128 a[12:15], v11 offset:4096
 v_mfma_f32_32x32x16_bf16 v[128:143], v[32:35], a[4:7], v[128:143]
 ds_read_b64_tr_b16 v[56:57], v20 offset:4096
 ds_read_b64_tr_b16 v[58:59], v20 offset:5120
 buffer_load_dwordx4 v23, s[40:43], s60 offen offset:1024 lds
 v_mfma_f32_32x32x16_bf16 v[96:111], v[40:43], a[0:3], v[96:111]
 ds_read_b64_tr_b16 v[60:61], v21 offset:4096
 ds_read_b64_tr_b16 v[62:63], v21 offset:5120
 v_mfma_f32_32x32x16_bf16 v[160:175], v[40:43], a[4:7], v[160:175]
 buffer_load_dwordx4 v24, s[40:43], s60 offen offset:2048 lds
 v_mfma_f32_32x32x16_bf16 v[112:127], v[44:47], a[0:3], v[112:127]
 v_mfma_f32_32x32x16_bf16 v[176:191], v[44:47], a[4:7], v[176:191]
 buffer_load_dwordx4 v25, s[40:43], s60 offen offset:3072 lds
 s_add_u32 s60, s60, 128
 s_waitcnt lgkmcnt(0)
 v_mfma_f32_32x32x16_bf16 v[64:79], v[48:51], a[8:11], v[64:79]
 ds_read_b64_tr_b16 v[32:33], v18 offset:8192
 ds_read_b64_tr_b16 v[34:35], v18 offset:9216
 v_mfma_f32_32x32x16_bf16 v[80:95], v[52:55], a[8:11], v[80:95]
 ds_read_b128 a[0:3], v12
 ds_read_b64_tr_b16 v[36:37], v19 offset:8192
 s_add_u32 m0, s57, 98304
 s_nop 0
 buffer_load_dwordx4 v26, s[44:47], s62 offen lds
 v_mfma_f32_32x32x16_bf16 v[144:159], v[52:55], a[12:15], v[144:159]
 ds_read_b64_tr_b16 v[38:39], v19 offset:9216
 ds_read_b128 a[4:7], v12 offset:4096
 v_mfma_f32_32x32x16_bf16 v[128:143], v[48:51], a[12:15], v[128:143]
 ds_read_b64_tr_b16 v[40:41], v20 offset:8192
 ds_read_b64_tr_b16 v[42:43], v20 offset:9216
 buffer_load_dwordx4 v27, s[44:47], s62 offen offset:1024 lds
 v_mfma_f32_32x32x16_bf16 v[96:111], v[56:59], a[8:11], v[96:111]
 ds_read_b64_tr_b16 v[44:45], v21 offset:8192
 ds_read_b64_tr_b16 v[46:47], v21 offset:9216
 v_mfma_f32_32x32x16_bf16 v[160:175], v[56:59], a[12:15], v[160:175]
 buffer_load_dwordx4 v28, s[44:47], s62 offen offset:2048 lds
 v_mfma_f32_32x32x16_bf16 v[112:127], v[60:63], a[8:11], v[112:127]
 v_mfma_f32_32x32x16_bf16 v[176:191], v[60:63], a[12:15], v[176:191]
 buffer_load_dwordx4 v29, s[44:47], s62 offen offset:3072 lds
 s_add_u32 s62, s62, 524288
 s_waitcnt lgkmcnt(0)
 v_mfma_f32_32x32x16_bf16 v[64:79], v[32:35], a[0:3], v[64:79]
 ds_read_b64_tr_b16 v[48:49], v18 offset:12288
 ds_read_b64_tr_b16 v[50:51], v18 offset:13312
 s_mov_b32 s48, s4
 s_mov_b32 s49, s5
 s_mov_b32 s50, 2359296
 v_mfma_f32_32x32x16_bf16 v[80:95], v[36:39], a[0:3], v[80:95]
 ds_read_b128 a[8:11], v13
 ds_read_b64_tr_b16 v[52:53], v19 offset:12288
 s_mov_b32 s51, 0x20000
 s_lshl_b32 s54, s28, 5
 s_mov_b32 s53, 1152
 v_mfma_f32_32x32x16_bf16 v[144:159], v[36:39], a[4:7], v[144:159]
 ds_read_b64_tr_b16 v[54:55], v19 offset:13312
 ds_read_b128 a[12:15], v13 offset:4096
 v_add_u32 v9, 0, v8
 v_and_b32 v9, 7, v9
 v_and_b32 v236, 7, v1
 v_mfma_f32_32x32x16_bf16 v[128:143], v[32:35], a[4:7], v[128:143]
 ds_read_b64_tr_b16 v[56:57], v20 offset:12288
 ds_read_b64_tr_b16 v[58:59], v20 offset:13312
 v_xor_b32 v9, v9, v236
 v_lshlrev_b32 v9, 4, v9
 s_add_u32 s52, s54, 0
 v_mfma_f32_32x32x16_bf16 v[96:111], v[40:43], a[0:3], v[96:111]
 ds_read_b64_tr_b16 v[60:61], v21 offset:12288
 ds_read_b64_tr_b16 v[62:63], v21 offset:13312
 v_add_u32 v236, s52, v7
 v_mul_lo_u32 v236, v236, s53
 v_add_u32 v236, v236, v9
 v_mfma_f32_32x32x16_bf16 v[160:175], v[40:43], a[4:7], v[160:175]
 s_add_u32 s64, s63, 16777216
 buffer_store_dwordx4 v[192:195], v30, s[36:39], s64 offen sc1
 buffer_store_dwordx4 v[200:203], v30, s[36:39], s64 offen offset:1024 sc1
 v_mfma_f32_32x32x16_bf16 v[112:127], v[44:47], a[0:3], v[112:127]
 v_add_u32 v9, 4, v8
 v_and_b32 v9, 7, v9
 v_and_b32 v237, 7, v1
 v_xor_b32 v9, v9, v237
 v_lshlrev_b32 v9, 4, v9
 v_mfma_f32_32x32x16_bf16 v[176:191], v[44:47], a[4:7], v[176:191]
 s_add_u32 s52, s54, 8
 v_add_u32 v237, s52, v7
 v_mul_lo_u32 v237, v237, s53
 v_add_u32 v237, v237, v9
 v_subrev_u32 v237, 1024, v237
 s_waitcnt lgkmcnt(0)
 v_mfma_f32_32x32x16_bf16 v[64:79], v[48:51], a[8:11], v[64:79]
 s_waitcnt vmcnt(18)
 s_barrier
 ds_read_b64_tr_b16 v[32:33], v18 offset:16384
 ds_read_b64_tr_b16 v[34:35], v18 offset:17408
 v_add_u32 v9, 0, v8
 v_mfma_f32_32x32x16_bf16 v[80:95], v[52:55], a[8:11], v[80:95]
 ds_read_b128 a[0:3], v10 offset:32768
 ds_read_b64_tr_b16 v[36:37], v19 offset:16384
 s_add_u32 m0, s56, 0
 s_nop 0
 buffer_load_dwordx4 v22, s[40:43], s58 offen lds
 v_mfma_f32_32x32x16_bf16 v[144:159], v[52:55], a[12:15], v[144:159]
 ds_read_b64_tr_b16 v[38:39], v19 offset:17408
 ds_read_b128 a[4:7], v10 offset:36864
 v_and_b32 v9, 7, v9
 v_and_b32 v238, 7, v1
 v_xor_b32 v9, v9, v238
 v_mfma_f32_32x32x16_bf16 v[128:143], v[48:51], a[12:15], v[128:143]
 ds_read_b64_tr_b16 v[40:41], v20 offset:16384
 ds_read_b64_tr_b16 v[42:43], v20 offset:17408
 buffer_load_dwordx4 v23, s[40:43], s58 offen offset:1024 lds
 v_lshlrev_b32 v9, 4, v9
 v_mfma_f32_32x32x16_bf16 v[96:111], v[56:59], a[8:11], v[96:111]
 ds_read_b64_tr_b16 v[44:45], v21 offset:16384
 ds_read_b64_tr_b16 v[46:47], v21 offset:17408
 s_add_u32 s52, s54, 16
 v_add_u32 v238, s52, v7
 v_mul_lo_u32 v238, v238, s53
 v_mfma_f32_32x32x16_bf16 v[160:175], v[56:59], a[12:15], v[160:175]
 buffer_load_dwordx4 v24, s[40:43], s58 offen offset:2048 lds
 v_add_u32 v238, v238, v9
 v_subrev_u32 v238, 2048, v238
 v_add_u32 v9, 4, v8
 v_mfma_f32_32x32x16_bf16 v[112:127], v[60:63], a[8:11], v[112:127]
 v_and_b32 v9, 7, v9
 v_and_b32 v239, 7, v1
 v_xor_b32 v9, v9, v239
 v_lshlrev_b32 v9, 4, v9
 s_add_u32 s52, s54, 24
 v_mfma_f32_32x32x16_bf16 v[176:191], v[60:63], a[12:15], v[176:191]
 buffer_load_dwordx4 v25, s[40:43], s58 offen offset:3072 lds
 s_add_u32 s58, s58, 128
 v_add_u32 v239, s52, v7
 v_mul_lo_u32 v239, v239, s53
 s_waitcnt lgkmcnt(0)
 v_mfma_f32_32x32x16_bf16 v[64:79], v[32:35], a[0:3], v[64:79]
 ds_read_b64_tr_b16 v[48:49], v18 offset:20480
 ds_read_b64_tr_b16 v[50:51], v18 offset:21504
 v_add_u32 v239, v239, v9
 v_subrev_u32 v239, 3072, v239
 s_lshl_b32 s54, s28, 4
 v_mfma_f32_32x32x16_bf16 v[80:95], v[36:39], a[0:3], v[80:95]
 ds_read_b128 a[8:11], v11 offset:32768
 ds_read_b64_tr_b16 v[52:53], v19 offset:20480
 s_add_u32 m0, s56, 4096
 s_nop 0
 buffer_load_dwordx4 v22, s[40:43], s60 offen lds
 v_mfma_f32_32x32x16_bf16 v[144:159], v[36:39], a[4:7], v[144:159]
 ds_read_b64_tr_b16 v[54:55], v19 offset:21504
 ds_read_b128 a[12:15], v11 offset:36864
 s_mov_b32 s53, 3456
 v_lshlrev_b32 v9, 2, v8
 v_and_b32 v240, 15, v1
 v_mfma_f32_32x32x16_bf16 v[128:143], v[32:35], a[4:7], v[128:143]
 ds_read_b64_tr_b16 v[56:57], v20 offset:20480
 ds_read_b64_tr_b16 v[58:59], v20 offset:21504
 buffer_load_dwordx4 v23, s[40:43], s60 offen offset:1024 lds
 v_xor_b32 v9, v9, v240
 v_mfma_f32_32x32x16_bf16 v[96:111], v[40:43], a[0:3], v[96:111]
 ds_read_b64_tr_b16 v[60:61], v21 offset:20480
 ds_read_b64_tr_b16 v[62:63], v21 offset:21504
 v_lshlrev_b32 v9, 4, v9
 s_add_u32 s52, s54, 0
 v_add_u32 v240, s52, v8
 v_mfma_f32_32x32x16_bf16 v[160:175], v[40:43], a[4:7], v[160:175]
 buffer_load_dwordx4 v24, s[40:43], s60 offen offset:2048 lds
 v_mul_lo_u32 v240, v240, s53
 v_add_u32 v240, v240, v9
 s_add_u32 s52, s54, 4
 v_mfma_f32_32x32x16_bf16 v[112:127], v[44:47], a[0:3], v[112:127]
 v_add_u32 v241, s52, v8
 v_mul_lo_u32 v241, v241, s53
 v_add_u32 v241, v241, v9
 v_subrev_u32 v241, 1024, v241
 s_add_u32 s52, s54, 8
 v_mfma_f32_32x32x16_bf16 v[176:191], v[44:47], a[4:7], v[176:191]
 buffer_load_dwordx4 v25, s[40:43], s60 offen offset:3072 lds
 s_add_u32 s60, s60, 128
 v_add_u32 v242, s52, v8
 v_mul_lo_u32 v242, v242, s53
 s_waitcnt lgkmcnt(0)
 v_mfma_f32_32x32x16_bf16 v[64:79], v[48:51], a[8:11], v[64:79]
 ds_read_b64_tr_b16 v[32:33], v18 offset:24576
 ds_read_b64_tr_b16 v[34:35], v18 offset:25600
 v_add_u32 v242, v242, v9
 v_subrev_u32 v242, 2048, v242
 s_add_u32 s52, s54, 12
 v_mfma_f32_32x32x16_bf16 v[80:95], v[52:55], a[8:11], v[80:95]
 ds_read_b128 a[0:3], v12 offset:32768
 ds_read_b64_tr_b16 v[36:37], v19 offset:24576
 s_add_u32 m0, s57, 65536
 s_nop 0
 buffer_load_dwordx4 v26, s[44:47], s62 offen lds
 v_mfma_f32_32x32x16_bf16 v[144:159], v[52:55], a[12:15], v[144:159]
 ds_read_b64_tr_b16 v[38:39], v19 offset:25600
 ds_read_b128 a[4:7], v12 offset:36864
 v_add_u32 v243, s52, v8
 v_mul_lo_u32 v243, v243, s53
 v_add_u32 v243, v243, v9
 v_mfma_f32_32x32x16_bf16 v[128:143], v[48:51], a[12:15], v[128:143]
 ds_read_b64_tr_b16 v[40:41], v20 offset:24576
 ds_read_b64_tr_b16 v[42:43], v20 offset:25600
 buffer_load_dwordx4 v27, s[44:47], s62 offen offset:1024 lds
 v_subrev_u32 v243, 3072, v243
 v_mfma_f32_32x32x16_bf16 v[96:111], v[56:59], a[8:11], v[96:111]
 ds_read_b64_tr_b16 v[44:45], v21 offset:24576
 ds_read_b64_tr_b16 v[46:47], v21 offset:25600
 s_lshr_b32 s54, s28, 1
 s_lshl_b32 s54, s54, 13
 v_bfe_u32 v9, v2, 1, 3
 v_mfma_f32_32x32x16_bf16 v[160:175], v[56:59], a[12:15], v[160:175]
 buffer_load_dwordx4 v28, s[44:47], s62 offen offset:2048 lds
 v_add_u32 v248, 0, v3
 v_xor_b32 v248, v248, v9
 v_lshlrev_b32 v248, 4, v248
 v_mfma_f32_32x32x16_bf16 v[112:127], v[60:63], a[8:11], v[112:127]
 v_lshl_add_u32 v248, v2, 7, v248
 v_add_u32 v248, s54, v248
 v_add_u32 v244, 0, v248
 v_add_u32 v248, 65536, v248
 v_add_u32 v249, 2, v3
 v_mfma_f32_32x32x16_bf16 v[176:191], v[60:63], a[12:15], v[176:191]
 buffer_load_dwordx4 v29, s[44:47], s62 offen offset:3072 lds
 s_add_u32 s62, s62, 524288
 v_xor_b32 v249, v249, v9
 v_lshlrev_b32 v249, 4, v249
 s_waitcnt lgkmcnt(0)
 v_mfma_f32_32x32x16_bf16 v[64:79], v[32:35], a[0:3], v[64:79]
 ds_read_b64_tr_b16 v[48:49], v18 offset:28672
 ds_read_b64_tr_b16 v[50:51], v18 offset:29696
 v_lshl_add_u32 v249, v2, 7, v249
 v_add_u32 v249, s54, v249
 v_add_u32 v245, 0, v249
 v_mfma_f32_32x32x16_bf16 v[80:95], v[36:39], a[0:3], v[80:95]
 ds_read_b128 a[8:11], v13 offset:32768
 ds_read_b64_tr_b16 v[52:53], v19 offset:28672
 buffer_store_dwordx4 v[208:211], v30, s[36:39], s64 offen offset:2048 sc1
 buffer_store_dwordx4 v[216:219], v30, s[36:39], s64 offen offset:3072 sc1
 v_mfma_f32_32x32x16_bf16 v[144:159], v[36:39], a[4:7], v[144:159]
 ds_read_b64_tr_b16 v[54:55], v19 offset:29696
 ds_read_b128 a[12:15], v13 offset:36864
 v_add_u32 v249, 65536, v249
 v_add_u32 v250, 4, v3
 v_xor_b32 v250, v250, v9
 v_mfma_f32_32x32x16_bf16 v[128:143], v[32:35], a[4:7], v[128:143]
 ds_read_b64_tr_b16 v[56:57], v20 offset:28672
 ds_read_b64_tr_b16 v[58:59], v20 offset:29696
 v_lshlrev_b32 v250, 4, v250
 v_lshl_add_u32 v250, v2, 7, v250
 v_add_u32 v250, s54, v250
 v_mfma_f32_32x32x16_bf16 v[96:111], v[40:43], a[0:3], v[96:111]
 ds_read_b64_tr_b16 v[60:61], v21 offset:28672
 ds_read_b64_tr_b16 v[62:63], v21 offset:29696
 v_add_u32 v246, 0, v250
 v_add_u32 v250, 65536, v250
 v_add_u32 v251, 6, v3
 v_mfma_f32_32x32x16_bf16 v[160:175], v[40:43], a[4:7], v[160:175]
 v_xor_b32 v251, v251, v9
 v_lshlrev_b32 v251, 4, v251
 v_lshl_add_u32 v251, v2, 7, v251
 v_add_u32 v251, s54, v251
 v_add_u32 v247, 0, v251
 v_mfma_f32_32x32x16_bf16 v[112:127], v[44:47], a[0:3], v[112:127]
 v_add_u32 v251, 65536, v251
 s_and_b32 s55, s28, 1
 s_lshl_b32 s55, s55, 1
 v_lshlrev_b32 v9, 3, v3
 v_add_u32 v9, v9, v4
 v_mfma_f32_32x32x16_bf16 v[176:191], v[44:47], a[4:7], v[176:191]
 v_lshlrev_b32 v9, 8, v9
 v_lshl_add_u32 v9, v5, 5, v9
 v_lshl_add_u32 v9, v6, 3, v9
 s_add_u32 s52, s55, 0
 v_xor_b32 v254, s52, v4
 s_waitcnt lgkmcnt(0)
 v_mfma_f32_32x32x16_bf16 v[64:79], v[48:51], a[8:11], v[64:79]
 s_waitcnt vmcnt(16)
 s_barrier
 ds_read_b64_tr_b16 v[32:33], v18 offset:32768
 ds_read_b64_tr_b16 v[34:35], v18 offset:33792
 v_lshl_add_u32 v254, v254, 6, v9
 v_mfma_f32_32x32x16_bf16 v[80:95], v[52:55], a[8:11], v[80:95]
 ds_read_b128 a[0:3], v14
 ds_read_b64_tr_b16 v[36:37], v19 offset:32768
 s_add_u32 m0, s56, 32768
 s_nop 0
 buffer_load_dwordx4 v22, s[40:43], s58 offen lds
 v_mfma_f32_32x32x16_bf16 v[144:159], v[52:55], a[12:15], v[144:159]
 ds_read_b64_tr_b16 v[38:39], v19 offset:33792
 ds_read_b128 a[4:7], v14 offset:4096
 v_add_u32 v252, 0, v254
 v_add_u32 v254, 65536, v254
 s_add_u32 s52, s55, 1
 v_mfma_f32_32x32x16_bf16 v[128:143], v[48:51], a[12:15], v[128:143]
 ds_read_b64_tr_b16 v[40:41], v20 offset:32768
 ds_read_b64_tr_b16 v[42:43], v20 offset:33792
 buffer_load_dwordx4 v23, s[40:43], s58 offen offset:1024 lds
 v_xor_b32 v255, s52, v4
 v_mfma_f32_32x32x16_bf16 v[96:111], v[56:59], a[8:11], v[96:111]
 ds_read_b64_tr_b16 v[44:45], v21 offset:32768
 ds_read_b64_tr_b16 v[46:47], v21 offset:33792
 v_lshl_add_u32 v255, v255, 6, v9
 v_add_u32 v253, 0, v255
 v_add_u32 v255, 65536, v255
 v_mfma_f32_32x32x16_bf16 v[160:175], v[56:59], a[12:15], v[160:175]
 buffer_load_dwordx4 v24, s[40:43], s58 offen offset:2048 lds
 s_and_b32 s52, s28, 1
 s_lshl_b32 s52, s52, 6
 s_lshl_b32 s71, s69, 7
 v_mfma_f32_32x32x16_bf16 v[112:127], v[60:63], a[8:11], v[112:127]
 s_add_u32 s71, s71, s52
 s_mov_b32 s34, 163840
 s_cmp_lt_u32 s71, 576
 s_cmov_b32 s34, 73728
 s_cselect_b32 s52, 0, 576
 v_mfma_f32_32x32x16_bf16 v[176:191], v[60:63], a[12:15], v[176:191]
 buffer_load_dwordx4 v25, s[40:43], s58 offen offset:3072 lds
 s_add_u32 s58, s58, 128
 s_sub_u32 s52, s71, s52
 s_mov_b32 s53, 3641
 s_waitcnt lgkmcnt(0)
 v_mfma_f32_32x32x16_bf16 v[64:79], v[32:35], a[0:3], v[64:79]
 ds_read_b64_tr_b16 v[48:49], v18 offset:36864
 ds_read_b64_tr_b16 v[50:51], v18 offset:37888
 v_lshlrev_b32 v224, 4, v2
 v_lshlrev_b32 v225, 2, v2
 v_lshlrev_b32 v226, 2, v3
 v_mfma_f32_32x32x16_bf16 v[80:95], v[36:39], a[0:3], v[80:95]
 ds_read_b128 a[8:11], v15
 ds_read_b64_tr_b16 v[52:53], v19 offset:36864
 s_add_u32 m0, s56, 36864
 s_nop 0
 buffer_load_dwordx4 v22, s[40:43], s60 offen lds
 v_mfma_f32_32x32x16_bf16 v[144:159], v[36:39], a[4:7], v[144:159]
 ds_read_b64_tr_b16 v[54:55], v19 offset:37888
 ds_read_b128 a[12:15], v15 offset:4096
 v_add_u32 v226, s52, v226
 v_mov_b32 v227, 0x80000000
 v_mov_b32 v231, 0x80000000
 v_mfma_f32_32x32x16_bf16 v[128:143], v[32:35], a[4:7], v[128:143]
 ds_read_b64_tr_b16 v[56:57], v20 offset:36864
 ds_read_b64_tr_b16 v[58:59], v20 offset:37888
 buffer_load_dwordx4 v23, s[40:43], s60 offen offset:1024 lds
 v_add_u32 v228, 0, v226
 v_mfma_f32_32x32x16_bf16 v[96:111], v[40:43], a[0:3], v[96:111]
 ds_read_b64_tr_b16 v[60:61], v21 offset:36864
 ds_read_b64_tr_b16 v[62:63], v21 offset:37888
 v_mul_lo_u32 v229, v228, s53
 v_lshrrev_b32 v229, 16, v229
 v_mul_u32_u24 v232, 18, v229
 v_mfma_f32_32x32x16_bf16 v[160:175], v[40:43], a[4:7], v[160:175]
 buffer_load_dwordx4 v24, s[40:43], s60 offen offset:2048 lds
 v_sub_u32 v232, v228, v232
 v_mul_lo_u32 v229, v229, s34
 v_cmp_eq_u32 vcc, 16, v232
 v_mfma_f32_32x32x16_bf16 v[112:127], v[44:47], a[0:3], v[112:127]
 v_add_u32 v228, v229, v225
 v_bfe_u32 v230, v232, 2, 1
 v_cndmask_b32 v231, v231, v228, vcc
 v_cmp_gt_u32 vcc, 8, v232
 v_lshlrev_b32 v230, 9, v230
 v_mfma_f32_32x32x16_bf16 v[176:191], v[44:47], a[4:7], v[176:191]
 buffer_load_dwordx4 v25, s[40:43], s60 offen offset:3072 lds
 s_add_u32 s60, s60, 128
 v_add3_u32 v230, v230, v229, v224
 v_cndmask_b32 v233, v227, v230, vcc
 s_waitcnt lgkmcnt(0)
 v_mfma_f32_32x32x16_bf16 v[64:79], v[48:51], a[8:11], v[64:79]
 ds_read_b64_tr_b16 v[32:33], v18 offset:40960
 ds_read_b64_tr_b16 v[34:35], v18 offset:41984
 v_accvgpr_write_b32 a139, v232
 v_accvgpr_write_b32 a128, v233
 v_add_u32 v228, -8, v232
 v_mfma_f32_32x32x16_bf16 v[80:95], v[52:55], a[8:11], v[80:95]
 ds_read_b128 a[0:3], v16
 ds_read_b64_tr_b16 v[36:37], v19 offset:40960
 s_add_u32 m0, s57, 81920
 s_nop 0
 buffer_load_dwordx4 v26, s[44:47], s62 offen lds
 v_mfma_f32_32x32x16_bf16 v[144:159], v[52:55], a[12:15], v[144:159]
 ds_read_b64_tr_b16 v[38:39], v19 offset:41984
 ds_read_b128 a[4:7], v16 offset:4096
 v_cmp_gt_u32 vcc, 8, v228
 v_add_u32 v230, 8, v230
 s_nop 0
 v_mfma_f32_32x32x16_bf16 v[128:143], v[48:51], a[12:15], v[128:143]
 ds_read_b64_tr_b16 v[40:41], v20 offset:40960
 ds_read_b64_tr_b16 v[42:43], v20 offset:41984
 buffer_load_dwordx4 v27, s[44:47], s62 offen offset:1024 lds
 v_cndmask_b32 v233, v227, v230, vcc
 v_mfma_f32_32x32x16_bf16 v[96:111], v[56:59], a[8:11], v[96:111]
 ds_read_b64_tr_b16 v[44:45], v21 offset:40960
 ds_read_b64_tr_b16 v[46:47], v21 offset:41984
 v_accvgpr_write_b32 a135, v233
 v_add_u32 v228, 8, v226
 v_mul_lo_u32 v229, v228, s53
 v_mfma_f32_32x32x16_bf16 v[160:175], v[56:59], a[12:15], v[160:175]
 buffer_load_dwordx4 v28, s[44:47], s62 offen offset:2048 lds
 v_lshrrev_b32 v229, 16, v229
 v_mul_u32_u24 v232, 18, v229
 v_sub_u32 v232, v228, v232
 v_mfma_f32_32x32x16_bf16 v[112:127], v[60:63], a[8:11], v[112:127]
 v_mul_lo_u32 v229, v229, s34
 v_cmp_eq_u32 vcc, 16, v232
 v_add_u32 v228, v229, v225
 v_bfe_u32 v230, v232, 2, 1
 v_cndmask_b32 v231, v231, v228, vcc
 v_mfma_f32_32x32x16_bf16 v[176:191], v[60:63], a[12:15], v[176:191]
 buffer_load_dwordx4 v29, s[44:47], s62 offen offset:3072 lds
 s_add_u32 s62, s62, 524288
 v_cmp_gt_u32 vcc, 8, v232
 v_lshlrev_b32 v230, 9, v230
 s_waitcnt lgkmcnt(0)
 v_mfma_f32_32x32x16_bf16 v[64:79], v[32:35], a[0:3], v[64:79]
 ds_read_b64_tr_b16 v[48:49], v18 offset:45056
 ds_read_b64_tr_b16 v[50:51], v18 offset:46080
 v_add3_u32 v230, v230, v229, v224
 v_cndmask_b32 v233, v227, v230, vcc
 v_accvgpr_write_b32 a140, v232
 v_mfma_f32_32x32x16_bf16 v[80:95], v[36:39], a[0:3], v[80:95]
 ds_read_b128 a[8:11], v17
 ds_read_b64_tr_b16 v[52:53], v19 offset:45056
 v_accvgpr_write_b32 a129, v233
 v_add_u32 v228, 16, v226
 v_mul_lo_u32 v229, v228, s53
 v_mfma_f32_32x32x16_bf16 v[144:159], v[36:39], a[4:7], v[144:159]
 ds_read_b64_tr_b16 v[54:55], v19 offset:46080
 ds_read_b128 a[12:15], v17 offset:4096
 v_lshrrev_b32 v229, 16, v229
 v_mul_u32_u24 v232, 18, v229
 v_sub_u32 v232, v228, v232
 v_mfma_f32_32x32x16_bf16 v[128:143], v[32:35], a[4:7], v[128:143]
 ds_read_b64_tr_b16 v[56:57], v20 offset:45056
 ds_read_b64_tr_b16 v[58:59], v20 offset:46080
 v_mul_lo_u32 v229, v229, s34
 v_cmp_eq_u32 vcc, 16, v232
 v_add_u32 v228, v229, v225
 v_mfma_f32_32x32x16_bf16 v[96:111], v[40:43], a[0:3], v[96:111]
 ds_read_b64_tr_b16 v[60:61], v21 offset:45056
 ds_read_b64_tr_b16 v[62:63], v21 offset:46080
 v_bfe_u32 v230, v232, 2, 1
 v_cndmask_b32 v231, v231, v228, vcc
 v_cmp_gt_u32 vcc, 8, v232
 v_mfma_f32_32x32x16_bf16 v[160:175], v[40:43], a[4:7], v[160:175]
 s_add_u32 s64, s63, 16781312
 buffer_store_dwordx4 v[196:199], v30, s[36:39], s64 offen sc1
 buffer_store_dwordx4 v[204:207], v30, s[36:39], s64 offen offset:1024 sc1
 v_mfma_f32_32x32x16_bf16 v[112:127], v[44:47], a[0:3], v[112:127]
 v_lshlrev_b32 v230, 9, v230
 v_add3_u32 v230, v230, v229, v224
 v_cndmask_b32 v233, v227, v230, vcc
 v_accvgpr_write_b32 a141, v232
 v_accvgpr_write_b32 a130, v233
 v_mfma_f32_32x32x16_bf16 v[176:191], v[44:47], a[4:7], v[176:191]
 v_add_u32 v228, 24, v226
 v_mul_lo_u32 v229, v228, s53
 v_lshrrev_b32 v229, 16, v229
 v_mul_u32_u24 v232, 18, v229
 v_sub_u32 v232, v228, v232
 s_waitcnt lgkmcnt(0)
 v_mfma_f32_32x32x16_bf16 v[64:79], v[48:51], a[8:11], v[64:79]
 s_waitcnt vmcnt(16)
 s_barrier
 ds_read_b64_tr_b16 v[32:33], v18
 ds_read_b64_tr_b16 v[34:35], v18 offset:1024
 v_mul_lo_u32 v229, v229, s34
 v_mfma_f32_32x32x16_bf16 v[80:95], v[52:55], a[8:11], v[80:95]
 ds_read_b128 a[0:3], v10
 ds_read_b64_tr_b16 v[36:37], v19
 s_add_u32 m0, s56, 131072
 s_nop 0
 buffer_load_dwordx4 v22, s[40:43], s58 offen lds
 v_mfma_f32_32x32x16_bf16 v[144:159], v[52:55], a[12:15], v[144:159]
 ds_read_b64_tr_b16 v[38:39], v19 offset:1024
 ds_read_b128 a[4:7], v10 offset:4096
 v_cmp_eq_u32 vcc, 16, v232
 v_add_u32 v228, v229, v225
 v_bfe_u32 v230, v232, 2, 1
 v_mfma_f32_32x32x16_bf16 v[128:143], v[48:51], a[12:15], v[128:143]
 ds_read_b64_tr_b16 v[40:41], v20
 ds_read_b64_tr_b16 v[42:43], v20 offset:1024
 buffer_load_dwordx4 v23, s[40:43], s58 offen offset:1024 lds
 v_cndmask_b32 v231, v231, v228, vcc
 v_mfma_f32_32x32x16_bf16 v[96:111], v[56:59], a[8:11], v[96:111]
 ds_read_b64_tr_b16 v[44:45], v21
 ds_read_b64_tr_b16 v[46:47], v21 offset:1024
 v_cmp_gt_u32 vcc, 8, v232
 v_lshlrev_b32 v230, 9, v230
 v_add3_u32 v230, v230, v229, v224
 v_mfma_f32_32x32x16_bf16 v[160:175], v[56:59], a[12:15], v[160:175]
 buffer_load_dwordx4 v24, s[40:43], s58 offen offset:2048 lds
 v_cndmask_b32 v233, v227, v230, vcc
 v_accvgpr_write_b32 a142, v232
 v_accvgpr_write_b32 a131, v233
 v_mfma_f32_32x32x16_bf16 v[112:127], v[60:63], a[8:11], v[112:127]
 v_add_u32 v228, 32, v226
 v_mul_lo_u32 v229, v228, s53
 v_lshrrev_b32 v229, 16, v229
 v_mul_u32_u24 v232, 18, v229
 v_sub_u32 v232, v228, v232
 v_mfma_f32_32x32x16_bf16 v[176:191], v[60:63], a[12:15], v[176:191]
 buffer_load_dwordx4 v25, s[40:43], s58 offen offset:3072 lds
 s_add_u32 s58, s58, 128
 v_mul_lo_u32 v229, v229, s34
 v_cmp_eq_u32 vcc, 16, v232
 s_waitcnt lgkmcnt(0)
 v_mfma_f32_32x32x16_bf16 v[64:79], v[32:35], a[0:3], v[64:79]
 ds_read_b64_tr_b16 v[48:49], v18 offset:4096
 ds_read_b64_tr_b16 v[50:51], v18 offset:5120
 v_add_u32 v228, v229, v225
 v_bfe_u32 v230, v232, 2, 1
 v_cndmask_b32 v231, v231, v228, vcc
 v_mfma_f32_32x32x16_bf16 v[80:95], v[36:39], a[0:3], v[80:95]
 ds_read_b128 a[8:11], v11
 ds_read_b64_tr_b16 v[52:53], v19 offset:4096
 s_add_u32 m0, s56, 135168
 s_nop 0
 buffer_load_dwordx4 v22, s[40:43], s60 offen lds
 v_mfma_f32_32x32x16_bf16 v[144:159], v[36:39], a[4:7], v[144:159]
 ds_read_b64_tr_b16 v[54:55], v19 offset:5120
 ds_read_b128 a[12:15], v11 offset:4096
 v_cmp_gt_u32 vcc, 8, v232
 v_lshlrev_b32 v230, 9, v230
 v_add3_u32 v230, v230, v229, v224
 v_mfma_f32_32x32x16_bf16 v[128:143], v[32:35], a[4:7], v[128:143]
 ds_read_b64_tr_b16 v[56:57], v20 offset:4096
 ds_read_b64_tr_b16 v[58:59], v20 offset:5120
 buffer_load_dwordx4 v23, s[40:43], s60 offen offset:1024 lds
 v_cndmask_b32 v233, v227, v230, vcc
 v_mfma_f32_32x32x16_bf16 v[96:111], v[40:43], a[0:3], v[96:111]
 ds_read_b64_tr_b16 v[60:61], v21 offset:4096
 ds_read_b64_tr_b16 v[62:63], v21 offset:5120
 v_accvgpr_write_b32 a143, v232
 v_accvgpr_write_b32 a132, v233
 v_add_u32 v228, 40, v226
 v_mfma_f32_32x32x16_bf16 v[160:175], v[40:43], a[4:7], v[160:175]
 buffer_load_dwordx4 v24, s[40:43], s60 offen offset:2048 lds
 v_mul_lo_u32 v229, v228, s53
 v_lshrrev_b32 v229, 16, v229
 v_mul_u32_u24 v232, 18, v229
 v_mfma_f32_32x32x16_bf16 v[112:127], v[44:47], a[0:3], v[112:127]
 v_sub_u32 v232, v228, v232
 v_mul_lo_u32 v229, v229, s34
 v_cmp_eq_u32 vcc, 16, v232
 v_add_u32 v228, v229, v225
 v_bfe_u32 v230, v232, 2, 1
 v_mfma_f32_32x32x16_bf16 v[176:191], v[44:47], a[4:7], v[176:191]
 buffer_load_dwordx4 v25, s[40:43], s60 offen offset:3072 lds
 s_add_u32 s60, s60, 128
 v_cndmask_b32 v231, v231, v228, vcc
 v_cmp_gt_u32 vcc, 8, v232
 s_waitcnt lgkmcnt(0)
 v_mfma_f32_32x32x16_bf16 v[64:79], v[48:51], a[8:11], v[64:79]
 ds_read_b64_tr_b16 v[32:33], v18 offset:8192
 ds_read_b64_tr_b16 v[34:35], v18 offset:9216
 v_lshlrev_b32 v230, 9, v230
 v_add3_u32 v230, v230, v229, v224
 v_cndmask_b32 v233, v227, v230, vcc
 v_mfma_f32_32x32x16_bf16 v[80:95], v[52:55], a[8:11], v[80:95]
 ds_read_b128 a[0:3], v12
 ds_read_b64_tr_b16 v[36:37], v19 offset:8192
 s_add_u32 m0, s57, 98304
 s_nop 0
 buffer_load_dwordx4 v26, s[44:47], s62 offen lds
 v_mfma_f32_32x32x16_bf16 v[144:159], v[52:55], a[12:15], v[144:159]
 ds_read_b64_tr_b16 v[38:39], v19 offset:9216
 ds_read_b128 a[4:7], v12 offset:4096
 v_accvgpr_write_b32 a144, v232
 v_accvgpr_write_b32 a133, v233
 v_add_u32 v228, 48, v226
 v_mfma_f32_32x32x16_bf16 v[128:143], v[48:51], a[12:15], v[128:143]
 ds_read_b64_tr_b16 v[40:41], v20 offset:8192
 ds_read_b64_tr_b16 v[42:43], v20 offset:9216
 buffer_load_dwordx4 v27, s[44:47], s62 offen offset:1024 lds
 v_mul_lo_u32 v229, v228, s53
 v_mfma_f32_32x32x16_bf16 v[96:111], v[56:59], a[8:11], v[96:111]
 ds_read_b64_tr_b16 v[44:45], v21 offset:8192
 ds_read_b64_tr_b16 v[46:47], v21 offset:9216
 v_lshrrev_b32 v229, 16, v229
 v_mul_u32_u24 v232, 18, v229
 v_sub_u32 v232, v228, v232
 v_mfma_f32_32x32x16_bf16 v[160:175], v[56:59], a[12:15], v[160:175]
 buffer_load_dwordx4 v28, s[44:47], s62 offen offset:2048 lds
 v_mul_lo_u32 v229, v229, s34
 v_cmp_eq_u32 vcc, 16, v232
 v_add_u32 v228, v229, v225
 v_mfma_f32_32x32x16_bf16 v[112:127], v[60:63], a[8:11], v[112:127]
 v_bfe_u32 v230, v232, 2, 1
 v_cndmask_b32 v231, v231, v228, vcc
 v_cmp_gt_u32 vcc, 8, v232
 v_lshlrev_b32 v230, 9, v230
 v_add3_u32 v230, v230, v229, v224
 v_mfma_f32_32x32x16_bf16 v[176:191], v[60:63], a[12:15], v[176:191]
 buffer_load_dwordx4 v29, s[44:47], s62 offen offset:3072 lds
 s_add_u32 s62, s62, 524288
 v_cndmask_b32 v233, v227, v230, vcc
 v_accvgpr_write_b32 a145, v232
 s_waitcnt lgkmcnt(0)
 v_mfma_f32_32x32x16_bf16 v[64:79], v[32:35], a[0:3], v[64:79]
 ds_read_b64_tr_b16 v[48:49], v18 offset:12288
 ds_read_b64_tr_b16 v[50:51], v18 offset:13312
 v_accvgpr_write_b32 a134, v233
 v_add_u32 v228, 56, v226
 v_mul_lo_u32 v229, v228, s53
 v_mfma_f32_32x32x16_bf16 v[80:95], v[36:39], a[0:3], v[80:95]
 ds_read_b128 a[8:11], v13
 ds_read_b64_tr_b16 v[52:53], v19 offset:12288
 buffer_store_dwordx4 v[212:215], v30, s[36:39], s64 offen offset:2048 sc1
 buffer_store_dwordx4 v[220:223], v30, s[36:39], s64 offen offset:3072 sc1
 v_mfma_f32_32x32x16_bf16 v[144:159], v[36:39], a[4:7], v[144:159]
 ds_read_b64_tr_b16 v[54:55], v19 offset:13312
 ds_read_b128 a[12:15], v13 offset:4096
 v_lshrrev_b32 v229, 16, v229
 v_mul_u32_u24 v232, 18, v229
 v_sub_u32 v232, v228, v232
 v_mfma_f32_32x32x16_bf16 v[128:143], v[32:35], a[4:7], v[128:143]
 ds_read_b64_tr_b16 v[56:57], v20 offset:12288
 ds_read_b64_tr_b16 v[58:59], v20 offset:13312
 v_mul_lo_u32 v229, v229, s34
 v_cmp_eq_u32 vcc, 16, v232
 v_add_u32 v228, v229, v225
 v_mfma_f32_32x32x16_bf16 v[96:111], v[40:43], a[0:3], v[96:111]
 ds_read_b64_tr_b16 v[60:61], v21 offset:12288
 ds_read_b64_tr_b16 v[62:63], v21 offset:13312
 v_bfe_u32 v230, v232, 2, 1
 v_cndmask_b32 v231, v231, v228, vcc
 v_cmp_gt_u32 vcc, 8, v232
 v_mfma_f32_32x32x16_bf16 v[160:175], v[40:43], a[4:7], v[160:175]
 v_lshlrev_b32 v230, 9, v230
 v_add3_u32 v230, v230, v229, v224
 v_cndmask_b32 v233, v227, v230, vcc
 v_accvgpr_write_b32 a146, v232
 v_accvgpr_write_b32 a136, v233
 v_mfma_f32_32x32x16_bf16 v[112:127], v[44:47], a[0:3], v[112:127]
 v_add_u32 v233, s34, v231
 v_accvgpr_write_b32 a137, v231
 v_accvgpr_write_b32 a138, v233
 v_mfma_f32_32x32x16_bf16 v[176:191], v[44:47], a[4:7], v[176:191]
 s_waitcnt lgkmcnt(0)
 v_mfma_f32_32x32x16_bf16 v[64:79], v[48:51], a[8:11], v[64:79]
 s_waitcnt vmcnt(16)
 s_barrier
 ds_read_b64_tr_b16 v[32:33], v18 offset:16384
 ds_read_b64_tr_b16 v[34:35], v18 offset:17408
 v_mfma_f32_32x32x16_bf16 v[80:95], v[52:55], a[8:11], v[80:95]
 ds_read_b128 a[0:3], v10 offset:32768
 ds_read_b64_tr_b16 v[36:37], v19 offset:16384
 s_mov_b32 s44, s6
 s_mov_b32 s45, s7
 s_mov_b32 s46, 1990656
 s_mov_b32 s47, 0x20000
 v_mfma_f32_32x32x16_bf16 v[144:159], v[52:55], a[12:15], v[144:159]
 ds_read_b64_tr_b16 v[38:39], v19 offset:17408
 ds_read_b128 a[4:7], v10 offset:36864
 s_add_u32 m0, s65, 0
 s_nop 0
 buffer_load_dwordx4 v236, s[48:51], s66 offen lds
 v_mfma_f32_32x32x16_bf16 v[128:143], v[48:51], a[12:15], v[128:143]
 ds_read_b64_tr_b16 v[40:41], v20 offset:16384
 ds_read_b64_tr_b16 v[42:43], v20 offset:17408
 v_mfma_f32_32x32x16_bf16 v[96:111], v[56:59], a[8:11], v[96:111]
 ds_read_b64_tr_b16 v[44:45], v21 offset:16384
 ds_read_b64_tr_b16 v[46:47], v21 offset:17408
 buffer_load_dwordx4 v237, s[48:51], s66 offen offset:1024 lds
 v_mfma_f32_32x32x16_bf16 v[160:175], v[56:59], a[12:15], v[160:175]
 v_mfma_f32_32x32x16_bf16 v[112:127], v[60:63], a[8:11], v[112:127]
 buffer_load_dwordx4 v238, s[48:51], s66 offen offset:2048 lds
 v_mfma_f32_32x32x16_bf16 v[176:191], v[60:63], a[12:15], v[176:191]
 s_waitcnt lgkmcnt(0)
 v_mfma_f32_32x32x16_bf16 v[64:79], v[32:35], a[0:3], v[64:79]
 ds_read_b64_tr_b16 v[48:49], v18 offset:20480
 ds_read_b64_tr_b16 v[50:51], v18 offset:21504
 buffer_load_dwordx4 v239, s[48:51], s66 offen offset:3072 lds
 s_add_u32 s66, s66, 128
 v_mfma_f32_32x32x16_bf16 v[80:95], v[36:39], a[0:3], v[80:95]
 ds_read_b128 a[8:11], v11 offset:32768
 ds_read_b64_tr_b16 v[52:53], v19 offset:20480
 v_mfma_f32_32x32x16_bf16 v[144:159], v[36:39], a[4:7], v[144:159]
 ds_read_b64_tr_b16 v[54:55], v19 offset:21504
 ds_read_b128 a[12:15], v11 offset:36864
 s_add_u32 m0, s65, 16384
 s_nop 0
 buffer_load_dwordx4 v240, s[44:47], s67 offen lds
 v_mfma_f32_32x32x16_bf16 v[128:143], v[32:35], a[4:7], v[128:143]
 ds_read_b64_tr_b16 v[56:57], v20 offset:20480
 ds_read_b64_tr_b16 v[58:59], v20 offset:21504
 v_mfma_f32_32x32x16_bf16 v[96:111], v[40:43], a[0:3], v[96:111]
 ds_read_b64_tr_b16 v[60:61], v21 offset:20480
 ds_read_b64_tr_b16 v[62:63], v21 offset:21504
 buffer_load_dwordx4 v241, s[44:47], s67 offen offset:1024 lds
 v_mfma_f32_32x32x16_bf16 v[160:175], v[40:43], a[4:7], v[160:175]
 v_mfma_f32_32x32x16_bf16 v[112:127], v[44:47], a[0:3], v[112:127]
 buffer_load_dwordx4 v242, s[44:47], s67 offen offset:2048 lds
 v_mfma_f32_32x32x16_bf16 v[176:191], v[44:47], a[4:7], v[176:191]
 s_waitcnt lgkmcnt(0)
 v_mfma_f32_32x32x16_bf16 v[64:79], v[48:51], a[8:11], v[64:79]
 ds_read_b64_tr_b16 v[32:33], v18 offset:24576
 ds_read_b64_tr_b16 v[34:35], v18 offset:25600
 buffer_load_dwordx4 v243, s[44:47], s67 offen offset:3072 lds
 s_add_u32 s67, s67, 221184
 v_mfma_f32_32x32x16_bf16 v[80:95], v[52:55], a[8:11], v[80:95]
 ds_read_b128 a[0:3], v12 offset:32768
 ds_read_b64_tr_b16 v[36:37], v19 offset:24576
 v_mfma_f32_32x32x16_bf16 v[144:159], v[52:55], a[12:15], v[144:159]
 ds_read_b64_tr_b16 v[38:39], v19 offset:25600
 ds_read_b128 a[4:7], v12 offset:36864
 v_mfma_f32_32x32x16_bf16 v[128:143], v[48:51], a[12:15], v[128:143]
 ds_read_b64_tr_b16 v[40:41], v20 offset:24576
 ds_read_b64_tr_b16 v[42:43], v20 offset:25600
 v_mfma_f32_32x32x16_bf16 v[96:111], v[56:59], a[8:11], v[96:111]
 ds_read_b64_tr_b16 v[44:45], v21 offset:24576
 ds_read_b64_tr_b16 v[46:47], v21 offset:25600
 v_mfma_f32_32x32x16_bf16 v[160:175], v[56:59], a[12:15], v[160:175]
 v_mfma_f32_32x32x16_bf16 v[112:127], v[60:63], a[8:11], v[112:127]
 v_mfma_f32_32x32x16_bf16 v[176:191], v[60:63], a[12:15], v[176:191]
 s_waitcnt lgkmcnt(0)
 v_mfma_f32_32x32x16_bf16 v[64:79], v[32:35], a[0:3], v[64:79]
 ds_read_b64_tr_b16 v[48:49], v18 offset:28672
 ds_read_b64_tr_b16 v[50:51], v18 offset:29696
 v_mfma_f32_32x32x16_bf16 v[80:95], v[36:39], a[0:3], v[80:95]
 ds_read_b128 a[8:11], v13 offset:32768
 ds_read_b64_tr_b16 v[52:53], v19 offset:28672
 v_mfma_f32_32x32x16_bf16 v[144:159], v[36:39], a[4:7], v[144:159]
 ds_read_b64_tr_b16 v[54:55], v19 offset:29696
 ds_read_b128 a[12:15], v13 offset:36864
 v_mfma_f32_32x32x16_bf16 v[128:143], v[32:35], a[4:7], v[128:143]
 ds_read_b64_tr_b16 v[56:57], v20 offset:28672
 ds_read_b64_tr_b16 v[58:59], v20 offset:29696
 v_mfma_f32_32x32x16_bf16 v[96:111], v[40:43], a[0:3], v[96:111]
 ds_read_b64_tr_b16 v[60:61], v21 offset:28672
 ds_read_b64_tr_b16 v[62:63], v21 offset:29696
 v_mfma_f32_32x32x16_bf16 v[160:175], v[40:43], a[4:7], v[160:175]
 v_mfma_f32_32x32x16_bf16 v[112:127], v[44:47], a[0:3], v[112:127]
 v_mfma_f32_32x32x16_bf16 v[176:191], v[44:47], a[4:7], v[176:191]
 s_waitcnt lgkmcnt(0)
 v_mfma_f32_32x32x16_bf16 v[64:79], v[48:51], a[8:11], v[64:79]
 s_waitcnt vmcnt(10)
 s_barrier
 ds_read_b64_tr_b16 v[32:33], v18 offset:32768
 ds_read_b64_tr_b16 v[34:35], v18 offset:33792
 v_mfma_f32_32x32x16_bf16 v[80:95], v[52:55], a[8:11], v[80:95]
 ds_read_b128 a[0:3], v14
 ds_read_b64_tr_b16 v[36:37], v19 offset:32768
 s_add_u32 m0, s65, 32768
 s_nop 0
 buffer_load_dwordx4 v236, s[48:51], s66 offen lds
 v_mfma_f32_32x32x16_bf16 v[144:159], v[52:55], a[12:15], v[144:159]
 ds_read_b64_tr_b16 v[38:39], v19 offset:33792
 ds_read_b128 a[4:7], v14 offset:4096
 v_mfma_f32_32x32x16_bf16 v[128:143], v[48:51], a[12:15], v[128:143]
 ds_read_b64_tr_b16 v[40:41], v20 offset:32768
 ds_read_b64_tr_b16 v[42:43], v20 offset:33792
 buffer_load_dwordx4 v237, s[48:51], s66 offen offset:1024 lds
 v_mfma_f32_32x32x16_bf16 v[96:111], v[56:59], a[8:11], v[96:111]
 ds_read_b64_tr_b16 v[44:45], v21 offset:32768
 ds_read_b64_tr_b16 v[46:47], v21 offset:33792
 v_mfma_f32_32x32x16_bf16 v[160:175], v[56:59], a[12:15], v[160:175]
 buffer_load_dwordx4 v238, s[48:51], s66 offen offset:2048 lds
 v_mfma_f32_32x32x16_bf16 v[112:127], v[60:63], a[8:11], v[112:127]
 v_mfma_f32_32x32x16_bf16 v[176:191], v[60:63], a[12:15], v[176:191]
 buffer_load_dwordx4 v239, s[48:51], s66 offen offset:3072 lds
 s_add_u32 s66, s66, 128
 s_waitcnt lgkmcnt(0)
 v_mfma_f32_32x32x16_bf16 v[64:79], v[32:35], a[0:3], v[64:79]
 ds_read_b64_tr_b16 v[48:49], v18 offset:36864
 ds_read_b64_tr_b16 v[50:51], v18 offset:37888
 v_mfma_f32_32x32x16_bf16 v[80:95], v[36:39], a[0:3], v[80:95]
 ds_read_b128 a[8:11], v15
 ds_read_b64_tr_b16 v[52:53], v19 offset:36864
 s_add_u32 m0, s65, 49152
 s_nop 0
 buffer_load_dwordx4 v240, s[44:47], s67 offen lds
 v_mfma_f32_32x32x16_bf16 v[144:159], v[36:39], a[4:7], v[144:159]
 ds_read_b64_tr_b16 v[54:55], v19 offset:37888
 ds_read_b128 a[12:15], v15 offset:4096
 v_mfma_f32_32x32x16_bf16 v[128:143], v[32:35], a[4:7], v[128:143]
 ds_read_b64_tr_b16 v[56:57], v20 offset:36864
 ds_read_b64_tr_b16 v[58:59], v20 offset:37888
 buffer_load_dwordx4 v241, s[44:47], s67 offen offset:1024 lds
 v_mfma_f32_32x32x16_bf16 v[96:111], v[40:43], a[0:3], v[96:111]
 ds_read_b64_tr_b16 v[60:61], v21 offset:36864
 ds_read_b64_tr_b16 v[62:63], v21 offset:37888
 v_mfma_f32_32x32x16_bf16 v[160:175], v[40:43], a[4:7], v[160:175]
 buffer_load_dwordx4 v242, s[44:47], s67 offen offset:2048 lds
 v_mfma_f32_32x32x16_bf16 v[112:127], v[44:47], a[0:3], v[112:127]
 v_mfma_f32_32x32x16_bf16 v[176:191], v[44:47], a[4:7], v[176:191]
 buffer_load_dwordx4 v243, s[44:47], s67 offen offset:3072 lds
 s_add_u32 s67, s67, 221184
 s_waitcnt lgkmcnt(0)
 v_mfma_f32_32x32x16_bf16 v[64:79], v[48:51], a[8:11], v[64:79]
 ds_read_b64_tr_b16 v[32:33], v18 offset:40960
 ds_read_b64_tr_b16 v[34:35], v18 offset:41984
 v_mfma_f32_32x32x16_bf16 v[80:95], v[52:55], a[8:11], v[80:95]
 ds_read_b128 a[0:3], v16
 ds_read_b64_tr_b16 v[36:37], v19 offset:40960
 s_add_u32 m0, s65, 65536
 s_nop 0
 buffer_load_dwordx4 v236, s[48:51], s66 offen lds
 v_mfma_f32_32x32x16_bf16 v[144:159], v[52:55], a[12:15], v[144:159]
 ds_read_b64_tr_b16 v[38:39], v19 offset:41984
 ds_read_b128 a[4:7], v16 offset:4096
 v_mfma_f32_32x32x16_bf16 v[128:143], v[48:51], a[12:15], v[128:143]
 ds_read_b64_tr_b16 v[40:41], v20 offset:40960
 ds_read_b64_tr_b16 v[42:43], v20 offset:41984
 buffer_load_dwordx4 v237, s[48:51], s66 offen offset:1024 lds
 v_mfma_f32_32x32x16_bf16 v[96:111], v[56:59], a[8:11], v[96:111]
 ds_read_b64_tr_b16 v[44:45], v21 offset:40960
 ds_read_b64_tr_b16 v[46:47], v21 offset:41984
 v_mfma_f32_32x32x16_bf16 v[160:175], v[56:59], a[12:15], v[160:175]
 buffer_load_dwordx4 v238, s[48:51], s66 offen offset:2048 lds
 v_mfma_f32_32x32x16_bf16 v[112:127], v[60:63], a[8:11], v[112:127]
 v_mfma_f32_32x32x16_bf16 v[176:191], v[60:63], a[12:15], v[176:191]
 buffer_load_dwordx4 v239, s[48:51], s66 offen offset:3072 lds
 s_add_u32 s66, s66, 128
 s_waitcnt lgkmcnt(0)
 v_mfma_f32_32x32x16_bf16 v[64:79], v[32:35], a[0:3], v[64:79]
 ds_read_b64_tr_b16 v[48:49], v18 offset:45056
 ds_read_b64_tr_b16 v[50:51], v18 offset:46080
 ds_read_b128 a[8:11], v17
 ds_read_b64_tr_b16 v[52:53], v19 offset:45056
 v_mfma_f32_32x32x16_bf16 v[80:95], v[36:39], a[0:3], v[80:95]
 ds_read_b64_tr_b16 v[54:55], v19 offset:46080
 ds_read_b128 a[12:15], v17 offset:4096
 ds_read_b64_tr_b16 v[56:57], v20 offset:45056
 ds_read_b64_tr_b16 v[58:59], v20 offset:46080
 v_mfma_f32_32x32x16_bf16 v[144:159], v[36:39], a[4:7], v[144:159]
 ds_read_b64_tr_b16 v[60:61], v21 offset:45056
 ds_read_b64_tr_b16 v[62:63], v21 offset:46080
 s_waitcnt vmcnt(12)
 s_barrier
 v_mfma_f32_32x32x16_bf16 v[128:143], v[32:35], a[4:7], v[128:143]
 ds_read_b64_tr_b16 a[24:25], v252 offset:16384
 ds_read_b64_tr_b16 a[26:27], v252 offset:17408
 ds_read_b128 a[16:19], v244
 ds_read_b64_tr_b16 a[28:29], v253 offset:16384
 v_mfma_f32_32x32x16_bf16 v[96:111], v[40:43], a[0:3], v[96:111]
 ds_read_b64_tr_b16 a[30:31], v253 offset:17408
 ds_read_b128 a[20:23], v244 offset:4096
 s_add_u32 m0, s65, 81920
 s_nop 0
 buffer_load_dwordx4 v240, s[44:47], s67 offen lds
 v_mfma_f32_32x32x16_bf16 v[160:175], v[40:43], a[4:7], v[160:175]
 v_mfma_f32_32x32x16_bf16 v[112:127], v[44:47], a[0:3], v[112:127]
 buffer_load_dwordx4 v241, s[44:47], s67 offen offset:1024 lds
 v_mfma_f32_32x32x16_bf16 v[176:191], v[44:47], a[4:7], v[176:191]
 s_mov_b64 exec, 1
 buffer_atomic_add v31, v0, s[72:75], 0 offen offset:128 sc1
 s_mov_b64 exec, -1
 s_waitcnt lgkmcnt(0)
 v_mfma_f32_32x32x16_bf16 v[64:79], v[48:51], a[8:11], v[64:79]
 ds_read_b64_tr_b16 a[40:41], v252 offset:20480
 ds_read_b64_tr_b16 a[42:43], v252 offset:21504
 buffer_load_dwordx4 v242, s[44:47], s67 offen offset:2048 lds
 v_mfma_f32_32x32x16_bf16 v[80:95], v[52:55], a[8:11], v[80:95]
 ds_read_b128 a[32:35], v245
 ds_read_b64_tr_b16 a[44:45], v253 offset:20480
 v_mfma_f32_32x32x16_bf16 v[144:159], v[52:55], a[12:15], v[144:159]
 ds_read_b64_tr_b16 a[46:47], v253 offset:21504
 ds_read_b128 a[36:39], v245 offset:4096
 buffer_load_dwordx4 v243, s[44:47], s67 offen offset:3072 lds
 s_add_u32 s67, s67, 221184
 v_mfma_f32_32x32x16_bf16 v[128:143], v[48:51], a[12:15], v[128:143]
 v_mfma_f32_32x32x16_bf16 v[96:111], v[56:59], a[8:11], v[96:111]
 v_mfma_f32_32x32x16_bf16 v[160:175], v[56:59], a[12:15], v[160:175]
 v_mfma_f32_32x32x16_bf16 v[112:127], v[60:63], a[8:11], v[112:127]
 v_mfma_f32_32x32x16_bf16 v[176:191], v[60:63], a[12:15], v[176:191]
 s_cmp_ge_u32 s69, 9
 s_cbranch_scc1 L_aq_V
 v_mfma_f32_32x32x16_bf16 a[64:79], a[24:27], a[16:19], 0
 ds_read_b64_tr_b16 a[56:57], v252 offset:24576
 ds_read_b64_tr_b16 a[58:59], v252 offset:25600
 v_lshlrev_b32 v14, 4, v1
 s_lshl_b32 s63, s31, 19
 s_lshl_b32 s57, s28, 11
 v_mfma_f32_32x32x16_bf16 a[80:95], a[28:31], a[16:19], 0
 ds_read_b128 a[48:51], v246
 ds_read_b64_tr_b16 a[60:61], v253 offset:24576
 v_add_u32 v15, s57, v14
 v_add_u32 v12, 16384, v15
 v_add_u32 v13, 16777216, v15
 v_mfma_f32_32x32x16_bf16 a[112:127], a[28:31], a[20:23], 0
 ds_read_b64_tr_b16 a[62:63], v253 offset:25600
 ds_read_b128 a[52:55], v246 offset:4096
 s_mov_b32 s59, s63
 v_lshlrev_b32 v9, 2, v3
 v_add_u32 v9, v9, v4
 v_mfma_f32_32x32x16_bf16 a[96:111], a[24:27], a[20:23], 0
 v_mul_u32_u24 v9, 320, v9
 v_lshl_add_u32 v9, v5, 5, v9
 v_lshl_add_u32 v9, v6, 3, v9
 s_mul_i32 s55, s28, 5120
 v_add_u32 v26, s55, v9
 s_waitcnt lgkmcnt(4)
 v_mfma_f32_32x32x16_bf16 a[64:79], a[40:43], a[32:35], a[64:79]
 ds_read_b64_tr_b16 a[24:25], v252 offset:28672
 ds_read_b64_tr_b16 a[26:27], v252 offset:29696
 s_lshr_b32 s55, s28, 1
 s_and_b32 s55, s55, s28
 s_lshl_b32 s55, s55, 31
 v_mfma_f32_32x32x16_bf16 a[80:95], a[44:47], a[32:35], a[80:95]
 ds_read_b128 a[16:19], v247
 ds_read_b64_tr_b16 a[28:29], v253 offset:28672
 v_or_b32 v27, s55, v14
 v_mul_f32 v64, s70, v64
 v_mul_f32 v65, s70, v65
 v_mfma_f32_32x32x16_bf16 a[112:127], a[44:47], a[36:39], a[112:127]
 ds_read_b64_tr_b16 a[30:31], v253 offset:29696
 ds_read_b128 a[20:23], v247 offset:4096
 v_mul_f32 v66, s70, v66
 v_mul_f32 v67, s70, v67
 v_mul_f32 v68, s70, v68
 v_mfma_f32_32x32x16_bf16 a[96:111], a[40:43], a[36:39], a[96:111]
 v_mul_f32 v69, s70, v69
 v_mul_f32 v70, s70, v70
 v_mul_f32 v71, s70, v71
 v_mul_f32 v72, s70, v72
 v_mul_f32 v73, s70, v73
 s_waitcnt lgkmcnt(4)
 v_mfma_f32_32x32x16_bf16 a[64:79], a[56:59], a[48:51], a[64:79]
 s_waitcnt vmcnt(9)
 s_barrier
 ds_read_b64_tr_b16 a[40:41], v252 offset:49152
 ds_read_b64_tr_b16 a[42:43], v252 offset:50176
 v_mul_f32 v74, s70, v74
 v_mfma_f32_32x32x16_bf16 a[80:95], a[60:63], a[48:51], a[80:95]
 ds_read_b128 a[32:35], v244 offset:32768
 ds_read_b64_tr_b16 a[44:45], v253 offset:49152
 s_add_u32 m0, s65, 98304
 s_nop 0
 buffer_load_dwordx4 v236, s[48:51], s66 offen lds
 v_mfma_f32_32x32x16_bf16 a[112:127], a[60:63], a[52:55], a[112:127]
 ds_read_b64_tr_b16 a[46:47], v253 offset:50176
 ds_read_b128 a[36:39], v244 offset:36864
 v_mul_f32 v75, s70, v75
 v_mul_f32 v76, s70, v76
 v_mul_f32 v77, s70, v77
 v_mfma_f32_32x32x16_bf16 a[96:111], a[56:59], a[52:55], a[96:111]
 buffer_load_dwordx4 v237, s[48:51], s66 offen offset:1024 lds
 v_mul_f32 v78, s70, v78
 v_mul_f32 v79, s70, v79
 v_cvt_pk_bf16_f32 v192, v64, v65
 s_waitcnt lgkmcnt(4)
 v_mfma_f32_32x32x16_bf16 a[64:79], a[24:27], a[16:19], a[64:79]
 ds_read_b64_tr_b16 a[56:57], v252 offset:53248
 ds_read_b64_tr_b16 a[58:59], v252 offset:54272
 v_cvt_pk_bf16_f32 v193, v66, v67
 v_cvt_pk_bf16_f32 v194, v68, v69
 v_cvt_pk_bf16_f32 v195, v70, v71
 v_mfma_f32_32x32x16_bf16 a[80:95], a[28:31], a[16:19], a[80:95]
 ds_read_b128 a[48:51], v245 offset:32768
 ds_read_b64_tr_b16 a[60:61], v253 offset:53248
 buffer_load_dwordx4 v238, s[48:51], s66 offen offset:2048 lds
 v_cvt_pk_bf16_f32 v196, v72, v73
 v_mfma_f32_32x32x16_bf16 a[112:127], a[28:31], a[20:23], a[112:127]
 ds_read_b64_tr_b16 a[62:63], v253 offset:54272
 ds_read_b128 a[52:55], v245 offset:36864
 v_cvt_pk_bf16_f32 v197, v74, v75
 v_cvt_pk_bf16_f32 v198, v76, v77
 v_cvt_pk_bf16_f32 v199, v78, v79
 v_mfma_f32_32x32x16_bf16 a[96:111], a[24:27], a[20:23], a[96:111]
 buffer_load_dwordx4 v239, s[48:51], s66 offen offset:3072 lds
 s_add_u32 s66, s66, 128
 v_mul_f32 v80, s70, v80
 v_mul_f32 v81, s70, v81
 s_waitcnt lgkmcnt(4)
 v_mfma_f32_32x32x16_bf16 a[64:79], a[40:43], a[32:35], a[64:79]
 ds_read_b64_tr_b16 a[24:25], v252 offset:57344
 ds_read_b64_tr_b16 a[26:27], v252 offset:58368
 v_mul_f32 v82, s70, v82
 v_mul_f32 v83, s70, v83
 v_mul_f32 v84, s70, v84
 v_mfma_f32_32x32x16_bf16 a[80:95], a[44:47], a[32:35], a[80:95]
 ds_read_b128 a[16:19], v246 offset:32768
 ds_read_b64_tr_b16 a[28:29], v253 offset:57344
 s_add_u32 m0, s65, 114688
 s_nop 0
 buffer_load_dwordx4 v240, s[44:47], s67 offen lds
 v_mfma_f32_32x32x16_bf16 a[112:127], a[44:47], a[36:39], a[112:127]
 ds_read_b64_tr_b16 a[30:31], v253 offset:58368
 ds_read_b128 a[20:23], v246 offset:36864
 v_mul_f32 v85, s70, v85
 v_mul_f32 v86, s70, v86
 v_mul_f32 v87, s70, v87
 v_mfma_f32_32x32x16_bf16 a[96:111], a[40:43], a[36:39], a[96:111]
 buffer_load_dwordx4 v241, s[44:47], s67 offen offset:1024 lds
 v_mul_f32 v88, s70, v88
 v_mul_f32 v89, s70, v89
 v_mul_f32 v90, s70, v90
 s_waitcnt lgkmcnt(4)
 v_mfma_f32_32x32x16_bf16 a[64:79], a[56:59], a[48:51], a[64:79]
 ds_read_b64_tr_b16 a[40:41], v252 offset:61440
 ds_read_b64_tr_b16 a[42:43], v252 offset:62464
 v_mul_f32 v91, s70, v91
 v_mul_f32 v92, s70, v92
 v_mul_f32 v93, s70, v93
 v_mfma_f32_32x32x16_bf16 a[80:95], a[60:63], a[48:51], a[80:95]
 ds_read_b128 a[32:35], v247 offset:32768
 ds_read_b64_tr_b16 a[44:45], v253 offset:61440
 buffer_load_dwordx4 v242, s[44:47], s67 offen offset:2048 lds
 v_mul_f32 v94, s70, v94
 v_mfma_f32_32x32x16_bf16 a[112:127], a[60:63], a[52:55], a[112:127]
 ds_read_b64_tr_b16 a[46:47], v253 offset:62464
 ds_read_b128 a[36:39], v247 offset:36864
 v_mul_f32 v95, s70, v95
 v_cvt_pk_bf16_f32 v200, v80, v81
 v_cvt_pk_bf16_f32 v201, v82, v83
 v_mfma_f32_32x32x16_bf16 a[96:111], a[56:59], a[52:55], a[96:111]
 buffer_load_dwordx4 v243, s[44:47], s67 offen offset:3072 lds
 s_add_u32 s67, s67, 221184
 v_cvt_pk_bf16_f32 v202, v84, v85
 v_cvt_pk_bf16_f32 v203, v86, v87
 s_waitcnt lgkmcnt(4)
 v_mfma_f32_32x32x16_bf16 a[64:79], a[24:27], a[16:19], a[64:79]
 s_waitcnt vmcnt(8)
 s_barrier
 ds_read_b64_tr_b16 a[56:57], v254 offset:16384
 ds_read_b64_tr_b16 a[58:59], v254 offset:17408
 v_cvt_pk_bf16_f32 v204, v88, v89
 v_mfma_f32_32x32x16_bf16 a[80:95], a[28:31], a[16:19], a[80:95]
 ds_read_b128 a[48:51], v248
 ds_read_b64_tr_b16 a[60:61], v255 offset:16384
 s_add_u32 m0, s65, 0
 s_nop 0
 buffer_load_dwordx4 v236, s[48:51], s66 offen lds
 v_mfma_f32_32x32x16_bf16 a[112:127], a[28:31], a[20:23], a[112:127]
 ds_read_b64_tr_b16 a[62:63], v255 offset:17408
 ds_read_b128 a[52:55], v248 offset:4096
 v_cvt_pk_bf16_f32 v205, v90, v91
 v_cvt_pk_bf16_f32 v206, v92, v93
 v_cvt_pk_bf16_f32 v207, v94, v95
 v_mfma_f32_32x32x16_bf16 a[96:111], a[24:27], a[20:23], a[96:111]
 buffer_load_dwordx4 v237, s[48:51], s66 offen offset:1024 lds
 v_mul_f32 v96, s70, v96
 v_mul_f32 v97, s70, v97
 v_mul_f32 v98, s70, v98
 s_waitcnt lgkmcnt(4)
 v_mfma_f32_32x32x16_bf16 a[64:79], a[40:43], a[32:35], a[64:79]
 ds_read_b64_tr_b16 a[24:25], v254 offset:20480
 ds_read_b64_tr_b16 a[26:27], v254 offset:21504
 v_mul_f32 v99, s70, v99
 v_mul_f32 v100, s70, v100
 v_mul_f32 v101, s70, v101
 v_mfma_f32_32x32x16_bf16 a[80:95], a[44:47], a[32:35], a[80:95]
 ds_read_b128 a[16:19], v249
 ds_read_b64_tr_b16 a[28:29], v255 offset:20480
 buffer_load_dwordx4 v238, s[48:51], s66 offen offset:2048 lds
 v_mul_f32 v102, s70, v102
 v_mfma_f32_32x32x16_bf16 a[112:127], a[44:47], a[36:39], a[112:127]
 ds_read_b64_tr_b16 a[30:31], v255 offset:21504
 ds_read_b128 a[20:23], v249 offset:4096
 v_mul_f32 v103, s70, v103
 v_mul_f32 v104, s70, v104
 v_mul_f32 v105, s70, v105
 v_mfma_f32_32x32x16_bf16 a[96:111], a[40:43], a[36:39], a[96:111]
 buffer_load_dwordx4 v239, s[48:51], s66 offen offset:3072 lds
 s_add_u32 s66, s66, 128
 v_mul_f32 v106, s70, v106
 v_mul_f32 v107, s70, v107
 s_waitcnt lgkmcnt(4)
 v_mfma_f32_32x32x16_bf16 a[64:79], a[56:59], a[48:51], a[64:79]
 ds_read_b64_tr_b16 a[40:41], v254 offset:24576
 ds_read_b64_tr_b16 a[42:43], v254 offset:25600
 v_mul_f32 v108, s70, v108
 v_mul_f32 v109, s70, v109
 v_mul_f32 v110, s70, v110
 v_mfma_f32_32x32x16_bf16 a[80:95], a[60:63], a[48:51], a[80:95]
 ds_read_b128 a[32:35], v250
 ds_read_b64_tr_b16 a[44:45], v255 offset:24576
 s_add_u32 m0, s65, 16384
 s_nop 0
 buffer_load_dwordx4 v240, s[44:47], s67 offen lds
 v_mfma_f32_32x32x16_bf16 a[112:127], a[60:63], a[52:55], a[112:127]
 ds_read_b64_tr_b16 a[46:47], v255 offset:25600
 ds_read_b128 a[36:39], v250 offset:4096
 v_mul_f32 v111, s70, v111
 v_cvt_pk_bf16_f32 v208, v96, v97
 v_cvt_pk_bf16_f32 v209, v98, v99
 v_mfma_f32_32x32x16_bf16 a[96:111], a[56:59], a[52:55], a[96:111]
 buffer_load_dwordx4 v241, s[44:47], s67 offen offset:1024 lds
 v_cvt_pk_bf16_f32 v210, v100, v101
 v_cvt_pk_bf16_f32 v211, v102, v103
 v_cvt_pk_bf16_f32 v212, v104, v105
 s_waitcnt lgkmcnt(4)
 v_mfma_f32_32x32x16_bf16 a[64:79], a[24:27], a[16:19], a[64:79]
 ds_read_b64_tr_b16 a[56:57], v254 offset:28672
 ds_read_b64_tr_b16 a[58:59], v254 offset:29696
 v_cvt_pk_bf16_f32 v213, v106, v107
 v_cvt_pk_bf16_f32 v214, v108, v109
 v_cvt_pk_bf16_f32 v215, v110, v111
 v_mfma_f32_32x32x16_bf16 a[80:95], a[28:31], a[16:19], a[80:95]
 ds_read_b128 a[48:51], v251
 ds_read_b64_tr_b16 a[60:61], v255 offset:28672
 buffer_load_dwordx4 v242, s[44:47], s67 offen offset:2048 lds
 v_mul_f32 v112, s70, v112
 v_mfma_f32_32x32x16_bf16 a[112:127], a[28:31], a[20:23], a[112:127]
 ds_read_b64_tr_b16 a[62:63], v255 offset:29696
 ds_read_b128 a[52:55], v251 offset:4096
 v_mul_f32 v113, s70, v113
 v_mul_f32 v114, s70, v114
 v_mul_f32 v115, s70, v115
 v_mfma_f32_32x32x16_bf16 a[96:111], a[24:27], a[20:23], a[96:111]
 buffer_load_dwordx4 v243, s[44:47], s67 offen offset:3072 lds
 s_add_u32 s67, s67, 221184
 v_mul_f32 v116, s70, v116
 v_mul_f32 v117, s70, v117
 s_waitcnt lgkmcnt(4)
 v_mfma_f32_32x32x16_bf16 a[64:79], a[40:43], a[32:35], a[64:79]
 s_waitcnt vmcnt(8)
 s_barrier
 ds_read_b64_tr_b16 a[24:25], v254 offset:49152
 ds_read_b64_tr_b16 a[26:27], v254 offset:50176
 v_mul_f32 v118, s70, v118
 v_mfma_f32_32x32x16_bf16 a[80:95], a[44:47], a[32:35], a[80:95]
 ds_read_b128 a[16:19], v248 offset:32768
 ds_read_b64_tr_b16 a[28:29], v255 offset:49152
 s_add_u32 m0, s65, 32768
 s_nop 0
 buffer_load_dwordx4 v236, s[48:51], s66 offen lds
 v_mfma_f32_32x32x16_bf16 a[112:127], a[44:47], a[36:39], a[112:127]
 ds_read_b64_tr_b16 a[30:31], v255 offset:50176
 ds_read_b128 a[20:23], v248 offset:36864
 v_mul_f32 v119, s70, v119
 v_mul_f32 v120, s70, v120
 v_mul_f32 v121, s70, v121
 v_mfma_f32_32x32x16_bf16 a[96:111], a[40:43], a[36:39], a[96:111]
 buffer_load_dwordx4 v237, s[48:51], s66 offen offset:1024 lds
 v_mul_f32 v122, s70, v122
 v_mul_f32 v123, s70, v123
 v_mul_f32 v124, s70, v124
 s_waitcnt lgkmcnt(4)
 v_mfma_f32_32x32x16_bf16 a[64:79], a[56:59], a[48:51], a[64:79]
 ds_read_b64_tr_b16 a[40:41], v254 offset:53248
 ds_read_b64_tr_b16 a[42:43], v254 offset:54272
 v_mul_f32 v125, s70, v125
 v_mul_f32 v126, s70, v126
 v_mul_f32 v127, s70, v127
 v_mfma_f32_32x32x16_bf16 a[80:95], a[60:63], a[48:51], a[80:95]
 ds_read_b128 a[32:35], v249 offset:32768
 ds_read_b64_tr_b16 a[44:45], v255 offset:53248
 buffer_load_dwordx4 v238, s[48:51], s66 offen offset:2048 lds
 v_cvt_pk_bf16_f32 v216, v112, v113
 v_mfma_f32_32x32x16_bf16 a[112:127], a[60:63], a[52:55], a[112:127]
 ds_read_b64_tr_b16 a[46:47], v255 offset:54272
 ds_read_b128 a[36:39], v249 offset:36864
 v_cvt_pk_bf16_f32 v217, v114, v115
 v_cvt_pk_bf16_f32 v218, v116, v117
 v_cvt_pk_bf16_f32 v219, v118, v119
 v_mfma_f32_32x32x16_bf16 a[96:111], a[56:59], a[52:55], a[96:111]
 buffer_load_dwordx4 v239, s[48:51], s66 offen offset:3072 lds
 s_add_u32 s66, s66, 128
 v_cvt_pk_bf16_f32 v220, v120, v121
 v_cvt_pk_bf16_f32 v221, v122, v123
 s_waitcnt lgkmcnt(4)
 v_mfma_f32_32x32x16_bf16 a[64:79], a[24:27], a[16:19], a[64:79]
 ds_read_b64_tr_b16 a[56:57], v254 offset:57344
 ds_read_b64_tr_b16 a[58:59], v254 offset:58368
 v_cvt_pk_bf16_f32 v222, v124, v125
 v_cvt_pk_bf16_f32 v223, v126, v127
 s_lshl_b32 s64, s31, 2
 v_mfma_f32_32x32x16_bf16 a[80:95], a[28:31], a[16:19], a[80:95]
 ds_read_b128 a[48:51], v250 offset:32768
 ds_read_b64_tr_b16 a[60:61], v255 offset:57344
 s_add_u32 m0, s65, 49152
 s_nop 0
 buffer_load_dwordx4 v240, s[44:47], s67 offen lds
 v_mfma_f32_32x32x16_bf16 a[112:127], a[28:31], a[20:23], a[112:127]
 ds_read_b64_tr_b16 a[62:63], v255 offset:58368
 ds_read_b128 a[52:55], v250 offset:36864
 v_mov_b32 v31, s64
 v_mfma_f32_32x32x16_bf16 a[96:111], a[24:27], a[20:23], a[96:111]
 buffer_load_dwordx4 v241, s[44:47], s67 offen offset:1024 lds
 s_waitcnt lgkmcnt(4)
 v_mfma_f32_32x32x16_bf16 a[64:79], a[40:43], a[32:35], a[64:79]
 ds_read_b64_tr_b16 a[24:25], v254 offset:61440
 ds_read_b64_tr_b16 a[26:27], v254 offset:62464
 v_mfma_f32_32x32x16_bf16 a[80:95], a[44:47], a[32:35], a[80:95]
 ds_read_b128 a[16:19], v251 offset:32768
 ds_read_b64_tr_b16 a[28:29], v255 offset:61440
 buffer_load_dwordx4 v242, s[44:47], s67 offen offset:2048 lds
 v_mfma_f32_32x32x16_bf16 a[112:127], a[44:47], a[36:39], a[112:127]
 ds_read_b64_tr_b16 a[30:31], v255 offset:62464
 ds_read_b128 a[20:23], v251 offset:36864
 v_mfma_f32_32x32x16_bf16 a[96:111], a[40:43], a[36:39], a[96:111]
 buffer_load_dwordx4 v243, s[44:47], s67 offen offset:3072 lds
 s_add_u32 s67, s67, 221184
 s_waitcnt lgkmcnt(4)
 v_mfma_f32_32x32x16_bf16 a[64:79], a[56:59], a[48:51], a[64:79]
 s_waitcnt vmcnt(8)
 s_barrier
 ds_read_b64_tr_b16 a[40:41], v252 offset:16384
 ds_read_b64_tr_b16 a[42:43], v252 offset:17408
 v_mfma_f32_32x32x16_bf16 a[80:95], a[60:63], a[48:51], a[80:95]
 ds_read_b128 a[32:35], v244
 ds_read_b64_tr_b16 a[44:45], v253 offset:16384
 s_add_u32 m0, s65, 65536
 s_nop 0
 buffer_load_dwordx4 v236, s[48:51], s66 offen lds
 v_mfma_f32_32x32x16_bf16 a[112:127], a[60:63], a[52:55], a[112:127]
 ds_read_b64_tr_b16 a[46:47], v253 offset:17408
 ds_read_b128 a[36:39], v244 offset:4096
 v_mfma_f32_32x32x16_bf16 a[96:111], a[56:59], a[52:55], a[96:111]
 buffer_load_dwordx4 v237, s[48:51], s66 offen offset:1024 lds
 s_waitcnt lgkmcnt(4)
 v_mfma_f32_32x32x16_bf16 a[64:79], a[24:27], a[16:19], a[64:79]
 ds_read_b64_tr_b16 a[56:57], v252 offset:20480
 ds_read_b64_tr_b16 a[58:59], v252 offset:21504
 v_mfma_f32_32x32x16_bf16 a[80:95], a[28:31], a[16:19], a[80:95]
 ds_read_b128 a[48:51], v245
 ds_read_b64_tr_b16 a[60:61], v253 offset:20480
 buffer_load_dwordx4 v238, s[48:51], s66 offen offset:2048 lds
 v_mfma_f32_32x32x16_bf16 a[112:127], a[28:31], a[20:23], a[112:127]
 ds_read_b64_tr_b16 a[62:63], v253 offset:21504
 ds_read_b128 a[52:55], v245 offset:4096
 v_mfma_f32_32x32x16_bf16 a[96:111], a[24:27], a[20:23], a[96:111]
 buffer_load_dwordx4 v239, s[48:51], s66 offen offset:3072 lds
 s_add_u32 s66, s66, 128
 s_waitcnt lgkmcnt(4)
 v_mfma_f32_32x32x16_bf16 a[64:79], a[40:43], a[32:35], a[64:79]
 ds_read_b64_tr_b16 a[24:25], v252 offset:24576
 ds_read_b64_tr_b16 a[26:27], v252 offset:25600
 v_mfma_f32_32x32x16_bf16 a[80:95], a[44:47], a[32:35], a[80:95]
 ds_read_b128 a[16:19], v246
 ds_read_b64_tr_b16 a[28:29], v253 offset:24576
 s_add_u32 m0, s65, 81920
 s_nop 0
 buffer_load_dwordx4 v240, s[44:47], s67 offen lds
 v_mfma_f32_32x32x16_bf16 a[112:127], a[44:47], a[36:39], a[112:127]
 ds_read_b64_tr_b16 a[30:31], v253 offset:25600
 ds_read_b128 a[20:23], v246 offset:4096
 v_mfma_f32_32x32x16_bf16 a[96:111], a[40:43], a[36:39], a[96:111]
 buffer_load_dwordx4 v241, s[44:47], s67 offen offset:1024 lds
 s_waitcnt lgkmcnt(4)
 v_mfma_f32_32x32x16_bf16 a[64:79], a[56:59], a[48:51], a[64:79]
 ds_read_b64_tr_b16 a[40:41], v252 offset:28672
 ds_read_b64_tr_b16 a[42:43], v252 offset:29696
 s_mov_b32 s56, 52428800
 s_mov_b32 s60, 20480
 v_mfma_f32_32x32x16_bf16 a[80:95], a[60:63], a[48:51], a[80:95]
 ds_read_b128 a[32:35], v247
 ds_read_b64_tr_b16 a[44:45], v253 offset:28672
 buffer_load_dwordx4 v242, s[44:47], s67 offen offset:2048 lds
 v_mfma_f32_32x32x16_bf16 a[112:127], a[60:63], a[52:55], a[112:127]
 ds_read_b64_tr_b16 a[46:47], v253 offset:29696
 ds_read_b128 a[36:39], v247 offset:4096
 s_cmp_lt_u32 s71, 576
 s_cmov_b32 s56, 58720256
 s_cmov_b32 s60, 9216
 v_mfma_f32_32x32x16_bf16 a[96:111], a[56:59], a[52:55], a[96:111]
 buffer_load_dwordx4 v243, s[44:47], s67 offen offset:3072 lds
 s_add_u32 s67, s67, 221184
 s_cmp_lt_u32 s71, 576
 s_cselect_b32 s61, 1, 0
 s_waitcnt lgkmcnt(4)
 v_mfma_f32_32x32x16_bf16 a[64:79], a[24:27], a[16:19], a[64:79]
 s_waitcnt vmcnt(8)
 s_barrier
 ds_read_b64_tr_b16 a[56:57], v252 offset:49152
 ds_read_b64_tr_b16 a[58:59], v252 offset:50176
 s_lshl_b32 s62, s68, 2
 v_mfma_f32_32x32x16_bf16 a[80:95], a[28:31], a[16:19], a[80:95]
 ds_read_b128 a[48:51], v244 offset:32768
 ds_read_b64_tr_b16 a[60:61], v253 offset:49152
 s_add_u32 m0, s65, 98304
 s_nop 0
 buffer_load_dwordx4 v236, s[48:51], s66 offen lds
 v_mfma_f32_32x32x16_bf16 a[112:127], a[28:31], a[20:23], a[112:127]
 ds_read_b64_tr_b16 a[62:63], v253 offset:50176
 ds_read_b128 a[52:55], v244 offset:36864
 s_and_b32 s52, s28, 2
 s_add_u32 s62, s62, s52
 s_lshr_b32 s52, s62, 3
 v_mfma_f32_32x32x16_bf16 a[96:111], a[24:27], a[20:23], a[96:111]
 buffer_load_dwordx4 v237, s[48:51], s66 offen offset:1024 lds
 s_mul_i32 s52, s52, s60
 s_add_u32 s56, s56, s52
 s_and_b32 s62, s62, 7
 buffer_load_dword v31, v31, s[72:75], 0 offen offset:128 sc1
 s_waitcnt lgkmcnt(4)
 v_mfma_f32_32x32x16_bf16 a[64:79], a[40:43], a[32:35], a[64:79]
 ds_read_b64_tr_b16 a[24:25], v252 offset:53248
 ds_read_b64_tr_b16 a[26:27], v252 offset:54272
 v_mul_f32 v128, s70, v128
 v_mul_f32 v129, s70, v129
 v_mul_f32 v130, s70, v130
 v_mfma_f32_32x32x16_bf16 a[80:95], a[44:47], a[32:35], a[80:95]
 ds_read_b128 a[16:19], v245 offset:32768
 ds_read_b64_tr_b16 a[28:29], v253 offset:53248
 buffer_load_dwordx4 v238, s[48:51], s66 offen offset:2048 lds
 v_mul_f32 v131, s70, v131
 v_mfma_f32_32x32x16_bf16 a[112:127], a[44:47], a[36:39], a[112:127]
 ds_read_b64_tr_b16 a[30:31], v253 offset:54272
 ds_read_b128 a[20:23], v245 offset:36864
 v_mul_f32 v132, s70, v132
 v_mul_f32 v133, s70, v133
 v_mul_f32 v134, s70, v134
 v_mfma_f32_32x32x16_bf16 a[96:111], a[40:43], a[36:39], a[96:111]
 buffer_load_dwordx4 v239, s[48:51], s66 offen offset:3072 lds
 s_add_u32 s66, s66, 128
 v_mul_f32 v135, s70, v135
 v_mul_f32 v136, s70, v136
 s_waitcnt lgkmcnt(4)
 v_mfma_f32_32x32x16_bf16 a[64:79], a[56:59], a[48:51], a[64:79]
 ds_read_b64_tr_b16 a[40:41], v252 offset:57344
 ds_read_b64_tr_b16 a[42:43], v252 offset:58368
 v_mul_f32 v137, s70, v137
 v_mul_f32 v138, s70, v138
 v_mul_f32 v139, s70, v139
 v_mfma_f32_32x32x16_bf16 a[80:95], a[60:63], a[48:51], a[80:95]
 ds_read_b128 a[32:35], v246 offset:32768
 ds_read_b64_tr_b16 a[44:45], v253 offset:57344
 s_add_u32 m0, s65, 114688
 s_nop 0
 buffer_load_dwordx4 v240, s[44:47], s67 offen lds
 v_mfma_f32_32x32x16_bf16 a[112:127], a[60:63], a[52:55], a[112:127]
 ds_read_b64_tr_b16 a[46:47], v253 offset:58368
 ds_read_b128 a[36:39], v246 offset:36864
 v_mul_f32 v140, s70, v140
 v_mul_f32 v141, s70, v141
 v_mul_f32 v142, s70, v142
 v_mfma_f32_32x32x16_bf16 a[96:111], a[56:59], a[52:55], a[96:111]
 buffer_load_dwordx4 v241, s[44:47], s67 offen offset:1024 lds
 v_mul_f32 v143, s70, v143
 v_cvt_pk_bf16_f32 v224, v128, v129
 v_cvt_pk_bf16_f32 v225, v130, v131
 s_waitcnt lgkmcnt(4)
 v_mfma_f32_32x32x16_bf16 a[64:79], a[24:27], a[16:19], a[64:79]
 ds_read_b64_tr_b16 a[56:57], v252 offset:61440
 ds_read_b64_tr_b16 a[58:59], v252 offset:62464
 v_cvt_pk_bf16_f32 v226, v132, v133
 v_cvt_pk_bf16_f32 v227, v134, v135
 v_cvt_pk_bf16_f32 v228, v136, v137
 v_mfma_f32_32x32x16_bf16 a[80:95], a[28:31], a[16:19], a[80:95]
 ds_read_b128 a[48:51], v247 offset:32768
 ds_read_b64_tr_b16 a[60:61], v253 offset:61440
 buffer_load_dwordx4 v242, s[44:47], s67 offen offset:2048 lds
 v_cvt_pk_bf16_f32 v229, v138, v139
 v_mfma_f32_32x32x16_bf16 a[112:127], a[28:31], a[20:23], a[112:127]
 ds_read_b64_tr_b16 a[62:63], v253 offset:62464
 ds_read_b128 a[52:55], v247 offset:36864
 v_cvt_pk_bf16_f32 v230, v140, v141
 v_cvt_pk_bf16_f32 v231, v142, v143
 v_mul_f32 v144, s70, v144
 v_mfma_f32_32x32x16_bf16 a[96:111], a[24:27], a[20:23], a[96:111]
 buffer_load_dwordx4 v243, s[44:47], s67 offen offset:3072 lds
 s_add_u32 s67, s67, 221184
 v_mul_f32 v145, s70, v145
 v_mul_f32 v146, s70, v146
 s_waitcnt lgkmcnt(4)
 v_mfma_f32_32x32x16_bf16 a[64:79], a[40:43], a[32:35], a[64:79]
 s_waitcnt vmcnt(9)
 s_barrier
 ds_read_b64_tr_b16 a[24:25], v254 offset:16384
 ds_read_b64_tr_b16 a[26:27], v254 offset:17408
 v_mul_f32 v147, s70, v147
 v_mfma_f32_32x32x16_bf16 a[80:95], a[44:47], a[32:35], a[80:95]
 ds_read_b128 a[16:19], v248
 ds_read_b64_tr_b16 a[28:29], v255 offset:16384
 s_add_u32 m0, s65, 0
 s_nop 0
 buffer_load_dwordx4 v236, s[48:51], s66 offen lds
 v_mfma_f32_32x32x16_bf16 a[112:127], a[44:47], a[36:39], a[112:127]
 ds_read_b64_tr_b16 a[30:31], v255 offset:17408
 ds_read_b128 a[20:23], v248 offset:4096
 v_mul_f32 v148, s70, v148
 v_mul_f32 v149, s70, v149
 v_mul_f32 v150, s70, v150
 v_mfma_f32_32x32x16_bf16 a[96:111], a[40:43], a[36:39], a[96:111]
 buffer_load_dwordx4 v237, s[48:51], s66 offen offset:1024 lds
 v_mul_f32 v151, s70, v151
 v_mul_f32 v152, s70, v152
 v_mul_f32 v153, s70, v153
 s_waitcnt lgkmcnt(4)
 v_mfma_f32_32x32x16_bf16 a[64:79], a[56:59], a[48:51], a[64:79]
 ds_read_b64_tr_b16 a[40:41], v254 offset:20480
 ds_read_b64_tr_b16 a[42:43], v254 offset:21504
 v_mul_f32 v154, s70, v154
 v_mul_f32 v155, s70, v155
 v_mul_f32 v156, s70, v156
 v_mfma_f32_32x32x16_bf16 a[80:95], a[60:63], a[48:51], a[80:95]
 ds_read_b128 a[32:35], v249
 ds_read_b64_tr_b16 a[44:45], v255 offset:20480
 buffer_load_dwordx4 v238, s[48:51], s66 offen offset:2048 lds
 v_mul_f32 v157, s70, v157
 v_mfma_f32_32x32x16_bf16 a[112:127], a[60:63], a[52:55], a[112:127]
 ds_read_b64_tr_b16 a[46:47], v255 offset:21504
 ds_read_b128 a[36:39], v249 offset:4096
 v_mul_f32 v158, s70, v158
 v_mul_f32 v159, s70, v159
 v_cvt_pk_bf16_f32 v232, v144, v145
 v_mfma_f32_32x32x16_bf16 a[96:111], a[56:59], a[52:55], a[96:111]
 buffer_load_dwordx4 v239, s[48:51], s66 offen offset:3072 lds
 s_add_u32 s66, s66, 128
 v_cvt_pk_bf16_f32 v233, v146, v147
 v_cvt_pk_bf16_f32 v234, v148, v149
 s_waitcnt vmcnt(10)
 v_readfirstlane_b32 s64, v31
 s_cmp_lt_u32 s64, 8
 s_cbranch_scc1 L_kvspin_FT
L_kvok_FT:
 s_waitcnt lgkmcnt(2)
 v_mfma_f32_32x32x16_bf16 a[64:79], a[24:27], a[16:19], a[64:79]
 ds_read_b64_tr_b16 a[56:57], v254 offset:24576
 ds_read_b64_tr_b16 a[58:59], v254 offset:25600
 v_cvt_pk_bf16_f32 v235, v150, v151
 v_mul_f32 v160, s70, v160
 v_mul_f32 v161, s70, v161
 v_mfma_f32_32x32x16_bf16 a[80:95], a[28:31], a[16:19], a[80:95]
 ds_read_b128 a[48:51], v250
 ds_read_b64_tr_b16 a[60:61], v255 offset:24576
 s_add_u32 m0, s65, 16384
 s_nop 0
 buffer_load_dwordx4 v240, s[44:47], s67 offen lds
 v_mfma_f32_32x32x16_bf16 a[112:127], a[28:31], a[20:23], a[112:127]
 ds_read_b64_tr_b16 a[62:63], v255 offset:25600
 ds_read_b128 a[52:55], v250 offset:4096
 v_mul_f32 v162, s70, v162
 v_mul_f32 v163, s70, v163
 v_mul_f32 v164, s70, v164
 v_mfma_f32_32x32x16_bf16 a[96:111], a[24:27], a[20:23], a[96:111]
 buffer_load_dwordx4 v241, s[44:47], s67 offen offset:1024 lds
 v_mul_f32 v165, s70, v165
 v_mul_f32 v166, s70, v166
 v_mul_f32 v167, s70, v167
 v_mfma_f32_32x32x16_bf16 a[64:79], a[40:43], a[32:35], a[64:79]
 ds_read_b64_tr_b16 a[24:25], v254 offset:28672
 ds_read_b64_tr_b16 a[26:27], v254 offset:29696
 v_mul_f32 v168, s70, v168
 v_mul_f32 v169, s70, v169
 v_mul_f32 v170, s70, v170
 s_waitcnt lgkmcnt(4)
 v_mfma_f32_32x32x16_bf16 a[80:95], a[44:47], a[32:35], a[80:95]
 ds_read_b128 a[16:19], v251
 ds_read_b64_tr_b16 a[28:29], v255 offset:28672
 buffer_load_dwordx4 v242, s[44:47], s67 offen offset:2048 lds
 v_mul_f32 v171, s70, v171
 v_mfma_f32_32x32x16_bf16 a[112:127], a[44:47], a[36:39], a[112:127]
 ds_read_b64_tr_b16 a[30:31], v255 offset:29696
 ds_read_b128 a[20:23], v251 offset:4096
 v_mul_f32 v172, s70, v172
 v_mul_f32 v173, s70, v173
 v_mul_f32 v174, s70, v174
 v_mfma_f32_32x32x16_bf16 a[96:111], a[40:43], a[36:39], a[96:111]
 buffer_load_dwordx4 v243, s[44:47], s67 offen offset:3072 lds
 s_add_u32 s67, s67, 221184
 v_mul_f32 v175, s70, v175
 v_mul_f32 v176, s70, v176
 v_mfma_f32_32x32x16_bf16 a[64:79], a[56:59], a[48:51], a[64:79]
 s_waitcnt vmcnt(8)
 s_barrier
 ds_read_b64_tr_b16 a[40:41], v254 offset:49152
 ds_read_b64_tr_b16 a[42:43], v254 offset:50176
 v_mul_f32 v177, s70, v177
 s_waitcnt lgkmcnt(4)
 v_mfma_f32_32x32x16_bf16 a[80:95], a[60:63], a[48:51], a[80:95]
 ds_read_b128 a[32:35], v248 offset:32768
 ds_read_b64_tr_b16 a[44:45], v255 offset:49152
 s_add_u32 m0, s57, 131072
 s_add_u32 s64, s63, 0
 buffer_load_dwordx4 v15, s[36:39], s64 offen sc1 lds
 v_mfma_f32_32x32x16_bf16 a[112:127], a[60:63], a[52:55], a[112:127]
 ds_read_b64_tr_b16 a[46:47], v255 offset:50176
 ds_read_b128 a[36:39], v248 offset:36864
 v_mul_f32 v178, s70, v178
 v_mul_f32 v179, s70, v179
 v_mul_f32 v180, s70, v180
 v_mfma_f32_32x32x16_bf16 a[96:111], a[56:59], a[52:55], a[96:111]
 buffer_load_dwordx4 v15, s[36:39], s64 offen offset:1024 sc1 lds
 v_mul_f32 v181, s70, v181
 v_mul_f32 v182, s70, v182
 v_mul_f32 v183, s70, v183
 v_mfma_f32_32x32x16_bf16 a[64:79], a[24:27], a[16:19], a[64:79]
 ds_read_b64_tr_b16 a[56:57], v254 offset:53248
 ds_read_b64_tr_b16 a[58:59], v254 offset:54272
 s_add_u32 m0, s57, 147456
 s_add_u32 s64, s63, 8192
 v_mul_f32 v184, s70, v184
 s_waitcnt lgkmcnt(4)
 v_mfma_f32_32x32x16_bf16 a[80:95], a[28:31], a[16:19], a[80:95]
 ds_read_b128 a[48:51], v249 offset:32768
 ds_read_b64_tr_b16 a[60:61], v255 offset:53248
 buffer_load_dwordx4 v15, s[36:39], s64 offen sc1 lds
 v_mul_f32 v185, s70, v185
 v_mfma_f32_32x32x16_bf16 a[112:127], a[28:31], a[20:23], a[112:127]
 ds_read_b64_tr_b16 a[62:63], v255 offset:54272
 ds_read_b128 a[52:55], v249 offset:36864
 v_mul_f32 v186, s70, v186
 v_mul_f32 v187, s70, v187
 v_mul_f32 v188, s70, v188
 v_mfma_f32_32x32x16_bf16 a[96:111], a[24:27], a[20:23], a[96:111]
 buffer_load_dwordx4 v15, s[36:39], s64 offen offset:1024 sc1 lds
 v_mul_f32 v189, s70, v189
 v_mul_f32 v190, s70, v190
 v_mul_f32 v191, s70, v191
 v_mfma_f32_32x32x16_bf16 a[64:79], a[40:43], a[32:35], a[64:79]
 ds_read_b64_tr_b16 a[24:25], v254 offset:57344
 ds_read_b64_tr_b16 a[26:27], v254 offset:58368
 v_add_u32 v19, 32768, v14
 v_add_u32 v11, 98304, v19
 v_add_u32 v10, 114688, v19
 s_waitcnt lgkmcnt(4)
 v_mfma_f32_32x32x16_bf16 a[80:95], a[44:47], a[32:35], a[80:95]
 ds_read_b128 a[16:19], v250 offset:32768
 ds_read_b64_tr_b16 a[28:29], v255 offset:57344
 s_add_u32 m0, s57, 32768
 s_nop 0
 buffer_load_dwordx4 v12, s[36:39], s59 offen sc1 lds
 v_mfma_f32_32x32x16_bf16 a[112:127], a[44:47], a[36:39], a[112:127]
 ds_read_b64_tr_b16 a[30:31], v255 offset:58368
 ds_read_b128 a[20:23], v250 offset:36864
 s_lshl_b32 s55, s28, 5
 v_lshlrev_b32 v9, 2, v3
 v_sub_u32 v9, v2, v9
 v_mfma_f32_32x32x16_bf16 a[96:111], a[40:43], a[36:39], a[96:111]
 buffer_load_dwordx4 v12, s[36:39], s59 offen offset:1024 sc1 lds
 s_add_u32 m0, s57, 40960
 v_add_u32 v22, s55, v9
 v_mov_b32 v25, 0xf149f2ca
 v_mfma_f32_32x32x16_bf16 a[64:79], a[56:59], a[48:51], a[64:79]
 ds_read_b64_tr_b16 a[40:41], v254 offset:61440
 ds_read_b64_tr_b16 a[42:43], v254 offset:62464
 v_mov_b32 v20, 0
 v_mov_b32 v17, 0
 v_mov_b32 v18, 0
 s_waitcnt lgkmcnt(4)
 v_mfma_f32_32x32x16_bf16 a[80:95], a[60:63], a[48:51], a[80:95]
 ds_read_b128 a[32:35], v251 offset:32768
 ds_read_b64_tr_b16 a[44:45], v255 offset:61440
 buffer_load_dwordx4 v13, s[36:39], s59 offen sc1 lds
 s_add_u32 s57, s57, 16384
 v_mfma_f32_32x32x16_bf16 a[112:127], a[60:63], a[52:55], a[112:127]
 ds_read_b64_tr_b16 a[46:47], v255 offset:62464
 ds_read_b128 a[36:39], v251 offset:36864
 v_accvgpr_read_b32 v29, a147
 v_accvgpr_read_b32 v30, a148
 v_accvgpr_read_b32 v0, a149
 v_mfma_f32_32x32x16_bf16 a[96:111], a[56:59], a[52:55], a[96:111]
 buffer_load_dwordx4 v13, s[36:39], s59 offen offset:1024 sc1 lds
 s_and_b32 s57, s57, 0x1ffff
 v_accvgpr_read_b32 v7, a150
 v_accvgpr_read_b32 v28, a151
 v_mfma_f32_32x32x16_bf16 a[64:79], a[24:27], a[16:19], a[64:79]
 s_waitcnt vmcnt(8)
 s_barrier
 ds_read_b64_tr_b16 a[56:57], v252 offset:16384
 ds_read_b64_tr_b16 a[58:59], v252 offset:17408
 v_cvt_pk_bf16_f32 v236, v152, v153
 s_waitcnt lgkmcnt(4)
 v_mfma_f32_32x32x16_bf16 a[80:95], a[28:31], a[16:19], a[80:95]
 ds_read_b128 a[48:51], v244
 ds_read_b64_tr_b16 a[60:61], v253 offset:16384
 s_add_u32 s59, s59, 8192
 v_cvt_pk_bf16_f32 v237, v154, v155
 v_cvt_pk_bf16_f32 v238, v156, v157
 v_mfma_f32_32x32x16_bf16 a[112:127], a[28:31], a[20:23], a[112:127]
 ds_read_b64_tr_b16 a[62:63], v253 offset:17408
 ds_read_b128 a[52:55], v244 offset:4096
 s_add_u32 m0, s57, 32768
 s_nop 0
 buffer_load_dwordx4 v12, s[36:39], s59 offen sc1 lds
 v_mfma_f32_32x32x16_bf16 a[96:111], a[24:27], a[20:23], a[96:111]
 v_cvt_pk_bf16_f32 v239, v158, v159
 v_cvt_pk_bf16_f32 v240, v160, v161
 v_cvt_pk_bf16_f32 v241, v162, v163
 v_cvt_pk_bf16_f32 v242, v164, v165
 v_cvt_pk_bf16_f32 v243, v166, v167
 v_mfma_f32_32x32x16_bf16 a[64:79], a[40:43], a[32:35], a[64:79]
 ds_read_b64_tr_b16 a[24:25], v252 offset:20480
 ds_read_b64_tr_b16 a[26:27], v252 offset:21504
 buffer_load_dwordx4 v12, s[36:39], s59 offen offset:1024 sc1 lds
 s_add_u32 m0, s57, 40960
 s_waitcnt lgkmcnt(4)
 v_mfma_f32_32x32x16_bf16 a[80:95], a[44:47], a[32:35], a[80:95]
 ds_read_b128 a[16:19], v245
 ds_read_b64_tr_b16 a[28:29], v253 offset:20480
 v_mfma_f32_32x32x16_bf16 a[112:127], a[44:47], a[36:39], a[112:127]
 ds_read_b64_tr_b16 a[30:31], v253 offset:21504
 ds_read_b128 a[20:23], v245 offset:4096
 buffer_load_dwordx4 v13, s[36:39], s59 offen sc1 lds
 s_add_u32 s57, s57, 16384
 v_mfma_f32_32x32x16_bf16 a[96:111], a[40:43], a[36:39], a[96:111]
 v_mfma_f32_32x32x16_bf16 a[64:79], a[56:59], a[48:51], a[64:79]
 ds_read_b64_tr_b16 a[40:41], v252 offset:24576
 ds_read_b64_tr_b16 a[42:43], v252 offset:25600
 buffer_load_dwordx4 v13, s[36:39], s59 offen offset:1024 sc1 lds
 s_and_b32 s57, s57, 0x1ffff
 s_waitcnt lgkmcnt(4)
 v_mfma_f32_32x32x16_bf16 a[80:95], a[60:63], a[48:51], a[80:95]
 ds_read_b128 a[32:35], v246
 ds_read_b64_tr_b16 a[44:45], v253 offset:24576
 s_add_u32 s59, s59, 8192
 v_mfma_f32_32x32x16_bf16 a[112:127], a[60:63], a[52:55], a[112:127]
 ds_read_b64_tr_b16 a[46:47], v253 offset:25600
 ds_read_b128 a[36:39], v246 offset:4096
 s_add_u32 m0, s57, 32768
 s_nop 0
 buffer_load_dwordx4 v12, s[36:39], s59 offen sc1 lds
 v_mfma_f32_32x32x16_bf16 a[96:111], a[56:59], a[52:55], a[96:111]
 v_mfma_f32_32x32x16_bf16 a[64:79], a[24:27], a[16:19], a[64:79]
 ds_read_b64_tr_b16 a[56:57], v252 offset:28672
 ds_read_b64_tr_b16 a[58:59], v252 offset:29696
 buffer_load_dwordx4 v12, s[36:39], s59 offen offset:1024 sc1 lds
 s_add_u32 m0, s57, 40960
 s_waitcnt lgkmcnt(4)
 v_mfma_f32_32x32x16_bf16 a[80:95], a[28:31], a[16:19], a[80:95]
 ds_read_b128 a[48:51], v247
 ds_read_b64_tr_b16 a[60:61], v253 offset:28672
 v_mfma_f32_32x32x16_bf16 a[112:127], a[28:31], a[20:23], a[112:127]
 ds_read_b64_tr_b16 a[62:63], v253 offset:29696
 ds_read_b128 a[52:55], v247 offset:4096
 buffer_load_dwordx4 v13, s[36:39], s59 offen sc1 lds
 s_add_u32 s57, s57, 16384
 v_mfma_f32_32x32x16_bf16 a[96:111], a[24:27], a[20:23], a[96:111]
 v_mfma_f32_32x32x16_bf16 a[64:79], a[40:43], a[32:35], a[64:79]
 s_barrier
 v_cvt_pk_bf16_f32 v244, v168, v169
 v_cvt_pk_bf16_f32 v245, v170, v171
 v_cvt_pk_bf16_f32 v246, v172, v173
 v_cvt_pk_bf16_f32 v247, v174, v175
 s_waitcnt lgkmcnt(2)
 v_mfma_f32_32x32x16_bf16 a[80:95], a[44:47], a[32:35], a[80:95]
 buffer_load_dwordx4 v13, s[36:39], s59 offen offset:1024 sc1 lds
 s_and_b32 s57, s57, 0x1ffff
 v_cvt_pk_bf16_f32 v248, v176, v177
 v_cvt_pk_bf16_f32 v249, v178, v179
 v_mfma_f32_32x32x16_bf16 a[112:127], a[44:47], a[36:39], a[112:127]
 s_add_u32 s59, s59, 8192
 v_cvt_pk_bf16_f32 v250, v180, v181
 v_cvt_pk_bf16_f32 v251, v182, v183
 v_cvt_pk_bf16_f32 v252, v184, v185
 v_cvt_pk_bf16_f32 v253, v186, v187
 v_mfma_f32_32x32x16_bf16 a[96:111], a[40:43], a[36:39], a[96:111]
 s_add_u32 m0, s57, 32768
 s_nop 0
 buffer_load_dwordx4 v12, s[36:39], s59 offen sc1 lds
 v_cvt_pk_bf16_f32 v254, v188, v189
 v_mfma_f32_32x32x16_bf16 a[64:79], a[56:59], a[48:51], a[64:79]
 v_cvt_pk_bf16_f32 v255, v190, v191
 s_waitcnt lgkmcnt(0)
 v_mfma_f32_32x32x16_bf16 a[80:95], a[60:63], a[48:51], a[80:95]
 buffer_load_dwordx4 v12, s[36:39], s59 offen offset:1024 sc1 lds
 s_add_u32 m0, s57, 40960
 v_mfma_f32_32x32x16_bf16 a[112:127], a[60:63], a[52:55], a[112:127]
 v_mfma_f32_32x32x16_bf16 a[96:111], a[56:59], a[52:55], a[96:111]
 buffer_load_dwordx4 v13, s[36:39], s59 offen sc1 lds
 s_add_u32 s57, s57, 16384
 buffer_load_dwordx4 v13, s[36:39], s59 offen offset:1024 sc1 lds
 s_and_b32 s57, s57, 0x1ffff
 s_add_u32 s59, s59, 8192
 s_add_u32 m0, s57, 32768
 s_nop 0
 buffer_load_dwordx4 v12, s[36:39], s59 offen sc1 lds
 buffer_load_dwordx4 v12, s[36:39], s59 offen offset:1024 sc1 lds
 s_add_u32 m0, s57, 40960
 s_nop 0
 buffer_load_dwordx4 v13, s[36:39], s59 offen sc1 lds
 s_add_u32 s57, s57, 16384
 buffer_load_dwordx4 v13, s[36:39], s59 offen offset:1024 sc1 lds
 s_and_b32 s57, s57, 0x1ffff
 s_add_u32 s59, s59, 8192
 s_waitcnt vmcnt(20)
 s_barrier
 v_accvgpr_read_b32 v176, a152
 v_accvgpr_read_b32 v177, a153
 v_accvgpr_read_b32 v178, a154
 v_accvgpr_read_b32 v179, a155
 v_accvgpr_read_b32 v180, a156
 v_accvgpr_read_b32 v181, a157
 v_accvgpr_read_b32 v182, a158
 v_accvgpr_read_b32 v183, a159
 v_accvgpr_read_b32 v184, a160
 v_accvgpr_read_b32 v185, a161
 v_accvgpr_read_b32 v186, a162
 v_accvgpr_read_b32 v187, a163
 v_accvgpr_read_b32 v188, a164
 v_accvgpr_read_b32 v189, a165
 v_accvgpr_read_b32 v190, a166
 v_accvgpr_read_b32 v191, a167
 ds_read_b128 a[160:163], v11
 ds_read_b128 a[164:167], v11 offset:1024
 ds_read_b128 a[168:171], v11 offset:2048
 ds_read_b128 a[172:175], v11 offset:3072
 ds_read_b128 a[176:179], v11 offset:4096
 ds_read_b128 a[180:183], v11 offset:5120
 ds_read_b128 a[184:187], v11 offset:6144
 ds_read_b128 a[188:191], v11 offset:7168
 s_lshl_b32 s52, s28, 12
 v_add_u32 v9, s52, v14
 v_add_u32 v15, 32768, v9
 v_add_u32 v16, 16777216, v9
 v_accvgpr_read_b32 v96, a128
 v_accvgpr_read_b32 v97, a129
 v_accvgpr_read_b32 v98, a130
 v_accvgpr_read_b32 v99, a131
 v_accvgpr_read_b32 v100, a132
 v_accvgpr_read_b32 v101, a133
 v_accvgpr_read_b32 v102, a134
 v_accvgpr_read_b32 v103, a135
 v_accvgpr_read_b32 v104, a136
 v_accvgpr_read_b32 v105, a137
 v_accvgpr_read_b32 v106, a138
 v_accvgpr_read_b32 v107, a139
 v_accvgpr_read_b32 v108, a140
 v_accvgpr_read_b32 v109, a141
 v_accvgpr_read_b32 v110, a142
 v_accvgpr_read_b32 v111, a143
 v_accvgpr_read_b32 v112, a144
 v_accvgpr_read_b32 v113, a145
 v_accvgpr_read_b32 v114, a146
 s_cmp_eq_u32 s61, 0
 s_cselect_b32 s52, 1.0, 0x3eae1a93
 s_mov_b32 s53, s52
 s_lshl_b32 s34, s62, 10
 s_add_u32 s34, s34, s56
 s_add_u32 s35, s34, 1024
 s_lshl_b32 s71, s62, 7
 s_add_u32 s71, s71, s56
 s_add_u32 s71, s71, 8192
 v_accvgpr_read_b32 v64, a64
 v_accvgpr_read_b32 v65, a65
 v_accvgpr_read_b32 v66, a66
 v_accvgpr_read_b32 v67, a67
 v_accvgpr_read_b32 v68, a68
 v_accvgpr_read_b32 v69, a69
 v_accvgpr_read_b32 v70, a70
 v_accvgpr_read_b32 v71, a71
 v_accvgpr_read_b32 v72, a72
 v_accvgpr_read_b32 v73, a73
 v_accvgpr_read_b32 v74, a74
 v_accvgpr_read_b32 v75, a75
 v_accvgpr_read_b32 v76, a76
 v_accvgpr_read_b32 v77, a77
 v_accvgpr_read_b32 v78, a78
 v_accvgpr_read_b32 v79, a79
 v_pk_mul_f32 v[64:65], v[64:65], s[52:53]
 v_pk_mul_f32 v[66:67], v[66:67], s[52:53]
 v_pk_mul_f32 v[68:69], v[68:69], s[52:53]
 v_pk_mul_f32 v[70:71], v[70:71], s[52:53]
 v_pk_mul_f32 v[72:73], v[72:73], s[52:53]
 v_pk_mul_f32 v[74:75], v[74:75], s[52:53]
 v_pk_mul_f32 v[76:77], v[76:77], s[52:53]
 v_pk_mul_f32 v[78:79], v[78:79], s[52:53]
 v_cvt_pk_bf16_f32 v128, v64, v65
 v_cvt_pk_bf16_f32 v129, v66, v67
 v_cvt_pk_bf16_f32 v130, v68, v69
 v_cvt_pk_bf16_f32 v131, v70, v71
 v_cvt_pk_bf16_f32 v132, v72, v73
 v_cvt_pk_bf16_f32 v133, v74, v75
 v_cvt_pk_bf16_f32 v134, v76, v77
 v_cvt_pk_bf16_f32 v135, v78, v79
 v_accvgpr_read_b32 v64, a80
 v_accvgpr_read_b32 v65, a81
 v_accvgpr_read_b32 v66, a82
 v_accvgpr_read_b32 v67, a83
 v_accvgpr_read_b32 v68, a84
 v_accvgpr_read_b32 v69, a85
 v_accvgpr_read_b32 v70, a86
 v_accvgpr_read_b32 v71, a87
 v_accvgpr_read_b32 v72, a88
 v_accvgpr_read_b32 v73, a89
 v_accvgpr_read_b32 v74, a90
 v_accvgpr_read_b32 v75, a91
 v_accvgpr_read_b32 v76, a92
 v_accvgpr_read_b32 v77, a93
 v_accvgpr_read_b32 v78, a94
 v_accvgpr_read_b32 v79, a95
 v_pk_mul_f32 v[64:65], v[64:65], s[52:53]
 v_pk_mul_f32 v[66:67], v[66:67], s[52:53]
 v_pk_mul_f32 v[68:69], v[68:69], s[52:53]
 v_pk_mul_f32 v[70:71], v[70:71], s[52:53]
 v_pk_mul_f32 v[72:73], v[72:73], s[52:53]
 v_pk_mul_f32 v[74:75], v[74:75], s[52:53]
 v_pk_mul_f32 v[76:77], v[76:77], s[52:53]
 v_pk_mul_f32 v[78:79], v[78:79], s[52:53]
 v_cvt_pk_bf16_f32 v136, v64, v65
 v_cvt_pk_bf16_f32 v137, v66, v67
 v_cvt_pk_bf16_f32 v138, v68, v69
 v_cvt_pk_bf16_f32 v139, v70, v71
 v_cvt_pk_bf16_f32 v140, v72, v73
 v_cvt_pk_bf16_f32 v141, v74, v75
 v_cvt_pk_bf16_f32 v142, v76, v77
 v_cvt_pk_bf16_f32 v143, v78, v79
 v_accvgpr_read_b32 v64, a96
 v_accvgpr_read_b32 v65, a97
 v_accvgpr_read_b32 v66, a98
 v_accvgpr_read_b32 v67, a99
 v_accvgpr_read_b32 v68, a100
 v_accvgpr_read_b32 v69, a101
 v_accvgpr_read_b32 v70, a102
 v_accvgpr_read_b32 v71, a103
 v_accvgpr_read_b32 v72, a104
 v_accvgpr_read_b32 v73, a105
 v_accvgpr_read_b32 v74, a106
 v_accvgpr_read_b32 v75, a107
 v_accvgpr_read_b32 v76, a108
 v_accvgpr_read_b32 v77, a109
 v_accvgpr_read_b32 v78, a110
 v_accvgpr_read_b32 v79, a111
 v_pk_mul_f32 v[64:65], v[64:65], s[52:53]
 v_pk_mul_f32 v[66:67], v[66:67], s[52:53]
 v_pk_mul_f32 v[68:69], v[68:69], s[52:53]
 v_pk_mul_f32 v[70:71], v[70:71], s[52:53]
 v_pk_mul_f32 v[72:73], v[72:73], s[52:53]
 v_pk_mul_f32 v[74:75], v[74:75], s[52:53]
 v_pk_mul_f32 v[76:77], v[76:77], s[52:53]
 v_pk_mul_f32 v[78:79], v[78:79], s[52:53]
 s_waitcnt lgkmcnt(0)
 v_mfma_f32_32x32x16_bf16 v[80:95], a[160:163], v[224:227], 0
 v_cvt_pk_bf16_f32 v144, v64, v65
 v_cvt_pk_bf16_f32 v145, v66, v67
 v_cvt_pk_bf16_f32 v146, v68, v69
 v_cvt_pk_bf16_f32 v147, v70, v71
 v_cvt_pk_bf16_f32 v148, v72, v73
 v_cvt_pk_bf16_f32 v149, v74, v75
 v_mfma_f32_32x32x16_bf16 v[80:95], a[164:167], v[228:231], v[80:95]
 v_cvt_pk_bf16_f32 v150, v76, v77
 v_cvt_pk_bf16_f32 v151, v78, v79
 v_accvgpr_read_b32 v64, a112
 v_accvgpr_read_b32 v65, a113
 v_accvgpr_read_b32 v66, a114
 v_accvgpr_read_b32 v67, a115
 v_mfma_f32_32x32x16_bf16 v[80:95], a[168:171], v[232:235], v[80:95]
 v_accvgpr_read_b32 v68, a116
 v_accvgpr_read_b32 v69, a117
 v_accvgpr_read_b32 v70, a118
 v_accvgpr_read_b32 v71, a119
 v_accvgpr_read_b32 v72, a120
 v_accvgpr_read_b32 v73, a121
 v_mfma_f32_32x32x16_bf16 v[80:95], a[172:175], v[236:239], v[80:95]
 v_accvgpr_read_b32 v74, a122
 v_accvgpr_read_b32 v75, a123
 v_accvgpr_read_b32 v76, a124
 v_accvgpr_read_b32 v77, a125
 v_accvgpr_read_b32 v78, a126
 v_accvgpr_read_b32 v79, a127
 v_mfma_f32_32x32x16_bf16 v[80:95], a[176:179], v[240:243], v[80:95]
 v_mul_f32 v64, s52, v64
 v_mul_f32 v65, s52, v65
 v_mul_f32 v66, s52, v66
 v_mul_f32 v67, s52, v67
 v_mul_f32 v68, s52, v68
 v_mul_f32 v69, s52, v69
 v_mfma_f32_32x32x16_bf16 v[80:95], a[180:183], v[244:247], v[80:95]
 v_mul_f32 v70, s52, v70
 v_mul_f32 v71, s52, v71
 v_mul_f32 v72, s52, v72
 v_mul_f32 v73, s52, v73
 v_mul_f32 v74, s52, v74
 v_mul_f32 v75, s52, v75
 v_mfma_f32_32x32x16_bf16 v[80:95], a[184:187], v[248:251], v[80:95]
 v_mul_f32 v76, s52, v76
 v_mul_f32 v77, s52, v77
 v_mul_f32 v78, s52, v78
 v_mul_f32 v79, s52, v79
 v_cvt_pk_bf16_f32 v152, v64, v65
 v_cvt_pk_bf16_f32 v153, v66, v67
 v_mfma_f32_32x32x16_bf16 v[80:95], a[188:191], v[252:255], v[80:95]
 v_cvt_pk_bf16_f32 v154, v68, v69
 v_cvt_pk_bf16_f32 v155, v70, v71
 v_cvt_pk_bf16_f32 v156, v72, v73
 v_cvt_pk_bf16_f32 v157, v74, v75
 v_cvt_pk_bf16_f32 v158, v76, v77
 v_cvt_pk_bf16_f32 v159, v78, v79
 s_cmp_eq_u32 s32, 0
 s_cselect_b32 s60, s28, 64
 s_cmp_eq_u32 s32, 7
 s_cselect_b32 s61, s28, 64
 s_mov_b32 s56, 114688
 v_cmp_eq_u32 s[42:43], 16, v107
 v_cmp_eq_u32 s[44:45], 16, v108
 v_cmp_eq_u32 s[46:47], 16, v109
 v_cmp_eq_u32 s[48:49], 16, v110
 v_cmp_eq_u32 s[50:51], 16, v111
 v_cmp_eq_u32 s[40:41], 16, v112
 v_cmp_eq_u32 s[66:67], 16, v113
 v_cmp_eq_u32 s[68:69], 16, v114
 s_cmp_eq_u64 s[42:43], 0
 s_cbranch_scc1 L_aq_np0
 s_mov_b64 exec, s[42:43]
 buffer_store_dword v128, v105, s[36:39], s71 offen sc1
 buffer_store_dword v129, v106, s[36:39], s71 offen sc1
 buffer_store_dword v144, v105, s[36:39], s71 offen offset:128 sc1
 buffer_store_dword v145, v106, s[36:39], s71 offen offset:128 sc1
 s_mov_b64 exec, -1
L_aq_np0:
 s_cmp_eq_u64 s[44:45], 0
 s_cbranch_scc1 L_aq_np1
 s_mov_b64 exec, s[44:45]
 buffer_store_dword v130, v105, s[36:39], s71 offen sc1
 buffer_store_dword v131, v106, s[36:39], s71 offen sc1
 buffer_store_dword v146, v105, s[36:39], s71 offen offset:128 sc1
 buffer_store_dword v147, v106, s[36:39], s71 offen offset:128 sc1
 s_mov_b64 exec, -1
L_aq_np1:
 s_cmp_eq_u64 s[46:47], 0
 s_cbranch_scc1 L_aq_np2
 s_mov_b64 exec, s[46:47]
 buffer_store_dword v132, v105, s[36:39], s71 offen sc1
 buffer_store_dword v133, v106, s[36:39], s71 offen sc1
 buffer_store_dword v148, v105, s[36:39], s71 offen offset:128 sc1
 buffer_store_dword v149, v106, s[36:39], s71 offen offset:128 sc1
 s_mov_b64 exec, -1
L_aq_np2:
 s_cmp_eq_u64 s[48:49], 0
 s_cbranch_scc1 L_aq_np3
 s_mov_b64 exec, s[48:49]
 buffer_store_dword v134, v105, s[36:39], s71 offen sc1
 buffer_store_dword v135, v106, s[36:39], s71 offen sc1
 buffer_store_dword v150, v105, s[36:39], s71 offen offset:128 sc1
 buffer_store_dword v151, v106, s[36:39], s71 offen offset:128 sc1
 s_mov_b64 exec, -1
L_aq_np3:
 s_cmp_eq_u64 s[50:51], 0
 s_cbranch_scc1 L_aq_np4
 s_mov_b64 exec, s[50:51]
 buffer_store_dword v136, v105, s[36:39], s71 offen sc1
 buffer_store_dword v137, v106, s[36:39], s71 offen sc1
 buffer_store_dword v152, v105, s[36:39], s71 offen offset:128 sc1
 buffer_store_dword v153, v106, s[36:39], s71 offen offset:128 sc1
 s_mov_b64 exec, -1
L_aq_np4:
 s_cmp_eq_u64 s[40:41], 0
 s_cbranch_scc1 L_aq_np5
 s_mov_b64 exec, s[40:41]
 buffer_store_dword v138, v105, s[36:39], s71 offen sc1
 buffer_store_dword v139, v106, s[36:39], s71 offen sc1
 buffer_store_dword v154, v105, s[36:39], s71 offen offset:128 sc1
 buffer_store_dword v155, v106, s[36:39], s71 offen offset:128 sc1
 s_mov_b64 exec, -1
L_aq_np5:
 s_cmp_eq_u64 s[66:67], 0
 s_cbranch_scc1 L_aq_np6
 s_mov_b64 exec, s[66:67]
 buffer_store_dword v140, v105, s[36:39], s71 offen sc1
 buffer_store_dword v141, v106, s[36:39], s71 offen sc1
 buffer_store_dword v156, v105, s[36:39], s71 offen offset:128 sc1
 buffer_store_dword v157, v106, s[36:39], s71 offen offset:128 sc1
 s_mov_b64 exec, -1
L_aq_np6:
 s_cmp_eq_u64 s[68:69], 0
 s_cbranch_scc1 L_aq_np7
 s_mov_b64 exec, s[68:69]
 buffer_store_dword v142, v105, s[36:39], s71 offen sc1
 buffer_store_dword v143, v106, s[36:39], s71 offen sc1
 buffer_store_dword v158, v105, s[36:39], s71 offen offset:128 sc1
 buffer_store_dword v159, v106, s[36:39], s71 offen offset:128 sc1
 s_mov_b64 exec, -1
L_aq_np7:
 s_cmp_eq_u32 s60, 0
 s_cselect_b32 s64, 1.0, 0
 s_cmp_lt_u32 s60, 0
 s_cselect_b32 s65, 0xf149f2ca, 0
 v_add_f32 v23, s65, v20
 v_fma_f32 v32, v176, s64, v23
 buffer_store_dwordx4 v[128:131], v96, s[36:39], s34 offen sc1
 v_fma_f32 v33, v177, s64, v23
 v_fma_f32 v34, v178, s64, v23
 v_fma_f32 v35, v179, s64, v23
 v_fma_f32 v36, v180, s64, v23
 v_fma_f32 v37, v181, s64, v23
 v_fma_f32 v38, v182, s64, v23
 v_fma_f32 v39, v183, s64, v23
 v_fma_f32 v40, v184, s64, v23
 buffer_store_dwordx4 v[130:133], v97, s[36:39], s34 offen sc1
 v_fma_f32 v41, v185, s64, v23
 v_fma_f32 v42, v186, s64, v23
 v_fma_f32 v43, v187, s64, v23
 v_fma_f32 v44, v188, s64, v23
 v_fma_f32 v45, v189, s64, v23
 v_fma_f32 v46, v190, s64, v23
 v_fma_f32 v47, v191, s64, v23
 buffer_store_dwordx4 v[132:135], v98, s[36:39], s34 offen sc1
 s_nop 1
 v_mfma_f32_32x32x16_bf16 v[64:79], a[160:163], v[192:195], v[32:47]
 ds_read_b128 a[128:131], v10
 ds_read_b128 a[132:135], v10 offset:1024
 ds_read_b128 a[136:139], v10 offset:2048
 v_max3_f32 v21, v80, v81, v82
 v_max3_f32 v21, v21, v83, v84
 buffer_store_dwordx4 v[134:137], v99, s[36:39], s34 offen sc1
 v_max3_f32 v21, v21, v85, v86
 v_max3_f32 v21, v21, v87, v88
 v_max3_f32 v21, v21, v89, v90
 v_max3_f32 v21, v21, v91, v92
 v_mfma_f32_32x32x16_bf16 v[64:79], a[164:167], v[196:199], v[64:79]
 ds_read_b128 a[140:143], v10 offset:3072
 ds_read_b128 a[144:147], v10 offset:4096
 ds_read_b128 a[148:151], v10 offset:5120
 buffer_store_dwordx4 v[136:139], v100, s[36:39], s34 offen sc1
 v_max3_f32 v21, v21, v93, v94
 v_max_f32 v21, v21, v95
 v_mov_b32 v8, v21
 s_nop 1
 v_permlane32_swap_b32 v21, v8
 s_nop 1
 v_mfma_f32_32x32x16_bf16 v[64:79], a[168:171], v[200:203], v[64:79]
 buffer_store_dwordx4 v[138:141], v101, s[36:39], s34 offen sc1
 v_max_f32 v21, v21, v8
 v_sub_f32 v21, 0, v21
 v_add_f32 v80, v80, v21
 v_add_f32 v81, v81, v21
 v_add_f32 v82, v82, v21
 v_add_f32 v83, v83, v21
 v_mfma_f32_32x32x16_bf16 v[64:79], a[172:175], v[204:207], v[64:79]
 v_add_f32 v84, v84, v21
 buffer_store_dwordx4 v[140:143], v102, s[36:39], s34 offen sc1
 v_add_f32 v85, v85, v21
 v_add_f32 v86, v86, v21
 v_add_f32 v87, v87, v21
 v_add_f32 v88, v88, v21
 v_add_f32 v89, v89, v21
 v_mfma_f32_32x32x16_bf16 v[64:79], a[176:179], v[208:211], v[64:79]
 v_add_f32 v90, v90, v21
 buffer_store_dwordx2 v[128:129], v103, s[36:39], s34 offen sc1
 v_add_f32 v91, v91, v21
 v_add_f32 v92, v92, v21
 v_add_f32 v93, v93, v21
 v_add_f32 v94, v94, v21
 v_add_f32 v95, v95, v21
 v_mfma_f32_32x32x16_bf16 v[64:79], a[180:183], v[212:215], v[64:79]
 v_mov_b32 v48, v21
 v_mov_b32 v49, v21
 buffer_store_dwordx2 v[142:143], v104, s[36:39], s34 offen sc1
 v_mov_b32 v50, v21
 v_mov_b32 v51, v21
 v_mov_b32 v52, v21
 v_mov_b32 v53, v21
 v_mfma_f32_32x32x16_bf16 v[64:79], a[184:187], v[216:219], v[64:79]
 v_mov_b32 v54, v21
 v_mov_b32 v55, v21
 buffer_store_dwordx4 v[144:147], v96, s[36:39], s35 offen sc1
 v_mov_b32 v56, v21
 v_mov_b32 v57, v21
 v_mov_b32 v58, v21
 v_mov_b32 v59, v21
 v_mfma_f32_32x32x16_bf16 v[64:79], a[188:191], v[220:223], v[64:79]
 v_mov_b32 v60, v21
 v_mov_b32 v61, v21
 buffer_store_dwordx4 v[146:149], v97, s[36:39], s35 offen sc1
 v_mov_b32 v62, v21
 v_mov_b32 v63, v21
 s_nop 7
 v_max3_f32 v20, v64, v65, v66
 v_max3_f32 v20, v20, v67, v68
 v_max3_f32 v20, v20, v69, v70
 v_max3_f32 v20, v20, v71, v72
 v_max3_f32 v20, v20, v73, v74
 buffer_store_dwordx4 v[148:151], v98, s[36:39], s35 offen sc1
 v_max3_f32 v20, v20, v75, v76
 v_max3_f32 v20, v20, v77, v78
 v_max_f32 v20, v20, v79
 v_mov_b32 v8, v20
 s_nop 1
 v_permlane32_swap_b32 v20, v8
 s_nop 1
 buffer_store_dwordx4 v[150:153], v99, s[36:39], s35 offen sc1
 v_max_f32 v20, v20, v8
 v_sub_f32 v20, 0, v20
 v_add_f32 v64, v64, v20
 v_add_f32 v65, v65, v20
 v_add_f32 v66, v66, v20
 v_add_f32 v67, v67, v20
 v_add_f32 v68, v68, v20
 v_add_f32 v69, v69, v20
 buffer_store_dwordx4 v[152:155], v100, s[36:39], s35 offen sc1
 v_add_f32 v70, v70, v20
 v_add_f32 v71, v71, v20
 v_add_f32 v72, v72, v20
 v_add_f32 v73, v73, v20
 v_add_f32 v74, v74, v20
 v_add_f32 v75, v75, v20
 v_add_f32 v76, v76, v20
 buffer_store_dwordx4 v[154:157], v101, s[36:39], s35 offen sc1
 v_add_f32 v77, v77, v20
 v_add_f32 v78, v78, v20
 v_add_f32 v79, v79, v20
 s_cmp_eq_u32 s60, 1
 s_cselect_b32 s64, 1.0, 0
 s_cmp_lt_u32 s60, 1
 s_cselect_b32 s65, 0xf149f2ca, 0
 v_add_f32 v23, s65, v20
 buffer_store_dwordx4 v[156:159], v102, s[36:39], s35 offen sc1
 v_fma_f32 v32, v176, s64, v23
 v_fma_f32 v33, v177, s64, v23
 v_fma_f32 v34, v178, s64, v23
 v_fma_f32 v35, v179, s64, v23
 v_fma_f32 v36, v180, s64, v23
 v_fma_f32 v37, v181, s64, v23
 v_fma_f32 v38, v182, s64, v23
 buffer_store_dwordx2 v[144:145], v103, s[36:39], s35 offen sc1
 v_fma_f32 v39, v183, s64, v23
 v_fma_f32 v40, v184, s64, v23
 v_fma_f32 v41, v185, s64, v23
 v_fma_f32 v42, v186, s64, v23
 v_fma_f32 v43, v187, s64, v23
 v_fma_f32 v44, v188, s64, v23
 v_fma_f32 v45, v189, s64, v23
 buffer_store_dwordx2 v[158:159], v104, s[36:39], s35 offen sc1
 v_fma_f32 v46, v190, s64, v23
 v_fma_f32 v47, v191, s64, v23
 s_waitcnt lgkmcnt(0)
 s_nop 0
 s_branch L_attn
L_aq_V:
 v_mfma_f32_32x32x16_bf16 a[64:79], a[16:19], a[24:27], 0
 ds_read_b64_tr_b16 a[56:57], v252 offset:24576
 ds_read_b64_tr_b16 a[58:59], v252 offset:25600
 v_lshlrev_b32 v14, 4, v1
 s_lshl_b32 s63, s31, 19
 s_lshl_b32 s57, s28, 11
 v_mfma_f32_32x32x16_bf16 a[80:95], a[16:19], a[28:31], 0
 ds_read_b128 a[48:51], v246
 ds_read_b64_tr_b16 a[60:61], v253 offset:24576
 v_add_u32 v15, s57, v14
 v_add_u32 v12, 16384, v15
 v_add_u32 v13, 16777216, v15
 v_mfma_f32_32x32x16_bf16 a[112:127], a[20:23], a[28:31], 0
 ds_read_b64_tr_b16 a[62:63], v253 offset:25600
 ds_read_b128 a[52:55], v246 offset:4096
 s_mov_b32 s59, s63
 v_lshlrev_b32 v9, 2, v3
 v_add_u32 v9, v9, v4
 v_mfma_f32_32x32x16_bf16 a[96:111], a[20:23], a[24:27], 0
 v_mul_u32_u24 v9, 320, v9
 v_lshl_add_u32 v9, v5, 5, v9
 v_lshl_add_u32 v9, v6, 3, v9
 s_mul_i32 s55, s28, 5120
 v_add_u32 v26, s55, v9
 s_waitcnt lgkmcnt(4)
 v_mfma_f32_32x32x16_bf16 a[64:79], a[32:35], a[40:43], a[64:79]
 ds_read_b64_tr_b16 a[24:25], v252 offset:28672
 ds_read_b64_tr_b16 a[26:27], v252 offset:29696
 s_lshr_b32 s55, s28, 1
 s_and_b32 s55, s55, s28
 s_lshl_b32 s55, s55, 31
 v_mfma_f32_32x32x16_bf16 a[80:95], a[32:35], a[44:47], a[80:95]
 ds_read_b128 a[16:19], v247
 ds_read_b64_tr_b16 a[28:29], v253 offset:28672
 v_or_b32 v27, s55, v14
 v_mul_f32 v64, s70, v64
 v_mul_f32 v65, s70, v65
 v_mfma_f32_32x32x16_bf16 a[112:127], a[36:39], a[44:47], a[112:127]
 ds_read_b64_tr_b16 a[30:31], v253 offset:29696
 ds_read_b128 a[20:23], v247 offset:4096
 v_mul_f32 v66, s70, v66
 v_mul_f32 v67, s70, v67
 v_mul_f32 v68, s70, v68
 v_mfma_f32_32x32x16_bf16 a[96:111], a[36:39], a[40:43], a[96:111]
 v_mul_f32 v69, s70, v69
 v_mul_f32 v70, s70, v70
 v_mul_f32 v71, s70, v71
 v_mul_f32 v72, s70, v72
 v_mul_f32 v73, s70, v73
 s_waitcnt lgkmcnt(4)
 v_mfma_f32_32x32x16_bf16 a[64:79], a[48:51], a[56:59], a[64:79]
 s_waitcnt vmcnt(9)
 s_barrier
 ds_read_b64_tr_b16 a[40:41], v252 offset:49152
 ds_read_b64_tr_b16 a[42:43], v252 offset:50176
 v_mul_f32 v74, s70, v74
 v_mfma_f32_32x32x16_bf16 a[80:95], a[48:51], a[60:63], a[80:95]
 ds_read_b128 a[32:35], v244 offset:32768
 ds_read_b64_tr_b16 a[44:45], v253 offset:49152
 s_add_u32 m0, s65, 98304
 s_nop 0
 buffer_load_dwordx4 v236, s[48:51], s66 offen lds
 v_mfma_f32_32x32x16_bf16 a[112:127], a[52:55], a[60:63], a[112:127]
 ds_read_b64_tr_b16 a[46:47], v253 offset:50176
 ds_read_b128 a[36:39], v244 offset:36864
 v_mul_f32 v75, s70, v75
 v_mul_f32 v76, s70, v76
 v_mul_f32 v77, s70, v77
 v_mfma_f32_32x32x16_bf16 a[96:111], a[52:55], a[56:59], a[96:111]
 buffer_load_dwordx4 v237, s[48:51], s66 offen offset:1024 lds
 v_mul_f32 v78, s70, v78
 v_mul_f32 v79, s70, v79
 v_cvt_pk_bf16_f32 v192, v64, v65
 s_waitcnt lgkmcnt(4)
 v_mfma_f32_32x32x16_bf16 a[64:79], a[16:19], a[24:27], a[64:79]
 ds_read_b64_tr_b16 a[56:57], v252 offset:53248
 ds_read_b64_tr_b16 a[58:59], v252 offset:54272
 v_cvt_pk_bf16_f32 v193, v66, v67
 v_cvt_pk_bf16_f32 v194, v68, v69
 v_cvt_pk_bf16_f32 v195, v70, v71
 v_mfma_f32_32x32x16_bf16 a[80:95], a[16:19], a[28:31], a[80:95]
 ds_read_b128 a[48:51], v245 offset:32768
 ds_read_b64_tr_b16 a[60:61], v253 offset:53248
 buffer_load_dwordx4 v238, s[48:51], s66 offen offset:2048 lds
 v_cvt_pk_bf16_f32 v196, v72, v73
 v_mfma_f32_32x32x16_bf16 a[112:127], a[20:23], a[28:31], a[112:127]
 ds_read_b64_tr_b16 a[62:63], v253 offset:54272
 ds_read_b128 a[52:55], v245 offset:36864
 v_cvt_pk_bf16_f32 v197, v74, v75
 v_cvt_pk_bf16_f32 v198, v76, v77
 v_cvt_pk_bf16_f32 v199, v78, v79
 v_mfma_f32_32x32x16_bf16 a[96:111], a[20:23], a[24:27], a[96:111]
 buffer_load_dwordx4 v239, s[48:51], s66 offen offset:3072 lds
 s_add_u32 s66, s66, 128
 v_mul_f32 v80, s70, v80
 v_mul_f32 v81, s70, v81
 s_waitcnt lgkmcnt(4)
 v_mfma_f32_32x32x16_bf16 a[64:79], a[32:35], a[40:43], a[64:79]
 ds_read_b64_tr_b16 a[24:25], v252 offset:57344
 ds_read_b64_tr_b16 a[26:27], v252 offset:58368
 v_mul_f32 v82, s70, v82
 v_mul_f32 v83, s70, v83
 v_mul_f32 v84, s70, v84
 v_mfma_f32_32x32x16_bf16 a[80:95], a[32:35], a[44:47], a[80:95]
 ds_read_b128 a[16:19], v246 offset:32768
 ds_read_b64_tr_b16 a[28:29], v253 offset:57344
 s_add_u32 m0, s65, 114688
 s_nop 0
 buffer_load_dwordx4 v240, s[44:47], s67 offen lds
 v_mfma_f32_32x32x16_bf16 a[112:127], a[36:39], a[44:47], a[112:127]
 ds_read_b64_tr_b16 a[30:31], v253 offset:58368
 ds_read_b128 a[20:23], v246 offset:36864
 v_mul_f32 v85, s70, v85
 v_mul_f32 v86, s70, v86
 v_mul_f32 v87, s70, v87
 v_mfma_f32_32x32x16_bf16 a[96:111], a[36:39], a[40:43], a[96:111]
 buffer_load_dwordx4 v241, s[44:47], s67 offen offset:1024 lds
 v_mul_f32 v88, s70, v88
 v_mul_f32 v89, s70, v89
 v_mul_f32 v90, s70, v90
 s_waitcnt lgkmcnt(4)
 v_mfma_f32_32x32x16_bf16 a[64:79], a[48:51], a[56:59], a[64:79]
 ds_read_b64_tr_b16 a[40:41], v252 offset:61440
 ds_read_b64_tr_b16 a[42:43], v252 offset:62464
 v_mul_f32 v91, s70, v91
 v_mul_f32 v92, s70, v92
 v_mul_f32 v93, s70, v93
 v_mfma_f32_32x32x16_bf16 a[80:95], a[48:51], a[60:63], a[80:95]
 ds_read_b128 a[32:35], v247 offset:32768
 ds_read_b64_tr_b16 a[44:45], v253 offset:61440
 buffer_load_dwordx4 v242, s[44:47], s67 offen offset:2048 lds
 v_mul_f32 v94, s70, v94
 v_mfma_f32_32x32x16_bf16 a[112:127], a[52:55], a[60:63], a[112:127]
 ds_read_b64_tr_b16 a[46:47], v253 offset:62464
 ds_read_b128 a[36:39], v247 offset:36864
 v_mul_f32 v95, s70, v95
 v_cvt_pk_bf16_f32 v200, v80, v81
 v_cvt_pk_bf16_f32 v201, v82, v83
 v_mfma_f32_32x32x16_bf16 a[96:111], a[52:55], a[56:59], a[96:111]
 buffer_load_dwordx4 v243, s[44:47], s67 offen offset:3072 lds
 s_add_u32 s67, s67, 221184
 v_cvt_pk_bf16_f32 v202, v84, v85
 v_cvt_pk_bf16_f32 v203, v86, v87
 s_waitcnt lgkmcnt(4)
 v_mfma_f32_32x32x16_bf16 a[64:79], a[16:19], a[24:27], a[64:79]
 s_waitcnt vmcnt(8)
 s_barrier
 ds_read_b64_tr_b16 a[56:57], v254 offset:16384
 ds_read_b64_tr_b16 a[58:59], v254 offset:17408
 v_cvt_pk_bf16_f32 v204, v88, v89
 v_mfma_f32_32x32x16_bf16 a[80:95], a[16:19], a[28:31], a[80:95]
 ds_read_b128 a[48:51], v248
 ds_read_b64_tr_b16 a[60:61], v255 offset:16384
 s_add_u32 m0, s65, 0
 s_nop 0
 buffer_load_dwordx4 v236, s[48:51], s66 offen lds
 v_mfma_f32_32x32x16_bf16 a[112:127], a[20:23], a[28:31], a[112:127]
 ds_read_b64_tr_b16 a[62:63], v255 offset:17408
 ds_read_b128 a[52:55], v248 offset:4096
 v_cvt_pk_bf16_f32 v205, v90, v91
 v_cvt_pk_bf16_f32 v206, v92, v93
 v_cvt_pk_bf16_f32 v207, v94, v95
 v_mfma_f32_32x32x16_bf16 a[96:111], a[20:23], a[24:27], a[96:111]
 buffer_load_dwordx4 v237, s[48:51], s66 offen offset:1024 lds
 v_mul_f32 v96, s70, v96
 v_mul_f32 v97, s70, v97
 v_mul_f32 v98, s70, v98
 s_waitcnt lgkmcnt(4)
 v_mfma_f32_32x32x16_bf16 a[64:79], a[32:35], a[40:43], a[64:79]
 ds_read_b64_tr_b16 a[24:25], v254 offset:20480
 ds_read_b64_tr_b16 a[26:27], v254 offset:21504
 v_mul_f32 v99, s70, v99
 v_mul_f32 v100, s70, v100
 v_mul_f32 v101, s70, v101
 v_mfma_f32_32x32x16_bf16 a[80:95], a[32:35], a[44:47], a[80:95]
 ds_read_b128 a[16:19], v249
 ds_read_b64_tr_b16 a[28:29], v255 offset:20480
 buffer_load_dwordx4 v238, s[48:51], s66 offen offset:2048 lds
 v_mul_f32 v102, s70, v102
 v_mfma_f32_32x32x16_bf16 a[112:127], a[36:39], a[44:47], a[112:127]
 ds_read_b64_tr_b16 a[30:31], v255 offset:21504
 ds_read_b128 a[20:23], v249 offset:4096
 v_mul_f32 v103, s70, v103
 v_mul_f32 v104, s70, v104
 v_mul_f32 v105, s70, v105
 v_mfma_f32_32x32x16_bf16 a[96:111], a[36:39], a[40:43], a[96:111]
 buffer_load_dwordx4 v239, s[48:51], s66 offen offset:3072 lds
 s_add_u32 s66, s66, 128
 v_mul_f32 v106, s70, v106
 v_mul_f32 v107, s70, v107
 s_waitcnt lgkmcnt(4)
 v_mfma_f32_32x32x16_bf16 a[64:79], a[48:51], a[56:59], a[64:79]
 ds_read_b64_tr_b16 a[40:41], v254 offset:24576
 ds_read_b64_tr_b16 a[42:43], v254 offset:25600
 v_mul_f32 v108, s70, v108
 v_mul_f32 v109, s70, v109
 v_mul_f32 v110, s70, v110
 v_mfma_f32_32x32x16_bf16 a[80:95], a[48:51], a[60:63], a[80:95]
 ds_read_b128 a[32:35], v250
 ds_read_b64_tr_b16 a[44:45], v255 offset:24576
 s_add_u32 m0, s65, 16384
 s_nop 0
 buffer_load_dwordx4 v240, s[44:47], s67 offen lds
 v_mfma_f32_32x32x16_bf16 a[112:127], a[52:55], a[60:63], a[112:127]
 ds_read_b64_tr_b16 a[46:47], v255 offset:25600
 ds_read_b128 a[36:39], v250 offset:4096
 v_mul_f32 v111, s70, v111
 v_cvt_pk_bf16_f32 v208, v96, v97
 v_cvt_pk_bf16_f32 v209, v98, v99
 v_mfma_f32_32x32x16_bf16 a[96:111], a[52:55], a[56:59], a[96:111]
 buffer_load_dwordx4 v241, s[44:47], s67 offen offset:1024 lds
 v_cvt_pk_bf16_f32 v210, v100, v101
 v_cvt_pk_bf16_f32 v211, v102, v103
 v_cvt_pk_bf16_f32 v212, v104, v105
 s_waitcnt lgkmcnt(4)
 v_mfma_f32_32x32x16_bf16 a[64:79], a[16:19], a[24:27], a[64:79]
 ds_read_b64_tr_b16 a[56:57], v254 offset:28672
 ds_read_b64_tr_b16 a[58:59], v254 offset:29696
 v_cvt_pk_bf16_f32 v213, v106, v107
 v_cvt_pk_bf16_f32 v214, v108, v109
 v_cvt_pk_bf16_f32 v215, v110, v111
 v_mfma_f32_32x32x16_bf16 a[80:95], a[16:19], a[28:31], a[80:95]
 ds_read_b128 a[48:51], v251
 ds_read_b64_tr_b16 a[60:61], v255 offset:28672
 buffer_load_dwordx4 v242, s[44:47], s67 offen offset:2048 lds
 v_mul_f32 v112, s70, v112
 v_mfma_f32_32x32x16_bf16 a[112:127], a[20:23], a[28:31], a[112:127]
 ds_read_b64_tr_b16 a[62:63], v255 offset:29696
 ds_read_b128 a[52:55], v251 offset:4096
 v_mul_f32 v113, s70, v113
 v_mul_f32 v114, s70, v114
 v_mul_f32 v115, s70, v115
 v_mfma_f32_32x32x16_bf16 a[96:111], a[20:23], a[24:27], a[96:111]
 buffer_load_dwordx4 v243, s[44:47], s67 offen offset:3072 lds
 s_add_u32 s67, s67, 221184
 v_mul_f32 v116, s70, v116
 v_mul_f32 v117, s70, v117
 s_waitcnt lgkmcnt(4)
 v_mfma_f32_32x32x16_bf16 a[64:79], a[32:35], a[40:43], a[64:79]
 s_waitcnt vmcnt(8)
 s_barrier
 ds_read_b64_tr_b16 a[24:25], v254 offset:49152
 ds_read_b64_tr_b16 a[26:27], v254 offset:50176
 v_mul_f32 v118, s70, v118
 v_mfma_f32_32x32x16_bf16 a[80:95], a[32:35], a[44:47], a[80:95]
 ds_read_b128 a[16:19], v248 offset:32768
 ds_read_b64_tr_b16 a[28:29], v255 offset:49152
 s_add_u32 m0, s65, 32768
 s_nop 0
 buffer_load_dwordx4 v236, s[48:51], s66 offen lds
 v_mfma_f32_32x32x16_bf16 a[112:127], a[36:39], a[44:47], a[112:127]
 ds_read_b64_tr_b16 a[30:31], v255 offset:50176
 ds_read_b128 a[20:23], v248 offset:36864
 v_mul_f32 v119, s70, v119
 v_mul_f32 v120, s70, v120
 v_mul_f32 v121, s70, v121
 v_mfma_f32_32x32x16_bf16 a[96:111], a[36:39], a[40:43], a[96:111]
 buffer_load_dwordx4 v237, s[48:51], s66 offen offset:1024 lds
 v_mul_f32 v122, s70, v122
 v_mul_f32 v123, s70, v123
 v_mul_f32 v124, s70, v124
 s_waitcnt lgkmcnt(4)
 v_mfma_f32_32x32x16_bf16 a[64:79], a[48:51], a[56:59], a[64:79]
 ds_read_b64_tr_b16 a[40:41], v254 offset:53248
 ds_read_b64_tr_b16 a[42:43], v254 offset:54272
 v_mul_f32 v125, s70, v125
 v_mul_f32 v126, s70, v126
 v_mul_f32 v127, s70, v127
 v_mfma_f32_32x32x16_bf16 a[80:95], a[48:51], a[60:63], a[80:95]
 ds_read_b128 a[32:35], v249 offset:32768
 ds_read_b64_tr_b16 a[44:45], v255 offset:53248
 buffer_load_dwordx4 v238, s[48:51], s66 offen offset:2048 lds
 v_cvt_pk_bf16_f32 v216, v112, v113
 v_mfma_f32_32x32x16_bf16 a[112:127], a[52:55], a[60:63], a[112:127]
 ds_read_b64_tr_b16 a[46:47], v255 offset:54272
 ds_read_b128 a[36:39], v249 offset:36864
 v_cvt_pk_bf16_f32 v217, v114, v115
 v_cvt_pk_bf16_f32 v218, v116, v117
 v_cvt_pk_bf16_f32 v219, v118, v119
 v_mfma_f32_32x32x16_bf16 a[96:111], a[52:55], a[56:59], a[96:111]
 buffer_load_dwordx4 v239, s[48:51], s66 offen offset:3072 lds
 s_add_u32 s66, s66, 128
 v_cvt_pk_bf16_f32 v220, v120, v121
 v_cvt_pk_bf16_f32 v221, v122, v123
 s_waitcnt lgkmcnt(4)
 v_mfma_f32_32x32x16_bf16 a[64:79], a[16:19], a[24:27], a[64:79]
 ds_read_b64_tr_b16 a[56:57], v254 offset:57344
 ds_read_b64_tr_b16 a[58:59], v254 offset:58368
 v_cvt_pk_bf16_f32 v222, v124, v125
 v_cvt_pk_bf16_f32 v223, v126, v127
 s_lshl_b32 s64, s31, 2
 v_mfma_f32_32x32x16_bf16 a[80:95], a[16:19], a[28:31], a[80:95]
 ds_read_b128 a[48:51], v250 offset:32768
 ds_read_b64_tr_b16 a[60:61], v255 offset:57344
 s_add_u32 m0, s65, 49152
 s_nop 0
 buffer_load_dwordx4 v240, s[44:47], s67 offen lds
 v_mfma_f32_32x32x16_bf16 a[112:127], a[20:23], a[28:31], a[112:127]
 ds_read_b64_tr_b16 a[62:63], v255 offset:58368
 ds_read_b128 a[52:55], v250 offset:36864
 v_mov_b32 v31, s64
 v_mfma_f32_32x32x16_bf16 a[96:111], a[20:23], a[24:27], a[96:111]
 buffer_load_dwordx4 v241, s[44:47], s67 offen offset:1024 lds
 s_waitcnt lgkmcnt(4)
 v_mfma_f32_32x32x16_bf16 a[64:79], a[32:35], a[40:43], a[64:79]
 ds_read_b64_tr_b16 a[24:25], v254 offset:61440
 ds_read_b64_tr_b16 a[26:27], v254 offset:62464
 v_mfma_f32_32x32x16_bf16 a[80:95], a[32:35], a[44:47], a[80:95]
 ds_read_b128 a[16:19], v251 offset:32768
 ds_read_b64_tr_b16 a[28:29], v255 offset:61440
 buffer_load_dwordx4 v242, s[44:47], s67 offen offset:2048 lds
 v_mfma_f32_32x32x16_bf16 a[112:127], a[36:39], a[44:47], a[112:127]
 ds_read_b64_tr_b16 a[30:31], v255 offset:62464
 ds_read_b128 a[20:23], v251 offset:36864
 v_mfma_f32_32x32x16_bf16 a[96:111], a[36:39], a[40:43], a[96:111]
 buffer_load_dwordx4 v243, s[44:47], s67 offen offset:3072 lds
 s_add_u32 s67, s67, 221184
 s_waitcnt lgkmcnt(4)
 v_mfma_f32_32x32x16_bf16 a[64:79], a[48:51], a[56:59], a[64:79]
 s_waitcnt vmcnt(8)
 s_barrier
 ds_read_b64_tr_b16 a[40:41], v252 offset:16384
 ds_read_b64_tr_b16 a[42:43], v252 offset:17408
 v_mfma_f32_32x32x16_bf16 a[80:95], a[48:51], a[60:63], a[80:95]
 ds_read_b128 a[32:35], v244
 ds_read_b64_tr_b16 a[44:45], v253 offset:16384
 s_add_u32 m0, s65, 65536
 s_nop 0
 buffer_load_dwordx4 v236, s[48:51], s66 offen lds
 v_mfma_f32_32x32x16_bf16 a[112:127], a[52:55], a[60:63], a[112:127]
 ds_read_b64_tr_b16 a[46:47], v253 offset:17408
 ds_read_b128 a[36:39], v244 offset:4096
 v_mfma_f32_32x32x16_bf16 a[96:111], a[52:55], a[56:59], a[96:111]
 buffer_load_dwordx4 v237, s[48:51], s66 offen offset:1024 lds
 s_waitcnt lgkmcnt(4)
 v_mfma_f32_32x32x16_bf16 a[64:79], a[16:19], a[24:27], a[64:79]
 ds_read_b64_tr_b16 a[56:57], v252 offset:20480
 ds_read_b64_tr_b16 a[58:59], v252 offset:21504
 v_mfma_f32_32x32x16_bf16 a[80:95], a[16:19], a[28:31], a[80:95]
 ds_read_b128 a[48:51], v245
 ds_read_b64_tr_b16 a[60:61], v253 offset:20480
 buffer_load_dwordx4 v238, s[48:51], s66 offen offset:2048 lds
 v_mfma_f32_32x32x16_bf16 a[112:127], a[20:23], a[28:31], a[112:127]
 ds_read_b64_tr_b16 a[62:63], v253 offset:21504
 ds_read_b128 a[52:55], v245 offset:4096
 v_mfma_f32_32x32x16_bf16 a[96:111], a[20:23], a[24:27], a[96:111]
 buffer_load_dwordx4 v239, s[48:51], s66 offen offset:3072 lds
 s_add_u32 s66, s66, 128
 s_waitcnt lgkmcnt(4)
 v_mfma_f32_32x32x16_bf16 a[64:79], a[32:35], a[40:43], a[64:79]
 ds_read_b64_tr_b16 a[24:25], v252 offset:24576
 ds_read_b64_tr_b16 a[26:27], v252 offset:25600
 v_mfma_f32_32x32x16_bf16 a[80:95], a[32:35], a[44:47], a[80:95]
 ds_read_b128 a[16:19], v246
 ds_read_b64_tr_b16 a[28:29], v253 offset:24576
 s_add_u32 m0, s65, 81920
 s_nop 0
 buffer_load_dwordx4 v240, s[44:47], s67 offen lds
 v_mfma_f32_32x32x16_bf16 a[112:127], a[36:39], a[44:47], a[112:127]
 ds_read_b64_tr_b16 a[30:31], v253 offset:25600
 ds_read_b128 a[20:23], v246 offset:4096
 v_mfma_f32_32x32x16_bf16 a[96:111], a[36:39], a[40:43], a[96:111]
 buffer_load_dwordx4 v241, s[44:47], s67 offen offset:1024 lds
 s_waitcnt lgkmcnt(4)
 v_mfma_f32_32x32x16_bf16 a[64:79], a[48:51], a[56:59], a[64:79]
 ds_read_b64_tr_b16 a[40:41], v252 offset:28672
 ds_read_b64_tr_b16 a[42:43], v252 offset:29696
 s_sub_u32 s71, s71, 1152
 s_lshl_b32 s62, s68, 2
 s_and_b32 s52, s28, 2
 v_mfma_f32_32x32x16_bf16 a[80:95], a[48:51], a[60:63], a[80:95]
 ds_read_b128 a[32:35], v247
 ds_read_b64_tr_b16 a[44:45], v253 offset:28672
 buffer_load_dwordx4 v242, s[44:47], s67 offen offset:2048 lds
 s_add_u32 s62, s62, s52
 v_mfma_f32_32x32x16_bf16 a[112:127], a[52:55], a[60:63], a[112:127]
 ds_read_b64_tr_b16 a[46:47], v253 offset:29696
 ds_read_b128 a[36:39], v247 offset:4096
 s_lshr_b32 s52, s62, 3
 s_mul_i32 s56, s52, 20480
 s_and_b32 s62, s62, 7
 v_mfma_f32_32x32x16_bf16 a[96:111], a[52:55], a[56:59], a[96:111]
 buffer_load_dwordx4 v243, s[44:47], s67 offen offset:3072 lds
 s_add_u32 s67, s67, 221184
 s_mul_i32 s52, s62, 1280
 s_add_u32 s56, s56, s52
 s_waitcnt lgkmcnt(4)
 v_mfma_f32_32x32x16_bf16 a[64:79], a[16:19], a[24:27], a[64:79]
 s_waitcnt vmcnt(8)
 s_barrier
 ds_read_b64_tr_b16 a[56:57], v252 offset:49152
 ds_read_b64_tr_b16 a[58:59], v252 offset:50176
 s_add_u32 s56, s56, 52438016
 v_mfma_f32_32x32x16_bf16 a[80:95], a[16:19], a[28:31], a[80:95]
 ds_read_b128 a[48:51], v244 offset:32768
 ds_read_b64_tr_b16 a[60:61], v253 offset:49152
 s_add_u32 m0, s65, 98304
 s_nop 0
 buffer_load_dwordx4 v236, s[48:51], s66 offen lds
 v_mfma_f32_32x32x16_bf16 a[112:127], a[20:23], a[28:31], a[112:127]
 ds_read_b64_tr_b16 a[62:63], v253 offset:50176
 ds_read_b128 a[52:55], v244 offset:36864
 s_mov_b32 s53, 3641
 s_mov_b32 s34, 163840
 v_mul_u32_u24 v52, 320, v3
 v_mfma_f32_32x32x16_bf16 a[96:111], a[20:23], a[24:27], a[96:111]
 buffer_load_dwordx4 v237, s[48:51], s66 offen offset:1024 lds
 v_mov_b32 v55, 0x80000000
 s_add_u32 s52, s71, 0
 v_add_u32 v56, s52, v2
 buffer_load_dword v31, v31, s[72:75], 0 offen offset:128 sc1
 s_waitcnt lgkmcnt(4)
 v_mfma_f32_32x32x16_bf16 a[64:79], a[32:35], a[40:43], a[64:79]
 ds_read_b64_tr_b16 a[24:25], v252 offset:53248
 ds_read_b64_tr_b16 a[26:27], v252 offset:54272
 v_mul_lo_u32 v57, v56, s53
 v_lshrrev_b32 v57, 16, v57
 v_mul_u32_u24 v58, 18, v57
 v_mfma_f32_32x32x16_bf16 a[80:95], a[32:35], a[44:47], a[80:95]
 ds_read_b128 a[16:19], v245 offset:32768
 ds_read_b64_tr_b16 a[28:29], v253 offset:53248
 buffer_load_dwordx4 v238, s[48:51], s66 offen offset:2048 lds
 v_sub_u32 v58, v56, v58
 v_mfma_f32_32x32x16_bf16 a[112:127], a[36:39], a[44:47], a[112:127]
 ds_read_b64_tr_b16 a[30:31], v253 offset:54272
 ds_read_b128 a[20:23], v245 offset:36864
 v_mul_lo_u32 v57, v57, s34
 v_lshlrev_b32 v58, 4, v58
 v_cmp_gt_u32 vcc, 576, v56
 v_mfma_f32_32x32x16_bf16 a[96:111], a[36:39], a[40:43], a[96:111]
 buffer_load_dwordx4 v239, s[48:51], s66 offen offset:3072 lds
 s_add_u32 s66, s66, 128
 v_add3_u32 v58, v58, v57, v52
 s_nop 0
 s_waitcnt lgkmcnt(4)
 v_mfma_f32_32x32x16_bf16 a[64:79], a[48:51], a[56:59], a[64:79]
 ds_read_b64_tr_b16 a[40:41], v252 offset:57344
 ds_read_b64_tr_b16 a[42:43], v252 offset:58368
 v_cndmask_b32 v32, v55, v58, vcc
 s_add_u32 s52, s71, 32
 v_add_u32 v56, s52, v2
 v_mfma_f32_32x32x16_bf16 a[80:95], a[48:51], a[60:63], a[80:95]
 ds_read_b128 a[32:35], v246 offset:32768
 ds_read_b64_tr_b16 a[44:45], v253 offset:57344
 s_add_u32 m0, s65, 114688
 s_nop 0
 buffer_load_dwordx4 v240, s[44:47], s67 offen lds
 v_mfma_f32_32x32x16_bf16 a[112:127], a[52:55], a[60:63], a[112:127]
 ds_read_b64_tr_b16 a[46:47], v253 offset:58368
 ds_read_b128 a[36:39], v246 offset:36864
 v_mul_lo_u32 v57, v56, s53
 v_lshrrev_b32 v57, 16, v57
 v_mul_u32_u24 v58, 18, v57
 v_mfma_f32_32x32x16_bf16 a[96:111], a[52:55], a[56:59], a[96:111]
 buffer_load_dwordx4 v241, s[44:47], s67 offen offset:1024 lds
 v_sub_u32 v58, v56, v58
 v_mul_lo_u32 v57, v57, s34
 v_lshlrev_b32 v58, 4, v58
 s_waitcnt lgkmcnt(4)
 v_mfma_f32_32x32x16_bf16 a[64:79], a[16:19], a[24:27], a[64:79]
 ds_read_b64_tr_b16 a[56:57], v252 offset:61440
 ds_read_b64_tr_b16 a[58:59], v252 offset:62464
 v_cmp_gt_u32 vcc, 576, v56
 v_add3_u32 v58, v58, v57, v52
 s_nop 0
 v_mfma_f32_32x32x16_bf16 a[80:95], a[16:19], a[28:31], a[80:95]
 ds_read_b128 a[48:51], v247 offset:32768
 ds_read_b64_tr_b16 a[60:61], v253 offset:61440
 buffer_load_dwordx4 v242, s[44:47], s67 offen offset:2048 lds
 v_cndmask_b32 v33, v55, v58, vcc
 v_mfma_f32_32x32x16_bf16 a[112:127], a[20:23], a[28:31], a[112:127]
 ds_read_b64_tr_b16 a[62:63], v253 offset:62464
 ds_read_b128 a[52:55], v247 offset:36864
 v_mul_f32 v128, s70, v128
 v_mul_f32 v129, s70, v129
 v_mul_f32 v130, s70, v130
 v_mfma_f32_32x32x16_bf16 a[96:111], a[20:23], a[24:27], a[96:111]
 buffer_load_dwordx4 v243, s[44:47], s67 offen offset:3072 lds
 s_add_u32 s67, s67, 221184
 v_mul_f32 v131, s70, v131
 v_mul_f32 v132, s70, v132
 s_waitcnt lgkmcnt(4)
 v_mfma_f32_32x32x16_bf16 a[64:79], a[32:35], a[40:43], a[64:79]
 s_waitcnt vmcnt(9)
 s_barrier
 ds_read_b64_tr_b16 a[24:25], v254 offset:16384
 ds_read_b64_tr_b16 a[26:27], v254 offset:17408
 v_mul_f32 v133, s70, v133
 v_mfma_f32_32x32x16_bf16 a[80:95], a[32:35], a[44:47], a[80:95]
 ds_read_b128 a[16:19], v248
 ds_read_b64_tr_b16 a[28:29], v255 offset:16384
 s_add_u32 m0, s65, 0
 s_nop 0
 buffer_load_dwordx4 v236, s[48:51], s66 offen lds
 v_mfma_f32_32x32x16_bf16 a[112:127], a[36:39], a[44:47], a[112:127]
 ds_read_b64_tr_b16 a[30:31], v255 offset:17408
 ds_read_b128 a[20:23], v248 offset:4096
 v_mul_f32 v134, s70, v134
 v_mul_f32 v135, s70, v135
 v_mul_f32 v136, s70, v136
 v_mfma_f32_32x32x16_bf16 a[96:111], a[36:39], a[40:43], a[96:111]
 buffer_load_dwordx4 v237, s[48:51], s66 offen offset:1024 lds
 v_mul_f32 v137, s70, v137
 v_mul_f32 v138, s70, v138
 v_mul_f32 v139, s70, v139
 s_waitcnt lgkmcnt(4)
 v_mfma_f32_32x32x16_bf16 a[64:79], a[48:51], a[56:59], a[64:79]
 ds_read_b64_tr_b16 a[40:41], v254 offset:20480
 ds_read_b64_tr_b16 a[42:43], v254 offset:21504
 v_mul_f32 v140, s70, v140
 v_mul_f32 v141, s70, v141
 v_mul_f32 v142, s70, v142
 v_mfma_f32_32x32x16_bf16 a[80:95], a[48:51], a[60:63], a[80:95]
 ds_read_b128 a[32:35], v249
 ds_read_b64_tr_b16 a[44:45], v255 offset:20480
 buffer_load_dwordx4 v238, s[48:51], s66 offen offset:2048 lds
 v_mul_f32 v143, s70, v143
 v_mfma_f32_32x32x16_bf16 a[112:127], a[52:55], a[60:63], a[112:127]
 ds_read_b64_tr_b16 a[46:47], v255 offset:21504
 ds_read_b128 a[36:39], v249 offset:4096
 v_cvt_pk_bf16_f32 v224, v128, v129
 v_cvt_pk_bf16_f32 v225, v130, v131
 v_cvt_pk_bf16_f32 v226, v132, v133
 v_mfma_f32_32x32x16_bf16 a[96:111], a[52:55], a[56:59], a[96:111]
 buffer_load_dwordx4 v239, s[48:51], s66 offen offset:3072 lds
 s_add_u32 s66, s66, 128
 v_cvt_pk_bf16_f32 v227, v134, v135
 v_cvt_pk_bf16_f32 v228, v136, v137
 s_waitcnt vmcnt(10)
 v_readfirstlane_b32 s64, v31
 s_cmp_lt_u32 s64, 8
 s_cbranch_scc1 L_kvspin_TF
L_kvok_TF:
 s_waitcnt lgkmcnt(2)
 v_mfma_f32_32x32x16_bf16 a[64:79], a[16:19], a[24:27], a[64:79]
 ds_read_b64_tr_b16 a[56:57], v254 offset:24576
 ds_read_b64_tr_b16 a[58:59], v254 offset:25600
 v_cvt_pk_bf16_f32 v229, v138, v139
 v_cvt_pk_bf16_f32 v230, v140, v141
 v_cvt_pk_bf16_f32 v231, v142, v143
 v_mfma_f32_32x32x16_bf16 a[80:95], a[16:19], a[28:31], a[80:95]
 ds_read_b128 a[48:51], v250
 ds_read_b64_tr_b16 a[60:61], v255 offset:24576
 s_add_u32 m0, s65, 16384
 s_nop 0
 buffer_load_dwordx4 v240, s[44:47], s67 offen lds
 v_mfma_f32_32x32x16_bf16 a[112:127], a[20:23], a[28:31], a[112:127]
 ds_read_b64_tr_b16 a[62:63], v255 offset:25600
 ds_read_b128 a[52:55], v250 offset:4096
 v_mul_f32 v144, s70, v144
 v_mul_f32 v145, s70, v145
 v_mul_f32 v146, s70, v146
 v_mfma_f32_32x32x16_bf16 a[96:111], a[20:23], a[24:27], a[96:111]
 buffer_load_dwordx4 v241, s[44:47], s67 offen offset:1024 lds
 v_mul_f32 v147, s70, v147
 v_mul_f32 v148, s70, v148
 v_mul_f32 v149, s70, v149
 v_mfma_f32_32x32x16_bf16 a[64:79], a[32:35], a[40:43], a[64:79]
 ds_read_b64_tr_b16 a[24:25], v254 offset:28672
 ds_read_b64_tr_b16 a[26:27], v254 offset:29696
 v_mul_f32 v150, s70, v150
 v_mul_f32 v151, s70, v151
 v_mul_f32 v152, s70, v152
 s_waitcnt lgkmcnt(4)
 v_mfma_f32_32x32x16_bf16 a[80:95], a[32:35], a[44:47], a[80:95]
 ds_read_b128 a[16:19], v251
 ds_read_b64_tr_b16 a[28:29], v255 offset:28672
 buffer_load_dwordx4 v242, s[44:47], s67 offen offset:2048 lds
 v_mul_f32 v153, s70, v153
 v_mfma_f32_32x32x16_bf16 a[112:127], a[36:39], a[44:47], a[112:127]
 ds_read_b64_tr_b16 a[30:31], v255 offset:29696
 ds_read_b128 a[20:23], v251 offset:4096
 v_mul_f32 v154, s70, v154
 v_mul_f32 v155, s70, v155
 v_mul_f32 v156, s70, v156
 v_mfma_f32_32x32x16_bf16 a[96:111], a[36:39], a[40:43], a[96:111]
 buffer_load_dwordx4 v243, s[44:47], s67 offen offset:3072 lds
 s_add_u32 s67, s67, 221184
 v_mul_f32 v157, s70, v157
 v_mul_f32 v158, s70, v158
 v_mfma_f32_32x32x16_bf16 a[64:79], a[48:51], a[56:59], a[64:79]
 s_waitcnt vmcnt(8)
 s_barrier
 ds_read_b64_tr_b16 a[40:41], v254 offset:49152
 ds_read_b64_tr_b16 a[42:43], v254 offset:50176
 v_mul_f32 v159, s70, v159
 s_waitcnt lgkmcnt(4)
 v_mfma_f32_32x32x16_bf16 a[80:95], a[48:51], a[60:63], a[80:95]
 ds_read_b128 a[32:35], v248 offset:32768
 ds_read_b64_tr_b16 a[44:45], v255 offset:49152
 s_add_u32 m0, s57, 131072
 s_add_u32 s64, s63, 0
 buffer_load_dwordx4 v15, s[36:39], s64 offen sc1 lds
 v_mfma_f32_32x32x16_bf16 a[112:127], a[52:55], a[60:63], a[112:127]
 ds_read_b64_tr_b16 a[46:47], v255 offset:50176
 ds_read_b128 a[36:39], v248 offset:36864
 v_cvt_pk_bf16_f32 v232, v144, v145
 v_cvt_pk_bf16_f32 v233, v146, v147
 v_cvt_pk_bf16_f32 v234, v148, v149
 v_mfma_f32_32x32x16_bf16 a[96:111], a[52:55], a[56:59], a[96:111]
 buffer_load_dwordx4 v15, s[36:39], s64 offen offset:1024 sc1 lds
 v_cvt_pk_bf16_f32 v235, v150, v151
 v_mul_f32 v160, s70, v160
 v_mul_f32 v161, s70, v161
 v_mfma_f32_32x32x16_bf16 a[64:79], a[16:19], a[24:27], a[64:79]
 ds_read_b64_tr_b16 a[56:57], v254 offset:53248
 ds_read_b64_tr_b16 a[58:59], v254 offset:54272
 s_add_u32 m0, s57, 147456
 s_add_u32 s64, s63, 8192
 v_mul_f32 v162, s70, v162
 s_waitcnt lgkmcnt(4)
 v_mfma_f32_32x32x16_bf16 a[80:95], a[16:19], a[28:31], a[80:95]
 ds_read_b128 a[48:51], v249 offset:32768
 ds_read_b64_tr_b16 a[60:61], v255 offset:53248
 buffer_load_dwordx4 v15, s[36:39], s64 offen sc1 lds
 v_mul_f32 v163, s70, v163
 v_mfma_f32_32x32x16_bf16 a[112:127], a[20:23], a[28:31], a[112:127]
 ds_read_b64_tr_b16 a[62:63], v255 offset:54272
 ds_read_b128 a[52:55], v249 offset:36864
 v_mul_f32 v164, s70, v164
 v_mul_f32 v165, s70, v165
 v_mul_f32 v166, s70, v166
 v_mfma_f32_32x32x16_bf16 a[96:111], a[20:23], a[24:27], a[96:111]
 buffer_load_dwordx4 v15, s[36:39], s64 offen offset:1024 sc1 lds
 v_mul_f32 v167, s70, v167
 v_mul_f32 v168, s70, v168
 v_mul_f32 v169, s70, v169
 v_mfma_f32_32x32x16_bf16 a[64:79], a[32:35], a[40:43], a[64:79]
 ds_read_b64_tr_b16 a[24:25], v254 offset:57344
 ds_read_b64_tr_b16 a[26:27], v254 offset:58368
 v_mul_f32 v170, s70, v170
 v_mul_f32 v171, s70, v171
 v_mul_f32 v172, s70, v172
 s_waitcnt lgkmcnt(4)
 v_mfma_f32_32x32x16_bf16 a[80:95], a[32:35], a[44:47], a[80:95]
 ds_read_b128 a[16:19], v250 offset:32768
 ds_read_b64_tr_b16 a[28:29], v255 offset:57344
 s_add_u32 m0, s57, 32768
 s_nop 0
 buffer_load_dwordx4 v12, s[36:39], s59 offen sc1 lds
 v_mfma_f32_32x32x16_bf16 a[112:127], a[36:39], a[44:47], a[112:127]
 ds_read_b64_tr_b16 a[30:31], v255 offset:58368
 ds_read_b128 a[20:23], v250 offset:36864
 v_mul_f32 v173, s70, v173
 v_mul_f32 v174, s70, v174
 v_mul_f32 v175, s70, v175
 v_mfma_f32_32x32x16_bf16 a[96:111], a[36:39], a[40:43], a[96:111]
 buffer_load_dwordx4 v12, s[36:39], s59 offen offset:1024 sc1 lds
 s_add_u32 m0, s57, 40960
 v_mul_f32 v176, s70, v176
 v_mul_f32 v177, s70, v177
 v_mfma_f32_32x32x16_bf16 a[64:79], a[48:51], a[56:59], a[64:79]
 ds_read_b64_tr_b16 a[40:41], v254 offset:61440
 ds_read_b64_tr_b16 a[42:43], v254 offset:62464
 v_mul_f32 v178, s70, v178
 v_mul_f32 v179, s70, v179
 v_mul_f32 v180, s70, v180
 s_waitcnt lgkmcnt(4)
 v_mfma_f32_32x32x16_bf16 a[80:95], a[48:51], a[60:63], a[80:95]
 ds_read_b128 a[32:35], v251 offset:32768
 ds_read_b64_tr_b16 a[44:45], v255 offset:61440
 buffer_load_dwordx4 v13, s[36:39], s59 offen sc1 lds
 s_add_u32 s57, s57, 16384
 v_mfma_f32_32x32x16_bf16 a[112:127], a[52:55], a[60:63], a[112:127]
 ds_read_b64_tr_b16 a[46:47], v255 offset:62464
 ds_read_b128 a[36:39], v251 offset:36864
 v_mul_f32 v181, s70, v181
 v_mul_f32 v182, s70, v182
 v_mul_f32 v183, s70, v183
 v_mfma_f32_32x32x16_bf16 a[96:111], a[52:55], a[56:59], a[96:111]
 buffer_load_dwordx4 v13, s[36:39], s59 offen offset:1024 sc1 lds
 s_and_b32 s57, s57, 0x1ffff
 v_mul_f32 v184, s70, v184
 v_mul_f32 v185, s70, v185
 v_mfma_f32_32x32x16_bf16 a[64:79], a[16:19], a[24:27], a[64:79]
 s_waitcnt vmcnt(8)
 s_barrier
 ds_read_b64_tr_b16 a[56:57], v252 offset:16384
 ds_read_b64_tr_b16 a[58:59], v252 offset:17408
 v_mul_f32 v186, s70, v186
 s_waitcnt lgkmcnt(4)
 v_mfma_f32_32x32x16_bf16 a[80:95], a[16:19], a[28:31], a[80:95]
 ds_read_b128 a[48:51], v244
 ds_read_b64_tr_b16 a[60:61], v253 offset:16384
 s_add_u32 s59, s59, 8192
 v_mul_f32 v187, s70, v187
 v_mul_f32 v188, s70, v188
 v_mfma_f32_32x32x16_bf16 a[112:127], a[20:23], a[28:31], a[112:127]
 ds_read_b64_tr_b16 a[62:63], v253 offset:17408
 ds_read_b128 a[52:55], v244 offset:4096
 s_add_u32 m0, s57, 32768
 s_nop 0
 buffer_load_dwordx4 v12, s[36:39], s59 offen sc1 lds
 v_mfma_f32_32x32x16_bf16 a[96:111], a[20:23], a[24:27], a[96:111]
 v_mul_f32 v189, s70, v189
 v_mul_f32 v190, s70, v190
 v_mul_f32 v191, s70, v191
 v_add_u32 v19, 32768, v14
 v_add_u32 v11, 98304, v19
 v_mfma_f32_32x32x16_bf16 a[64:79], a[32:35], a[40:43], a[64:79]
 ds_read_b64_tr_b16 a[24:25], v252 offset:20480
 ds_read_b64_tr_b16 a[26:27], v252 offset:21504
 buffer_load_dwordx4 v12, s[36:39], s59 offen offset:1024 sc1 lds
 s_add_u32 m0, s57, 40960
 s_waitcnt lgkmcnt(4)
 v_mfma_f32_32x32x16_bf16 a[80:95], a[32:35], a[44:47], a[80:95]
 ds_read_b128 a[16:19], v245
 ds_read_b64_tr_b16 a[28:29], v253 offset:20480
 v_add_u32 v10, 114688, v19
 s_lshl_b32 s55, s28, 5
 v_lshlrev_b32 v9, 2, v3
 v_mfma_f32_32x32x16_bf16 a[112:127], a[36:39], a[44:47], a[112:127]
 ds_read_b64_tr_b16 a[30:31], v253 offset:21504
 ds_read_b128 a[20:23], v245 offset:4096
 buffer_load_dwordx4 v13, s[36:39], s59 offen sc1 lds
 s_add_u32 s57, s57, 16384
 v_mfma_f32_32x32x16_bf16 a[96:111], a[36:39], a[40:43], a[96:111]
 v_sub_u32 v9, v2, v9
 v_add_u32 v22, s55, v9
 v_mov_b32 v25, 0xf149f2ca
 v_mov_b32 v20, 0
 v_mov_b32 v17, 0
 v_mfma_f32_32x32x16_bf16 a[64:79], a[48:51], a[56:59], a[64:79]
 ds_read_b64_tr_b16 a[40:41], v252 offset:24576
 ds_read_b64_tr_b16 a[42:43], v252 offset:25600
 buffer_load_dwordx4 v13, s[36:39], s59 offen offset:1024 sc1 lds
 s_and_b32 s57, s57, 0x1ffff
 s_waitcnt lgkmcnt(4)
 v_mfma_f32_32x32x16_bf16 a[80:95], a[48:51], a[60:63], a[80:95]
 ds_read_b128 a[32:35], v246
 ds_read_b64_tr_b16 a[44:45], v253 offset:24576
 s_add_u32 s59, s59, 8192
 v_mov_b32 v18, 0
 v_accvgpr_read_b32 v29, a147
 v_mfma_f32_32x32x16_bf16 a[112:127], a[52:55], a[60:63], a[112:127]
 ds_read_b64_tr_b16 a[46:47], v253 offset:25600
 ds_read_b128 a[36:39], v246 offset:4096
 s_add_u32 m0, s57, 32768
 s_nop 0
 buffer_load_dwordx4 v12, s[36:39], s59 offen sc1 lds
 v_mfma_f32_32x32x16_bf16 a[96:111], a[52:55], a[56:59], a[96:111]
 v_accvgpr_read_b32 v30, a148
 v_accvgpr_read_b32 v0, a149
 v_accvgpr_read_b32 v7, a150
 v_accvgpr_read_b32 v28, a151
 v_cvt_pk_bf16_f32 v236, v152, v153
 v_mfma_f32_32x32x16_bf16 a[64:79], a[16:19], a[24:27], a[64:79]
 ds_read_b64_tr_b16 a[56:57], v252 offset:28672
 ds_read_b64_tr_b16 a[58:59], v252 offset:29696
 buffer_load_dwordx4 v12, s[36:39], s59 offen offset:1024 sc1 lds
 s_add_u32 m0, s57, 40960
 s_waitcnt lgkmcnt(4)
 v_mfma_f32_32x32x16_bf16 a[80:95], a[16:19], a[28:31], a[80:95]
 ds_read_b128 a[48:51], v247
 ds_read_b64_tr_b16 a[60:61], v253 offset:28672
 v_cvt_pk_bf16_f32 v237, v154, v155
 v_cvt_pk_bf16_f32 v238, v156, v157
 v_cvt_pk_bf16_f32 v239, v158, v159
 v_mfma_f32_32x32x16_bf16 a[112:127], a[20:23], a[28:31], a[112:127]
 ds_read_b64_tr_b16 a[62:63], v253 offset:29696
 ds_read_b128 a[52:55], v247 offset:4096
 buffer_load_dwordx4 v13, s[36:39], s59 offen sc1 lds
 s_add_u32 s57, s57, 16384
 v_mfma_f32_32x32x16_bf16 a[96:111], a[20:23], a[24:27], a[96:111]
 v_cvt_pk_bf16_f32 v240, v160, v161
 v_cvt_pk_bf16_f32 v241, v162, v163
 v_cvt_pk_bf16_f32 v242, v164, v165
 v_cvt_pk_bf16_f32 v243, v166, v167
 v_mfma_f32_32x32x16_bf16 a[64:79], a[32:35], a[40:43], a[64:79]
 s_barrier
 v_cvt_pk_bf16_f32 v244, v168, v169
 v_cvt_pk_bf16_f32 v245, v170, v171
 v_cvt_pk_bf16_f32 v246, v172, v173
 v_cvt_pk_bf16_f32 v247, v174, v175
 s_waitcnt lgkmcnt(2)
 v_mfma_f32_32x32x16_bf16 a[80:95], a[32:35], a[44:47], a[80:95]
 buffer_load_dwordx4 v13, s[36:39], s59 offen offset:1024 sc1 lds
 s_and_b32 s57, s57, 0x1ffff
 v_cvt_pk_bf16_f32 v248, v176, v177
 v_cvt_pk_bf16_f32 v249, v178, v179
 v_mfma_f32_32x32x16_bf16 a[112:127], a[36:39], a[44:47], a[112:127]
 s_add_u32 s59, s59, 8192
 v_cvt_pk_bf16_f32 v250, v180, v181
 v_cvt_pk_bf16_f32 v251, v182, v183
 v_cvt_pk_bf16_f32 v252, v184, v185
 v_cvt_pk_bf16_f32 v253, v186, v187
 v_mfma_f32_32x32x16_bf16 a[96:111], a[36:39], a[40:43], a[96:111]
 s_add_u32 m0, s57, 32768
 s_nop 0
 buffer_load_dwordx4 v12, s[36:39], s59 offen sc1 lds
 v_cvt_pk_bf16_f32 v254, v188, v189
 v_mfma_f32_32x32x16_bf16 a[64:79], a[48:51], a[56:59], a[64:79]
 v_cvt_pk_bf16_f32 v255, v190, v191
 s_waitcnt lgkmcnt(0)
 v_mfma_f32_32x32x16_bf16 a[80:95], a[48:51], a[60:63], a[80:95]
 buffer_load_dwordx4 v12, s[36:39], s59 offen offset:1024 sc1 lds
 s_add_u32 m0, s57, 40960
 v_mfma_f32_32x32x16_bf16 a[112:127], a[52:55], a[60:63], a[112:127]
 v_mfma_f32_32x32x16_bf16 a[96:111], a[52:55], a[56:59], a[96:111]
 buffer_load_dwordx4 v13, s[36:39], s59 offen sc1 lds
 s_add_u32 s57, s57, 16384
 buffer_load_dwordx4 v13, s[36:39], s59 offen offset:1024 sc1 lds
 s_and_b32 s57, s57, 0x1ffff
 s_add_u32 s59, s59, 8192
 s_add_u32 m0, s57, 32768
 s_nop 0
 buffer_load_dwordx4 v12, s[36:39], s59 offen sc1 lds
 buffer_load_dwordx4 v12, s[36:39], s59 offen offset:1024 sc1 lds
 s_add_u32 m0, s57, 40960
 s_nop 0
 buffer_load_dwordx4 v13, s[36:39], s59 offen sc1 lds
 s_add_u32 s57, s57, 16384
 buffer_load_dwordx4 v13, s[36:39], s59 offen offset:1024 sc1 lds
 s_and_b32 s57, s57, 0x1ffff
 s_add_u32 s59, s59, 8192
 s_waitcnt vmcnt(20)
 s_barrier
 s_cmp_eq_u32 s69, 14
 s_cbranch_scc1 L_wt2_n
 s_cmp_lg_u32 s69, 13
 s_cbranch_scc1 L_wt2_skip
 s_cmp_lg_u32 s30, 6
 s_cbranch_scc1 L_wt2_skip
 s_lshr_b32 s35, s29, 1
 s_mul_i32 s54, s35, 165888
 s_add_u32 s54, s54, 18432
 s_add_u32 s35, s35, 32
 s_mov_b32 s55, 3277
 v_add_u32 v9, 0, v1
 v_mul_lo_u32 v8, v9, s55
 v_lshrrev_b32 v8, 16, v8
 v_mul_u32_u24 v162, 20, v8
 v_sub_u32 v9, v9, v162
 v_bfe_u32 v160, v8, 2, 1
 v_lshlrev_b32 v160, 2, v160
 v_lshrrev_b32 v161, 3, v8
 v_lshl_add_u32 v160, v161, 1, v160
 v_bfe_u32 v161, v8, 1, 1
 v_add_u32 v160, v160, v161
 v_mul_u32_u24 v160, 18, v160
 v_and_b32 v8, 1, v8
 v_add_u32 v8, v8, v160
 v_mul_u32_u24 v8, 1152, v8
 v_lshl_add_u32 v162, v9, 4, v8
 v_add_u32 v9, 64, v1
 v_mul_lo_u32 v8, v9, s55
 v_lshrrev_b32 v8, 16, v8
 v_mul_u32_u24 v163, 20, v8
 v_sub_u32 v9, v9, v163
 v_bfe_u32 v160, v8, 2, 1
 v_lshlrev_b32 v160, 2, v160
 v_lshrrev_b32 v161, 3, v8
 v_lshl_add_u32 v160, v161, 1, v160
 v_bfe_u32 v161, v8, 1, 1
 v_add_u32 v160, v160, v161
 v_mul_u32_u24 v160, 18, v160
 v_and_b32 v8, 1, v8
 v_add_u32 v8, v8, v160
 v_mul_u32_u24 v8, 1152, v8
 v_lshl_add_u32 v163, v9, 4, v8
 v_subrev_u32 v163, 1024, v163
 v_add_u32 v9, 128, v1
 v_mul_lo_u32 v8, v9, s55
 v_lshrrev_b32 v8, 16, v8
 v_mul_u32_u24 v164, 20, v8
 v_sub_u32 v9, v9, v164
 v_bfe_u32 v160, v8, 2, 1
 v_lshlrev_b32 v160, 2, v160
 v_lshrrev_b32 v161, 3, v8
 v_lshl_add_u32 v160, v161, 1, v160
 v_bfe_u32 v161, v8, 1, 1
 v_add_u32 v160, v160, v161
 v_mul_u32_u24 v160, 18, v160
 v_and_b32 v8, 1, v8
 v_add_u32 v8, v8, v160
 v_mul_u32_u24 v8, 1152, v8
 v_lshl_add_u32 v164, v9, 4, v8
 v_subrev_u32 v164, 2048, v164
 v_add_u32 v9, 192, v1
 v_mul_lo_u32 v8, v9, s55
 v_lshrrev_b32 v8, 16, v8
 v_mul_u32_u24 v165, 20, v8
 v_sub_u32 v9, v9, v165
 v_bfe_u32 v160, v8, 2, 1
 v_lshlrev_b32 v160, 2, v160
 v_lshrrev_b32 v161, 3, v8
 v_lshl_add_u32 v160, v161, 1, v160
 v_bfe_u32 v161, v8, 1, 1
 v_add_u32 v160, v160, v161
 v_mul_u32_u24 v160, 18, v160
 v_and_b32 v8, 1, v8
 v_add_u32 v8, v8, v160
 v_mul_u32_u24 v8, 1152, v8
 v_lshl_add_u32 v165, v9, 4, v8
 v_subrev_u32 v165, 3072, v165
 v_add_u32 v9, 256, v1
 v_mul_lo_u32 v8, v9, s55
 v_lshrrev_b32 v8, 16, v8
 v_mul_u32_u24 v166, 20, v8
 v_sub_u32 v9, v9, v166
 v_bfe_u32 v160, v8, 2, 1
 v_lshlrev_b32 v160, 2, v160
 v_lshrrev_b32 v161, 3, v8
 v_lshl_add_u32 v160, v161, 1, v160
 v_bfe_u32 v161, v8, 1, 1
 v_add_u32 v160, v160, v161
 v_mul_u32_u24 v160, 18, v160
 v_and_b32 v8, 1, v8
 v_add_u32 v8, v8, v160
 v_mul_u32_u24 v8, 1152, v8
 v_lshl_add_u32 v166, v9, 4, v8
 s_branch L_wt2_go
L_wt2_n:
 s_lshl_b32 s35, s29, 2
 s_add_u32 s35, s35, s30
 s_sub_u32 s35, s35, 28
 s_mul_i32 s54, s35, 20736
 s_mov_b32 s55, 3277
 v_add_u32 v9, 0, v1
 v_mul_lo_u32 v8, v9, s55
 v_lshrrev_b32 v8, 16, v8
 v_mul_u32_u24 v162, 20, v8
 v_sub_u32 v9, v9, v162
 v_mul_u32_u24 v8, 1152, v8
 v_lshl_add_u32 v162, v9, 4, v8
 v_add_u32 v9, 64, v1
 v_mul_lo_u32 v8, v9, s55
 v_lshrrev_b32 v8, 16, v8
 v_mul_u32_u24 v163, 20, v8
 v_sub_u32 v9, v9, v163
 v_mul_u32_u24 v8, 1152, v8
 v_lshl_add_u32 v163, v9, 4, v8
 v_subrev_u32 v163, 1024, v163
 v_add_u32 v9, 128, v1
 v_mul_lo_u32 v8, v9, s55
 v_lshrrev_b32 v8, 16, v8
 v_mul_u32_u24 v164, 20, v8
 v_sub_u32 v9, v9, v164
 v_mul_u32_u24 v8, 1152, v8
 v_lshl_add_u32 v164, v9, 4, v8
 v_subrev_u32 v164, 2048, v164
 v_add_u32 v9, 192, v1
 v_mul_lo_u32 v8, v9, s55
 v_lshrrev_b32 v8, 16, v8
 v_mul_u32_u24 v165, 20, v8
 v_sub_u32 v9, v9, v165
 v_mul_u32_u24 v8, 1152, v8
 v_lshl_add_u32 v165, v9, 4, v8
 v_subrev_u32 v165, 3072, v165
 v_add_u32 v9, 256, v1
 v_mul_lo_u32 v8, v9, s55
 v_lshrrev_b32 v8, 16, v8
 v_mul_u32_u24 v166, 20, v8
 v_sub_u32 v9, v9, v166
 v_mul_u32_u24 v8, 1152, v8
 v_lshl_add_u32 v166, v9, 4, v8
L_wt2_go:
 s_mov_b32 s40, s8
 s_mov_b32 s41, s9
 s_mov_b32 s42, 663552
 s_mov_b32 s43, 0x20000
 s_mul_i32 s52, s28, 5120
 s_mov_b32 m0, s52
 s_mul_i32 s53, s28, 320
 s_add_u32 s53, s53, s54
 buffer_load_dwordx4 v162, s[40:43], s53 offen lds
 buffer_load_dwordx4 v163, s[40:43], s53 offen offset:1024 lds
 buffer_load_dwordx4 v164, s[40:43], s53 offen offset:2048 lds
 buffer_load_dwordx4 v165, s[40:43], s53 offen offset:3072 lds
 s_add_u32 m0, s52, 4096
 s_nop 0
 buffer_load_dwordx4 v166, s[40:43], s53 offen lds
 s_mul_i32 s54, s35, 18432
 s_mul_i32 s55, s28, 5120
 s_add_u32 s54, s54, s55
 s_add_u32 s54, s54, 69730304
 s_add_u32 s55, s54, 4096
 s_waitcnt vmcnt(0)
 ds_read_b64_tr_b16 a[192:193], v26
 ds_read_b64_tr_b16 a[194:195], v26 offset:2560
 ds_read_b64_tr_b16 a[196:197], v26 offset:64
 ds_read_b64_tr_b16 a[198:199], v26 offset:2624
 ds_read_b64_tr_b16 a[200:201], v26 offset:128
 ds_read_b64_tr_b16 a[202:203], v26 offset:2688
 ds_read_b64_tr_b16 a[204:205], v26 offset:192
 ds_read_b64_tr_b16 a[206:207], v26 offset:2752
 ds_read_b64_tr_b16 a[208:209], v26 offset:256
 ds_read_b64_tr_b16 a[210:211], v26 offset:2816
 s_waitcnt lgkmcnt(0)
 buffer_store_dwordx4 a[192:195], v14, s[36:39], s54 offen sc1
 buffer_store_dwordx4 a[196:199], v14, s[36:39], s54 offen offset:1024 sc1
 buffer_store_dwordx4 a[200:203], v14, s[36:39], s54 offen offset:2048 sc1
 buffer_store_dwordx4 a[204:207], v27, s[36:39], s54 offen offset:3072 sc1
 buffer_store_dwordx4 a[208:211], v27, s[36:39], s55 offen sc1
L_wt2_skip:
 v_accvgpr_read_b32 v176, a152
 v_accvgpr_read_b32 v177, a153
 v_accvgpr_read_b32 v178, a154
 v_accvgpr_read_b32 v179, a155
 v_accvgpr_read_b32 v180, a156
 v_accvgpr_read_b32 v181, a157
 v_accvgpr_read_b32 v182, a158
 v_accvgpr_read_b32 v183, a159
 v_accvgpr_read_b32 v184, a160
 v_accvgpr_read_b32 v185, a161
 v_accvgpr_read_b32 v186, a162
 v_accvgpr_read_b32 v187, a163
 v_accvgpr_read_b32 v188, a164
 v_accvgpr_read_b32 v189, a165
 v_accvgpr_read_b32 v190, a166
 v_accvgpr_read_b32 v191, a167
 ds_read_b128 a[160:163], v11
 ds_read_b128 a[164:167], v11 offset:1024
 ds_read_b128 a[168:171], v11 offset:2048
 ds_read_b128 a[172:175], v11 offset:3072
 ds_read_b128 a[176:179], v11 offset:4096
 ds_read_b128 a[180:183], v11 offset:5120
 ds_read_b128 a[184:187], v11 offset:6144
 ds_read_b128 a[188:191], v11 offset:7168
 s_lshl_b32 s52, s28, 12
 v_add_u32 v9, s52, v14
 v_add_u32 v15, 32768, v9
 v_add_u32 v16, 16777216, v9
 v_mov_b32 v96, v32
 v_mov_b32 v97, v33
 s_mov_b32 s34, s56
 v_accvgpr_read_b32 v64, a64
 v_accvgpr_read_b32 v65, a65
 v_accvgpr_read_b32 v66, a66
 v_accvgpr_read_b32 v67, a67
 v_accvgpr_read_b32 v68, a68
 v_accvgpr_read_b32 v69, a69
 v_accvgpr_read_b32 v70, a70
 v_accvgpr_read_b32 v71, a71
 v_accvgpr_read_b32 v72, a72
 v_accvgpr_read_b32 v73, a73
 v_accvgpr_read_b32 v74, a74
 v_accvgpr_read_b32 v75, a75
 v_accvgpr_read_b32 v76, a76
 v_accvgpr_read_b32 v77, a77
 v_accvgpr_read_b32 v78, a78
 v_accvgpr_read_b32 v79, a79
 v_cvt_pk_bf16_f32 v128, v64, v65
 v_cvt_pk_bf16_f32 v129, v66, v67
 v_cvt_pk_bf16_f32 v130, v68, v69
 v_cvt_pk_bf16_f32 v131, v70, v71
 v_cvt_pk_bf16_f32 v132, v72, v73
 v_cvt_pk_bf16_f32 v133, v74, v75
 v_cvt_pk_bf16_f32 v134, v76, v77
 v_cvt_pk_bf16_f32 v135, v78, v79
 v_accvgpr_read_b32 v64, a80
 v_accvgpr_read_b32 v65, a81
 v_accvgpr_read_b32 v66, a82
 v_accvgpr_read_b32 v67, a83
 v_accvgpr_read_b32 v68, a84
 v_accvgpr_read_b32 v69, a85
 v_accvgpr_read_b32 v70, a86
 v_accvgpr_read_b32 v71, a87
 v_accvgpr_read_b32 v72, a88
 v_accvgpr_read_b32 v73, a89
 v_accvgpr_read_b32 v74, a90
 v_accvgpr_read_b32 v75, a91
 v_accvgpr_read_b32 v76, a92
 v_accvgpr_read_b32 v77, a93
 v_accvgpr_read_b32 v78, a94
 v_accvgpr_read_b32 v79, a95
 v_cvt_pk_bf16_f32 v136, v64, v65
 v_cvt_pk_bf16_f32 v137, v66, v67
 v_cvt_pk_bf16_f32 v138, v68, v69
 v_cvt_pk_bf16_f32 v139, v70, v71
 v_cvt_pk_bf16_f32 v140, v72, v73
 v_cvt_pk_bf16_f32 v141, v74, v75
 v_cvt_pk_bf16_f32 v142, v76, v77
 v_cvt_pk_bf16_f32 v143, v78, v79
 s_waitcnt lgkmcnt(0)
 v_mfma_f32_32x32x16_bf16 v[80:95], a[160:163], v[224:227], 0
 v_accvgpr_read_b32 v64, a96
 v_accvgpr_read_b32 v65, a97
 v_accvgpr_read_b32 v66, a98
 v_accvgpr_read_b32 v67, a99
 v_accvgpr_read_b32 v68, a100
 v_accvgpr_read_b32 v69, a101
 v_mfma_f32_32x32x16_bf16 v[80:95], a[164:167], v[228:231], v[80:95]
 v_accvgpr_read_b32 v70, a102
 v_accvgpr_read_b32 v71, a103
 v_accvgpr_read_b32 v72, a104
 v_accvgpr_read_b32 v73, a105
 v_accvgpr_read_b32 v74, a106
 v_accvgpr_read_b32 v75, a107
 v_mfma_f32_32x32x16_bf16 v[80:95], a[168:171], v[232:235], v[80:95]
 v_accvgpr_read_b32 v76, a108
 v_accvgpr_read_b32 v77, a109
 v_accvgpr_read_b32 v78, a110
 v_accvgpr_read_b32 v79, a111
 v_cvt_pk_bf16_f32 v144, v64, v65
 v_cvt_pk_bf16_f32 v145, v66, v67
 v_mfma_f32_32x32x16_bf16 v[80:95], a[172:175], v[236:239], v[80:95]
 v_cvt_pk_bf16_f32 v146, v68, v69
 v_cvt_pk_bf16_f32 v147, v70, v71
 v_cvt_pk_bf16_f32 v148, v72, v73
 v_cvt_pk_bf16_f32 v149, v74, v75
 v_cvt_pk_bf16_f32 v150, v76, v77
 v_cvt_pk_bf16_f32 v151, v78, v79
 v_mfma_f32_32x32x16_bf16 v[80:95], a[176:179], v[240:243], v[80:95]
 v_accvgpr_read_b32 v64, a112
 v_accvgpr_read_b32 v65, a113
 v_accvgpr_read_b32 v66, a114
 v_accvgpr_read_b32 v67, a115
 v_accvgpr_read_b32 v68, a116
 v_accvgpr_read_b32 v69, a117
 v_mfma_f32_32x32x16_bf16 v[80:95], a[180:183], v[244:247], v[80:95]
 v_accvgpr_read_b32 v70, a118
 v_accvgpr_read_b32 v71, a119
 v_accvgpr_read_b32 v72, a120
 v_accvgpr_read_b32 v73, a121
 v_accvgpr_read_b32 v74, a122
 v_accvgpr_read_b32 v75, a123
 v_mfma_f32_32x32x16_bf16 v[80:95], a[184:187], v[248:251], v[80:95]
 v_accvgpr_read_b32 v76, a124
 v_accvgpr_read_b32 v77, a125
 v_accvgpr_read_b32 v78, a126
 v_accvgpr_read_b32 v79, a127
 v_cvt_pk_bf16_f32 v152, v64, v65
 v_cvt_pk_bf16_f32 v153, v66, v67
 v_mfma_f32_32x32x16_bf16 v[80:95], a[188:191], v[252:255], v[80:95]
 v_cvt_pk_bf16_f32 v154, v68, v69
 v_cvt_pk_bf16_f32 v155, v70, v71
 v_cvt_pk_bf16_f32 v156, v72, v73
 v_cvt_pk_bf16_f32 v157, v74, v75
 v_cvt_pk_bf16_f32 v158, v76, v77
 v_cvt_pk_bf16_f32 v159, v78, v79
 s_cmp_eq_u32 s32, 0
 s_cselect_b32 s60, s28, 64
 s_cmp_eq_u32 s32, 7
 s_cselect_b32 s61, s28, 64
 s_mov_b32 s56, 114688
 s_cmp_eq_u32 s60, 0
 s_cselect_b32 s64, 1.0, 0
 s_cmp_lt_u32 s60, 0
 s_cselect_b32 s65, 0xf149f2ca, 0
 v_add_f32 v23, s65, v20
 buffer_store_dwordx4 v[128:131], v96, s[36:39], s34 offen sc1
 v_fma_f32 v32, v176, s64, v23
 v_fma_f32 v33, v177, s64, v23
 v_fma_f32 v34, v178, s64, v23
 v_fma_f32 v35, v179, s64, v23
 v_fma_f32 v36, v180, s64, v23
 v_fma_f32 v37, v181, s64, v23
 v_fma_f32 v38, v182, s64, v23
 v_fma_f32 v39, v183, s64, v23
 v_fma_f32 v40, v184, s64, v23
 v_fma_f32 v41, v185, s64, v23
 v_fma_f32 v42, v186, s64, v23
 v_fma_f32 v43, v187, s64, v23
 v_fma_f32 v44, v188, s64, v23
 v_fma_f32 v45, v189, s64, v23
 buffer_store_dwordx4 v[132:135], v96, s[36:39], s34 offen offset:640 sc1
 v_fma_f32 v46, v190, s64, v23
 v_fma_f32 v47, v191, s64, v23
 s_nop 1
 v_mfma_f32_32x32x16_bf16 v[64:79], a[160:163], v[192:195], v[32:47]
 ds_read_b128 a[128:131], v10
 ds_read_b128 a[132:135], v10 offset:1024
 ds_read_b128 a[136:139], v10 offset:2048
 v_max3_f32 v21, v80, v81, v82
 v_max3_f32 v21, v21, v83, v84
 v_max3_f32 v21, v21, v85, v86
 v_max3_f32 v21, v21, v87, v88
 v_max3_f32 v21, v21, v89, v90
 v_max3_f32 v21, v21, v91, v92
 v_mfma_f32_32x32x16_bf16 v[64:79], a[164:167], v[196:199], v[64:79]
 ds_read_b128 a[140:143], v10 offset:3072
 ds_read_b128 a[144:147], v10 offset:4096
 ds_read_b128 a[148:151], v10 offset:5120
 v_max3_f32 v21, v21, v93, v94
 buffer_store_dwordx4 v[136:139], v97, s[36:39], s34 offen sc1
 v_max_f32 v21, v21, v95
 v_mov_b32 v8, v21
 s_nop 1
 v_permlane32_swap_b32 v21, v8
 s_nop 1
 v_mfma_f32_32x32x16_bf16 v[64:79], a[168:171], v[200:203], v[64:79]
 v_max_f32 v21, v21, v8
 v_sub_f32 v21, 0, v21
 v_add_f32 v80, v80, v21
 v_add_f32 v81, v81, v21
 v_add_f32 v82, v82, v21
 v_add_f32 v83, v83, v21
 v_mfma_f32_32x32x16_bf16 v[64:79], a[172:175], v[204:207], v[64:79]
 v_add_f32 v84, v84, v21
 v_add_f32 v85, v85, v21
 v_add_f32 v86, v86, v21
 v_add_f32 v87, v87, v21
 v_add_f32 v88, v88, v21
 buffer_store_dwordx4 v[140:143], v97, s[36:39], s34 offen offset:640 sc1
 v_add_f32 v89, v89, v21
 v_mfma_f32_32x32x16_bf16 v[64:79], a[176:179], v[208:211], v[64:79]
 v_add_f32 v90, v90, v21
 v_add_f32 v91, v91, v21
 v_add_f32 v92, v92, v21
 v_add_f32 v93, v93, v21
 v_add_f32 v94, v94, v21
 v_add_f32 v95, v95, v21
 v_mfma_f32_32x32x16_bf16 v[64:79], a[180:183], v[212:215], v[64:79]
 v_mov_b32 v48, v21
 v_mov_b32 v49, v21
 v_mov_b32 v50, v21
 v_mov_b32 v51, v21
 v_mov_b32 v52, v21
 v_mov_b32 v53, v21
 v_mfma_f32_32x32x16_bf16 v[64:79], a[184:187], v[216:219], v[64:79]
 v_mov_b32 v54, v21
 buffer_store_dwordx4 v[144:147], v96, s[36:39], s34 offen offset:1280 sc1
 v_mov_b32 v55, v21
 v_mov_b32 v56, v21
 v_mov_b32 v57, v21
 v_mov_b32 v58, v21
 v_mov_b32 v59, v21
 v_mfma_f32_32x32x16_bf16 v[64:79], a[188:191], v[220:223], v[64:79]
 v_mov_b32 v60, v21
 v_mov_b32 v61, v21
 v_mov_b32 v62, v21
 v_mov_b32 v63, v21
 s_nop 7
 v_max3_f32 v20, v64, v65, v66
 v_max3_f32 v20, v20, v67, v68
 v_max3_f32 v20, v20, v69, v70
 v_max3_f32 v20, v20, v71, v72
 v_max3_f32 v20, v20, v73, v74
 v_max3_f32 v20, v20, v75, v76
 v_max3_f32 v20, v20, v77, v78
 buffer_store_dwordx4 v[148:151], v96, s[36:39], s34 offen offset:1920 sc1
 v_max_f32 v20, v20, v79
 v_mov_b32 v8, v20
 s_nop 1
 v_permlane32_swap_b32 v20, v8
 s_nop 1
 v_max_f32 v20, v20, v8
 v_sub_f32 v20, 0, v20
 v_add_f32 v64, v64, v20
 v_add_f32 v65, v65, v20
 v_add_f32 v66, v66, v20
 v_add_f32 v67, v67, v20
 v_add_f32 v68, v68, v20
 v_add_f32 v69, v69, v20
 v_add_f32 v70, v70, v20
 v_add_f32 v71, v71, v20
 v_add_f32 v72, v72, v20
 v_add_f32 v73, v73, v20
 v_add_f32 v74, v74, v20
 buffer_store_dwordx4 v[152:155], v97, s[36:39], s34 offen offset:1280 sc1
 v_add_f32 v75, v75, v20
 v_add_f32 v76, v76, v20
 v_add_f32 v77, v77, v20
 v_add_f32 v78, v78, v20
 v_add_f32 v79, v79, v20
 s_cmp_eq_u32 s60, 1
 s_cselect_b32 s64, 1.0, 0
 s_cmp_lt_u32 s60, 1
 s_cselect_b32 s65, 0xf149f2ca, 0
 v_add_f32 v23, s65, v20
 v_fma_f32 v32, v176, s64, v23
 v_fma_f32 v33, v177, s64, v23
 v_fma_f32 v34, v178, s64, v23
 v_fma_f32 v35, v179, s64, v23
 v_fma_f32 v36, v180, s64, v23
 v_fma_f32 v37, v181, s64, v23
 v_fma_f32 v38, v182, s64, v23
 buffer_store_dwordx4 v[156:159], v97, s[36:39], s34 offen offset:1920 sc1
 v_fma_f32 v39, v183, s64, v23
 v_fma_f32 v40, v184, s64, v23
 v_fma_f32 v41, v185, s64, v23
 v_fma_f32 v42, v186, s64, v23
 v_fma_f32 v43, v187, s64, v23
 v_fma_f32 v44, v188, s64, v23
 v_fma_f32 v45, v189, s64, v23
 v_fma_f32 v46, v190, s64, v23
 v_fma_f32 v47, v191, s64, v23
 s_waitcnt lgkmcnt(0)
 s_nop 0
L_attn:
 v_mfma_f32_32x32x16_bf16 v[96:111], a[128:131], v[192:195], v[32:47]
 ds_read_b128 a[152:155], v10 offset:6144
 s_add_u32 m0, s57, 32768
 v_exp_f32 v64, v64
 v_exp_f32 v65, v65
 v_add_f32 v17, v17, v64
 v_exp_f32 v66, v66
 v_add_f32 v17, v17, v65
 s_waitcnt lgkmcnt(2)
 v_mfma_f32_32x32x16_bf16 v[112:127], a[128:131], v[224:227], v[48:63]
 s_add_u32 s56, s56, 16384
 buffer_load_dwordx4 v12, s[36:39], s59 offen sc1 lds
 v_cvt_pk_bf16_f32 v128, v64, v65
 v_exp_f32 v67, v67
 v_add_f32 v17, v17, v66
 v_exp_f32 v68, v68
 v_mfma_f32_32x32x16_bf16 v[96:111], a[132:135], v[196:199], v[96:111]
 ds_read_b128 a[156:159], v10 offset:7168
 buffer_load_dwordx4 v12, s[36:39], s59 offen offset:1024 sc1 lds
 s_add_u32 m0, s57, 40960
 s_cmp_eq_u32 s60, 2
 s_cselect_b32 s64, 1.0, 0
 v_add_f32 v17, v17, v67
 v_cvt_pk_bf16_f32 v129, v66, v67
 v_exp_f32 v69, v69
 v_mfma_f32_32x32x16_bf16 v[112:127], a[132:135], v[228:231], v[112:127]
 s_and_b32 s56, s56, 0x1ffff
 buffer_load_dwordx4 v13, s[36:39], s59 offen sc1 lds
 s_add_u32 s57, s57, 16384
 s_cmp_lt_u32 s60, 2
 s_cselect_b32 s65, 0xf149f2ca, 0
 v_add_u32 v11, s56, v19
 v_add_f32 v17, v17, v68
 v_exp_f32 v70, v70
 v_mfma_f32_32x32x16_bf16 v[96:111], a[136:139], v[200:203], v[96:111]
 s_waitcnt vmcnt(27)
 s_barrier
 ds_read_b128 a[160:163], v11
 buffer_load_dwordx4 v13, s[36:39], s59 offen offset:1024 sc1 lds
 s_and_b32 s57, s57, 0x1ffff
 v_add_f32 v17, v17, v69
 v_cvt_pk_bf16_f32 v130, v68, v69
 v_add_f32 v23, s65, v20
 v_exp_f32 v71, v71
 v_mfma_f32_32x32x16_bf16 v[112:127], a[136:139], v[232:235], v[112:127]
 s_add_u32 s59, s59, 8192
 v_add_f32 v17, v17, v70
 v_exp_f32 v72, v72
 v_add_f32 v17, v17, v71
 v_fma_f32 v32, v176, s64, v23
 v_cvt_pk_bf16_f32 v131, v70, v71
 v_exp_f32 v73, v73
 v_add_f32 v17, v17, v72
 v_fma_f32 v33, v177, s64, v23
 v_mfma_f32_32x32x16_bf16 v[96:111], a[140:143], v[204:207], v[96:111]
 ds_read_b128 a[164:167], v11 offset:1024
 v_exp_f32 v74, v74
 v_add_f32 v17, v17, v73
 v_cvt_pk_bf16_f32 v132, v72, v73
 v_exp_f32 v75, v75
 v_fma_f32 v34, v178, s64, v23
 v_add_f32 v17, v17, v74
 v_add_f32 v17, v17, v75
 v_mfma_f32_32x32x16_bf16 v[112:127], a[140:143], v[236:239], v[112:127]
 v_exp_f32 v76, v76
 v_cvt_pk_bf16_f32 v133, v74, v75
 v_fma_f32 v35, v179, s64, v23
 v_exp_f32 v77, v77
 v_add_f32 v17, v17, v76
 v_exp_f32 v78, v78
 v_fma_f32 v36, v180, s64, v23
 v_mfma_f32_32x32x16_bf16 v[96:111], a[144:147], v[208:211], v[96:111]
 ds_read_b128 a[168:171], v11 offset:2048
 v_add_f32 v17, v17, v77
 v_cvt_pk_bf16_f32 v134, v76, v77
 v_exp_f32 v79, v79
 v_add_f32 v17, v17, v78
 v_fma_f32 v37, v181, s64, v23
 v_exp_f32 v80, v80
 s_waitcnt lgkmcnt(2)
 v_mfma_f32_32x32x16_bf16 v[112:127], a[144:147], v[240:243], v[112:127]
 v_add_f32 v17, v17, v79
 v_cvt_pk_bf16_f32 v135, v78, v79
 v_fma_f32 v38, v182, s64, v23
 v_exp_f32 v81, v81
 v_add_f32 v18, v18, v80
 v_exp_f32 v82, v82
 v_add_f32 v18, v18, v81
 v_fma_f32 v39, v183, s64, v23
 v_mfma_f32_32x32x16_bf16 v[96:111], a[148:151], v[212:215], v[96:111]
 ds_read_b128 a[172:175], v11 offset:3072
 v_cvt_pk_bf16_f32 v136, v80, v81
 v_exp_f32 v83, v83
 v_add_f32 v18, v18, v82
 v_fma_f32 v40, v184, s64, v23
 v_exp_f32 v84, v84
 v_add_f32 v18, v18, v83
 v_cvt_pk_bf16_f32 v137, v82, v83
 v_mfma_f32_32x32x16_bf16 v[112:127], a[148:151], v[244:247], v[112:127]
 v_exp_f32 v85, v85
 v_fma_f32 v41, v185, s64, v23
 v_add_f32 v18, v18, v84
 v_exp_f32 v86, v86
 v_add_f32 v18, v18, v85
 v_cvt_pk_bf16_f32 v138, v84, v85
 v_fma_f32 v42, v186, s64, v23
 v_add_f32 v18, v18, v86
 v_mfma_f32_32x32x16_bf16 v[96:111], a[152:155], v[216:219], v[96:111]
 ds_read_b128 a[176:179], v11 offset:4096
 v_exp_f32 v87, v87
 v_exp_f32 v88, v88
 v_fma_f32 v43, v187, s64, v23
 v_add_f32 v18, v18, v87
 v_cvt_pk_bf16_f32 v139, v86, v87
 v_exp_f32 v89, v89
 v_mfma_f32_32x32x16_bf16 v[112:127], a[152:155], v[248:251], v[112:127]
 v_add_f32 v18, v18, v88
 v_fma_f32 v44, v188, s64, v23
 v_exp_f32 v90, v90
 v_add_f32 v18, v18, v89
 v_cvt_pk_bf16_f32 v140, v88, v89
 v_fma_f32 v45, v189, s64, v23
 v_exp_f32 v91, v91
 v_add_f32 v18, v18, v90
 v_mfma_f32_32x32x16_bf16 v[96:111], a[156:159], v[220:223], v[96:111]
 ds_read_b128 a[180:183], v11 offset:5120
 v_exp_f32 v92, v92
 v_add_f32 v18, v18, v91
 v_fma_f32 v46, v190, s64, v23
 v_cvt_pk_bf16_f32 v141, v90, v91
 v_exp_f32 v93, v93
 v_add_f32 v18, v18, v92
 v_fma_f32 v47, v191, s64, v23
 v_mfma_f32_32x32x16_bf16 v[112:127], a[156:159], v[252:255], v[112:127]
 v_exp_f32 v94, v94
 v_add_f32 v18, v18, v93
 v_cvt_pk_bf16_f32 v142, v92, v93
 v_exp_f32 v95, v95
 v_add_f32 v18, v18, v94
 v_add_f32 v18, v18, v95
 v_cvt_pk_bf16_f32 v143, v94, v95
 v_mfma_f32_32x32x16_bf16 v[64:79], a[160:163], v[192:195], v[32:47]
 ds_read_b128 a[184:187], v11 offset:6144
 s_add_u32 m0, s57, 32768
 v_exp_f32 v96, v96
 s_waitcnt lgkmcnt(2)
 v_mfma_f32_32x32x16_bf16 v[80:95], a[160:163], v[224:227], v[48:63]
 buffer_load_dwordx4 v12, s[36:39], s59 offen sc1 lds
 v_exp_f32 v97, v97
 v_add_f32 v17, v17, v96
 v_add_f32 v17, v17, v97
 v_mfma_f32_32x32x16_bf16 v[64:79], a[164:167], v[196:199], v[64:79]
 ds_read_b128 a[188:191], v11 offset:7168
 v_exp_f32 v98, v98
 v_cvt_pk_bf16_f32 v144, v96, v97
 v_exp_f32 v99, v99
 v_mfma_f32_32x32x16_bf16 v[80:95], a[164:167], v[228:231], v[80:95]
 buffer_load_dwordx4 v12, s[36:39], s59 offen offset:1024 sc1 lds
 v_add_f32 v17, v17, v98
 v_exp_f32 v100, v100
 v_mfma_f32_32x32x16_bf16 v[64:79], a[168:171], v[200:203], v[64:79]
 ds_read_b128 a[128:131], v11 offset:8192
 s_add_u32 m0, s57, 40960
 s_cmp_eq_u32 s60, 3
 s_cselect_b32 s64, 1.0, 0
 v_add_f32 v17, v17, v99
 v_cvt_pk_bf16_f32 v145, v98, v99
 v_mfma_f32_32x32x16_bf16 v[80:95], a[168:171], v[232:235], v[80:95]
 buffer_load_dwordx4 v13, s[36:39], s59 offen sc1 lds
 v_exp_f32 v101, v101
 v_add_f32 v17, v17, v100
 v_mfma_f32_32x32x16_bf16 v[64:79], a[172:175], v[204:207], v[64:79]
 ds_read_b128 a[132:135], v11 offset:9216
 s_add_u32 s57, s57, 16384
 s_cmp_lt_u32 s60, 3
 s_cselect_b32 s65, 0xf149f2ca, 0
 v_exp_f32 v102, v102
 v_add_f32 v17, v17, v101
 v_mfma_f32_32x32x16_bf16 v[80:95], a[172:175], v[236:239], v[80:95]
 buffer_load_dwordx4 v13, s[36:39], s59 offen offset:1024 sc1 lds
 v_cvt_pk_bf16_f32 v146, v100, v101
 v_add_f32 v23, s65, v20
 v_add_f32 v17, v17, v102
 v_mfma_f32_32x32x16_bf16 v[64:79], a[176:179], v[208:211], v[64:79]
 ds_read_b128 a[136:139], v11 offset:10240
 s_and_b32 s57, s57, 0x1ffff
 v_exp_f32 v103, v103
 v_fma_f32 v32, v176, s64, v23
 s_waitcnt lgkmcnt(2)
 v_mfma_f32_32x32x16_bf16 v[80:95], a[176:179], v[240:243], v[80:95]
 s_add_u32 s59, s59, 8192
 v_exp_f32 v104, v104
 v_add_f32 v17, v17, v103
 v_cvt_pk_bf16_f32 v147, v102, v103
 v_exp_f32 v105, v105
 v_mfma_f32_32x32x16_bf16 v[64:79], a[180:183], v[212:215], v[64:79]
 ds_read_b128 a[140:143], v11 offset:11264
 s_mov_b32 s40, s20
 s_mov_b32 s41, s21
 s_mov_b32 s42, 4718592
 s_mov_b32 s43, 0x20000
 s_mul_i32 s54, s33, 18432
 v_mfma_f32_32x32x16_bf16 v[80:95], a[180:183], v[244:247], v[80:95]
 s_mul_i32 s52, s28, 5120
 s_mov_b32 m0, s52
 s_mul_i32 s53, s28, 320
 s_add_u32 s53, s53, s54
 v_add_f32 v17, v17, v104
 v_fma_f32 v33, v177, s64, v23
 v_add_f32 v17, v17, v105
 v_mfma_f32_32x32x16_bf16 v[64:79], a[184:187], v[216:219], v[64:79]
 ds_read_b128 a[144:147], v11 offset:12288
 v_exp_f32 v106, v106
 v_cvt_pk_bf16_f32 v148, v104, v105
 v_exp_f32 v107, v107
 v_mfma_f32_32x32x16_bf16 v[80:95], a[184:187], v[248:251], v[80:95]
 buffer_load_dwordx4 v29, s[40:43], s53 offen nt lds
 v_fma_f32 v34, v178, s64, v23
 v_add_f32 v17, v17, v106
 v_add_f32 v17, v17, v107
 v_mfma_f32_32x32x16_bf16 v[64:79], a[188:191], v[220:223], v[64:79]
 ds_read_b128 a[148:151], v11 offset:13312
 v_exp_f32 v108, v108
 v_cvt_pk_bf16_f32 v149, v106, v107
 v_fma_f32 v35, v179, s64, v23
 v_exp_f32 v109, v109
 v_mfma_f32_32x32x16_bf16 v[80:95], a[188:191], v[252:255], v[80:95]
 buffer_load_dwordx4 v30, s[40:43], s53 offen offset:1024 nt lds
 v_add_f32 v17, v17, v108
 v_exp_f32 v110, v110
 v_mfma_f32_32x32x16_bf16 a[0:15], a[128:131], v[128:131], 0
 ds_read_b128 a[152:155], v11 offset:14336
 v_fma_f32 v36, v180, s64, v23
 v_add_f32 v17, v17, v109
 v_cvt_pk_bf16_f32 v150, v108, v109
 v_add_f32 v17, v17, v110
 s_waitcnt lgkmcnt(2)
 v_mfma_f32_32x32x16_bf16 a[64:79], a[128:131], v[136:139], 0
 s_add_u32 s56, s56, 16384
 buffer_load_dwordx4 v0, s[40:43], s53 offen offset:2048 nt lds
 v_exp_f32 v111, v111
 v_fma_f32 v37, v181, s64, v23
 v_mfma_f32_32x32x16_bf16 a[16:31], a[132:135], v[128:131], 0
 ds_read_b128 a[156:159], v11 offset:15360
 v_exp_f32 v112, v112
 v_add_f32 v17, v17, v111
 v_cvt_pk_bf16_f32 v151, v110, v111
 v_fma_f32 v38, v182, s64, v23
 v_mfma_f32_32x32x16_bf16 a[80:95], a[132:135], v[136:139], 0
 s_and_b32 s56, s56, 0x1ffff
 buffer_load_dwordx4 v7, s[40:43], s53 offen offset:3072 nt lds
 v_add_u32 v10, s56, v19
 v_exp_f32 v113, v113
 v_mfma_f32_32x32x16_bf16 a[32:47], a[136:139], v[128:131], 0
 s_waitcnt vmcnt(32)
 s_barrier
 ds_read_b128 a[160:163], v10
 s_add_u32 m0, s52, 4096
 v_add_f32 v18, v18, v112
 v_add_f32 v18, v18, v113
 v_mfma_f32_32x32x16_bf16 a[96:111], a[136:139], v[136:139], 0
 buffer_load_dwordx4 v28, s[40:43], s53 offen nt lds
 v_exp_f32 v114, v114
 v_fma_f32 v39, v183, s64, v23
 v_mfma_f32_32x32x16_bf16 a[48:63], a[140:143], v[128:131], 0
 ds_read_b128 a[164:167], v10 offset:1024
 v_cvt_pk_bf16_f32 v152, v112, v113
 v_exp_f32 v115, v115
 v_add_f32 v18, v18, v114
 v_fma_f32 v40, v184, s64, v23
 v_add_f32 v18, v18, v115
 v_mfma_f32_32x32x16_bf16 a[112:127], a[140:143], v[136:139], 0
 v_exp_f32 v116, v116
 v_cvt_pk_bf16_f32 v153, v114, v115
 v_exp_f32 v117, v117
 v_fma_f32 v41, v185, s64, v23
 v_mfma_f32_32x32x16_bf16 a[0:15], a[144:147], v[132:135], a[0:15]
 ds_read_b128 a[168:171], v10 offset:2048
 v_add_f32 v18, v18, v116
 v_exp_f32 v118, v118
 v_add_f32 v18, v18, v117
 s_waitcnt lgkmcnt(2)
 v_mfma_f32_32x32x16_bf16 a[64:79], a[144:147], v[140:143], a[64:79]
 v_cvt_pk_bf16_f32 v154, v116, v117
 v_fma_f32 v42, v186, s64, v23
 v_exp_f32 v119, v119
 v_add_f32 v18, v18, v118
 v_exp_f32 v120, v120
 v_mfma_f32_32x32x16_bf16 a[16:31], a[148:151], v[132:135], a[16:31]
 ds_read_b128 a[172:175], v10 offset:3072
 v_fma_f32 v43, v187, s64, v23
 v_add_f32 v18, v18, v119
 v_cvt_pk_bf16_f32 v155, v118, v119
 v_exp_f32 v121, v121
 v_mfma_f32_32x32x16_bf16 a[80:95], a[148:151], v[140:143], a[80:95]
 v_add_f32 v18, v18, v120
 v_fma_f32 v44, v188, s64, v23
 v_exp_f32 v122, v122
 v_add_f32 v18, v18, v121
 v_cvt_pk_bf16_f32 v156, v120, v121
 v_fma_f32 v45, v189, s64, v23
 v_mfma_f32_32x32x16_bf16 a[32:47], a[152:155], v[132:135], a[32:47]
 ds_read_b128 a[176:179], v10 offset:4096
 v_exp_f32 v123, v123
 v_add_f32 v18, v18, v122
 v_exp_f32 v124, v124
 v_mfma_f32_32x32x16_bf16 a[96:111], a[152:155], v[140:143], a[96:111]
 v_add_f32 v18, v18, v123
 v_fma_f32 v46, v190, s64, v23
 v_cvt_pk_bf16_f32 v157, v122, v123
 v_exp_f32 v125, v125
 v_add_f32 v18, v18, v124
 v_mfma_f32_32x32x16_bf16 a[48:63], a[156:159], v[132:135], a[48:63]
 ds_read_b128 a[180:183], v10 offset:5120
 v_fma_f32 v47, v191, s64, v23
 v_exp_f32 v126, v126
 v_add_f32 v18, v18, v125
 v_cvt_pk_bf16_f32 v158, v124, v125
 v_add_f32 v18, v18, v126
 v_mfma_f32_32x32x16_bf16 a[112:127], a[156:159], v[140:143], a[112:127]
 s_lshl_b32 s62, s32, 1
 s_cmp_eq_u32 s32, 0
 v_exp_f32 v127, v127
 s_nop 0
 v_add_f32 v18, v18, v127
 v_cvt_pk_bf16_f32 v159, v126, v127
 s_cbranch_scc1 L_b_DL
 s_cmp_eq_u32 s32, 1
 s_cbranch_scc1 L_b_DS0
L_b_dloop:
 v_mfma_f32_32x32x16_bf16 v[96:111], a[160:163], v[192:195], v[32:47]
 ds_read_b128 a[184:187], v10 offset:6144
 s_add_u32 m0, s57, 32768
 v_exp_f32 v64, v64
 s_waitcnt lgkmcnt(2)
 v_mfma_f32_32x32x16_bf16 v[112:127], a[160:163], v[224:227], v[48:63]
 buffer_load_dwordx4 v12, s[36:39], s59 offen sc1 lds
 v_exp_f32 v65, v65
 v_add_f32 v17, v17, v64
 v_mfma_f32_32x32x16_bf16 v[96:111], a[164:167], v[196:199], v[96:111]
 ds_read_b128 a[188:191], v10 offset:7168
 v_exp_f32 v66, v66
 v_add_f32 v17, v17, v65
 v_cvt_pk_bf16_f32 v128, v64, v65
 v_add_f32 v17, v17, v66
 v_mfma_f32_32x32x16_bf16 v[112:127], a[164:167], v[228:231], v[112:127]
 buffer_load_dwordx4 v12, s[36:39], s59 offen offset:1024 sc1 lds
 v_exp_f32 v67, v67
 v_mfma_f32_32x32x16_bf16 v[96:111], a[168:171], v[200:203], v[96:111]
 ds_read_b128 a[128:131], v10 offset:8192
 s_add_u32 m0, s57, 40960
 v_exp_f32 v68, v68
 v_add_f32 v17, v17, v67
 v_cvt_pk_bf16_f32 v129, v66, v67
 v_mfma_f32_32x32x16_bf16 v[112:127], a[168:171], v[232:235], v[112:127]
 buffer_load_dwordx4 v13, s[36:39], s59 offen sc1 lds
 v_exp_f32 v69, v69
 v_add_f32 v17, v17, v68
 v_mfma_f32_32x32x16_bf16 v[96:111], a[172:175], v[204:207], v[96:111]
 ds_read_b128 a[132:135], v10 offset:9216
 s_add_u32 s57, s57, 16384
 v_exp_f32 v70, v70
 v_add_f32 v17, v17, v69
 v_cvt_pk_bf16_f32 v130, v68, v69
 v_mfma_f32_32x32x16_bf16 v[112:127], a[172:175], v[236:239], v[112:127]
 buffer_load_dwordx4 v13, s[36:39], s59 offen offset:1024 sc1 lds
 v_exp_f32 v71, v71
 v_add_f32 v17, v17, v70
 v_mfma_f32_32x32x16_bf16 v[96:111], a[176:179], v[208:211], v[96:111]
 ds_read_b128 a[136:139], v10 offset:10240
 s_and_b32 s57, s57, 0x1ffff
 v_exp_f32 v72, v72
 v_add_f32 v17, v17, v71
 s_waitcnt lgkmcnt(2)
 v_mfma_f32_32x32x16_bf16 v[112:127], a[176:179], v[240:243], v[112:127]
 s_add_u32 s59, s59, 8192
 v_cvt_pk_bf16_f32 v131, v70, v71
 v_exp_f32 v73, v73
 v_add_f32 v17, v17, v72
 v_add_f32 v17, v17, v73
 v_mfma_f32_32x32x16_bf16 v[96:111], a[180:183], v[212:215], v[96:111]
 ds_read_b128 a[140:143], v10 offset:11264
 v_exp_f32 v74, v74
 v_cvt_pk_bf16_f32 v132, v72, v73
 v_exp_f32 v75, v75
 v_mfma_f32_32x32x16_bf16 v[112:127], a[180:183], v[244:247], v[112:127]
 v_add_f32 v17, v17, v74
 v_exp_f32 v76, v76
 v_add_f32 v17, v17, v75
 v_cvt_pk_bf16_f32 v133, v74, v75
 v_add_f32 v17, v17, v76
 v_mfma_f32_32x32x16_bf16 v[96:111], a[184:187], v[216:219], v[96:111]
 ds_read_b128 a[144:147], v10 offset:12288
 v_exp_f32 v77, v77
 v_exp_f32 v78, v78
 v_add_f32 v17, v17, v77
 v_mfma_f32_32x32x16_bf16 v[112:127], a[184:187], v[248:251], v[112:127]
 v_cvt_pk_bf16_f32 v134, v76, v77
 v_exp_f32 v79, v79
 v_add_f32 v17, v17, v78
 v_exp_f32 v80, v80
 v_mfma_f32_32x32x16_bf16 v[96:111], a[188:191], v[220:223], v[96:111]
 ds_read_b128 a[148:151], v10 offset:13312
 v_add_f32 v17, v17, v79
 v_cvt_pk_bf16_f32 v135, v78, v79
 v_exp_f32 v81, v81
 v_add_f32 v18, v18, v80
 v_mfma_f32_32x32x16_bf16 v[112:127], a[188:191], v[252:255], v[112:127]
 v_exp_f32 v82, v82
 v_add_f32 v18, v18, v81
 v_cvt_pk_bf16_f32 v136, v80, v81
 v_exp_f32 v83, v83
 v_mfma_f32_32x32x16_bf16 a[0:15], a[128:131], v[144:147], a[0:15]
 ds_read_b128 a[152:155], v10 offset:14336
 v_add_f32 v18, v18, v82
 v_exp_f32 v84, v84
 v_add_f32 v18, v18, v83
 s_waitcnt lgkmcnt(2)
 v_mfma_f32_32x32x16_bf16 a[64:79], a[128:131], v[152:155], a[64:79]
 s_add_u32 s56, s56, 16384
 v_cvt_pk_bf16_f32 v137, v82, v83
 v_exp_f32 v85, v85
 v_add_f32 v18, v18, v84
 v_add_f32 v18, v18, v85
 v_mfma_f32_32x32x16_bf16 a[16:31], a[132:135], v[144:147], a[16:31]
 ds_read_b128 a[156:159], v10 offset:15360
 v_exp_f32 v86, v86
 v_cvt_pk_bf16_f32 v138, v84, v85
 v_exp_f32 v87, v87
 v_mfma_f32_32x32x16_bf16 a[80:95], a[132:135], v[152:155], a[80:95]
 s_and_b32 s56, s56, 0x1ffff
 v_add_u32 v11, s56, v19
 v_add_f32 v18, v18, v86
 v_exp_f32 v88, v88
 v_add_f32 v18, v18, v87
 v_mfma_f32_32x32x16_bf16 a[32:47], a[136:139], v[144:147], a[32:47]
 s_waitcnt vmcnt(20)
 s_barrier
 ds_read_b128 a[160:163], v11
 v_cvt_pk_bf16_f32 v139, v86, v87
 v_exp_f32 v89, v89
 v_mfma_f32_32x32x16_bf16 a[96:111], a[136:139], v[152:155], a[96:111]
 v_add_f32 v18, v18, v88
 v_exp_f32 v90, v90
 v_add_f32 v18, v18, v89
 v_cvt_pk_bf16_f32 v140, v88, v89
 v_add_f32 v18, v18, v90
 v_mfma_f32_32x32x16_bf16 a[48:63], a[140:143], v[144:147], a[48:63]
 ds_read_b128 a[164:167], v11 offset:1024
 v_exp_f32 v91, v91
 v_exp_f32 v92, v92
 v_add_f32 v18, v18, v91
 v_mfma_f32_32x32x16_bf16 a[112:127], a[140:143], v[152:155], a[112:127]
 v_cvt_pk_bf16_f32 v141, v90, v91
 v_exp_f32 v93, v93
 v_add_f32 v18, v18, v92
 v_exp_f32 v94, v94
 v_mfma_f32_32x32x16_bf16 a[0:15], a[144:147], v[148:151], a[0:15]
 ds_read_b128 a[168:171], v11 offset:2048
 v_add_f32 v18, v18, v93
 v_cvt_pk_bf16_f32 v142, v92, v93
 v_exp_f32 v95, v95
 s_waitcnt lgkmcnt(2)
 v_mfma_f32_32x32x16_bf16 a[64:79], a[144:147], v[156:159], a[64:79]
 v_add_f32 v18, v18, v94
 v_add_f32 v18, v18, v95
 v_cvt_pk_bf16_f32 v143, v94, v95
 v_mfma_f32_32x32x16_bf16 a[16:31], a[148:151], v[148:151], a[16:31]
 ds_read_b128 a[172:175], v11 offset:3072
 v_mfma_f32_32x32x16_bf16 a[80:95], a[148:151], v[156:159], a[80:95]
 v_mfma_f32_32x32x16_bf16 a[32:47], a[152:155], v[148:151], a[32:47]
 ds_read_b128 a[176:179], v11 offset:4096
 v_mfma_f32_32x32x16_bf16 a[96:111], a[152:155], v[156:159], a[96:111]
 v_mfma_f32_32x32x16_bf16 a[48:63], a[156:159], v[148:151], a[48:63]
 ds_read_b128 a[180:183], v11 offset:5120
 v_mfma_f32_32x32x16_bf16 a[112:127], a[156:159], v[156:159], a[112:127]
 v_mfma_f32_32x32x16_bf16 v[64:79], a[160:163], v[192:195], v[32:47]
 ds_read_b128 a[184:187], v11 offset:6144
 s_add_u32 m0, s57, 32768
 v_exp_f32 v96, v96
 s_waitcnt lgkmcnt(2)
 v_mfma_f32_32x32x16_bf16 v[80:95], a[160:163], v[224:227], v[48:63]
 buffer_load_dwordx4 v12, s[36:39], s59 offen sc1 lds
 v_exp_f32 v97, v97
 v_add_f32 v17, v17, v96
 v_mfma_f32_32x32x16_bf16 v[64:79], a[164:167], v[196:199], v[64:79]
 ds_read_b128 a[188:191], v11 offset:7168
 v_exp_f32 v98, v98
 v_add_f32 v17, v17, v97
 v_cvt_pk_bf16_f32 v144, v96, v97
 v_add_f32 v17, v17, v98
 v_mfma_f32_32x32x16_bf16 v[80:95], a[164:167], v[228:231], v[80:95]
 buffer_load_dwordx4 v12, s[36:39], s59 offen offset:1024 sc1 lds
 v_exp_f32 v99, v99
 v_mfma_f32_32x32x16_bf16 v[64:79], a[168:171], v[200:203], v[64:79]
 ds_read_b128 a[128:131], v11 offset:8192
 s_add_u32 m0, s57, 40960
 v_exp_f32 v100, v100
 v_add_f32 v17, v17, v99
 v_cvt_pk_bf16_f32 v145, v98, v99
 v_mfma_f32_32x32x16_bf16 v[80:95], a[168:171], v[232:235], v[80:95]
 buffer_load_dwordx4 v13, s[36:39], s59 offen sc1 lds
 v_exp_f32 v101, v101
 v_add_f32 v17, v17, v100
 v_mfma_f32_32x32x16_bf16 v[64:79], a[172:175], v[204:207], v[64:79]
 ds_read_b128 a[132:135], v11 offset:9216
 s_add_u32 s57, s57, 16384
 v_exp_f32 v102, v102
 v_add_f32 v17, v17, v101
 v_cvt_pk_bf16_f32 v146, v100, v101
 v_mfma_f32_32x32x16_bf16 v[80:95], a[172:175], v[236:239], v[80:95]
 buffer_load_dwordx4 v13, s[36:39], s59 offen offset:1024 sc1 lds
 v_exp_f32 v103, v103
 v_add_f32 v17, v17, v102
 v_mfma_f32_32x32x16_bf16 v[64:79], a[176:179], v[208:211], v[64:79]
 ds_read_b128 a[136:139], v11 offset:10240
 s_and_b32 s57, s57, 0x1ffff
 v_exp_f32 v104, v104
 v_add_f32 v17, v17, v103
 s_waitcnt lgkmcnt(2)
 v_mfma_f32_32x32x16_bf16 v[80:95], a[176:179], v[240:243], v[80:95]
 s_add_u32 s59, s59, 8192
 v_cvt_pk_bf16_f32 v147, v102, v103
 v_exp_f32 v105, v105
 v_add_f32 v17, v17, v104
 v_add_f32 v17, v17, v105
 v_mfma_f32_32x32x16_bf16 v[64:79], a[180:183], v[212:215], v[64:79]
 ds_read_b128 a[140:143], v11 offset:11264
 v_exp_f32 v106, v106
 v_cvt_pk_bf16_f32 v148, v104, v105
 v_exp_f32 v107, v107
 v_mfma_f32_32x32x16_bf16 v[80:95], a[180:183], v[244:247], v[80:95]
 v_add_f32 v17, v17, v106
 v_exp_f32 v108, v108
 v_add_f32 v17, v17, v107
 v_cvt_pk_bf16_f32 v149, v106, v107
 v_add_f32 v17, v17, v108
 v_mfma_f32_32x32x16_bf16 v[64:79], a[184:187], v[216:219], v[64:79]
 ds_read_b128 a[144:147], v11 offset:12288
 v_exp_f32 v109, v109
 v_exp_f32 v110, v110
 v_add_f32 v17, v17, v109
 v_mfma_f32_32x32x16_bf16 v[80:95], a[184:187], v[248:251], v[80:95]
 v_cvt_pk_bf16_f32 v150, v108, v109
 v_exp_f32 v111, v111
 v_add_f32 v17, v17, v110
 v_exp_f32 v112, v112
 v_mfma_f32_32x32x16_bf16 v[64:79], a[188:191], v[220:223], v[64:79]
 ds_read_b128 a[148:151], v11 offset:13312
 v_add_f32 v17, v17, v111
 v_cvt_pk_bf16_f32 v151, v110, v111
 v_exp_f32 v113, v113
 v_add_f32 v18, v18, v112
 v_mfma_f32_32x32x16_bf16 v[80:95], a[188:191], v[252:255], v[80:95]
 v_exp_f32 v114, v114
 v_add_f32 v18, v18, v113
 v_cvt_pk_bf16_f32 v152, v112, v113
 v_exp_f32 v115, v115
 v_mfma_f32_32x32x16_bf16 a[0:15], a[128:131], v[128:131], a[0:15]
 ds_read_b128 a[152:155], v11 offset:14336
 v_add_f32 v18, v18, v114
 v_exp_f32 v116, v116
 v_add_f32 v18, v18, v115
 s_waitcnt lgkmcnt(2)
 v_mfma_f32_32x32x16_bf16 a[64:79], a[128:131], v[136:139], a[64:79]
 s_add_u32 s56, s56, 16384
 v_cvt_pk_bf16_f32 v153, v114, v115
 v_exp_f32 v117, v117
 v_add_f32 v18, v18, v116
 v_add_f32 v18, v18, v117
 v_mfma_f32_32x32x16_bf16 a[16:31], a[132:135], v[128:131], a[16:31]
 ds_read_b128 a[156:159], v11 offset:15360
 v_exp_f32 v118, v118
 v_cvt_pk_bf16_f32 v154, v116, v117
 v_exp_f32 v119, v119
 v_mfma_f32_32x32x16_bf16 a[80:95], a[132:135], v[136:139], a[80:95]
 s_and_b32 s56, s56, 0x1ffff
 v_add_u32 v10, s56, v19
 v_add_f32 v18, v18, v118
 v_exp_f32 v120, v120
 v_add_f32 v18, v18, v119
 v_mfma_f32_32x32x16_bf16 a[32:47], a[136:139], v[128:131], a[32:47]
 s_waitcnt vmcnt(20)
 s_barrier
 ds_read_b128 a[160:163], v10
 v_cvt_pk_bf16_f32 v155, v118, v119
 v_exp_f32 v121, v121
 v_mfma_f32_32x32x16_bf16 a[96:111], a[136:139], v[136:139], a[96:111]
 v_add_f32 v18, v18, v120
 v_exp_f32 v122, v122
 v_add_f32 v18, v18, v121
 v_cvt_pk_bf16_f32 v156, v120, v121
 v_add_f32 v18, v18, v122
 v_mfma_f32_32x32x16_bf16 a[48:63], a[140:143], v[128:131], a[48:63]
 ds_read_b128 a[164:167], v10 offset:1024
 v_exp_f32 v123, v123
 v_exp_f32 v124, v124
 v_add_f32 v18, v18, v123
 v_mfma_f32_32x32x16_bf16 a[112:127], a[140:143], v[136:139], a[112:127]
 v_cvt_pk_bf16_f32 v157, v122, v123
 v_exp_f32 v125, v125
 v_add_f32 v18, v18, v124
 v_exp_f32 v126, v126
 v_mfma_f32_32x32x16_bf16 a[0:15], a[144:147], v[132:135], a[0:15]
 ds_read_b128 a[168:171], v10 offset:2048
 v_add_f32 v18, v18, v125
 v_cvt_pk_bf16_f32 v158, v124, v125
 v_exp_f32 v127, v127
 s_waitcnt lgkmcnt(2)
 v_mfma_f32_32x32x16_bf16 a[64:79], a[144:147], v[140:143], a[64:79]
 v_add_f32 v18, v18, v126
 v_add_f32 v18, v18, v127
 v_cvt_pk_bf16_f32 v159, v126, v127
 v_mfma_f32_32x32x16_bf16 a[16:31], a[148:151], v[132:135], a[16:31]
 ds_read_b128 a[172:175], v10 offset:3072
 v_mfma_f32_32x32x16_bf16 a[80:95], a[148:151], v[140:143], a[80:95]
 v_mfma_f32_32x32x16_bf16 a[32:47], a[152:155], v[132:135], a[32:47]
 ds_read_b128 a[176:179], v10 offset:4096
 v_mfma_f32_32x32x16_bf16 a[96:111], a[152:155], v[140:143], a[96:111]
 v_mfma_f32_32x32x16_bf16 a[48:63], a[156:159], v[132:135], a[48:63]
 ds_read_b128 a[180:183], v10 offset:5120
 v_mfma_f32_32x32x16_bf16 a[112:127], a[156:159], v[140:143], a[112:127]
 s_sub_u32 s62, s62, 1
 s_cmp_gt_u32 s62, 2
 s_cbranch_scc1 L_b_dloop
L_b_DS0:
 v_mfma_f32_32x32x16_bf16 v[96:111], a[160:163], v[192:195], v[32:47]
 ds_read_b128 a[184:187], v10 offset:6144
 s_add_u32 m0, s57, 32768
 v_exp_f32 v64, v64
 s_waitcnt lgkmcnt(2)
 v_mfma_f32_32x32x16_bf16 v[112:127], a[160:163], v[224:227], v[48:63]
 buffer_load_dwordx4 v12, s[36:39], s59 offen sc1 lds
 v_exp_f32 v65, v65
 v_add_f32 v17, v17, v64
 v_mfma_f32_32x32x16_bf16 v[96:111], a[164:167], v[196:199], v[96:111]
 ds_read_b128 a[188:191], v10 offset:7168
 v_exp_f32 v66, v66
 v_add_f32 v17, v17, v65
 v_cvt_pk_bf16_f32 v128, v64, v65
 v_add_f32 v17, v17, v66
 v_mfma_f32_32x32x16_bf16 v[112:127], a[164:167], v[228:231], v[112:127]
 buffer_load_dwordx4 v12, s[36:39], s59 offen offset:1024 sc1 lds
 v_exp_f32 v67, v67
 v_mfma_f32_32x32x16_bf16 v[96:111], a[168:171], v[200:203], v[96:111]
 ds_read_b128 a[128:131], v10 offset:8192
 s_add_u32 m0, s57, 40960
 s_cmp_eq_u32 s28, 0
 s_cselect_b32 s64, 1.0, 0
 v_exp_f32 v68, v68
 v_mfma_f32_32x32x16_bf16 v[112:127], a[168:171], v[232:235], v[112:127]
 buffer_load_dwordx4 v13, s[36:39], s59 offen sc1 lds
 v_add_f32 v17, v17, v67
 v_cvt_pk_bf16_f32 v129, v66, v67
 v_add_f32 v17, v17, v68
 v_mfma_f32_32x32x16_bf16 v[96:111], a[172:175], v[204:207], v[96:111]
 ds_read_b128 a[132:135], v10 offset:9216
 s_add_u32 s57, s57, 16384
 s_cmp_lt_u32 s28, 0
 s_cselect_b32 s65, 0xf149f2ca, 0
 v_exp_f32 v69, v69
 v_mfma_f32_32x32x16_bf16 v[112:127], a[172:175], v[236:239], v[112:127]
 buffer_load_dwordx4 v13, s[36:39], s59 offen offset:1024 sc1 lds
 v_exp_f32 v70, v70
 v_add_f32 v17, v17, v69
 v_mfma_f32_32x32x16_bf16 v[96:111], a[176:179], v[208:211], v[96:111]
 ds_read_b128 a[136:139], v10 offset:10240
 s_and_b32 s57, s57, 0x1ffff
 v_cvt_pk_bf16_f32 v130, v68, v69
 v_add_f32 v23, s65, v20
 v_add_f32 v17, v17, v70
 s_waitcnt lgkmcnt(2)
 v_mfma_f32_32x32x16_bf16 v[112:127], a[176:179], v[240:243], v[112:127]
 s_add_u32 s59, s59, 8192
 v_exp_f32 v71, v71
 v_exp_f32 v72, v72
 v_add_f32 v17, v17, v71
 v_mfma_f32_32x32x16_bf16 v[96:111], a[180:183], v[212:215], v[96:111]
 ds_read_b128 a[140:143], v10 offset:11264
 v_fma_f32 v32, v176, s64, v23
 v_cvt_pk_bf16_f32 v131, v70, v71
 v_exp_f32 v73, v73
 v_add_f32 v17, v17, v72
 v_mfma_f32_32x32x16_bf16 v[112:127], a[180:183], v[244:247], v[112:127]
 v_fma_f32 v33, v177, s64, v23
 v_exp_f32 v74, v74
 v_add_f32 v17, v17, v73
 v_cvt_pk_bf16_f32 v132, v72, v73
 v_fma_f32 v34, v178, s64, v23
 v_mfma_f32_32x32x16_bf16 v[96:111], a[184:187], v[216:219], v[96:111]
 ds_read_b128 a[144:147], v10 offset:12288
 v_exp_f32 v75, v75
 v_add_f32 v17, v17, v74
 v_exp_f32 v76, v76
 v_mfma_f32_32x32x16_bf16 v[112:127], a[184:187], v[248:251], v[112:127]
 v_add_f32 v17, v17, v75
 v_cvt_pk_bf16_f32 v133, v74, v75
 v_fma_f32 v35, v179, s64, v23
 v_exp_f32 v77, v77
 v_add_f32 v17, v17, v76
 v_mfma_f32_32x32x16_bf16 v[96:111], a[188:191], v[220:223], v[96:111]
 ds_read_b128 a[148:151], v10 offset:13312
 v_exp_f32 v78, v78
 v_fma_f32 v36, v180, s64, v23
 v_add_f32 v17, v17, v77
 v_cvt_pk_bf16_f32 v134, v76, v77
 v_mfma_f32_32x32x16_bf16 v[112:127], a[188:191], v[252:255], v[112:127]
 v_exp_f32 v79, v79
 v_add_f32 v17, v17, v78
 v_fma_f32 v37, v181, s64, v23
 v_exp_f32 v80, v80
 v_mfma_f32_32x32x16_bf16 a[0:15], a[128:131], v[144:147], a[0:15]
 ds_read_b128 a[152:155], v10 offset:14336
 v_add_f32 v17, v17, v79
 v_cvt_pk_bf16_f32 v135, v78, v79
 v_fma_f32 v38, v182, s64, v23
 v_add_f32 v18, v18, v80
 s_waitcnt lgkmcnt(2)
 v_mfma_f32_32x32x16_bf16 a[64:79], a[128:131], v[152:155], a[64:79]
 s_add_u32 s56, s56, 16384
 v_exp_f32 v81, v81
 v_exp_f32 v82, v82
 v_add_f32 v18, v18, v81
 v_mfma_f32_32x32x16_bf16 a[16:31], a[132:135], v[144:147], a[16:31]
 ds_read_b128 a[156:159], v10 offset:15360
 v_fma_f32 v39, v183, s64, v23
 v_cvt_pk_bf16_f32 v136, v80, v81
 v_exp_f32 v83, v83
 v_add_f32 v18, v18, v82
 v_mfma_f32_32x32x16_bf16 a[80:95], a[132:135], v[152:155], a[80:95]
 s_and_b32 s56, s56, 0x1ffff
 v_add_u32 v11, s56, v19
 v_fma_f32 v40, v184, s64, v23
 v_exp_f32 v84, v84
 v_add_f32 v18, v18, v83
 v_mfma_f32_32x32x16_bf16 a[32:47], a[136:139], v[144:147], a[32:47]
 s_waitcnt vmcnt(20)
 s_barrier
 ds_read_b128 a[160:163], v11
 v_cvt_pk_bf16_f32 v137, v82, v83
 v_exp_f32 v85, v85
 v_mfma_f32_32x32x16_bf16 a[96:111], a[136:139], v[152:155], a[96:111]
 v_fma_f32 v41, v185, s64, v23
 v_add_f32 v18, v18, v84
 v_exp_f32 v86, v86
 v_add_f32 v18, v18, v85
 v_cvt_pk_bf16_f32 v138, v84, v85
 v_mfma_f32_32x32x16_bf16 a[48:63], a[140:143], v[144:147], a[48:63]
 ds_read_b128 a[164:167], v11 offset:1024
 v_fma_f32 v42, v186, s64, v23
 v_exp_f32 v87, v87
 v_add_f32 v18, v18, v86
 v_fma_f32 v43, v187, s64, v23
 v_mfma_f32_32x32x16_bf16 a[112:127], a[140:143], v[152:155], a[112:127]
 v_exp_f32 v88, v88
 v_add_f32 v18, v18, v87
 v_cvt_pk_bf16_f32 v139, v86, v87
 v_exp_f32 v89, v89
 v_mfma_f32_32x32x16_bf16 a[0:15], a[144:147], v[148:151], a[0:15]
 ds_read_b128 a[168:171], v11 offset:2048
 v_add_f32 v18, v18, v88
 v_fma_f32 v44, v188, s64, v23
 v_exp_f32 v90, v90
 s_waitcnt lgkmcnt(2)
 v_mfma_f32_32x32x16_bf16 a[64:79], a[144:147], v[156:159], a[64:79]
 v_add_f32 v18, v18, v89
 v_cvt_pk_bf16_f32 v140, v88, v89
 v_fma_f32 v45, v189, s64, v23
 v_exp_f32 v91, v91
 v_add_f32 v18, v18, v90
 v_mfma_f32_32x32x16_bf16 a[16:31], a[148:151], v[148:151], a[16:31]
 ds_read_b128 a[172:175], v11 offset:3072
 v_exp_f32 v92, v92
 v_add_f32 v18, v18, v91
 v_fma_f32 v46, v190, s64, v23
 v_cvt_pk_bf16_f32 v141, v90, v91
 v_mfma_f32_32x32x16_bf16 a[80:95], a[148:151], v[156:159], a[80:95]
 v_exp_f32 v93, v93
 v_add_f32 v18, v18, v92
 v_fma_f32 v47, v191, s64, v23
 v_exp_f32 v94, v94
 v_mfma_f32_32x32x16_bf16 a[32:47], a[152:155], v[148:151], a[32:47]
 ds_read_b128 a[176:179], v11 offset:4096
 v_add_f32 v18, v18, v93
 v_cvt_pk_bf16_f32 v142, v92, v93
 v_exp_f32 v95, v95
 v_add_f32 v18, v18, v94
 v_mfma_f32_32x32x16_bf16 a[96:111], a[152:155], v[156:159], a[96:111]
 v_add_f32 v18, v18, v95
 v_cvt_pk_bf16_f32 v143, v94, v95
 v_mfma_f32_32x32x16_bf16 a[48:63], a[156:159], v[148:151], a[48:63]
 ds_read_b128 a[180:183], v11 offset:5120
 v_mfma_f32_32x32x16_bf16 a[112:127], a[156:159], v[156:159], a[112:127]
 v_mfma_f32_32x32x16_bf16 v[64:79], a[160:163], v[192:195], v[32:47]
 ds_read_b128 a[184:187], v11 offset:6144
 s_add_u32 m0, s57, 32768
 v_exp_f32 v96, v96
 s_waitcnt lgkmcnt(2)
 v_mfma_f32_32x32x16_bf16 v[80:95], a[160:163], v[224:227], v[48:63]
 buffer_load_dwordx4 v12, s[36:39], s59 offen sc1 lds
 v_exp_f32 v97, v97
 v_add_f32 v17, v17, v96
 v_mfma_f32_32x32x16_bf16 v[64:79], a[164:167], v[196:199], v[64:79]
 ds_read_b128 a[188:191], v11 offset:7168
 v_exp_f32 v98, v98
 v_add_f32 v17, v17, v97
 v_cvt_pk_bf16_f32 v144, v96, v97
 v_add_f32 v17, v17, v98
 v_mfma_f32_32x32x16_bf16 v[80:95], a[164:167], v[228:231], v[80:95]
 buffer_load_dwordx4 v12, s[36:39], s59 offen offset:1024 sc1 lds
 v_exp_f32 v99, v99
 v_mfma_f32_32x32x16_bf16 v[64:79], a[168:171], v[200:203], v[64:79]
 ds_read_b128 a[128:131], v11 offset:8192
 s_add_u32 m0, s57, 40960
 s_cmp_eq_u32 s28, 1
 s_cselect_b32 s64, 1.0, 0
 v_exp_f32 v100, v100
 v_mfma_f32_32x32x16_bf16 v[80:95], a[168:171], v[232:235], v[80:95]
 buffer_load_dwordx4 v13, s[36:39], s59 offen sc1 lds
 v_add_f32 v17, v17, v99
 v_cvt_pk_bf16_f32 v145, v98, v99
 v_add_f32 v17, v17, v100
 v_mfma_f32_32x32x16_bf16 v[64:79], a[172:175], v[204:207], v[64:79]
 ds_read_b128 a[132:135], v11 offset:9216
 s_add_u32 s57, s57, 16384
 s_cmp_lt_u32 s28, 1
 s_cselect_b32 s65, 0xf149f2ca, 0
 v_exp_f32 v101, v101
 v_mfma_f32_32x32x16_bf16 v[80:95], a[172:175], v[236:239], v[80:95]
 buffer_load_dwordx4 v13, s[36:39], s59 offen offset:1024 sc1 lds
 v_exp_f32 v102, v102
 v_add_f32 v17, v17, v101
 v_mfma_f32_32x32x16_bf16 v[64:79], a[176:179], v[208:211], v[64:79]
 ds_read_b128 a[136:139], v11 offset:10240
 s_and_b32 s57, s57, 0x1ffff
 v_cvt_pk_bf16_f32 v146, v100, v101
 v_add_f32 v23, s65, v20
 v_add_f32 v17, v17, v102
 s_waitcnt lgkmcnt(2)
 v_mfma_f32_32x32x16_bf16 v[80:95], a[176:179], v[240:243], v[80:95]
 s_add_u32 s59, s59, 8192
 v_exp_f32 v103, v103
 v_exp_f32 v104, v104
 v_add_f32 v17, v17, v103
 v_mfma_f32_32x32x16_bf16 v[64:79], a[180:183], v[212:215], v[64:79]
 ds_read_b128 a[140:143], v11 offset:11264
 v_fma_f32 v32, v176, s64, v23
 v_cvt_pk_bf16_f32 v147, v102, v103
 v_exp_f32 v105, v105
 v_add_f32 v17, v17, v104
 v_mfma_f32_32x32x16_bf16 v[80:95], a[180:183], v[244:247], v[80:95]
 v_fma_f32 v33, v177, s64, v23
 v_exp_f32 v106, v106
 v_add_f32 v17, v17, v105
 v_cvt_pk_bf16_f32 v148, v104, v105
 v_fma_f32 v34, v178, s64, v23
 v_mfma_f32_32x32x16_bf16 v[64:79], a[184:187], v[216:219], v[64:79]
 ds_read_b128 a[144:147], v11 offset:12288
 v_exp_f32 v107, v107
 v_add_f32 v17, v17, v106
 v_exp_f32 v108, v108
 v_mfma_f32_32x32x16_bf16 v[80:95], a[184:187], v[248:251], v[80:95]
 v_add_f32 v17, v17, v107
 v_cvt_pk_bf16_f32 v149, v106, v107
 v_fma_f32 v35, v179, s64, v23
 v_exp_f32 v109, v109
 v_add_f32 v17, v17, v108
 v_mfma_f32_32x32x16_bf16 v[64:79], a[188:191], v[220:223], v[64:79]
 ds_read_b128 a[148:151], v11 offset:13312
 v_exp_f32 v110, v110
 v_fma_f32 v36, v180, s64, v23
 v_add_f32 v17, v17, v109
 v_cvt_pk_bf16_f32 v150, v108, v109
 v_mfma_f32_32x32x16_bf16 v[80:95], a[188:191], v[252:255], v[80:95]
 v_exp_f32 v111, v111
 v_add_f32 v17, v17, v110
 v_fma_f32 v37, v181, s64, v23
 v_exp_f32 v112, v112
 v_mfma_f32_32x32x16_bf16 a[0:15], a[128:131], v[128:131], a[0:15]
 ds_read_b128 a[152:155], v11 offset:14336
 v_add_f32 v17, v17, v111
 v_cvt_pk_bf16_f32 v151, v110, v111
 v_fma_f32 v38, v182, s64, v23
 v_add_f32 v18, v18, v112
 s_waitcnt lgkmcnt(2)
 v_mfma_f32_32x32x16_bf16 a[64:79], a[128:131], v[136:139], a[64:79]
 s_add_u32 s56, s56, 16384
 v_exp_f32 v113, v113
 v_exp_f32 v114, v114
 v_add_f32 v18, v18, v113
 v_mfma_f32_32x32x16_bf16 a[16:31], a[132:135], v[128:131], a[16:31]
 ds_read_b128 a[156:159], v11 offset:15360
 v_fma_f32 v39, v183, s64, v23
 v_cvt_pk_bf16_f32 v152, v112, v113
 v_exp_f32 v115, v115
 v_add_f32 v18, v18, v114
 v_mfma_f32_32x32x16_bf16 a[80:95], a[132:135], v[136:139], a[80:95]
 s_and_b32 s56, s56, 0x1ffff
 v_add_u32 v10, s56, v19
 v_fma_f32 v40, v184, s64, v23
 v_exp_f32 v116, v116
 v_add_f32 v18, v18, v115
 v_mfma_f32_32x32x16_bf16 a[32:47], a[136:139], v[128:131], a[32:47]
 s_waitcnt vmcnt(20)
 s_barrier
 ds_read_b128 a[160:163], v10
 v_cvt_pk_bf16_f32 v153, v114, v115
 v_exp_f32 v117, v117
 v_mfma_f32_32x32x16_bf16 a[96:111], a[136:139], v[136:139], a[96:111]
 v_fma_f32 v41, v185, s64, v23
 v_add_f32 v18, v18, v116
 v_exp_f32 v118, v118
 v_add_f32 v18, v18, v117
 v_cvt_pk_bf16_f32 v154, v116, v117
 v_mfma_f32_32x32x16_bf16 a[48:63], a[140:143], v[128:131], a[48:63]
 ds_read_b128 a[164:167], v10 offset:1024
 v_fma_f32 v42, v186, s64, v23
 v_exp_f32 v119, v119
 v_add_f32 v18, v18, v118
 v_fma_f32 v43, v187, s64, v23
 v_mfma_f32_32x32x16_bf16 a[112:127], a[140:143], v[136:139], a[112:127]
 v_exp_f32 v120, v120
 v_add_f32 v18, v18, v119
 v_cvt_pk_bf16_f32 v155, v118, v119
 v_exp_f32 v121, v121
 v_mfma_f32_32x32x16_bf16 a[0:15], a[144:147], v[132:135], a[0:15]
 ds_read_b128 a[168:171], v10 offset:2048
 v_add_f32 v18, v18, v120
 v_fma_f32 v44, v188, s64, v23
 v_exp_f32 v122, v122
 s_waitcnt lgkmcnt(2)
 v_mfma_f32_32x32x16_bf16 a[64:79], a[144:147], v[140:143], a[64:79]
 v_add_f32 v18, v18, v121
 v_cvt_pk_bf16_f32 v156, v120, v121
 v_fma_f32 v45, v189, s64, v23
 v_exp_f32 v123, v123
 v_add_f32 v18, v18, v122
 v_mfma_f32_32x32x16_bf16 a[16:31], a[148:151], v[132:135], a[16:31]
 ds_read_b128 a[172:175], v10 offset:3072
 v_exp_f32 v124, v124
 v_add_f32 v18, v18, v123
 v_fma_f32 v46, v190, s64, v23
 v_cvt_pk_bf16_f32 v157, v122, v123
 v_mfma_f32_32x32x16_bf16 a[80:95], a[148:151], v[140:143], a[80:95]
 v_exp_f32 v125, v125
 v_add_f32 v18, v18, v124
 v_fma_f32 v47, v191, s64, v23
 v_exp_f32 v126, v126
 v_mfma_f32_32x32x16_bf16 a[32:47], a[152:155], v[132:135], a[32:47]
 ds_read_b128 a[176:179], v10 offset:4096
 v_add_f32 v18, v18, v125
 v_cvt_pk_bf16_f32 v158, v124, v125
 v_exp_f32 v127, v127
 v_add_f32 v18, v18, v126
 v_mfma_f32_32x32x16_bf16 a[96:111], a[152:155], v[140:143], a[96:111]
 v_add_f32 v18, v18, v127
 v_cvt_pk_bf16_f32 v159, v126, v127
 v_mfma_f32_32x32x16_bf16 a[48:63], a[156:159], v[132:135], a[48:63]
 ds_read_b128 a[180:183], v10 offset:5120
 v_mfma_f32_32x32x16_bf16 a[112:127], a[156:159], v[140:143], a[112:127]
 v_mfma_f32_32x32x16_bf16 v[96:111], a[160:163], v[192:195], v[32:47]
 ds_read_b128 a[184:187], v10 offset:6144
 s_add_u32 m0, s57, 32768
 v_exp_f32 v64, v64
 s_waitcnt lgkmcnt(2)
 v_mfma_f32_32x32x16_bf16 v[112:127], a[160:163], v[224:227], v[48:63]
 buffer_load_dwordx4 v12, s[36:39], s59 offen sc1 lds
 v_exp_f32 v65, v65
 v_add_f32 v17, v17, v64
 v_mfma_f32_32x32x16_bf16 v[96:111], a[164:167], v[196:199], v[96:111]
 ds_read_b128 a[188:191], v10 offset:7168
 v_exp_f32 v66, v66
 v_add_f32 v17, v17, v65
 v_cvt_pk_bf16_f32 v128, v64, v65
 v_add_f32 v17, v17, v66
 v_mfma_f32_32x32x16_bf16 v[112:127], a[164:167], v[228:231], v[112:127]
 buffer_load_dwordx4 v12, s[36:39], s59 offen offset:1024 sc1 lds
 v_exp_f32 v67, v67
 v_mfma_f32_32x32x16_bf16 v[96:111], a[168:171], v[200:203], v[96:111]
 ds_read_b128 a[128:131], v10 offset:8192
 s_add_u32 m0, s57, 40960
 s_cmp_eq_u32 s28, 2
 s_cselect_b32 s64, 1.0, 0
 v_exp_f32 v68, v68
 v_mfma_f32_32x32x16_bf16 v[112:127], a[168:171], v[232:235], v[112:127]
 buffer_load_dwordx4 v13, s[36:39], s59 offen sc1 lds
 v_add_f32 v17, v17, v67
 v_cvt_pk_bf16_f32 v129, v66, v67
 v_add_f32 v17, v17, v68
 v_mfma_f32_32x32x16_bf16 v[96:111], a[172:175], v[204:207], v[96:111]
 ds_read_b128 a[132:135], v10 offset:9216
 s_add_u32 s57, s57, 16384
 s_cmp_lt_u32 s28, 2
 s_cselect_b32 s65, 0xf149f2ca, 0
 v_exp_f32 v69, v69
 v_mfma_f32_32x32x16_bf16 v[112:127], a[172:175], v[236:239], v[112:127]
 buffer_load_dwordx4 v13, s[36:39], s59 offen offset:1024 sc1 lds
 v_exp_f32 v70, v70
 v_add_f32 v17, v17, v69
 v_mfma_f32_32x32x16_bf16 v[96:111], a[176:179], v[208:211], v[96:111]
 ds_read_b128 a[136:139], v10 offset:10240
 s_and_b32 s57, s57, 0x1ffff
 v_cvt_pk_bf16_f32 v130, v68, v69
 v_add_f32 v23, s65, v20
 v_add_f32 v17, v17, v70
 s_waitcnt lgkmcnt(2)
 v_mfma_f32_32x32x16_bf16 v[112:127], a[176:179], v[240:243], v[112:127]
 s_add_u32 s59, s59, 8192
 v_exp_f32 v71, v71
 v_exp_f32 v72, v72
 v_add_f32 v17, v17, v71
 v_mfma_f32_32x32x16_bf16 v[96:111], a[180:183], v[212:215], v[96:111]
 ds_read_b128 a[140:143], v10 offset:11264
 v_fma_f32 v32, v176, s64, v23
 v_cvt_pk_bf16_f32 v131, v70, v71
 v_exp_f32 v73, v73
 v_add_f32 v17, v17, v72
 v_mfma_f32_32x32x16_bf16 v[112:127], a[180:183], v[244:247], v[112:127]
 v_fma_f32 v33, v177, s64, v23
 v_exp_f32 v74, v74
 v_add_f32 v17, v17, v73
 v_cvt_pk_bf16_f32 v132, v72, v73
 v_fma_f32 v34, v178, s64, v23
 v_mfma_f32_32x32x16_bf16 v[96:111], a[184:187], v[216:219], v[96:111]
 ds_read_b128 a[144:147], v10 offset:12288
 v_exp_f32 v75, v75
 v_add_f32 v17, v17, v74
 v_exp_f32 v76, v76
 v_mfma_f32_32x32x16_bf16 v[112:127], a[184:187], v[248:251], v[112:127]
 v_add_f32 v17, v17, v75
 v_cvt_pk_bf16_f32 v133, v74, v75
 v_fma_f32 v35, v179, s64, v23
 v_exp_f32 v77, v77
 v_add_f32 v17, v17, v76
 v_mfma_f32_32x32x16_bf16 v[96:111], a[188:191], v[220:223], v[96:111]
 ds_read_b128 a[148:151], v10 offset:13312
 v_exp_f32 v78, v78
 v_fma_f32 v36, v180, s64, v23
 v_add_f32 v17, v17, v77
 v_cvt_pk_bf16_f32 v134, v76, v77
 v_mfma_f32_32x32x16_bf16 v[112:127], a[188:191], v[252:255], v[112:127]
 v_exp_f32 v79, v79
 v_add_f32 v17, v17, v78
 v_fma_f32 v37, v181, s64, v23
 v_exp_f32 v80, v80
 v_mfma_f32_32x32x16_bf16 a[0:15], a[128:131], v[144:147], a[0:15]
 ds_read_b128 a[152:155], v10 offset:14336
 v_add_f32 v17, v17, v79
 v_cvt_pk_bf16_f32 v135, v78, v79
 v_fma_f32 v38, v182, s64, v23
 v_add_f32 v18, v18, v80
 s_waitcnt lgkmcnt(2)
 v_mfma_f32_32x32x16_bf16 a[64:79], a[128:131], v[152:155], a[64:79]
 s_add_u32 s56, s56, 16384
 v_exp_f32 v81, v81
 v_exp_f32 v82, v82
 v_add_f32 v18, v18, v81
 v_mfma_f32_32x32x16_bf16 a[16:31], a[132:135], v[144:147], a[16:31]
 ds_read_b128 a[156:159], v10 offset:15360
 v_fma_f32 v39, v183, s64, v23
 v_cvt_pk_bf16_f32 v136, v80, v81
 v_exp_f32 v83, v83
 v_add_f32 v18, v18, v82
 v_mfma_f32_32x32x16_bf16 a[80:95], a[132:135], v[152:155], a[80:95]
 s_and_b32 s56, s56, 0x1ffff
 v_add_u32 v11, s56, v19
 v_fma_f32 v40, v184, s64, v23
 v_exp_f32 v84, v84
 v_add_f32 v18, v18, v83
 v_mfma_f32_32x32x16_bf16 a[32:47], a[136:139], v[144:147], a[32:47]
 s_waitcnt vmcnt(20)
 s_barrier
 ds_read_b128 a[160:163], v11
 v_cvt_pk_bf16_f32 v137, v82, v83
 v_exp_f32 v85, v85
 v_mfma_f32_32x32x16_bf16 a[96:111], a[136:139], v[152:155], a[96:111]
 v_fma_f32 v41, v185, s64, v23
 v_add_f32 v18, v18, v84
 v_exp_f32 v86, v86
 v_add_f32 v18, v18, v85
 v_cvt_pk_bf16_f32 v138, v84, v85
 v_mfma_f32_32x32x16_bf16 a[48:63], a[140:143], v[144:147], a[48:63]
 ds_read_b128 a[164:167], v11 offset:1024
 v_fma_f32 v42, v186, s64, v23
 v_exp_f32 v87, v87
 v_add_f32 v18, v18, v86
 v_fma_f32 v43, v187, s64, v23
 v_mfma_f32_32x32x16_bf16 a[112:127], a[140:143], v[152:155], a[112:127]
 v_exp_f32 v88, v88
 v_add_f32 v18, v18, v87
 v_cvt_pk_bf16_f32 v139, v86, v87
 v_exp_f32 v89, v89
 v_mfma_f32_32x32x16_bf16 a[0:15], a[144:147], v[148:151], a[0:15]
 ds_read_b128 a[168:171], v11 offset:2048
 v_add_f32 v18, v18, v88
 v_fma_f32 v44, v188, s64, v23
 v_exp_f32 v90, v90
 s_waitcnt lgkmcnt(2)
 v_mfma_f32_32x32x16_bf16 a[64:79], a[144:147], v[156:159], a[64:79]
 v_add_f32 v18, v18, v89
 v_cvt_pk_bf16_f32 v140, v88, v89
 v_fma_f32 v45, v189, s64, v23
 v_exp_f32 v91, v91
 v_add_f32 v18, v18, v90
 v_mfma_f32_32x32x16_bf16 a[16:31], a[148:151], v[148:151], a[16:31]
 ds_read_b128 a[172:175], v11 offset:3072
 v_exp_f32 v92, v92
 v_add_f32 v18, v18, v91
 v_fma_f32 v46, v190, s64, v23
 v_cvt_pk_bf16_f32 v141, v90, v91
 v_mfma_f32_32x32x16_bf16 a[80:95], a[148:151], v[156:159], a[80:95]
 v_exp_f32 v93, v93
 v_add_f32 v18, v18, v92
 v_fma_f32 v47, v191, s64, v23
 v_exp_f32 v94, v94
 v_mfma_f32_32x32x16_bf16 a[32:47], a[152:155], v[148:151], a[32:47]
 ds_read_b128 a[176:179], v11 offset:4096
 v_add_f32 v18, v18, v93
 v_cvt_pk_bf16_f32 v142, v92, v93
 v_exp_f32 v95, v95
 v_add_f32 v18, v18, v94
 v_mfma_f32_32x32x16_bf16 a[96:111], a[152:155], v[156:159], a[96:111]
 v_add_f32 v18, v18, v95
 v_cvt_pk_bf16_f32 v143, v94, v95
 v_mfma_f32_32x32x16_bf16 a[48:63], a[156:159], v[148:151], a[48:63]
 ds_read_b128 a[180:183], v11 offset:5120
 v_mfma_f32_32x32x16_bf16 a[112:127], a[156:159], v[156:159], a[112:127]
 v_mfma_f32_32x32x16_bf16 v[64:79], a[160:163], v[192:195], v[32:47]
 ds_read_b128 a[184:187], v11 offset:6144
 s_add_u32 m0, s57, 32768
 v_exp_f32 v96, v96
 s_waitcnt lgkmcnt(2)
 v_mfma_f32_32x32x16_bf16 v[80:95], a[160:163], v[224:227], v[48:63]
 buffer_load_dwordx4 v12, s[36:39], s59 offen sc1 lds
 v_exp_f32 v97, v97
 v_add_f32 v17, v17, v96
 v_mfma_f32_32x32x16_bf16 v[64:79], a[164:167], v[196:199], v[64:79]
 ds_read_b128 a[188:191], v11 offset:7168
 v_exp_f32 v98, v98
 v_add_f32 v17, v17, v97
 v_cvt_pk_bf16_f32 v144, v96, v97
 v_add_f32 v17, v17, v98
 v_mfma_f32_32x32x16_bf16 v[80:95], a[164:167], v[228:231], v[80:95]
 buffer_load_dwordx4 v12, s[36:39], s59 offen offset:1024 sc1 lds
 v_exp_f32 v99, v99
 v_mfma_f32_32x32x16_bf16 v[64:79], a[168:171], v[200:203], v[64:79]
 ds_read_b128 a[128:131], v11 offset:8192
 s_add_u32 m0, s57, 40960
 s_cmp_eq_u32 s28, 3
 s_cselect_b32 s64, 1.0, 0
 v_exp_f32 v100, v100
 v_mfma_f32_32x32x16_bf16 v[80:95], a[168:171], v[232:235], v[80:95]
 buffer_load_dwordx4 v13, s[36:39], s59 offen sc1 lds
 v_add_f32 v17, v17, v99
 v_cvt_pk_bf16_f32 v145, v98, v99
 v_add_f32 v17, v17, v100
 v_mfma_f32_32x32x16_bf16 v[64:79], a[172:175], v[204:207], v[64:79]
 ds_read_b128 a[132:135], v11 offset:9216
 s_add_u32 s57, s57, 16384
 s_cmp_lt_u32 s28, 3
 s_cselect_b32 s65, 0xf149f2ca, 0
 v_exp_f32 v101, v101
 v_mfma_f32_32x32x16_bf16 v[80:95], a[172:175], v[236:239], v[80:95]
 buffer_load_dwordx4 v13, s[36:39], s59 offen offset:1024 sc1 lds
 v_exp_f32 v102, v102
 v_add_f32 v17, v17, v101
 v_mfma_f32_32x32x16_bf16 v[64:79], a[176:179], v[208:211], v[64:79]
 ds_read_b128 a[136:139], v11 offset:10240
 s_and_b32 s57, s57, 0x1ffff
 v_cvt_pk_bf16_f32 v146, v100, v101
 v_add_f32 v23, s65, v20
 v_add_f32 v17, v17, v102
 s_waitcnt lgkmcnt(2)
 v_mfma_f32_32x32x16_bf16 v[80:95], a[176:179], v[240:243], v[80:95]
 s_add_u32 s59, s59, 8192
 v_exp_f32 v103, v103
 v_exp_f32 v104, v104
 v_add_f32 v17, v17, v103
 v_mfma_f32_32x32x16_bf16 v[64:79], a[180:183], v[212:215], v[64:79]
 ds_read_b128 a[140:143], v11 offset:11264
 v_fma_f32 v32, v176, s64, v23
 v_cvt_pk_bf16_f32 v147, v102, v103
 v_exp_f32 v105, v105
 v_add_f32 v17, v17, v104
 v_mfma_f32_32x32x16_bf16 v[80:95], a[180:183], v[244:247], v[80:95]
 v_fma_f32 v33, v177, s64, v23
 v_exp_f32 v106, v106
 v_add_f32 v17, v17, v105
 v_cvt_pk_bf16_f32 v148, v104, v105
 v_fma_f32 v34, v178, s64, v23
 v_mfma_f32_32x32x16_bf16 v[64:79], a[184:187], v[216:219], v[64:79]
 ds_read_b128 a[144:147], v11 offset:12288
 v_exp_f32 v107, v107
 v_add_f32 v17, v17, v106
 v_exp_f32 v108, v108
 v_mfma_f32_32x32x16_bf16 v[80:95], a[184:187], v[248:251], v[80:95]
 v_add_f32 v17, v17, v107
 v_cvt_pk_bf16_f32 v149, v106, v107
 v_fma_f32 v35, v179, s64, v23
 v_exp_f32 v109, v109
 v_add_f32 v17, v17, v108
 v_mfma_f32_32x32x16_bf16 v[64:79], a[188:191], v[220:223], v[64:79]
 ds_read_b128 a[148:151], v11 offset:13312
 v_exp_f32 v110, v110
 v_fma_f32 v36, v180, s64, v23
 v_add_f32 v17, v17, v109
 v_cvt_pk_bf16_f32 v150, v108, v109
 v_mfma_f32_32x32x16_bf16 v[80:95], a[188:191], v[252:255], v[80:95]
 v_exp_f32 v111, v111
 v_add_f32 v17, v17, v110
 v_fma_f32 v37, v181, s64, v23
 v_exp_f32 v112, v112
 v_mfma_f32_32x32x16_bf16 a[0:15], a[128:131], v[128:131], a[0:15]
 ds_read_b128 a[152:155], v11 offset:14336
 v_add_f32 v17, v17, v111
 v_cvt_pk_bf16_f32 v151, v110, v111
 v_fma_f32 v38, v182, s64, v23
 v_add_f32 v18, v18, v112
 s_waitcnt lgkmcnt(2)
 v_mfma_f32_32x32x16_bf16 a[64:79], a[128:131], v[136:139], a[64:79]
 s_add_u32 s56, s56, 16384
 v_exp_f32 v113, v113
 v_exp_f32 v114, v114
 v_add_f32 v18, v18, v113
 v_mfma_f32_32x32x16_bf16 a[16:31], a[132:135], v[128:131], a[16:31]
 ds_read_b128 a[156:159], v11 offset:15360
 v_fma_f32 v39, v183, s64, v23
 v_cvt_pk_bf16_f32 v152, v112, v113
 v_exp_f32 v115, v115
 v_add_f32 v18, v18, v114
 v_mfma_f32_32x32x16_bf16 a[80:95], a[132:135], v[136:139], a[80:95]
 s_and_b32 s56, s56, 0x1ffff
 v_add_u32 v10, s56, v19
 v_fma_f32 v40, v184, s64, v23
 v_exp_f32 v116, v116
 v_add_f32 v18, v18, v115
 v_mfma_f32_32x32x16_bf16 a[32:47], a[136:139], v[128:131], a[32:47]
 s_waitcnt vmcnt(20)
 s_barrier
 ds_read_b128 a[160:163], v10
 v_cvt_pk_bf16_f32 v153, v114, v115
 v_exp_f32 v117, v117
 v_mfma_f32_32x32x16_bf16 a[96:111], a[136:139], v[136:139], a[96:111]
 v_fma_f32 v41, v185, s64, v23
 v_add_f32 v18, v18, v116
 v_exp_f32 v118, v118
 v_add_f32 v18, v18, v117
 v_cvt_pk_bf16_f32 v154, v116, v117
 v_mfma_f32_32x32x16_bf16 a[48:63], a[140:143], v[128:131], a[48:63]
 ds_read_b128 a[164:167], v10 offset:1024
 v_fma_f32 v42, v186, s64, v23
 v_exp_f32 v119, v119
 v_add_f32 v18, v18, v118
 v_fma_f32 v43, v187, s64, v23
 v_mfma_f32_32x32x16_bf16 a[112:127], a[140:143], v[136:139], a[112:127]
 v_exp_f32 v120, v120
 v_add_f32 v18, v18, v119
 v_cvt_pk_bf16_f32 v155, v118, v119
 v_exp_f32 v121, v121
 v_mfma_f32_32x32x16_bf16 a[0:15], a[144:147], v[132:135], a[0:15]
 ds_read_b128 a[168:171], v10 offset:2048
 v_add_f32 v18, v18, v120
 v_fma_f32 v44, v188, s64, v23
 v_exp_f32 v122, v122
 s_waitcnt lgkmcnt(2)
 v_mfma_f32_32x32x16_bf16 a[64:79], a[144:147], v[140:143], a[64:79]
 v_add_f32 v18, v18, v121
 v_cvt_pk_bf16_f32 v156, v120, v121
 v_fma_f32 v45, v189, s64, v23
 v_exp_f32 v123, v123
 v_add_f32 v18, v18, v122
 v_mfma_f32_32x32x16_bf16 a[16:31], a[148:151], v[132:135], a[16:31]
 ds_read_b128 a[172:175], v10 offset:3072
 v_exp_f32 v124, v124
 v_add_f32 v18, v18, v123
 v_fma_f32 v46, v190, s64, v23
 v_cvt_pk_bf16_f32 v157, v122, v123
 v_mfma_f32_32x32x16_bf16 a[80:95], a[148:151], v[140:143], a[80:95]
 v_exp_f32 v125, v125
 v_add_f32 v18, v18, v124
 v_fma_f32 v47, v191, s64, v23
 v_exp_f32 v126, v126
 v_mfma_f32_32x32x16_bf16 a[32:47], a[152:155], v[132:135], a[32:47]
 ds_read_b128 a[176:179], v10 offset:4096
 v_add_f32 v18, v18, v125
 v_cvt_pk_bf16_f32 v158, v124, v125
 v_exp_f32 v127, v127
 v_add_f32 v18, v18, v126
 v_mfma_f32_32x32x16_bf16 a[96:111], a[152:155], v[140:143], a[96:111]
 v_add_f32 v18, v18, v127
 v_cvt_pk_bf16_f32 v159, v126, v127
 v_mfma_f32_32x32x16_bf16 a[48:63], a[156:159], v[132:135], a[48:63]
 ds_read_b128 a[180:183], v10 offset:5120
 v_mfma_f32_32x32x16_bf16 a[112:127], a[156:159], v[140:143], a[112:127]
L_b_DL:
 v_mfma_f32_32x32x16_bf16 v[96:111], a[160:163], v[192:195], v[32:47]
 ds_read_b128 a[184:187], v10 offset:6144
 s_add_u32 m0, s57, 32768
 v_exp_f32 v64, v64
 s_waitcnt lgkmcnt(2)
 v_mfma_f32_32x32x16_bf16 v[112:127], a[160:163], v[224:227], v[48:63]
 buffer_load_dwordx4 v12, s[36:39], s59 offen sc1 lds
 v_exp_f32 v65, v65
 v_add_f32 v17, v17, v64
 v_add_f32 v17, v17, v65
 v_mfma_f32_32x32x16_bf16 v[96:111], a[164:167], v[196:199], v[96:111]
 ds_read_b128 a[188:191], v10 offset:7168
 v_exp_f32 v66, v66
 v_cvt_pk_bf16_f32 v128, v64, v65
 v_exp_f32 v67, v67
 v_mfma_f32_32x32x16_bf16 v[112:127], a[164:167], v[228:231], v[112:127]
 buffer_load_dwordx4 v12, s[36:39], s59 offen offset:1024 sc1 lds
 s_cmp_eq_u32 s61, 0
 s_cselect_b32 s64, 1.0, 0
 v_add_f32 v17, v17, v66
 v_mfma_f32_32x32x16_bf16 v[96:111], a[168:171], v[200:203], v[96:111]
 ds_read_b128 a[128:131], v10 offset:8192
 s_add_u32 m0, s57, 40960
 s_cmp_lt_u32 s61, 0
 s_cselect_b32 s65, 0xf149f2ca, 0
 v_exp_f32 v68, v68
 v_mfma_f32_32x32x16_bf16 v[112:127], a[168:171], v[232:235], v[112:127]
 buffer_load_dwordx4 v13, s[36:39], s59 offen sc1 lds
 v_add_f32 v17, v17, v67
 v_cvt_pk_bf16_f32 v129, v66, v67
 v_add_f32 v23, s65, v21
 v_mfma_f32_32x32x16_bf16 v[96:111], a[172:175], v[204:207], v[96:111]
 ds_read_b128 a[132:135], v10 offset:9216
 s_add_u32 s57, s57, 16384
 v_exp_f32 v69, v69
 v_add_f32 v17, v17, v68
 v_fma_f32 v32, v176, s64, v23
 v_fma_f32 v33, v177, s64, v23
 v_mfma_f32_32x32x16_bf16 v[112:127], a[172:175], v[236:239], v[112:127]
 buffer_load_dwordx4 v13, s[36:39], s59 offen offset:1024 sc1 lds
 v_exp_f32 v70, v70
 v_add_f32 v17, v17, v69
 v_mfma_f32_32x32x16_bf16 v[96:111], a[176:179], v[208:211], v[96:111]
 ds_read_b128 a[136:139], v10 offset:10240
 s_and_b32 s57, s57, 0x1ffff
 v_cvt_pk_bf16_f32 v130, v68, v69
 v_fma_f32 v34, v178, s64, v23
 v_add_f32 v17, v17, v70
 s_waitcnt lgkmcnt(2)
 v_mfma_f32_32x32x16_bf16 v[112:127], a[176:179], v[240:243], v[112:127]
 s_add_u32 s59, s59, 8192
 v_exp_f32 v71, v71
 v_fma_f32 v35, v179, s64, v23
 v_exp_f32 v72, v72
 v_add_f32 v17, v17, v71
 v_mfma_f32_32x32x16_bf16 v[96:111], a[180:183], v[212:215], v[96:111]
 ds_read_b128 a[140:143], v10 offset:11264
 v_fma_f32 v36, v180, s64, v23
 v_cvt_pk_bf16_f32 v131, v70, v71
 v_exp_f32 v73, v73
 v_fma_f32 v37, v181, s64, v23
 v_mfma_f32_32x32x16_bf16 v[112:127], a[180:183], v[244:247], v[112:127]
 v_add_f32 v17, v17, v72
 v_fma_f32 v38, v182, s64, v23
 v_exp_f32 v74, v74
 v_add_f32 v17, v17, v73
 v_fma_f32 v39, v183, s64, v23
 v_cvt_pk_bf16_f32 v132, v72, v73
 v_mfma_f32_32x32x16_bf16 v[96:111], a[184:187], v[216:219], v[96:111]
 ds_read_b128 a[144:147], v10 offset:12288
 v_exp_f32 v75, v75
 v_fma_f32 v40, v184, s64, v23
 v_add_f32 v17, v17, v74
 v_fma_f32 v41, v185, s64, v23
 v_mfma_f32_32x32x16_bf16 v[112:127], a[184:187], v[248:251], v[112:127]
 v_exp_f32 v76, v76
 v_add_f32 v17, v17, v75
 v_cvt_pk_bf16_f32 v133, v74, v75
 v_fma_f32 v42, v186, s64, v23
 v_fma_f32 v43, v187, s64, v23
 v_mfma_f32_32x32x16_bf16 v[96:111], a[188:191], v[220:223], v[96:111]
 ds_read_b128 a[148:151], v10 offset:13312
 v_exp_f32 v77, v77
 v_add_f32 v17, v17, v76
 v_exp_f32 v78, v78
 v_fma_f32 v44, v188, s64, v23
 v_mfma_f32_32x32x16_bf16 v[112:127], a[188:191], v[252:255], v[112:127]
 v_add_f32 v17, v17, v77
 v_cvt_pk_bf16_f32 v134, v76, v77
 v_fma_f32 v45, v189, s64, v23
 v_exp_f32 v79, v79
 v_add_f32 v17, v17, v78
 v_mfma_f32_32x32x16_bf16 a[0:15], a[128:131], v[144:147], a[0:15]
 ds_read_b128 a[152:155], v10 offset:14336
 v_fma_f32 v46, v190, s64, v23
 v_exp_f32 v80, v80
 v_fma_f32 v47, v191, s64, v23
 s_waitcnt lgkmcnt(2)
 v_mfma_f32_32x32x16_bf16 a[64:79], a[128:131], v[152:155], a[64:79]
 s_add_u32 s56, s56, 16384
 s_cmp_eq_u32 s61, 1
 s_cselect_b32 s66, 1.0, 0
 v_add_f32 v17, v17, v79
 v_cvt_pk_bf16_f32 v135, v78, v79
 v_exp_f32 v81, v81
 v_mfma_f32_32x32x16_bf16 a[16:31], a[132:135], v[144:147], a[16:31]
 ds_read_b128 a[156:159], v10 offset:15360
 s_cmp_lt_u32 s61, 1
 s_cselect_b32 s67, 0xf149f2ca, 0
 v_add_f32 v18, v18, v80
 v_exp_f32 v82, v82
 v_mfma_f32_32x32x16_bf16 a[80:95], a[132:135], v[152:155], a[80:95]
 s_and_b32 s56, s56, 0x1ffff
 v_add_u32 v11, s56, v19
 v_add_f32 v18, v18, v81
 v_add_f32 v24, s67, v21
 v_cvt_pk_bf16_f32 v136, v80, v81
 v_exp_f32 v83, v83
 v_mfma_f32_32x32x16_bf16 a[32:47], a[136:139], v[144:147], a[32:47]
 s_waitcnt vmcnt(16)
 s_barrier
 ds_read_b128 a[160:163], v11
 v_fma_f32 v48, v176, s66, v24
 v_add_f32 v18, v18, v82
 v_fma_f32 v49, v177, s66, v24
 v_mfma_f32_32x32x16_bf16 a[96:111], a[136:139], v[152:155], a[96:111]
 ds_read_b128 a[164:167], v11 offset:16384
 v_exp_f32 v84, v84
 v_add_f32 v18, v18, v83
 v_fma_f32 v50, v178, s66, v24
 v_cvt_pk_bf16_f32 v137, v82, v83
 v_mfma_f32_32x32x16_bf16 a[48:63], a[140:143], v[144:147], a[48:63]
 ds_read_b128 a[168:171], v11 offset:1024
 v_exp_f32 v85, v85
 v_fma_f32 v51, v179, s66, v24
 v_add_f32 v18, v18, v84
 v_exp_f32 v86, v86
 v_mfma_f32_32x32x16_bf16 a[112:127], a[140:143], v[152:155], a[112:127]
 ds_read_b128 a[172:175], v11 offset:17408
 v_fma_f32 v52, v180, s66, v24
 v_add_f32 v18, v18, v85
 v_cvt_pk_bf16_f32 v138, v84, v85
 v_fma_f32 v53, v181, s66, v24
 v_fma_f32 v54, v182, s66, v24
 v_mfma_f32_32x32x16_bf16 a[0:15], a[144:147], v[148:151], a[0:15]
 ds_read_b128 a[176:179], v11 offset:2048
 v_exp_f32 v87, v87
 v_add_f32 v18, v18, v86
 v_fma_f32 v55, v183, s66, v24
 s_waitcnt lgkmcnt(4)
 v_mfma_f32_32x32x16_bf16 a[64:79], a[144:147], v[156:159], a[64:79]
 ds_read_b128 a[180:183], v11 offset:18432
 v_exp_f32 v88, v88
 v_add_f32 v18, v18, v87
 v_cvt_pk_bf16_f32 v139, v86, v87
 v_fma_f32 v56, v184, s66, v24
 v_add_f32 v18, v18, v88
 v_mfma_f32_32x32x16_bf16 a[16:31], a[148:151], v[148:151], a[16:31]
 ds_read_b128 a[184:187], v11 offset:3072
 v_exp_f32 v89, v89
 v_fma_f32 v57, v185, s66, v24
 v_exp_f32 v90, v90
 v_mfma_f32_32x32x16_bf16 a[80:95], a[148:151], v[156:159], a[80:95]
 ds_read_b128 a[188:191], v11 offset:19456
 v_add_f32 v18, v18, v89
 v_fma_f32 v58, v186, s66, v24
 v_cvt_pk_bf16_f32 v140, v88, v89
 v_fma_f32 v59, v187, s66, v24
 v_exp_f32 v91, v91
 v_mfma_f32_32x32x16_bf16 a[32:47], a[152:155], v[148:151], a[32:47]
 ds_read_b128 a[128:131], v11 offset:4096
 v_add_f32 v18, v18, v90
 v_fma_f32 v60, v188, s66, v24
 v_exp_f32 v92, v92
 v_add_f32 v18, v18, v91
 v_mfma_f32_32x32x16_bf16 a[96:111], a[152:155], v[156:159], a[96:111]
 ds_read_b128 a[132:135], v11 offset:20480
 v_fma_f32 v61, v189, s66, v24
 v_cvt_pk_bf16_f32 v141, v90, v91
 v_exp_f32 v93, v93
 v_fma_f32 v62, v190, s66, v24
 v_mfma_f32_32x32x16_bf16 a[48:63], a[156:159], v[148:151], a[48:63]
 ds_read_b128 a[136:139], v11 offset:5120
 v_add_f32 v18, v18, v92
 v_fma_f32 v63, v191, s66, v24
 v_exp_f32 v94, v94
 v_add_f32 v18, v18, v93
 v_cvt_pk_bf16_f32 v142, v92, v93
 v_mfma_f32_32x32x16_bf16 a[112:127], a[156:159], v[156:159], a[112:127]
 ds_read_b128 a[140:143], v11 offset:21504
 v_exp_f32 v95, v95
 v_add_f32 v18, v18, v94
 v_add_f32 v18, v18, v95
 v_cvt_pk_bf16_f32 v143, v94, v95
 v_mfma_f32_32x32x16_bf16 v[64:79], a[160:163], v[224:227], v[32:47]
 ds_read_b128 a[144:147], v11 offset:6144
 v_exp_f32 v96, v96
 v_exp_f32 v97, v97
 s_waitcnt lgkmcnt(4)
 v_mfma_f32_32x32x16_bf16 v[80:95], a[164:167], v[224:227], v[48:63]
 ds_read_b128 a[148:151], v11 offset:22528
 s_sub_u32 s59, s59, 16384
 v_add_f32 v17, v17, v96
 v_exp_f32 v98, v98
 v_add_f32 v17, v17, v97
 v_cvt_pk_bf16_f32 v144, v96, v97
 v_mfma_f32_32x32x16_bf16 v[64:79], a[168:171], v[228:231], v[64:79]
 ds_read_b128 a[152:155], v11 offset:7168
 s_cmp_eq_u32 s61, 2
 s_cselect_b32 s64, 1.0, 0
 v_exp_f32 v99, v99
 v_add_f32 v17, v17, v98
 v_mfma_f32_32x32x16_bf16 v[80:95], a[172:175], v[228:231], v[80:95]
 ds_read_b128 a[156:159], v11 offset:23552
 s_lshr_b32 s70, s28, 1
 s_lshl_b32 s70, s70, 14
 v_exp_f32 v100, v100
 v_mfma_f32_32x32x16_bf16 v[64:79], a[176:179], v[232:235], v[64:79]
 ds_read_b128 a[160:163], v11 offset:8192
 s_cmp_lt_u32 s61, 2
 s_cselect_b32 s65, 0xf149f2ca, 0
 v_add_f32 v17, v17, v99
 v_cvt_pk_bf16_f32 v145, v98, v99
 v_add_f32 v23, s65, v21
 v_add_f32 v17, v17, v100
 v_mfma_f32_32x32x16_bf16 v[80:95], a[180:183], v[232:235], v[80:95]
 s_and_b32 s71, s28, 1
 s_lshl_b32 s71, s71, 12
 v_exp_f32 v101, v101
 v_fma_f32 v32, v176, s64, v23
 v_exp_f32 v102, v102
 v_mfma_f32_32x32x16_bf16 v[64:79], a[184:187], v[236:239], v[64:79]
 ds_read_b128 a[164:167], v11 offset:9216
 v_fma_f32 v33, v177, s64, v23
 v_add_f32 v17, v17, v101
 v_cvt_pk_bf16_f32 v146, v100, v101
 v_fma_f32 v34, v178, s64, v23
 v_add_f32 v17, v17, v102
 v_mfma_f32_32x32x16_bf16 v[80:95], a[188:191], v[236:239], v[80:95]
 s_add_u32 s70, s70, s71
 s_lshl_b32 s71, s28, 11
 v_exp_f32 v103, v103
 v_fma_f32 v35, v179, s64, v23
 v_exp_f32 v104, v104
 v_mfma_f32_32x32x16_bf16 v[64:79], a[128:131], v[240:243], v[64:79]
 ds_read_b128 a[168:171], v11 offset:10240
 v_add_f32 v17, v17, v103
 v_fma_f32 v36, v180, s64, v23
 v_cvt_pk_bf16_f32 v147, v102, v103
 v_fma_f32 v37, v181, s64, v23
 s_waitcnt lgkmcnt(2)
 v_mfma_f32_32x32x16_bf16 v[80:95], a[132:135], v[240:243], v[80:95]
 s_sub_u32 s70, s70, s71
 s_add_u32 s57, s57, s70
 v_exp_f32 v105, v105
 v_add_f32 v17, v17, v104
 v_fma_f32 v38, v182, s64, v23
 v_add_f32 v17, v17, v105
 v_mfma_f32_32x32x16_bf16 v[64:79], a[136:139], v[244:247], v[64:79]
 ds_read_b128 a[172:175], v11 offset:11264
 v_exp_f32 v106, v106
 v_fma_f32 v39, v183, s64, v23
 v_cvt_pk_bf16_f32 v148, v104, v105
 v_exp_f32 v107, v107
 v_mfma_f32_32x32x16_bf16 v[80:95], a[140:143], v[244:247], v[80:95]
 s_cmp_eq_u32 s28, 0
 s_cselect_b32 s70, 0, 0x80000000
 v_fma_f32 v40, v184, s64, v23
 v_add_f32 v17, v17, v106
 v_exp_f32 v108, v108
 v_mfma_f32_32x32x16_bf16 v[64:79], a[144:147], v[248:251], v[64:79]
 ds_read_b128 a[176:179], v11 offset:12288
 v_fma_f32 v41, v185, s64, v23
 v_add_f32 v17, v17, v107
 v_cvt_pk_bf16_f32 v149, v106, v107
 v_fma_f32 v42, v186, s64, v23
 v_exp_f32 v109, v109
 v_mfma_f32_32x32x16_bf16 v[80:95], a[148:151], v[248:251], v[80:95]
 v_mov_b32 v8, s70
 v_mov_b32 v9, 1
 v_fma_f32 v43, v187, s64, v23
 v_add_f32 v17, v17, v108
 v_exp_f32 v110, v110
 v_fma_f32 v44, v188, s64, v23
 v_mfma_f32_32x32x16_bf16 v[64:79], a[152:155], v[252:255], v[64:79]
 ds_read_b128 a[180:183], v11 offset:13312
 v_add_f32 v17, v17, v109
 v_cvt_pk_bf16_f32 v150, v108, v109
 v_fma_f32 v45, v189, s64, v23
 v_exp_f32 v111, v111
 v_mfma_f32_32x32x16_bf16 v[80:95], a[156:159], v[252:255], v[80:95]
 s_mul_i32 s70, s33, 18432
 s_mul_i32 s71, s28, 5120
 v_add_f32 v17, v17, v110
 v_fma_f32 v46, v190, s64, v23
 v_exp_f32 v112, v112
 v_fma_f32 v47, v191, s64, v23
 v_mfma_f32_32x32x16_bf16 a[0:15], a[160:163], v[128:131], a[0:15]
 ds_read_b128 a[184:187], v11 offset:14336
 s_cmp_eq_u32 s61, 3
 s_cselect_b32 s66, 1.0, 0
 v_add_f32 v17, v17, v111
 v_cvt_pk_bf16_f32 v151, v110, v111
 s_waitcnt lgkmcnt(2)
 v_mfma_f32_32x32x16_bf16 a[64:79], a[160:163], v[136:139], a[64:79]
 s_add_u32 s56, s56, 32768
 s_add_u32 s70, s70, s71
 s_add_u32 s70, s70, 65011712
 v_exp_f32 v113, v113
 v_add_f32 v18, v18, v112
 v_mfma_f32_32x32x16_bf16 a[16:31], a[164:167], v[128:131], a[16:31]
 ds_read_b128 a[188:191], v11 offset:15360
 s_cmp_lt_u32 s61, 3
 s_cselect_b32 s67, 0xf149f2ca, 0
 v_exp_f32 v114, v114
 v_add_f32 v18, v18, v113
 v_add_f32 v24, s67, v21
 v_mfma_f32_32x32x16_bf16 a[80:95], a[164:167], v[136:139], a[80:95]
 s_and_b32 s56, s56, 0x1ffff
 s_add_u32 s71, s70, 4096
 v_add_u32 v10, s56, v19
 v_cvt_pk_bf16_f32 v152, v112, v113
 v_exp_f32 v115, v115
 v_mfma_f32_32x32x16_bf16 a[32:47], a[168:171], v[128:131], a[32:47]
 s_waitcnt vmcnt(8)
 s_barrier
 ds_read_b128 a[128:131], v10
 v_fma_f32 v48, v176, s66, v24
 v_add_f32 v18, v18, v114
 v_fma_f32 v49, v177, s66, v24
 v_add_f32 v18, v18, v115
 v_mfma_f32_32x32x16_bf16 a[96:111], a[168:171], v[136:139], a[96:111]
 ds_read_b128 a[132:135], v10 offset:16384
 v_exp_f32 v116, v116
 v_fma_f32 v50, v178, s66, v24
 v_cvt_pk_bf16_f32 v153, v114, v115
 v_exp_f32 v117, v117
 v_mfma_f32_32x32x16_bf16 a[48:63], a[172:175], v[128:131], a[48:63]
 ds_read_b128 a[136:139], v10 offset:1024
 v_fma_f32 v51, v179, s66, v24
 v_add_f32 v18, v18, v116
 v_exp_f32 v118, v118
 v_fma_f32 v52, v180, s66, v24
 v_mfma_f32_32x32x16_bf16 a[112:127], a[172:175], v[136:139], a[112:127]
 ds_read_b128 a[140:143], v10 offset:17408
 v_add_f32 v18, v18, v117
 v_cvt_pk_bf16_f32 v154, v116, v117
 v_fma_f32 v53, v181, s66, v24
 v_exp_f32 v119, v119
 v_fma_f32 v54, v182, s66, v24
 v_mfma_f32_32x32x16_bf16 a[0:15], a[176:179], v[132:135], a[0:15]
 ds_read_b128 a[144:147], v10 offset:2048
 v_add_f32 v18, v18, v118
 v_exp_f32 v120, v120
 v_fma_f32 v55, v183, s66, v24
 s_waitcnt lgkmcnt(4)
 v_mfma_f32_32x32x16_bf16 a[64:79], a[176:179], v[140:143], a[64:79]
 ds_read_b128 a[148:151], v10 offset:18432
 v_add_f32 v18, v18, v119
 v_cvt_pk_bf16_f32 v155, v118, v119
 v_fma_f32 v56, v184, s66, v24
 v_exp_f32 v121, v121
 v_add_f32 v18, v18, v120
 v_mfma_f32_32x32x16_bf16 a[16:31], a[180:183], v[132:135], a[16:31]
 ds_read_b128 a[152:155], v10 offset:3072
 v_fma_f32 v57, v185, s66, v24
 v_exp_f32 v122, v122
 v_add_f32 v18, v18, v121
 v_fma_f32 v58, v186, s66, v24
 v_cvt_pk_bf16_f32 v156, v120, v121
 v_mfma_f32_32x32x16_bf16 a[80:95], a[180:183], v[140:143], a[80:95]
 ds_read_b128 a[156:159], v10 offset:19456
 s_mov_b64 exec, 1
 buffer_atomic_add v9, v8, s[72:75], 0 offen sc1
 s_mov_b64 exec, -1
 v_mfma_f32_32x32x16_bf16 a[32:47], a[184:187], v[132:135], a[32:47]
 ds_read_b128 a[160:163], v10 offset:4096
 v_fma_f32 v59, v187, s66, v24
 v_exp_f32 v123, v123
 v_add_f32 v18, v18, v122
 v_fma_f32 v60, v188, s66, v24
 v_add_f32 v18, v18, v123
 v_mfma_f32_32x32x16_bf16 a[96:111], a[184:187], v[140:143], a[96:111]
 ds_read_b128 a[164:167], v10 offset:20480
 v_exp_f32 v124, v124
 v_fma_f32 v61, v189, s66, v24
 v_cvt_pk_bf16_f32 v157, v122, v123
 v_exp_f32 v125, v125
 v_mfma_f32_32x32x16_bf16 a[48:63], a[188:191], v[132:135], a[48:63]
 ds_read_b128 a[168:171], v10 offset:5120
 v_fma_f32 v62, v190, s66, v24
 v_add_f32 v18, v18, v124
 v_fma_f32 v63, v191, s66, v24
 v_exp_f32 v126, v126
 v_mfma_f32_32x32x16_bf16 a[112:127], a[188:191], v[140:143], a[112:127]
 ds_read_b128 a[172:175], v10 offset:21504
 v_add_f32 v18, v18, v125
 v_cvt_pk_bf16_f32 v158, v124, v125
 v_exp_f32 v127, v127
 v_add_f32 v18, v18, v126
 v_add_f32 v18, v18, v127
 v_cvt_pk_bf16_f32 v159, v126, v127
 v_mfma_f32_32x32x16_bf16 v[96:111], a[128:131], v[224:227], v[32:47]
 ds_read_b128 a[176:179], v10 offset:6144
 s_add_u32 m0, s57, 32768
 v_exp_f32 v64, v64
 s_waitcnt lgkmcnt(4)
 v_mfma_f32_32x32x16_bf16 v[112:127], a[132:135], v[224:227], v[48:63]
 ds_read_b128 a[180:183], v10 offset:22528
 buffer_load_dwordx4 v15, s[36:39], s59 offen sc1 lds
 v_exp_f32 v65, v65
 v_mfma_f32_32x32x16_bf16 v[96:111], a[136:139], v[228:231], v[96:111]
 ds_read_b128 a[184:187], v10 offset:7168
 v_add_f32 v18, v18, v64
 v_exp_f32 v66, v66
 v_add_f32 v18, v18, v65
 v_cvt_pk_bf16_f32 v128, v64, v65
 v_mfma_f32_32x32x16_bf16 v[112:127], a[140:143], v[228:231], v[112:127]
 ds_read_b128 a[188:191], v10 offset:23552
 buffer_load_dwordx4 v15, s[36:39], s59 offen offset:1024 sc1 lds
 v_exp_f32 v67, v67
 v_mfma_f32_32x32x16_bf16 v[96:111], a[144:147], v[232:235], v[96:111]
 ds_read_b128 a[128:131], v11 offset:24576
 v_add_f32 v18, v18, v66
 v_exp_f32 v68, v68
 v_add_f32 v18, v18, v67
 v_cvt_pk_bf16_f32 v129, v66, v67
 v_mfma_f32_32x32x16_bf16 v[112:127], a[148:151], v[232:235], v[112:127]
 buffer_load_dwordx4 v15, s[36:39], s59 offen offset:2048 sc1 lds
 v_exp_f32 v69, v69
 v_add_f32 v18, v18, v68
 v_mfma_f32_32x32x16_bf16 v[96:111], a[152:155], v[236:239], v[96:111]
 ds_read_b128 a[132:135], v11 offset:25600
 v_exp_f32 v70, v70
 v_add_f32 v18, v18, v69
 v_cvt_pk_bf16_f32 v130, v68, v69
 v_add_f32 v18, v18, v70
 v_mfma_f32_32x32x16_bf16 v[112:127], a[156:159], v[236:239], v[112:127]
 buffer_load_dwordx4 v15, s[36:39], s59 offen offset:3072 sc1 lds
 v_exp_f32 v71, v71
 v_mfma_f32_32x32x16_bf16 v[96:111], a[160:163], v[240:243], v[96:111]
 ds_read_b128 a[136:139], v11 offset:26624
 s_add_u32 s58, s57, 32768
 s_waitcnt vmcnt(9)
 ds_read_b64_tr_b16 a[192:193], v26
 ds_read_b64_tr_b16 a[194:195], v26 offset:2560
 s_waitcnt lgkmcnt(2)
 v_mfma_f32_32x32x16_bf16 v[112:127], a[164:167], v[240:243], v[112:127]
 s_and_b32 s58, s58, 0x1ffff
 s_add_u32 s59, s59, 16384
 ds_read_b64_tr_b16 a[196:197], v26 offset:64
 ds_read_b64_tr_b16 a[198:199], v26 offset:2624
 v_exp_f32 v72, v72
 v_mfma_f32_32x32x16_bf16 v[96:111], a[168:171], v[244:247], v[96:111]
 ds_read_b128 a[140:143], v11 offset:27648
 ds_read_b64_tr_b16 a[200:201], v26 offset:128
 ds_read_b64_tr_b16 a[202:203], v26 offset:2688
 v_add_f32 v18, v18, v71
 v_cvt_pk_bf16_f32 v131, v70, v71
 v_add_f32 v18, v18, v72
 v_mfma_f32_32x32x16_bf16 v[112:127], a[172:175], v[244:247], v[112:127]
 ds_read_b64_tr_b16 a[204:205], v26 offset:192
 ds_read_b64_tr_b16 a[206:207], v26 offset:2752
 v_exp_f32 v73, v73
 v_exp_f32 v74, v74
 v_mfma_f32_32x32x16_bf16 v[96:111], a[176:179], v[248:251], v[96:111]
 ds_read_b128 a[144:147], v11 offset:28672
 ds_read_b64_tr_b16 a[208:209], v26 offset:256
 ds_read_b64_tr_b16 a[210:211], v26 offset:2816
 v_add_f32 v18, v18, v73
 v_cvt_pk_bf16_f32 v132, v72, v73
 v_add_f32 v18, v18, v74
 v_mfma_f32_32x32x16_bf16 v[112:127], a[180:183], v[248:251], v[112:127]
 v_exp_f32 v75, v75
 v_exp_f32 v76, v76
 v_add_f32 v18, v18, v75
 v_cvt_pk_bf16_f32 v133, v74, v75
 v_mfma_f32_32x32x16_bf16 v[96:111], a[184:187], v[252:255], v[96:111]
 ds_read_b128 a[148:151], v11 offset:29696
 v_exp_f32 v77, v77
 v_add_f32 v18, v18, v76
 v_exp_f32 v78, v78
 v_mfma_f32_32x32x16_bf16 v[112:127], a[188:191], v[252:255], v[112:127]
 v_add_f32 v18, v18, v77
 v_cvt_pk_bf16_f32 v134, v76, v77
 v_exp_f32 v79, v79
 v_add_f32 v18, v18, v78
 v_add_f32 v18, v18, v79
 v_mfma_f32_32x32x16_bf16 a[0:15], a[128:131], v[144:147], a[0:15]
 ds_read_b128 a[152:155], v11 offset:30720
 v_exp_f32 v80, v80
 v_cvt_pk_bf16_f32 v135, v78, v79
 v_add_f32 v18, v18, v80
 s_waitcnt lgkmcnt(2)
 v_mfma_f32_32x32x16_bf16 a[64:79], a[128:131], v[152:155], a[64:79]
 s_add_u32 s56, s56, 32768
 v_exp_f32 v81, v81
 v_exp_f32 v82, v82
 v_add_f32 v18, v18, v81
 v_mfma_f32_32x32x16_bf16 a[16:31], a[132:135], v[144:147], a[16:31]
 ds_read_b128 a[156:159], v11 offset:31744
 v_cvt_pk_bf16_f32 v136, v80, v81
 v_exp_f32 v83, v83
 v_add_f32 v18, v18, v82
 v_add_f32 v18, v18, v83
 v_mfma_f32_32x32x16_bf16 a[80:95], a[132:135], v[152:155], a[80:95]
 s_and_b32 s56, s56, 0x1ffff
 v_add_u32 v11, s56, v19
 v_exp_f32 v84, v84
 v_cvt_pk_bf16_f32 v137, v82, v83
 v_add_f32 v18, v18, v84
 v_mfma_f32_32x32x16_bf16 a[32:47], a[136:139], v[144:147], a[32:47]
 s_waitcnt vmcnt(4)
 s_barrier
 ds_read_b128 a[160:163], v11
 v_exp_f32 v85, v85
 v_mfma_f32_32x32x16_bf16 a[96:111], a[136:139], v[152:155], a[96:111]
 ds_read_b128 a[164:167], v11 offset:16384
 v_exp_f32 v86, v86
 v_add_f32 v18, v18, v85
 v_cvt_pk_bf16_f32 v138, v84, v85
 v_add_f32 v18, v18, v86
 v_mfma_f32_32x32x16_bf16 a[48:63], a[140:143], v[144:147], a[48:63]
 ds_read_b128 a[168:171], v11 offset:1024
 v_exp_f32 v87, v87
 v_exp_f32 v88, v88
 v_add_f32 v18, v18, v87
 v_mfma_f32_32x32x16_bf16 a[112:127], a[140:143], v[152:155], a[112:127]
 ds_read_b128 a[172:175], v11 offset:17408
 buffer_store_dwordx4 a[192:195], v14, s[36:39], s70 offen sc1
 v_cvt_pk_bf16_f32 v139, v86, v87
 v_add_f32 v18, v18, v88
 v_mfma_f32_32x32x16_bf16 a[0:15], a[144:147], v[148:151], a[0:15]
 ds_read_b128 a[176:179], v11 offset:2048
 v_exp_f32 v89, v89
 v_exp_f32 v90, v90
 s_waitcnt lgkmcnt(4)
 v_mfma_f32_32x32x16_bf16 a[64:79], a[144:147], v[156:159], a[64:79]
 ds_read_b128 a[180:183], v11 offset:18432
 buffer_store_dwordx4 a[196:199], v14, s[36:39], s70 offen offset:1024 sc1
 v_add_f32 v18, v18, v89
 v_cvt_pk_bf16_f32 v140, v88, v89
 v_mfma_f32_32x32x16_bf16 a[16:31], a[148:151], v[148:151], a[16:31]
 ds_read_b128 a[184:187], v11 offset:3072
 v_exp_f32 v91, v91
 v_add_f32 v18, v18, v90
 v_exp_f32 v92, v92
 v_mfma_f32_32x32x16_bf16 a[80:95], a[148:151], v[156:159], a[80:95]
 ds_read_b128 a[188:191], v11 offset:19456
 buffer_store_dwordx4 a[200:203], v14, s[36:39], s70 offen offset:2048 sc1
 v_add_f32 v18, v18, v91
 v_cvt_pk_bf16_f32 v141, v90, v91
 v_mfma_f32_32x32x16_bf16 a[32:47], a[152:155], v[148:151], a[32:47]
 ds_read_b128 a[128:131], v11 offset:4096
 v_exp_f32 v93, v93
 v_add_f32 v18, v18, v92
 v_exp_f32 v94, v94
 v_mfma_f32_32x32x16_bf16 a[96:111], a[152:155], v[156:159], a[96:111]
 ds_read_b128 a[132:135], v11 offset:20480
 buffer_store_dwordx4 a[204:207], v27, s[36:39], s70 offen offset:3072 sc1
 v_add_f32 v18, v18, v93
 v_cvt_pk_bf16_f32 v142, v92, v93
 v_mfma_f32_32x32x16_bf16 a[48:63], a[156:159], v[148:151], a[48:63]
 ds_read_b128 a[136:139], v11 offset:5120
 v_exp_f32 v95, v95
 v_add_f32 v18, v18, v94
 v_add_f32 v18, v18, v95
 v_cvt_pk_bf16_f32 v143, v94, v95
 v_mfma_f32_32x32x16_bf16 a[112:127], a[156:159], v[156:159], a[112:127]
 ds_read_b128 a[140:143], v11 offset:21504
 buffer_store_dwordx4 a[208:211], v27, s[36:39], s71 offen sc1
 v_mov_b32 v8, v17
 s_nop 1
 v_permlane32_swap_b32 v17, v8
 s_nop 1
 v_add_f32 v17, v17, v8
 s_mov_b32 s52, 0x4e800000
 v_cmp_nge_f32 s[70:71], s52, v17
 v_rcp_f32 v9, v17
 s_lshl_b32 s53, s31, 13
 s_add_u32 s53, s53, 34603008
 s_lshl_b32 s52, s32, 2
 s_add_u32 s52, s52, s28
 s_lshl_b32 s52, s52, 18
 s_add_u32 s52, s52, s53
 s_add_u32 s53, s52, 4096
 v_mov_b32 v8, v9
 v_accvgpr_read_b32 v160, a0
 v_accvgpr_read_b32 v161, a1
 v_accvgpr_read_b32 v162, a2
 v_accvgpr_read_b32 v163, a3
 v_accvgpr_read_b32 v164, a4
 v_accvgpr_read_b32 v165, a5
 v_accvgpr_read_b32 v166, a6
 v_accvgpr_read_b32 v167, a7
 v_pk_mul_f32 v[160:161], v[160:161], v[8:9]
 v_pk_mul_f32 v[162:163], v[162:163], v[8:9]
 v_pk_mul_f32 v[164:165], v[164:165], v[8:9]
 v_pk_mul_f32 v[166:167], v[166:167], v[8:9]
 v_cvt_pk_bf16_f32 v168, v160, v161
 v_cvt_pk_bf16_f32 v169, v162, v163
 v_cvt_pk_bf16_f32 v170, v164, v165
 v_cvt_pk_bf16_f32 v171, v166, v167
 buffer_store_dwordx4 v[168:171], v14, s[36:39], s52 offen sc1
 v_accvgpr_read_b32 v160, a8
 v_accvgpr_read_b32 v161, a9
 v_accvgpr_read_b32 v162, a10
 v_accvgpr_read_b32 v163, a11
 v_accvgpr_read_b32 v164, a12
 v_accvgpr_read_b32 v165, a13
 v_accvgpr_read_b32 v166, a14
 v_accvgpr_read_b32 v167, a15
 v_pk_mul_f32 v[160:161], v[160:161], v[8:9]
 v_pk_mul_f32 v[162:163], v[162:163], v[8:9]
 v_pk_mul_f32 v[164:165], v[164:165], v[8:9]
 v_pk_mul_f32 v[166:167], v[166:167], v[8:9]
 v_cvt_pk_bf16_f32 v172, v160, v161
 v_cvt_pk_bf16_f32 v173, v162, v163
 v_cvt_pk_bf16_f32 v174, v164, v165
 v_cvt_pk_bf16_f32 v175, v166, v167
 buffer_store_dwordx4 v[172:175], v14, s[36:39], s52 offen offset:1024 sc1
 v_accvgpr_read_b32 v160, a16
 v_accvgpr_read_b32 v161, a17
 v_accvgpr_read_b32 v162, a18
 v_accvgpr_read_b32 v163, a19
 v_accvgpr_read_b32 v164, a20
 v_accvgpr_read_b32 v165, a21
 v_accvgpr_read_b32 v166, a22
 v_accvgpr_read_b32 v167, a23
 v_pk_mul_f32 v[160:161], v[160:161], v[8:9]
 v_pk_mul_f32 v[162:163], v[162:163], v[8:9]
 v_pk_mul_f32 v[164:165], v[164:165], v[8:9]
 v_pk_mul_f32 v[166:167], v[166:167], v[8:9]
 v_cvt_pk_bf16_f32 v168, v160, v161
 v_cvt_pk_bf16_f32 v169, v162, v163
 v_cvt_pk_bf16_f32 v170, v164, v165
 v_cvt_pk_bf16_f32 v171, v166, v167
 buffer_store_dwordx4 v[168:171], v14, s[36:39], s52 offen offset:2048 sc1
 v_accvgpr_read_b32 v160, a24
 v_accvgpr_read_b32 v161, a25
 v_accvgpr_read_b32 v162, a26
 v_accvgpr_read_b32 v163, a27
 v_accvgpr_read_b32 v164, a28
 v_accvgpr_read_b32 v165, a29
 v_accvgpr_read_b32 v166, a30
 v_accvgpr_read_b32 v167, a31
 v_pk_mul_f32 v[160:161], v[160:161], v[8:9]
 v_pk_mul_f32 v[162:163], v[162:163], v[8:9]
 v_pk_mul_f32 v[164:165], v[164:165], v[8:9]
 v_pk_mul_f32 v[166:167], v[166:167], v[8:9]
 v_cvt_pk_bf16_f32 v172, v160, v161
 v_cvt_pk_bf16_f32 v173, v162, v163
 v_cvt_pk_bf16_f32 v174, v164, v165
 v_cvt_pk_bf16_f32 v175, v166, v167
 buffer_store_dwordx4 v[172:175], v14, s[36:39], s52 offen offset:3072 sc1
 v_accvgpr_read_b32 v160, a32
 v_accvgpr_read_b32 v161, a33
 v_accvgpr_read_b32 v162, a34
 v_accvgpr_read_b32 v163, a35
 v_accvgpr_read_b32 v164, a36
 v_accvgpr_read_b32 v165, a37
 v_accvgpr_read_b32 v166, a38
 v_accvgpr_read_b32 v167, a39
 v_pk_mul_f32 v[160:161], v[160:161], v[8:9]
 v_pk_mul_f32 v[162:163], v[162:163], v[8:9]
 v_pk_mul_f32 v[164:165], v[164:165], v[8:9]
 v_pk_mul_f32 v[166:167], v[166:167], v[8:9]
 v_cvt_pk_bf16_f32 v168, v160, v161
 v_cvt_pk_bf16_f32 v169, v162, v163
 v_cvt_pk_bf16_f32 v170, v164, v165
 v_cvt_pk_bf16_f32 v171, v166, v167
 buffer_store_dwordx4 v[168:171], v14, s[36:39], s53 offen sc1
 v_accvgpr_read_b32 v160, a40
 v_accvgpr_read_b32 v161, a41
 v_accvgpr_read_b32 v162, a42
 v_accvgpr_read_b32 v163, a43
 v_accvgpr_read_b32 v164, a44
 v_accvgpr_read_b32 v165, a45
 v_accvgpr_read_b32 v166, a46
 v_accvgpr_read_b32 v167, a47
 v_pk_mul_f32 v[160:161], v[160:161], v[8:9]
 v_pk_mul_f32 v[162:163], v[162:163], v[8:9]
 v_pk_mul_f32 v[164:165], v[164:165], v[8:9]
 v_pk_mul_f32 v[166:167], v[166:167], v[8:9]
 v_cvt_pk_bf16_f32 v172, v160, v161
 v_cvt_pk_bf16_f32 v173, v162, v163
 v_cvt_pk_bf16_f32 v174, v164, v165
 v_cvt_pk_bf16_f32 v175, v166, v167
 buffer_store_dwordx4 v[172:175], v14, s[36:39], s53 offen offset:1024 sc1
 v_accvgpr_read_b32 v160, a48
 v_accvgpr_read_b32 v161, a49
 v_accvgpr_read_b32 v162, a50
 v_accvgpr_read_b32 v163, a51
 v_accvgpr_read_b32 v164, a52
 v_accvgpr_read_b32 v165, a53
 v_accvgpr_read_b32 v166, a54
 v_accvgpr_read_b32 v167, a55
 v_pk_mul_f32 v[160:161], v[160:161], v[8:9]
 v_pk_mul_f32 v[162:163], v[162:163], v[8:9]
 v_pk_mul_f32 v[164:165], v[164:165], v[8:9]
 v_pk_mul_f32 v[166:167], v[166:167], v[8:9]
 v_cvt_pk_bf16_f32 v168, v160, v161
 v_cvt_pk_bf16_f32 v169, v162, v163
 v_cvt_pk_bf16_f32 v170, v164, v165
 v_cvt_pk_bf16_f32 v171, v166, v167
 buffer_store_dwordx4 v[168:171], v14, s[36:39], s53 offen offset:2048 sc1
 v_accvgpr_read_b32 v160, a56
 v_accvgpr_read_b32 v161, a57
 v_accvgpr_read_b32 v162, a58
 v_accvgpr_read_b32 v163, a59
 v_accvgpr_read_b32 v164, a60
 v_accvgpr_read_b32 v165, a61
 v_accvgpr_read_b32 v166, a62
 v_accvgpr_read_b32 v167, a63
 v_pk_mul_f32 v[160:161], v[160:161], v[8:9]
 v_pk_mul_f32 v[162:163], v[162:163], v[8:9]
 v_pk_mul_f32 v[164:165], v[164:165], v[8:9]
 v_pk_mul_f32 v[166:167], v[166:167], v[8:9]
 v_cvt_pk_bf16_f32 v172, v160, v161
 v_cvt_pk_bf16_f32 v173, v162, v163
 v_cvt_pk_bf16_f32 v174, v164, v165
 v_cvt_pk_bf16_f32 v175, v166, v167
 buffer_store_dwordx4 v[172:175], v14, s[36:39], s53 offen offset:3072 sc1
 s_cmp_eq_u32 s32, 7
 s_cbranch_scc1 L_b_S0e
 v_mfma_f32_32x32x16_bf16 v[64:79], a[160:163], v[224:227], v[32:47]
 ds_read_b128 a[144:147], v11 offset:6144
 s_add_u32 m0, s57, 40960
 v_exp_f32 v96, v96
 s_waitcnt lgkmcnt(4)
 v_mfma_f32_32x32x16_bf16 v[80:95], a[164:167], v[224:227], v[48:63]
 ds_read_b128 a[148:151], v11 offset:22528
 buffer_load_dwordx4 v16, s[36:39], s59 offen sc1 lds
 v_exp_f32 v97, v97
 v_mfma_f32_32x32x16_bf16 v[64:79], a[168:171], v[228:231], v[64:79]
 ds_read_b128 a[152:155], v11 offset:7168
 v_add_f32 v18, v18, v96
 v_exp_f32 v98, v98
 v_add_f32 v18, v18, v97
 v_cvt_pk_bf16_f32 v144, v96, v97
 v_mfma_f32_32x32x16_bf16 v[80:95], a[172:175], v[228:231], v[80:95]
 ds_read_b128 a[156:159], v11 offset:23552
 buffer_load_dwordx4 v16, s[36:39], s59 offen offset:1024 sc1 lds
 v_exp_f32 v99, v99
 v_mfma_f32_32x32x16_bf16 v[64:79], a[176:179], v[232:235], v[64:79]
 ds_read_b128 a[160:163], v10 offset:8192
 v_add_f32 v18, v18, v98
 v_exp_f32 v100, v100
 v_add_f32 v18, v18, v99
 v_cvt_pk_bf16_f32 v145, v98, v99
 v_mfma_f32_32x32x16_bf16 v[80:95], a[180:183], v[232:235], v[80:95]
 ds_read_b128 a[164:167], v10 offset:9216
 buffer_load_dwordx4 v16, s[36:39], s59 offen offset:2048 sc1 lds
 v_exp_f32 v101, v101
 v_mfma_f32_32x32x16_bf16 v[64:79], a[184:187], v[236:239], v[64:79]
 ds_read_b128 a[168:171], v10 offset:10240
 v_add_f32 v18, v18, v100
 v_exp_f32 v102, v102
 v_add_f32 v18, v18, v101
 v_cvt_pk_bf16_f32 v146, v100, v101
 v_mfma_f32_32x32x16_bf16 v[80:95], a[188:191], v[236:239], v[80:95]
 ds_read_b128 a[172:175], v10 offset:11264
 buffer_load_dwordx4 v16, s[36:39], s59 offen offset:3072 sc1 lds
 v_exp_f32 v103, v103
 v_mfma_f32_32x32x16_bf16 v[64:79], a[128:131], v[240:243], v[64:79]
 ds_read_b128 a[176:179], v10 offset:12288
 s_add_u32 m0, s58, 32768
 v_add_f32 v18, v18, v102
 v_exp_f32 v104, v104
 s_waitcnt lgkmcnt(4)
 v_mfma_f32_32x32x16_bf16 v[80:95], a[132:135], v[240:243], v[80:95]
 ds_read_b128 a[180:183], v10 offset:13312
 buffer_load_dwordx4 v15, s[36:39], s59 offen sc1 lds
 v_add_f32 v18, v18, v103
 v_cvt_pk_bf16_f32 v147, v102, v103
 v_mfma_f32_32x32x16_bf16 v[64:79], a[136:139], v[244:247], v[64:79]
 ds_read_b128 a[184:187], v10 offset:14336
 v_exp_f32 v105, v105
 v_add_f32 v18, v18, v104
 v_exp_f32 v106, v106
 v_mfma_f32_32x32x16_bf16 v[80:95], a[140:143], v[244:247], v[80:95]
 ds_read_b128 a[188:191], v10 offset:15360
 buffer_load_dwordx4 v15, s[36:39], s59 offen offset:1024 sc1 lds
 v_add_f32 v18, v18, v105
 v_cvt_pk_bf16_f32 v148, v104, v105
 v_mfma_f32_32x32x16_bf16 v[64:79], a[144:147], v[248:251], v[64:79]
 ds_read_b128 a[128:131], v10 offset:24576
 v_exp_f32 v107, v107
 v_add_f32 v18, v18, v106
 v_exp_f32 v108, v108
 v_mfma_f32_32x32x16_bf16 v[80:95], a[148:151], v[248:251], v[80:95]
 ds_read_b128 a[132:135], v10 offset:25600
 buffer_load_dwordx4 v15, s[36:39], s59 offen offset:2048 sc1 lds
 v_add_f32 v18, v18, v107
 v_cvt_pk_bf16_f32 v149, v106, v107
 v_mfma_f32_32x32x16_bf16 v[64:79], a[152:155], v[252:255], v[64:79]
 ds_read_b128 a[136:139], v10 offset:26624
 v_exp_f32 v109, v109
 v_add_f32 v18, v18, v108
 v_exp_f32 v110, v110
 v_mfma_f32_32x32x16_bf16 v[80:95], a[156:159], v[252:255], v[80:95]
 ds_read_b128 a[140:143], v10 offset:27648
 buffer_load_dwordx4 v15, s[36:39], s59 offen offset:3072 sc1 lds
 v_add_f32 v18, v18, v109
 v_cvt_pk_bf16_f32 v150, v108, v109
 v_mfma_f32_32x32x16_bf16 a[64:79], a[160:163], v[128:131], a[64:79]
 ds_read_b128 a[144:147], v10 offset:28672
 s_add_u32 s57, s58, 32768
 v_exp_f32 v111, v111
 v_add_f32 v18, v18, v110
 s_waitcnt lgkmcnt(4)
 v_mfma_f32_32x32x16_bf16 a[80:95], a[164:167], v[128:131], a[80:95]
 ds_read_b128 a[148:151], v10 offset:29696
 s_add_u32 s56, s56, 32768
 s_and_b32 s57, s57, 0x1ffff
 s_add_u32 s59, s59, 16384
 v_exp_f32 v112, v112
 v_mfma_f32_32x32x16_bf16 a[96:111], a[168:171], v[128:131], a[96:111]
 ds_read_b128 a[152:155], v10 offset:30720
 v_add_f32 v18, v18, v111
 v_cvt_pk_bf16_f32 v151, v110, v111
 v_exp_f32 v113, v113
 v_add_f32 v18, v18, v112
 v_mfma_f32_32x32x16_bf16 a[112:127], a[172:175], v[128:131], a[112:127]
 ds_read_b128 a[156:159], v10 offset:31744
 s_and_b32 s56, s56, 0x1ffff
 v_add_u32 v10, s56, v19
 v_exp_f32 v114, v114
 v_add_f32 v18, v18, v113
 v_mfma_f32_32x32x16_bf16 a[64:79], a[176:179], v[132:135], a[64:79]
 s_waitcnt vmcnt(21)
 s_barrier
 ds_read_b128 a[160:163], v10
 v_cvt_pk_bf16_f32 v152, v112, v113
 v_exp_f32 v115, v115
 v_mfma_f32_32x32x16_bf16 a[80:95], a[180:183], v[132:135], a[80:95]
 ds_read_b128 a[164:167], v10 offset:16384
 v_add_f32 v18, v18, v114
 v_exp_f32 v116, v116
 v_add_f32 v18, v18, v115
 v_cvt_pk_bf16_f32 v153, v114, v115
 v_mfma_f32_32x32x16_bf16 a[96:111], a[184:187], v[132:135], a[96:111]
 ds_read_b128 a[168:171], v10 offset:1024
 v_exp_f32 v117, v117
 v_add_f32 v18, v18, v116
 v_exp_f32 v118, v118
 v_mfma_f32_32x32x16_bf16 a[112:127], a[188:191], v[132:135], a[112:127]
 ds_read_b128 a[172:175], v10 offset:17408
 v_add_f32 v18, v18, v117
 v_cvt_pk_bf16_f32 v154, v116, v117
 v_exp_f32 v119, v119
 v_add_f32 v18, v18, v118
 v_mfma_f32_32x32x16_bf16 a[64:79], a[128:131], v[136:139], a[64:79]
 ds_read_b128 a[176:179], v10 offset:2048
 v_exp_f32 v120, v120
 v_add_f32 v18, v18, v119
 v_cvt_pk_bf16_f32 v155, v118, v119
 s_waitcnt lgkmcnt(4)
 v_mfma_f32_32x32x16_bf16 a[80:95], a[132:135], v[136:139], a[80:95]
 ds_read_b128 a[180:183], v10 offset:18432
 v_exp_f32 v121, v121
 v_add_f32 v18, v18, v120
 v_exp_f32 v122, v122
 v_mfma_f32_32x32x16_bf16 a[96:111], a[136:139], v[136:139], a[96:111]
 ds_read_b128 a[184:187], v10 offset:3072
 v_add_f32 v18, v18, v121
 v_cvt_pk_bf16_f32 v156, v120, v121
 v_exp_f32 v123, v123
 v_add_f32 v18, v18, v122
 v_mfma_f32_32x32x16_bf16 a[112:127], a[140:143], v[136:139], a[112:127]
 ds_read_b128 a[188:191], v10 offset:19456
 v_exp_f32 v124, v124
 v_add_f32 v18, v18, v123
 v_cvt_pk_bf16_f32 v157, v122, v123
 v_add_f32 v18, v18, v124
 v_mfma_f32_32x32x16_bf16 a[64:79], a[144:147], v[140:143], a[64:79]
 ds_read_b128 a[128:131], v10 offset:4096
 v_exp_f32 v125, v125
 v_exp_f32 v126, v126
 v_add_f32 v18, v18, v125
 v_mfma_f32_32x32x16_bf16 a[80:95], a[148:151], v[140:143], a[80:95]
 ds_read_b128 a[132:135], v10 offset:20480
 v_cvt_pk_bf16_f32 v158, v124, v125
 v_exp_f32 v127, v127
 v_add_f32 v18, v18, v126
 v_add_f32 v18, v18, v127
 v_mfma_f32_32x32x16_bf16 a[96:111], a[152:155], v[140:143], a[96:111]
 ds_read_b128 a[136:139], v10 offset:5120
 v_cvt_pk_bf16_f32 v159, v126, v127
 v_mfma_f32_32x32x16_bf16 a[112:127], a[156:159], v[140:143], a[112:127]
 ds_read_b128 a[140:143], v10 offset:21504
 s_sub_u32 s62, 6, s32
 s_lshl_b32 s62, s62, 1
 s_cbranch_scc0 L_b_S3
L_b_sloop:
 v_mfma_f32_32x32x16_bf16 v[96:111], a[160:163], v[224:227], v[32:47]
 ds_read_b128 a[144:147], v10 offset:6144
 s_add_u32 m0, s58, 40960
 v_exp_f32 v64, v64
 s_waitcnt lgkmcnt(4)
 v_mfma_f32_32x32x16_bf16 v[112:127], a[164:167], v[224:227], v[48:63]
 ds_read_b128 a[148:151], v10 offset:22528
 buffer_load_dwordx4 v16, s[36:39], s59 offen sc1 lds
 v_exp_f32 v65, v65
 v_mfma_f32_32x32x16_bf16 v[96:111], a[168:171], v[228:231], v[96:111]
 ds_read_b128 a[152:155], v10 offset:7168
 v_add_f32 v18, v18, v64
 v_exp_f32 v66, v66
 v_add_f32 v18, v18, v65
 v_cvt_pk_bf16_f32 v128, v64, v65
 v_mfma_f32_32x32x16_bf16 v[112:127], a[172:175], v[228:231], v[112:127]
 ds_read_b128 a[156:159], v10 offset:23552
 buffer_load_dwordx4 v16, s[36:39], s59 offen offset:1024 sc1 lds
 v_exp_f32 v67, v67
 v_mfma_f32_32x32x16_bf16 v[96:111], a[176:179], v[232:235], v[96:111]
 ds_read_b128 a[160:163], v11 offset:8192
 v_add_f32 v18, v18, v66
 v_exp_f32 v68, v68
 v_add_f32 v18, v18, v67
 v_cvt_pk_bf16_f32 v129, v66, v67
 v_mfma_f32_32x32x16_bf16 v[112:127], a[180:183], v[232:235], v[112:127]
 ds_read_b128 a[164:167], v11 offset:9216
 buffer_load_dwordx4 v16, s[36:39], s59 offen offset:2048 sc1 lds
 v_exp_f32 v69, v69
 v_mfma_f32_32x32x16_bf16 v[96:111], a[184:187], v[236:239], v[96:111]
 ds_read_b128 a[168:171], v11 offset:10240
 v_add_f32 v18, v18, v68
 v_exp_f32 v70, v70
 v_add_f32 v18, v18, v69
 v_cvt_pk_bf16_f32 v130, v68, v69
 v_mfma_f32_32x32x16_bf16 v[112:127], a[188:191], v[236:239], v[112:127]
 ds_read_b128 a[172:175], v11 offset:11264
 buffer_load_dwordx4 v16, s[36:39], s59 offen offset:3072 sc1 lds
 v_exp_f32 v71, v71
 v_mfma_f32_32x32x16_bf16 v[96:111], a[128:131], v[240:243], v[96:111]
 ds_read_b128 a[176:179], v11 offset:12288
 s_add_u32 m0, s57, 32768
 v_add_f32 v18, v18, v70
 v_exp_f32 v72, v72
 s_waitcnt lgkmcnt(4)
 v_mfma_f32_32x32x16_bf16 v[112:127], a[132:135], v[240:243], v[112:127]
 ds_read_b128 a[180:183], v11 offset:13312
 buffer_load_dwordx4 v15, s[36:39], s59 offen sc1 lds
 v_add_f32 v18, v18, v71
 v_cvt_pk_bf16_f32 v131, v70, v71
 v_mfma_f32_32x32x16_bf16 v[96:111], a[136:139], v[244:247], v[96:111]
 ds_read_b128 a[184:187], v11 offset:14336
 v_exp_f32 v73, v73
 v_add_f32 v18, v18, v72
 v_exp_f32 v74, v74
 v_mfma_f32_32x32x16_bf16 v[112:127], a[140:143], v[244:247], v[112:127]
 ds_read_b128 a[188:191], v11 offset:15360
 buffer_load_dwordx4 v15, s[36:39], s59 offen offset:1024 sc1 lds
 v_add_f32 v18, v18, v73
 v_cvt_pk_bf16_f32 v132, v72, v73
 v_mfma_f32_32x32x16_bf16 v[96:111], a[144:147], v[248:251], v[96:111]
 ds_read_b128 a[128:131], v11 offset:24576
 v_exp_f32 v75, v75
 v_add_f32 v18, v18, v74
 v_exp_f32 v76, v76
 v_mfma_f32_32x32x16_bf16 v[112:127], a[148:151], v[248:251], v[112:127]
 ds_read_b128 a[132:135], v11 offset:25600
 buffer_load_dwordx4 v15, s[36:39], s59 offen offset:2048 sc1 lds
 v_add_f32 v18, v18, v75
 v_cvt_pk_bf16_f32 v133, v74, v75
 v_mfma_f32_32x32x16_bf16 v[96:111], a[152:155], v[252:255], v[96:111]
 ds_read_b128 a[136:139], v11 offset:26624
 v_exp_f32 v77, v77
 v_add_f32 v18, v18, v76
 v_exp_f32 v78, v78
 v_mfma_f32_32x32x16_bf16 v[112:127], a[156:159], v[252:255], v[112:127]
 ds_read_b128 a[140:143], v11 offset:27648
 buffer_load_dwordx4 v15, s[36:39], s59 offen offset:3072 sc1 lds
 v_add_f32 v18, v18, v77
 v_cvt_pk_bf16_f32 v134, v76, v77
 v_mfma_f32_32x32x16_bf16 a[64:79], a[160:163], v[144:147], a[64:79]
 ds_read_b128 a[144:147], v11 offset:28672
 s_add_u32 s58, s57, 32768
 v_exp_f32 v79, v79
 v_add_f32 v18, v18, v78
 s_waitcnt lgkmcnt(4)
 v_mfma_f32_32x32x16_bf16 a[80:95], a[164:167], v[144:147], a[80:95]
 ds_read_b128 a[148:151], v11 offset:29696
 s_add_u32 s56, s56, 32768
 s_and_b32 s58, s58, 0x1ffff
 s_add_u32 s59, s59, 16384
 v_exp_f32 v80, v80
 v_mfma_f32_32x32x16_bf16 a[96:111], a[168:171], v[144:147], a[96:111]
 ds_read_b128 a[152:155], v11 offset:30720
 v_add_f32 v18, v18, v79
 v_cvt_pk_bf16_f32 v135, v78, v79
 v_exp_f32 v81, v81
 v_add_f32 v18, v18, v80
 v_mfma_f32_32x32x16_bf16 a[112:127], a[172:175], v[144:147], a[112:127]
 ds_read_b128 a[156:159], v11 offset:31744
 s_and_b32 s56, s56, 0x1ffff
 v_add_u32 v11, s56, v19
 v_exp_f32 v82, v82
 v_add_f32 v18, v18, v81
 v_mfma_f32_32x32x16_bf16 a[64:79], a[176:179], v[148:151], a[64:79]
 s_waitcnt vmcnt(8)
 s_barrier
 ds_read_b128 a[160:163], v11
 v_cvt_pk_bf16_f32 v136, v80, v81
 v_exp_f32 v83, v83
 v_mfma_f32_32x32x16_bf16 a[80:95], a[180:183], v[148:151], a[80:95]
 ds_read_b128 a[164:167], v11 offset:16384
 v_add_f32 v18, v18, v82
 v_exp_f32 v84, v84
 v_add_f32 v18, v18, v83
 v_cvt_pk_bf16_f32 v137, v82, v83
 v_mfma_f32_32x32x16_bf16 a[96:111], a[184:187], v[148:151], a[96:111]
 ds_read_b128 a[168:171], v11 offset:1024
 v_exp_f32 v85, v85
 v_add_f32 v18, v18, v84
 v_exp_f32 v86, v86
 v_mfma_f32_32x32x16_bf16 a[112:127], a[188:191], v[148:151], a[112:127]
 ds_read_b128 a[172:175], v11 offset:17408
 v_add_f32 v18, v18, v85
 v_cvt_pk_bf16_f32 v138, v84, v85
 v_exp_f32 v87, v87
 v_add_f32 v18, v18, v86
 v_mfma_f32_32x32x16_bf16 a[64:79], a[128:131], v[152:155], a[64:79]
 ds_read_b128 a[176:179], v11 offset:2048
 v_exp_f32 v88, v88
 v_add_f32 v18, v18, v87
 v_cvt_pk_bf16_f32 v139, v86, v87
 s_waitcnt lgkmcnt(4)
 v_mfma_f32_32x32x16_bf16 a[80:95], a[132:135], v[152:155], a[80:95]
 ds_read_b128 a[180:183], v11 offset:18432
 v_exp_f32 v89, v89
 v_add_f32 v18, v18, v88
 v_exp_f32 v90, v90
 v_mfma_f32_32x32x16_bf16 a[96:111], a[136:139], v[152:155], a[96:111]
 ds_read_b128 a[184:187], v11 offset:3072
 v_add_f32 v18, v18, v89
 v_cvt_pk_bf16_f32 v140, v88, v89
 v_exp_f32 v91, v91
 v_add_f32 v18, v18, v90
 v_mfma_f32_32x32x16_bf16 a[112:127], a[140:143], v[152:155], a[112:127]
 ds_read_b128 a[188:191], v11 offset:19456
 v_exp_f32 v92, v92
 v_add_f32 v18, v18, v91
 v_cvt_pk_bf16_f32 v141, v90, v91
 v_add_f32 v18, v18, v92
 v_mfma_f32_32x32x16_bf16 a[64:79], a[144:147], v[156:159], a[64:79]
 ds_read_b128 a[128:131], v11 offset:4096
 v_exp_f32 v93, v93
 v_exp_f32 v94, v94
 v_add_f32 v18, v18, v93
 v_mfma_f32_32x32x16_bf16 a[80:95], a[148:151], v[156:159], a[80:95]
 ds_read_b128 a[132:135], v11 offset:20480
 v_cvt_pk_bf16_f32 v142, v92, v93
 v_exp_f32 v95, v95
 v_add_f32 v18, v18, v94
 v_add_f32 v18, v18, v95
 v_mfma_f32_32x32x16_bf16 a[96:111], a[152:155], v[156:159], a[96:111]
 ds_read_b128 a[136:139], v11 offset:5120
 v_cvt_pk_bf16_f32 v143, v94, v95
 v_mfma_f32_32x32x16_bf16 a[112:127], a[156:159], v[156:159], a[112:127]
 ds_read_b128 a[140:143], v11 offset:21504
 v_mfma_f32_32x32x16_bf16 v[64:79], a[160:163], v[224:227], v[32:47]
 ds_read_b128 a[144:147], v11 offset:6144
 s_add_u32 m0, s57, 40960
 v_exp_f32 v96, v96
 s_waitcnt lgkmcnt(4)
 v_mfma_f32_32x32x16_bf16 v[80:95], a[164:167], v[224:227], v[48:63]
 ds_read_b128 a[148:151], v11 offset:22528
 buffer_load_dwordx4 v16, s[36:39], s59 offen sc1 lds
 v_exp_f32 v97, v97
 v_mfma_f32_32x32x16_bf16 v[64:79], a[168:171], v[228:231], v[64:79]
 ds_read_b128 a[152:155], v11 offset:7168
 v_add_f32 v18, v18, v96
 v_exp_f32 v98, v98
 v_add_f32 v18, v18, v97
 v_cvt_pk_bf16_f32 v144, v96, v97
 v_mfma_f32_32x32x16_bf16 v[80:95], a[172:175], v[228:231], v[80:95]
 ds_read_b128 a[156:159], v11 offset:23552
 buffer_load_dwordx4 v16, s[36:39], s59 offen offset:1024 sc1 lds
 v_exp_f32 v99, v99
 v_mfma_f32_32x32x16_bf16 v[64:79], a[176:179], v[232:235], v[64:79]
 ds_read_b128 a[160:163], v10 offset:8192
 v_add_f32 v18, v18, v98
 v_exp_f32 v100, v100
 v_add_f32 v18, v18, v99
 v_cvt_pk_bf16_f32 v145, v98, v99
 v_mfma_f32_32x32x16_bf16 v[80:95], a[180:183], v[232:235], v[80:95]
 ds_read_b128 a[164:167], v10 offset:9216
 buffer_load_dwordx4 v16, s[36:39], s59 offen offset:2048 sc1 lds
 v_exp_f32 v101, v101
 v_mfma_f32_32x32x16_bf16 v[64:79], a[184:187], v[236:239], v[64:79]
 ds_read_b128 a[168:171], v10 offset:10240
 v_add_f32 v18, v18, v100
 v_exp_f32 v102, v102
 v_add_f32 v18, v18, v101
 v_cvt_pk_bf16_f32 v146, v100, v101
 v_mfma_f32_32x32x16_bf16 v[80:95], a[188:191], v[236:239], v[80:95]
 ds_read_b128 a[172:175], v10 offset:11264
 buffer_load_dwordx4 v16, s[36:39], s59 offen offset:3072 sc1 lds
 v_exp_f32 v103, v103
 v_mfma_f32_32x32x16_bf16 v[64:79], a[128:131], v[240:243], v[64:79]
 ds_read_b128 a[176:179], v10 offset:12288
 s_add_u32 m0, s58, 32768
 v_add_f32 v18, v18, v102
 v_exp_f32 v104, v104
 s_waitcnt lgkmcnt(4)
 v_mfma_f32_32x32x16_bf16 v[80:95], a[132:135], v[240:243], v[80:95]
 ds_read_b128 a[180:183], v10 offset:13312
 buffer_load_dwordx4 v15, s[36:39], s59 offen sc1 lds
 v_add_f32 v18, v18, v103
 v_cvt_pk_bf16_f32 v147, v102, v103
 v_mfma_f32_32x32x16_bf16 v[64:79], a[136:139], v[244:247], v[64:79]
 ds_read_b128 a[184:187], v10 offset:14336
 v_exp_f32 v105, v105
 v_add_f32 v18, v18, v104
 v_exp_f32 v106, v106
 v_mfma_f32_32x32x16_bf16 v[80:95], a[140:143], v[244:247], v[80:95]
 ds_read_b128 a[188:191], v10 offset:15360
 buffer_load_dwordx4 v15, s[36:39], s59 offen offset:1024 sc1 lds
 v_add_f32 v18, v18, v105
 v_cvt_pk_bf16_f32 v148, v104, v105
 v_mfma_f32_32x32x16_bf16 v[64:79], a[144:147], v[248:251], v[64:79]
 ds_read_b128 a[128:131], v10 offset:24576
 v_exp_f32 v107, v107
 v_add_f32 v18, v18, v106
 v_exp_f32 v108, v108
 v_mfma_f32_32x32x16_bf16 v[80:95], a[148:151], v[248:251], v[80:95]
 ds_read_b128 a[132:135], v10 offset:25600
 buffer_load_dwordx4 v15, s[36:39], s59 offen offset:2048 sc1 lds
 v_add_f32 v18, v18, v107
 v_cvt_pk_bf16_f32 v149, v106, v107
 v_mfma_f32_32x32x16_bf16 v[64:79], a[152:155], v[252:255], v[64:79]
 ds_read_b128 a[136:139], v10 offset:26624
 v_exp_f32 v109, v109
 v_add_f32 v18, v18, v108
 v_exp_f32 v110, v110
 v_mfma_f32_32x32x16_bf16 v[80:95], a[156:159], v[252:255], v[80:95]
 ds_read_b128 a[140:143], v10 offset:27648
 buffer_load_dwordx4 v15, s[36:39], s59 offen offset:3072 sc1 lds
 v_add_f32 v18, v18, v109
 v_cvt_pk_bf16_f32 v150, v108, v109
 v_mfma_f32_32x32x16_bf16 a[64:79], a[160:163], v[128:131], a[64:79]
 ds_read_b128 a[144:147], v10 offset:28672
 s_add_u32 s57, s58, 32768
 v_exp_f32 v111, v111
 v_add_f32 v18, v18, v110
 s_waitcnt lgkmcnt(4)
 v_mfma_f32_32x32x16_bf16 a[80:95], a[164:167], v[128:131], a[80:95]
 ds_read_b128 a[148:151], v10 offset:29696
 s_add_u32 s56, s56, 32768
 s_and_b32 s57, s57, 0x1ffff
 s_add_u32 s59, s59, 16384
 v_exp_f32 v112, v112
 v_mfma_f32_32x32x16_bf16 a[96:111], a[168:171], v[128:131], a[96:111]
 ds_read_b128 a[152:155], v10 offset:30720
 v_add_f32 v18, v18, v111
 v_cvt_pk_bf16_f32 v151, v110, v111
 v_exp_f32 v113, v113
 v_add_f32 v18, v18, v112
 v_mfma_f32_32x32x16_bf16 a[112:127], a[172:175], v[128:131], a[112:127]
 ds_read_b128 a[156:159], v10 offset:31744
 s_and_b32 s56, s56, 0x1ffff
 v_add_u32 v10, s56, v19
 v_exp_f32 v114, v114
 v_add_f32 v18, v18, v113
 v_mfma_f32_32x32x16_bf16 a[64:79], a[176:179], v[132:135], a[64:79]
 s_waitcnt vmcnt(8)
 s_barrier
 ds_read_b128 a[160:163], v10
 v_cvt_pk_bf16_f32 v152, v112, v113
 v_exp_f32 v115, v115
 v_mfma_f32_32x32x16_bf16 a[80:95], a[180:183], v[132:135], a[80:95]
 ds_read_b128 a[164:167], v10 offset:16384
 v_add_f32 v18, v18, v114
 v_exp_f32 v116, v116
 v_add_f32 v18, v18, v115
 v_cvt_pk_bf16_f32 v153, v114, v115
 v_mfma_f32_32x32x16_bf16 a[96:111], a[184:187], v[132:135], a[96:111]
 ds_read_b128 a[168:171], v10 offset:1024
 v_exp_f32 v117, v117
 v_add_f32 v18, v18, v116
 v_exp_f32 v118, v118
 v_mfma_f32_32x32x16_bf16 a[112:127], a[188:191], v[132:135], a[112:127]
 ds_read_b128 a[172:175], v10 offset:17408
 v_add_f32 v18, v18, v117
 v_cvt_pk_bf16_f32 v154, v116, v117
 v_exp_f32 v119, v119
 v_add_f32 v18, v18, v118
 v_mfma_f32_32x32x16_bf16 a[64:79], a[128:131], v[136:139], a[64:79]
 ds_read_b128 a[176:179], v10 offset:2048
 v_exp_f32 v120, v120
 v_add_f32 v18, v18, v119
 v_cvt_pk_bf16_f32 v155, v118, v119
 s_waitcnt lgkmcnt(4)
 v_mfma_f32_32x32x16_bf16 a[80:95], a[132:135], v[136:139], a[80:95]
 ds_read_b128 a[180:183], v10 offset:18432
 v_exp_f32 v121, v121
 v_add_f32 v18, v18, v120
 v_exp_f32 v122, v122
 v_mfma_f32_32x32x16_bf16 a[96:111], a[136:139], v[136:139], a[96:111]
 ds_read_b128 a[184:187], v10 offset:3072
 v_add_f32 v18, v18, v121
 v_cvt_pk_bf16_f32 v156, v120, v121
 v_exp_f32 v123, v123
 v_add_f32 v18, v18, v122
 v_mfma_f32_32x32x16_bf16 a[112:127], a[140:143], v[136:139], a[112:127]
 ds_read_b128 a[188:191], v10 offset:19456
 v_exp_f32 v124, v124
 v_add_f32 v18, v18, v123
 v_cvt_pk_bf16_f32 v157, v122, v123
 v_add_f32 v18, v18, v124
 v_mfma_f32_32x32x16_bf16 a[64:79], a[144:147], v[140:143], a[64:79]
 ds_read_b128 a[128:131], v10 offset:4096
 v_exp_f32 v125, v125
 v_exp_f32 v126, v126
 v_add_f32 v18, v18, v125
 v_mfma_f32_32x32x16_bf16 a[80:95], a[148:151], v[140:143], a[80:95]
 ds_read_b128 a[132:135], v10 offset:20480
 v_cvt_pk_bf16_f32 v158, v124, v125
 v_exp_f32 v127, v127
 v_add_f32 v18, v18, v126
 v_add_f32 v18, v18, v127
 v_mfma_f32_32x32x16_bf16 a[96:111], a[152:155], v[140:143], a[96:111]
 ds_read_b128 a[136:139], v10 offset:5120
 v_cvt_pk_bf16_f32 v159, v126, v127
 v_mfma_f32_32x32x16_bf16 a[112:127], a[156:159], v[140:143], a[112:127]
 ds_read_b128 a[140:143], v10 offset:21504
 s_sub_u32 s62, s62, 1
 s_cmp_lg_u32 s62, 0
 s_cbranch_scc1 L_b_sloop
L_b_S3:
 v_mfma_f32_32x32x16_bf16 v[96:111], a[160:163], v[224:227], v[32:47]
 ds_read_b128 a[144:147], v10 offset:6144
 s_add_u32 m0, s58, 40960
 v_exp_f32 v64, v64
 v_exp_f32 v65, v65
 v_add_f32 v18, v18, v64
 s_waitcnt lgkmcnt(4)
 v_mfma_f32_32x32x16_bf16 v[112:127], a[164:167], v[224:227], v[48:63]
 ds_read_b128 a[148:151], v10 offset:22528
 buffer_load_dwordx4 v16, s[36:39], s59 offen sc1 lds
 v_exp_f32 v66, v66
 v_add_f32 v18, v18, v65
 v_cvt_pk_bf16_f32 v128, v64, v65
 v_mfma_f32_32x32x16_bf16 v[96:111], a[168:171], v[228:231], v[96:111]
 ds_read_b128 a[152:155], v10 offset:7168
 s_cmp_eq_u32 s28, 0
 s_cselect_b32 s64, 1.0, 0
 v_exp_f32 v67, v67
 v_add_f32 v18, v18, v66
 v_mfma_f32_32x32x16_bf16 v[112:127], a[172:175], v[228:231], v[112:127]
 ds_read_b128 a[156:159], v10 offset:23552
 buffer_load_dwordx4 v16, s[36:39], s59 offen offset:1024 sc1 lds
 v_exp_f32 v68, v68
 v_mfma_f32_32x32x16_bf16 v[96:111], a[176:179], v[232:235], v[96:111]
 ds_read_b128 a[160:163], v11 offset:8192
 s_cmp_lt_u32 s28, 0
 s_cselect_b32 s65, 0xf149f2ca, 0
 v_add_f32 v18, v18, v67
 v_cvt_pk_bf16_f32 v129, v66, v67
 v_add_f32 v23, s65, v21
 v_add_f32 v18, v18, v68
 v_mfma_f32_32x32x16_bf16 v[112:127], a[180:183], v[232:235], v[112:127]
 ds_read_b128 a[164:167], v11 offset:9216
 buffer_load_dwordx4 v16, s[36:39], s59 offen offset:2048 sc1 lds
 v_exp_f32 v69, v69
 v_fma_f32 v32, v176, s64, v23
 v_mfma_f32_32x32x16_bf16 v[96:111], a[184:187], v[236:239], v[96:111]
 ds_read_b128 a[168:171], v11 offset:10240
 v_exp_f32 v70, v70
 v_fma_f32 v33, v177, s64, v23
 v_add_f32 v18, v18, v69
 v_cvt_pk_bf16_f32 v130, v68, v69
 v_fma_f32 v34, v178, s64, v23
 v_mfma_f32_32x32x16_bf16 v[112:127], a[188:191], v[236:239], v[112:127]
 ds_read_b128 a[172:175], v11 offset:11264
 buffer_load_dwordx4 v16, s[36:39], s59 offen offset:3072 sc1 lds
 v_exp_f32 v71, v71
 v_add_f32 v18, v18, v70
 v_mfma_f32_32x32x16_bf16 v[96:111], a[128:131], v[240:243], v[96:111]
 ds_read_b128 a[176:179], v11 offset:12288
 s_add_u32 m0, s57, 32768
 v_fma_f32 v35, v179, s64, v23
 v_exp_f32 v72, v72
 v_add_f32 v18, v18, v71
 s_waitcnt lgkmcnt(4)
 v_mfma_f32_32x32x16_bf16 v[112:127], a[132:135], v[240:243], v[112:127]
 ds_read_b128 a[180:183], v11 offset:13312
 buffer_load_dwordx4 v15, s[36:39], s59 offen sc1 lds
 v_fma_f32 v36, v180, s64, v23
 v_cvt_pk_bf16_f32 v131, v70, v71
 v_fma_f32 v37, v181, s64, v23
 v_mfma_f32_32x32x16_bf16 v[96:111], a[136:139], v[244:247], v[96:111]
 ds_read_b128 a[184:187], v11 offset:14336
 v_exp_f32 v73, v73
 v_add_f32 v18, v18, v72
 v_fma_f32 v38, v182, s64, v23
 v_exp_f32 v74, v74
 v_mfma_f32_32x32x16_bf16 v[112:127], a[140:143], v[244:247], v[112:127]
 ds_read_b128 a[188:191], v11 offset:15360
 buffer_load_dwordx4 v15, s[36:39], s59 offen offset:1024 sc1 lds
 v_add_f32 v18, v18, v73
 v_fma_f32 v39, v183, s64, v23
 v_cvt_pk_bf16_f32 v132, v72, v73
 v_mfma_f32_32x32x16_bf16 v[96:111], a[144:147], v[248:251], v[96:111]
 ds_read_b128 a[128:131], v11 offset:24576
 v_exp_f32 v75, v75
 v_fma_f32 v40, v184, s64, v23
 v_add_f32 v18, v18, v74
 v_exp_f32 v76, v76
 v_mfma_f32_32x32x16_bf16 v[112:127], a[148:151], v[248:251], v[112:127]
 ds_read_b128 a[132:135], v11 offset:25600
 buffer_load_dwordx4 v15, s[36:39], s59 offen offset:2048 sc1 lds
 v_fma_f32 v41, v185, s64, v23
 v_add_f32 v18, v18, v75
 v_cvt_pk_bf16_f32 v133, v74, v75
 v_mfma_f32_32x32x16_bf16 v[96:111], a[152:155], v[252:255], v[96:111]
 ds_read_b128 a[136:139], v11 offset:26624
 v_fma_f32 v42, v186, s64, v23
 v_exp_f32 v77, v77
 v_fma_f32 v43, v187, s64, v23
 v_add_f32 v18, v18, v76
 v_fma_f32 v44, v188, s64, v23
 v_mfma_f32_32x32x16_bf16 v[112:127], a[156:159], v[252:255], v[112:127]
 ds_read_b128 a[140:143], v11 offset:27648
 buffer_load_dwordx4 v15, s[36:39], s59 offen offset:3072 sc1 lds
 v_exp_f32 v78, v78
 v_add_f32 v18, v18, v77
 v_mfma_f32_32x32x16_bf16 a[64:79], a[160:163], v[144:147], a[64:79]
 ds_read_b128 a[144:147], v11 offset:28672
 s_add_u32 s58, s57, 32768
 v_cvt_pk_bf16_f32 v134, v76, v77
 v_fma_f32 v45, v189, s64, v23
 v_exp_f32 v79, v79
 s_waitcnt lgkmcnt(4)
 v_mfma_f32_32x32x16_bf16 a[80:95], a[164:167], v[144:147], a[80:95]
 ds_read_b128 a[148:151], v11 offset:29696
 s_add_u32 s56, s56, 32768
 s_and_b32 s58, s58, 0x1ffff
 s_add_u32 s59, s59, 16384
 v_add_f32 v18, v18, v78
 v_fma_f32 v46, v190, s64, v23
 v_fma_f32 v47, v191, s64, v23
 v_mfma_f32_32x32x16_bf16 a[96:111], a[168:171], v[144:147], a[96:111]
 ds_read_b128 a[152:155], v11 offset:30720
 s_cmp_eq_u32 s28, 1
 s_cselect_b32 s66, 1.0, 0
 v_exp_f32 v80, v80
 v_add_f32 v18, v18, v79
 v_cvt_pk_bf16_f32 v135, v78, v79
 v_mfma_f32_32x32x16_bf16 a[112:127], a[172:175], v[144:147], a[112:127]
 ds_read_b128 a[156:159], v11 offset:31744
 s_and_b32 s56, s56, 0x1ffff
 v_add_u32 v11, s56, v19
 v_exp_f32 v81, v81
 v_add_f32 v18, v18, v80
 v_mfma_f32_32x32x16_bf16 a[64:79], a[176:179], v[148:151], a[64:79]
 s_waitcnt vmcnt(8)
 s_barrier
 ds_read_b128 a[160:163], v11
 s_cmp_lt_u32 s28, 1
 s_cselect_b32 s67, 0xf149f2ca, 0
 v_exp_f32 v82, v82
 v_mfma_f32_32x32x16_bf16 a[80:95], a[180:183], v[148:151], a[80:95]
 ds_read_b128 a[164:167], v11 offset:16384
 v_add_f32 v18, v18, v81
 v_add_f32 v24, s67, v21
 v_cvt_pk_bf16_f32 v136, v80, v81
 v_exp_f32 v83, v83
 v_fma_f32 v48, v176, s66, v24
 v_mfma_f32_32x32x16_bf16 a[96:111], a[184:187], v[148:151], a[96:111]
 ds_read_b128 a[168:171], v11 offset:1024
 v_add_f32 v18, v18, v82
 v_fma_f32 v49, v177, s66, v24
 v_exp_f32 v84, v84
 v_add_f32 v18, v18, v83
 v_fma_f32 v50, v178, s66, v24
 v_mfma_f32_32x32x16_bf16 a[112:127], a[188:191], v[148:151], a[112:127]
 ds_read_b128 a[172:175], v11 offset:17408
 v_cvt_pk_bf16_f32 v137, v82, v83
 v_exp_f32 v85, v85
 v_fma_f32 v51, v179, s66, v24
 v_add_f32 v18, v18, v84
 v_fma_f32 v52, v180, s66, v24
 v_mfma_f32_32x32x16_bf16 a[64:79], a[128:131], v[152:155], a[64:79]
 ds_read_b128 a[176:179], v11 offset:2048
 v_exp_f32 v86, v86
 v_add_f32 v18, v18, v85
 v_cvt_pk_bf16_f32 v138, v84, v85
 v_fma_f32 v53, v181, s66, v24
 s_waitcnt lgkmcnt(4)
 v_mfma_f32_32x32x16_bf16 a[80:95], a[132:135], v[152:155], a[80:95]
 ds_read_b128 a[180:183], v11 offset:18432
 v_exp_f32 v87, v87
 v_fma_f32 v54, v182, s66, v24
 v_add_f32 v18, v18, v86
 v_exp_f32 v88, v88
 v_mfma_f32_32x32x16_bf16 a[96:111], a[136:139], v[152:155], a[96:111]
 ds_read_b128 a[184:187], v11 offset:3072
 v_fma_f32 v55, v183, s66, v24
 v_add_f32 v18, v18, v87
 v_cvt_pk_bf16_f32 v139, v86, v87
 v_fma_f32 v56, v184, s66, v24
 v_exp_f32 v89, v89
 v_mfma_f32_32x32x16_bf16 a[112:127], a[140:143], v[152:155], a[112:127]
 ds_read_b128 a[188:191], v11 offset:19456
 v_add_f32 v18, v18, v88
 v_fma_f32 v57, v185, s66, v24
 v_exp_f32 v90, v90
 v_add_f32 v18, v18, v89
 v_fma_f32 v58, v186, s66, v24
 v_mfma_f32_32x32x16_bf16 a[64:79], a[144:147], v[156:159], a[64:79]
 ds_read_b128 a[128:131], v11 offset:4096
 v_cvt_pk_bf16_f32 v140, v88, v89
 v_fma_f32 v59, v187, s66, v24
 v_exp_f32 v91, v91
 v_add_f32 v18, v18, v90
 v_fma_f32 v60, v188, s66, v24
 v_mfma_f32_32x32x16_bf16 a[80:95], a[148:151], v[156:159], a[80:95]
 ds_read_b128 a[132:135], v11 offset:20480
 v_exp_f32 v92, v92
 v_add_f32 v18, v18, v91
 v_fma_f32 v61, v189, s66, v24
 v_cvt_pk_bf16_f32 v141, v90, v91
 v_fma_f32 v62, v190, s66, v24
 v_mfma_f32_32x32x16_bf16 a[96:111], a[152:155], v[156:159], a[96:111]
 ds_read_b128 a[136:139], v11 offset:5120
 v_exp_f32 v93, v93
 v_add_f32 v18, v18, v92
 v_fma_f32 v63, v191, s66, v24
 v_exp_f32 v94, v94
 v_mfma_f32_32x32x16_bf16 a[112:127], a[156:159], v[156:159], a[112:127]
 ds_read_b128 a[140:143], v11 offset:21504
 v_add_f32 v18, v18, v93
 v_cvt_pk_bf16_f32 v142, v92, v93
 v_exp_f32 v95, v95
 v_add_f32 v18, v18, v94
 v_add_f32 v18, v18, v95
 v_cvt_pk_bf16_f32 v143, v94, v95
 v_mfma_f32_32x32x16_bf16 v[64:79], a[160:163], v[224:227], v[32:47]
 ds_read_b128 a[144:147], v11 offset:6144
 s_add_u32 m0, s57, 40960
 v_exp_f32 v96, v96
 s_waitcnt lgkmcnt(4)
 v_mfma_f32_32x32x16_bf16 v[80:95], a[164:167], v[224:227], v[48:63]
 ds_read_b128 a[148:151], v11 offset:22528
 buffer_load_dwordx4 v16, s[36:39], s59 offen sc1 lds
 v_exp_f32 v97, v97
 v_add_f32 v18, v18, v96
 v_mfma_f32_32x32x16_bf16 v[64:79], a[168:171], v[228:231], v[64:79]
 ds_read_b128 a[152:155], v11 offset:7168
 v_exp_f32 v98, v98
 v_add_f32 v18, v18, v97
 v_cvt_pk_bf16_f32 v144, v96, v97
 v_exp_f32 v99, v99
 v_mfma_f32_32x32x16_bf16 v[80:95], a[172:175], v[228:231], v[80:95]
 ds_read_b128 a[156:159], v11 offset:23552
 buffer_load_dwordx4 v16, s[36:39], s59 offen offset:1024 sc1 lds
 s_cmp_eq_u32 s28, 2
 s_cselect_b32 s64, 1.0, 0
 v_mfma_f32_32x32x16_bf16 v[64:79], a[176:179], v[232:235], v[64:79]
 ds_read_b128 a[160:163], v10 offset:8192
 s_cmp_lt_u32 s28, 2
 s_cselect_b32 s65, 0xf149f2ca, 0
 v_add_f32 v18, v18, v98
 v_exp_f32 v100, v100
 v_add_f32 v18, v18, v99
 v_mfma_f32_32x32x16_bf16 v[80:95], a[180:183], v[232:235], v[80:95]
 ds_read_b128 a[164:167], v10 offset:9216
 buffer_load_dwordx4 v16, s[36:39], s59 offen offset:2048 sc1 lds
 v_cvt_pk_bf16_f32 v145, v98, v99
 v_add_f32 v23, s65, v21
 v_add_f32 v18, v18, v100
 v_mfma_f32_32x32x16_bf16 v[64:79], a[184:187], v[236:239], v[64:79]
 ds_read_b128 a[168:171], v10 offset:10240
 v_exp_f32 v101, v101
 v_fma_f32 v32, v176, s64, v23
 v_exp_f32 v102, v102
 v_mfma_f32_32x32x16_bf16 v[80:95], a[188:191], v[236:239], v[80:95]
 ds_read_b128 a[172:175], v10 offset:11264
 buffer_load_dwordx4 v16, s[36:39], s59 offen offset:3072 sc1 lds
 v_fma_f32 v33, v177, s64, v23
 v_add_f32 v18, v18, v101
 v_cvt_pk_bf16_f32 v146, v100, v101
 v_mfma_f32_32x32x16_bf16 v[64:79], a[128:131], v[240:243], v[64:79]
 ds_read_b128 a[176:179], v10 offset:12288
 s_add_u32 s57, s58, 32768
 v_fma_f32 v34, v178, s64, v23
 v_exp_f32 v103, v103
 v_add_f32 v18, v18, v102
 s_waitcnt lgkmcnt(4)
 v_mfma_f32_32x32x16_bf16 v[80:95], a[132:135], v[240:243], v[80:95]
 ds_read_b128 a[180:183], v10 offset:13312
 s_and_b32 s57, s57, 0x1ffff
 s_add_u32 s59, s59, 16384
 v_fma_f32 v35, v179, s64, v23
 v_exp_f32 v104, v104
 v_mfma_f32_32x32x16_bf16 v[64:79], a[136:139], v[244:247], v[64:79]
 ds_read_b128 a[184:187], v10 offset:14336
 v_add_f32 v18, v18, v103
 v_fma_f32 v36, v180, s64, v23
 v_cvt_pk_bf16_f32 v147, v102, v103
 v_exp_f32 v105, v105
 v_fma_f32 v37, v181, s64, v23
 v_mfma_f32_32x32x16_bf16 v[80:95], a[140:143], v[244:247], v[80:95]
 ds_read_b128 a[188:191], v10 offset:15360
 v_add_f32 v18, v18, v104
 v_fma_f32 v38, v182, s64, v23
 v_exp_f32 v106, v106
 v_add_f32 v18, v18, v105
 v_fma_f32 v39, v183, s64, v23
 v_mfma_f32_32x32x16_bf16 v[64:79], a[144:147], v[248:251], v[64:79]
 ds_read_b128 a[128:131], v10 offset:24576
 v_cvt_pk_bf16_f32 v148, v104, v105
 v_exp_f32 v107, v107
 v_fma_f32 v40, v184, s64, v23
 v_add_f32 v18, v18, v106
 v_mfma_f32_32x32x16_bf16 v[80:95], a[148:151], v[248:251], v[80:95]
 ds_read_b128 a[132:135], v10 offset:25600
 v_exp_f32 v108, v108
 v_fma_f32 v41, v185, s64, v23
 v_add_f32 v18, v18, v107
 v_cvt_pk_bf16_f32 v149, v106, v107
 v_fma_f32 v42, v186, s64, v23
 v_mfma_f32_32x32x16_bf16 v[64:79], a[152:155], v[252:255], v[64:79]
 ds_read_b128 a[136:139], v10 offset:26624
 v_exp_f32 v109, v109
 v_fma_f32 v43, v187, s64, v23
 v_add_f32 v18, v18, v108
 v_exp_f32 v110, v110
 v_mfma_f32_32x32x16_bf16 v[80:95], a[156:159], v[252:255], v[80:95]
 ds_read_b128 a[140:143], v10 offset:27648
 v_fma_f32 v44, v188, s64, v23
 v_add_f32 v18, v18, v109
 v_cvt_pk_bf16_f32 v150, v108, v109
 v_fma_f32 v45, v189, s64, v23
 v_add_f32 v18, v18, v110
 v_mfma_f32_32x32x16_bf16 a[64:79], a[160:163], v[128:131], a[64:79]
 ds_read_b128 a[144:147], v10 offset:28672
 v_exp_f32 v111, v111
 v_fma_f32 v46, v190, s64, v23
 v_exp_f32 v112, v112
 s_waitcnt lgkmcnt(4)
 v_mfma_f32_32x32x16_bf16 a[80:95], a[164:167], v[128:131], a[80:95]
 ds_read_b128 a[148:151], v10 offset:29696
 s_add_u32 s56, s56, 32768
 s_cmp_eq_u32 s28, 3
 s_cselect_b32 s66, 1.0, 0
 v_fma_f32 v47, v191, s64, v23
 v_add_f32 v18, v18, v111
 v_cvt_pk_bf16_f32 v151, v110, v111
 v_mfma_f32_32x32x16_bf16 a[96:111], a[168:171], v[128:131], a[96:111]
 ds_read_b128 a[152:155], v10 offset:30720
 s_cmp_lt_u32 s28, 3
 s_cselect_b32 s67, 0xf149f2ca, 0
 v_exp_f32 v113, v113
 v_add_f32 v18, v18, v112
 v_mfma_f32_32x32x16_bf16 a[112:127], a[172:175], v[128:131], a[112:127]
 ds_read_b128 a[156:159], v10 offset:31744
 s_and_b32 s56, s56, 0x1ffff
 v_add_u32 v10, s56, v19
 v_exp_f32 v114, v114
 v_add_f32 v18, v18, v113
 v_add_f32 v24, s67, v21
 v_mfma_f32_32x32x16_bf16 a[64:79], a[176:179], v[132:135], a[64:79]
 s_waitcnt vmcnt(4)
 s_barrier
 ds_read_b128 a[160:163], v10
 v_cvt_pk_bf16_f32 v152, v112, v113
 v_exp_f32 v115, v115
 v_fma_f32 v48, v176, s66, v24
 v_mfma_f32_32x32x16_bf16 a[80:95], a[180:183], v[132:135], a[80:95]
 ds_read_b128 a[164:167], v10 offset:16384
 v_add_f32 v18, v18, v114
 v_fma_f32 v49, v177, s66, v24
 v_exp_f32 v116, v116
 v_add_f32 v18, v18, v115
 v_mfma_f32_32x32x16_bf16 a[96:111], a[184:187], v[132:135], a[96:111]
 ds_read_b128 a[168:171], v10 offset:1024
 v_fma_f32 v50, v178, s66, v24
 v_cvt_pk_bf16_f32 v153, v114, v115
 v_exp_f32 v117, v117
 v_fma_f32 v51, v179, s66, v24
 v_add_f32 v18, v18, v116
 v_mfma_f32_32x32x16_bf16 a[112:127], a[188:191], v[132:135], a[112:127]
 ds_read_b128 a[172:175], v10 offset:17408
 v_exp_f32 v118, v118
 v_fma_f32 v52, v180, s66, v24
 v_add_f32 v18, v18, v117
 v_cvt_pk_bf16_f32 v154, v116, v117
 v_fma_f32 v53, v181, s66, v24
 v_mfma_f32_32x32x16_bf16 a[64:79], a[128:131], v[136:139], a[64:79]
 ds_read_b128 a[176:179], v10 offset:2048
 v_exp_f32 v119, v119
 v_fma_f32 v54, v182, s66, v24
 v_add_f32 v18, v18, v118
 s_waitcnt lgkmcnt(4)
 v_mfma_f32_32x32x16_bf16 a[80:95], a[132:135], v[136:139], a[80:95]
 ds_read_b128 a[180:183], v10 offset:18432
 v_exp_f32 v120, v120
 v_fma_f32 v55, v183, s66, v24
 v_add_f32 v18, v18, v119
 v_cvt_pk_bf16_f32 v155, v118, v119
 v_fma_f32 v56, v184, s66, v24
 v_mfma_f32_32x32x16_bf16 a[96:111], a[136:139], v[136:139], a[96:111]
 ds_read_b128 a[184:187], v10 offset:3072
 v_exp_f32 v121, v121
 v_add_f32 v18, v18, v120
 v_fma_f32 v57, v185, s66, v24
 v_exp_f32 v122, v122
 v_mfma_f32_32x32x16_bf16 a[112:127], a[140:143], v[136:139], a[112:127]
 ds_read_b128 a[188:191], v10 offset:19456
 v_add_f32 v18, v18, v121
 v_fma_f32 v58, v186, s66, v24
 v_cvt_pk_bf16_f32 v156, v120, v121
 v_fma_f32 v59, v187, s66, v24
 v_add_f32 v18, v18, v122
 v_mfma_f32_32x32x16_bf16 a[64:79], a[144:147], v[140:143], a[64:79]
 ds_read_b128 a[128:131], v10 offset:4096
 v_exp_f32 v123, v123
 v_fma_f32 v60, v188, s66, v24
 v_exp_f32 v124, v124
 v_add_f32 v18, v18, v123
 v_mfma_f32_32x32x16_bf16 a[80:95], a[148:151], v[140:143], a[80:95]
 ds_read_b128 a[132:135], v10 offset:20480
 v_fma_f32 v61, v189, s66, v24
 v_cvt_pk_bf16_f32 v157, v122, v123
 v_exp_f32 v125, v125
 v_fma_f32 v62, v190, s66, v24
 v_add_f32 v18, v18, v124
 v_mfma_f32_32x32x16_bf16 a[96:111], a[152:155], v[140:143], a[96:111]
 ds_read_b128 a[136:139], v10 offset:5120
 v_fma_f32 v63, v191, s66, v24
 v_exp_f32 v126, v126
 v_add_f32 v18, v18, v125
 v_cvt_pk_bf16_f32 v158, v124, v125
 v_mfma_f32_32x32x16_bf16 a[112:127], a[156:159], v[140:143], a[112:127]
 ds_read_b128 a[140:143], v10 offset:21504
 v_exp_f32 v127, v127
 v_add_f32 v18, v18, v126
 v_add_f32 v18, v18, v127
 v_cvt_pk_bf16_f32 v159, v126, v127
 v_mfma_f32_32x32x16_bf16 v[96:111], a[160:163], v[224:227], v[32:47]
 ds_read_b128 a[144:147], v10 offset:6144
 s_add_u32 m0, s58, 40960
 v_exp_f32 v64, v64
 s_waitcnt lgkmcnt(4)
 v_mfma_f32_32x32x16_bf16 v[112:127], a[164:167], v[224:227], v[48:63]
 ds_read_b128 a[148:151], v10 offset:22528
 buffer_load_dwordx4 v16, s[36:39], s59 offen sc1 lds
 v_exp_f32 v65, v65
 v_mfma_f32_32x32x16_bf16 v[96:111], a[168:171], v[228:231], v[96:111]
 ds_read_b128 a[152:155], v10 offset:7168
 v_add_f32 v18, v18, v64
 v_exp_f32 v66, v66
 v_add_f32 v18, v18, v65
 v_cvt_pk_bf16_f32 v128, v64, v65
 v_mfma_f32_32x32x16_bf16 v[112:127], a[172:175], v[228:231], v[112:127]
 ds_read_b128 a[156:159], v10 offset:23552
 buffer_load_dwordx4 v16, s[36:39], s59 offen offset:1024 sc1 lds
 v_exp_f32 v67, v67
 v_mfma_f32_32x32x16_bf16 v[96:111], a[176:179], v[232:235], v[96:111]
 ds_read_b128 a[160:163], v11 offset:8192
 v_add_f32 v18, v18, v66
 v_exp_f32 v68, v68
 v_add_f32 v18, v18, v67
 v_cvt_pk_bf16_f32 v129, v66, v67
 v_mfma_f32_32x32x16_bf16 v[112:127], a[180:183], v[232:235], v[112:127]
 ds_read_b128 a[164:167], v11 offset:9216
 buffer_load_dwordx4 v16, s[36:39], s59 offen offset:2048 sc1 lds
 v_exp_f32 v69, v69
 v_mfma_f32_32x32x16_bf16 v[96:111], a[184:187], v[236:239], v[96:111]
 ds_read_b128 a[168:171], v11 offset:10240
 v_add_f32 v18, v18, v68
 v_exp_f32 v70, v70
 v_add_f32 v18, v18, v69
 v_cvt_pk_bf16_f32 v130, v68, v69
 v_mfma_f32_32x32x16_bf16 v[112:127], a[188:191], v[236:239], v[112:127]
 ds_read_b128 a[172:175], v11 offset:11264
 buffer_load_dwordx4 v16, s[36:39], s59 offen offset:3072 sc1 lds
 v_exp_f32 v71, v71
 v_mfma_f32_32x32x16_bf16 v[96:111], a[128:131], v[240:243], v[96:111]
 ds_read_b128 a[176:179], v11 offset:12288
 s_add_u32 s58, s57, 32768
 v_add_f32 v18, v18, v70
 v_exp_f32 v72, v72
 s_waitcnt lgkmcnt(4)
 v_mfma_f32_32x32x16_bf16 v[112:127], a[132:135], v[240:243], v[112:127]
 ds_read_b128 a[180:183], v11 offset:13312
 s_and_b32 s58, s58, 0x1ffff
 s_add_u32 s59, s59, 16384
 v_add_f32 v18, v18, v71
 v_cvt_pk_bf16_f32 v131, v70, v71
 v_add_f32 v18, v18, v72
 v_mfma_f32_32x32x16_bf16 v[96:111], a[136:139], v[244:247], v[96:111]
 ds_read_b128 a[184:187], v11 offset:14336
 v_exp_f32 v73, v73
 v_exp_f32 v74, v74
 v_add_f32 v18, v18, v73
 v_mfma_f32_32x32x16_bf16 v[112:127], a[140:143], v[244:247], v[112:127]
 ds_read_b128 a[188:191], v11 offset:15360
 v_cvt_pk_bf16_f32 v132, v72, v73
 v_exp_f32 v75, v75
 v_add_f32 v18, v18, v74
 v_add_f32 v18, v18, v75
 v_mfma_f32_32x32x16_bf16 v[96:111], a[144:147], v[248:251], v[96:111]
 ds_read_b128 a[128:131], v11 offset:24576
 v_exp_f32 v76, v76
 v_cvt_pk_bf16_f32 v133, v74, v75
 v_exp_f32 v77, v77
 v_mfma_f32_32x32x16_bf16 v[112:127], a[148:151], v[248:251], v[112:127]
 ds_read_b128 a[132:135], v11 offset:25600
 v_add_f32 v18, v18, v76
 v_exp_f32 v78, v78
 v_add_f32 v18, v18, v77
 v_cvt_pk_bf16_f32 v134, v76, v77
 v_mfma_f32_32x32x16_bf16 v[96:111], a[152:155], v[252:255], v[96:111]
 ds_read_b128 a[136:139], v11 offset:26624
 v_exp_f32 v79, v79
 v_add_f32 v18, v18, v78
 v_exp_f32 v80, v80
 v_mfma_f32_32x32x16_bf16 v[112:127], a[156:159], v[252:255], v[112:127]
 ds_read_b128 a[140:143], v11 offset:27648
 v_add_f32 v18, v18, v79
 v_cvt_pk_bf16_f32 v135, v78, v79
 v_exp_f32 v81, v81
 v_add_f32 v18, v18, v80
 v_mfma_f32_32x32x16_bf16 a[64:79], a[160:163], v[144:147], a[64:79]
 ds_read_b128 a[144:147], v11 offset:28672
 v_exp_f32 v82, v82
 v_add_f32 v18, v18, v81
 v_cvt_pk_bf16_f32 v136, v80, v81
 s_waitcnt lgkmcnt(4)
 v_mfma_f32_32x32x16_bf16 a[80:95], a[164:167], v[144:147], a[80:95]
 ds_read_b128 a[148:151], v11 offset:29696
 s_add_u32 s56, s56, 32768
 v_exp_f32 v83, v83
 v_add_f32 v18, v18, v82
 v_add_f32 v18, v18, v83
 v_mfma_f32_32x32x16_bf16 a[96:111], a[168:171], v[144:147], a[96:111]
 ds_read_b128 a[152:155], v11 offset:30720
 v_exp_f32 v84, v84
 v_cvt_pk_bf16_f32 v137, v82, v83
 v_exp_f32 v85, v85
 v_mfma_f32_32x32x16_bf16 a[112:127], a[172:175], v[144:147], a[112:127]
 ds_read_b128 a[156:159], v11 offset:31744
 s_and_b32 s56, s56, 0x1ffff
 v_add_u32 v11, s56, v19
 v_add_f32 v18, v18, v84
 v_exp_f32 v86, v86
 v_mfma_f32_32x32x16_bf16 a[64:79], a[176:179], v[148:151], a[64:79]
 s_waitcnt vmcnt(4)
 s_barrier
 ds_read_b128 a[160:163], v10 offset:8192
 v_add_f32 v18, v18, v85
 v_cvt_pk_bf16_f32 v138, v84, v85
 v_add_f32 v18, v18, v86
 v_mfma_f32_32x32x16_bf16 a[80:95], a[180:183], v[148:151], a[80:95]
 ds_read_b128 a[164:167], v10 offset:9216
 v_exp_f32 v87, v87
 v_exp_f32 v88, v88
 v_add_f32 v18, v18, v87
 v_mfma_f32_32x32x16_bf16 a[96:111], a[184:187], v[148:151], a[96:111]
 ds_read_b128 a[168:171], v10 offset:10240
 v_cvt_pk_bf16_f32 v139, v86, v87
 v_exp_f32 v89, v89
 v_add_f32 v18, v18, v88
 v_add_f32 v18, v18, v89
 v_mfma_f32_32x32x16_bf16 a[112:127], a[188:191], v[148:151], a[112:127]
 ds_read_b128 a[172:175], v10 offset:11264
 v_exp_f32 v90, v90
 v_cvt_pk_bf16_f32 v140, v88, v89
 v_exp_f32 v91, v91
 v_mfma_f32_32x32x16_bf16 a[64:79], a[128:131], v[152:155], a[64:79]
 ds_read_b128 a[176:179], v10 offset:12288
 v_add_f32 v18, v18, v90
 v_exp_f32 v92, v92
 v_add_f32 v18, v18, v91
 s_waitcnt lgkmcnt(4)
 v_mfma_f32_32x32x16_bf16 a[80:95], a[132:135], v[152:155], a[80:95]
 ds_read_b128 a[180:183], v10 offset:13312
 v_cvt_pk_bf16_f32 v141, v90, v91
 v_exp_f32 v93, v93
 v_add_f32 v18, v18, v92
 v_add_f32 v18, v18, v93
 v_mfma_f32_32x32x16_bf16 a[96:111], a[136:139], v[152:155], a[96:111]
 ds_read_b128 a[184:187], v10 offset:14336
 v_exp_f32 v94, v94
 v_cvt_pk_bf16_f32 v142, v92, v93
 v_exp_f32 v95, v95
 v_mfma_f32_32x32x16_bf16 a[112:127], a[140:143], v[152:155], a[112:127]
 ds_read_b128 a[188:191], v10 offset:15360
 v_add_f32 v18, v18, v94
 v_add_f32 v18, v18, v95
 v_cvt_pk_bf16_f32 v143, v94, v95
 v_mfma_f32_32x32x16_bf16 a[64:79], a[144:147], v[156:159], a[64:79]
 ds_read_b128 a[128:131], v10 offset:24576
 v_mfma_f32_32x32x16_bf16 a[80:95], a[148:151], v[156:159], a[80:95]
 ds_read_b128 a[132:135], v10 offset:25600
 v_mfma_f32_32x32x16_bf16 a[96:111], a[152:155], v[156:159], a[96:111]
 ds_read_b128 a[136:139], v10 offset:26624
 v_mfma_f32_32x32x16_bf16 a[112:127], a[156:159], v[156:159], a[112:127]
 ds_read_b128 a[140:143], v10 offset:27648
 v_mfma_f32_32x32x16_bf16 a[64:79], a[160:163], v[128:131], a[64:79]
 ds_read_b128 a[144:147], v10 offset:28672
 v_exp_f32 v96, v96
 v_exp_f32 v97, v97
 v_add_f32 v18, v18, v96
 v_exp_f32 v98, v98
 s_waitcnt lgkmcnt(4)
 v_mfma_f32_32x32x16_bf16 a[80:95], a[164:167], v[128:131], a[80:95]
 ds_read_b128 a[148:151], v10 offset:29696
 s_add_u32 s56, s56, 32768
 v_add_f32 v18, v18, v97
 v_cvt_pk_bf16_f32 v144, v96, v97
 v_exp_f32 v99, v99
 v_add_f32 v18, v18, v98
 v_exp_f32 v100, v100
 v_mfma_f32_32x32x16_bf16 a[96:111], a[168:171], v[128:131], a[96:111]
 ds_read_b128 a[152:155], v10 offset:30720
 v_add_f32 v18, v18, v99
 v_cvt_pk_bf16_f32 v145, v98, v99
 v_exp_f32 v101, v101
 v_add_f32 v18, v18, v100
 v_exp_f32 v102, v102
 v_add_f32 v18, v18, v101
 v_mfma_f32_32x32x16_bf16 a[112:127], a[172:175], v[128:131], a[112:127]
 ds_read_b128 a[156:159], v10 offset:31744
 s_and_b32 s56, s56, 0x1ffff
 v_add_u32 v10, s56, v19
 v_cvt_pk_bf16_f32 v146, v100, v101
 v_exp_f32 v103, v103
 v_add_f32 v18, v18, v102
 v_exp_f32 v104, v104
 v_mfma_f32_32x32x16_bf16 a[64:79], a[176:179], v[132:135], a[64:79]
 s_waitcnt vmcnt(0)
 s_barrier
 ds_read_b128 a[160:163], v11 offset:8192
 v_add_f32 v18, v18, v103
 v_cvt_pk_bf16_f32 v147, v102, v103
 v_exp_f32 v105, v105
 v_add_f32 v18, v18, v104
 v_add_f32 v18, v18, v105
 v_mfma_f32_32x32x16_bf16 a[80:95], a[180:183], v[132:135], a[80:95]
 ds_read_b128 a[164:167], v11 offset:9216
 v_exp_f32 v106, v106
 v_cvt_pk_bf16_f32 v148, v104, v105
 v_exp_f32 v107, v107
 v_add_f32 v18, v18, v106
 v_exp_f32 v108, v108
 v_mfma_f32_32x32x16_bf16 a[96:111], a[184:187], v[132:135], a[96:111]
 ds_read_b128 a[168:171], v11 offset:10240
 v_add_f32 v18, v18, v107
 v_cvt_pk_bf16_f32 v149, v106, v107
 v_exp_f32 v109, v109
 v_add_f32 v18, v18, v108
 v_exp_f32 v110, v110
 v_add_f32 v18, v18, v109
 v_mfma_f32_32x32x16_bf16 a[112:127], a[188:191], v[132:135], a[112:127]
 ds_read_b128 a[172:175], v11 offset:11264
 v_cvt_pk_bf16_f32 v150, v108, v109
 v_exp_f32 v111, v111
 v_add_f32 v18, v18, v110
 v_exp_f32 v112, v112
 v_add_f32 v18, v18, v111
 v_cvt_pk_bf16_f32 v151, v110, v111
 v_mfma_f32_32x32x16_bf16 a[64:79], a[128:131], v[136:139], a[64:79]
 ds_read_b128 a[176:179], v11 offset:12288
 v_exp_f32 v113, v113
 v_add_f32 v18, v18, v112
 v_exp_f32 v114, v114
 v_add_f32 v18, v18, v113
 v_cvt_pk_bf16_f32 v152, v112, v113
 s_waitcnt lgkmcnt(4)
 v_mfma_f32_32x32x16_bf16 a[80:95], a[132:135], v[136:139], a[80:95]
 ds_read_b128 a[180:183], v11 offset:13312
 v_exp_f32 v115, v115
 v_add_f32 v18, v18, v114
 v_exp_f32 v116, v116
 v_add_f32 v18, v18, v115
 v_cvt_pk_bf16_f32 v153, v114, v115
 v_add_f32 v18, v18, v116
 v_mfma_f32_32x32x16_bf16 a[96:111], a[136:139], v[136:139], a[96:111]
 ds_read_b128 a[184:187], v11 offset:14336
 v_mov_b32 v28, 0
 v_exp_f32 v117, v117
 v_exp_f32 v118, v118
 v_add_f32 v18, v18, v117
 v_cvt_pk_bf16_f32 v154, v116, v117
 v_add_f32 v18, v18, v118
 v_mfma_f32_32x32x16_bf16 a[112:127], a[140:143], v[136:139], a[112:127]
 ds_read_b128 a[188:191], v11 offset:15360
 v_exp_f32 v119, v119
 v_exp_f32 v120, v120
 v_add_f32 v18, v18, v119
 v_cvt_pk_bf16_f32 v155, v118, v119
 v_exp_f32 v121, v121
 v_mfma_f32_32x32x16_bf16 a[64:79], a[144:147], v[140:143], a[64:79]
 ds_read_b128 a[128:131], v11 offset:24576
 buffer_load_dword v28, v28, s[72:75], 0 offen sc1
 v_add_f32 v18, v18, v120
 v_exp_f32 v122, v122
 v_add_f32 v18, v18, v121
 v_cvt_pk_bf16_f32 v156, v120, v121
 v_mfma_f32_32x32x16_bf16 a[80:95], a[148:151], v[140:143], a[80:95]
 ds_read_b128 a[132:135], v11 offset:25600
 v_exp_f32 v123, v123
 v_add_f32 v18, v18, v122
 v_exp_f32 v124, v124
 v_add_f32 v18, v18, v123
 v_cvt_pk_bf16_f32 v157, v122, v123
 v_mfma_f32_32x32x16_bf16 a[96:111], a[152:155], v[140:143], a[96:111]
 ds_read_b128 a[136:139], v11 offset:26624
 v_exp_f32 v125, v125
 v_add_f32 v18, v18, v124
 v_exp_f32 v126, v126
 v_add_f32 v18, v18, v125
 v_cvt_pk_bf16_f32 v158, v124, v125
 v_mfma_f32_32x32x16_bf16 a[112:127], a[156:159], v[140:143], a[112:127]
 ds_read_b128 a[140:143], v11 offset:27648
 v_exp_f32 v127, v127
 v_add_f32 v18, v18, v126
 v_add_f32 v18, v18, v127
 v_cvt_pk_bf16_f32 v159, v126, v127
 s_branch L_b_F
L_b_S0e:
 s_waitcnt lgkmcnt(0)
 ds_read_b128 a[160:163], v10 offset:8192
 ds_read_b128 a[164:167], v10 offset:9216
 ds_read_b128 a[168:171], v10 offset:10240
 ds_read_b128 a[172:175], v10 offset:11264
 ds_read_b128 a[176:179], v10 offset:12288
 ds_read_b128 a[180:183], v10 offset:13312
 ds_read_b128 a[184:187], v10 offset:14336
 ds_read_b128 a[188:191], v10 offset:15360
 ds_read_b128 a[128:131], v10 offset:24576
 ds_read_b128 a[132:135], v10 offset:25600
 ds_read_b128 a[136:139], v10 offset:26624
 ds_read_b128 a[140:143], v10 offset:27648
 s_waitcnt lgkmcnt(0)
 v_mfma_f32_32x32x16_bf16 a[64:79], a[160:163], v[128:131], a[64:79]
 ds_read_b128 a[144:147], v10 offset:28672
 v_exp_f32 v96, v96
 v_exp_f32 v97, v97
 v_add_f32 v18, v18, v96
 v_exp_f32 v98, v98
 s_waitcnt lgkmcnt(4)
 v_mfma_f32_32x32x16_bf16 a[80:95], a[164:167], v[128:131], a[80:95]
 ds_read_b128 a[148:151], v10 offset:29696
 s_add_u32 s56, s56, 32768
 v_add_f32 v18, v18, v97
 v_cvt_pk_bf16_f32 v144, v96, v97
 v_exp_f32 v99, v99
 v_add_f32 v18, v18, v98
 v_exp_f32 v100, v100
 v_mfma_f32_32x32x16_bf16 a[96:111], a[168:171], v[128:131], a[96:111]
 ds_read_b128 a[152:155], v10 offset:30720
 v_add_f32 v18, v18, v99
 v_cvt_pk_bf16_f32 v145, v98, v99
 v_exp_f32 v101, v101
 v_add_f32 v18, v18, v100
 v_exp_f32 v102, v102
 v_add_f32 v18, v18, v101
 v_mfma_f32_32x32x16_bf16 a[112:127], a[172:175], v[128:131], a[112:127]
 ds_read_b128 a[156:159], v10 offset:31744
 s_and_b32 s56, s56, 0x1ffff
 v_add_u32 v10, s56, v19
 v_cvt_pk_bf16_f32 v146, v100, v101
 v_exp_f32 v103, v103
 v_add_f32 v18, v18, v102
 v_exp_f32 v104, v104
 v_mfma_f32_32x32x16_bf16 a[64:79], a[176:179], v[132:135], a[64:79]
 s_waitcnt vmcnt(63)
 s_barrier
 ds_read_b128 a[160:163], v11 offset:8192
 v_add_f32 v18, v18, v103
 v_cvt_pk_bf16_f32 v147, v102, v103
 v_exp_f32 v105, v105
 v_add_f32 v18, v18, v104
 v_add_f32 v18, v18, v105
 v_mfma_f32_32x32x16_bf16 a[80:95], a[180:183], v[132:135], a[80:95]
 ds_read_b128 a[164:167], v11 offset:9216
 v_exp_f32 v106, v106
 v_cvt_pk_bf16_f32 v148, v104, v105
 v_exp_f32 v107, v107
 v_add_f32 v18, v18, v106
 v_exp_f32 v108, v108
 v_mfma_f32_32x32x16_bf16 a[96:111], a[184:187], v[132:135], a[96:111]
 ds_read_b128 a[168:171], v11 offset:10240
 v_add_f32 v18, v18, v107
 v_cvt_pk_bf16_f32 v149, v106, v107
 v_exp_f32 v109, v109
 v_add_f32 v18, v18, v108
 v_exp_f32 v110, v110
 v_add_f32 v18, v18, v109
 v_mfma_f32_32x32x16_bf16 a[112:127], a[188:191], v[132:135], a[112:127]
 ds_read_b128 a[172:175], v11 offset:11264
 v_cvt_pk_bf16_f32 v150, v108, v109
 v_exp_f32 v111, v111
 v_add_f32 v18, v18, v110
 v_exp_f32 v112, v112
 v_add_f32 v18, v18, v111
 v_cvt_pk_bf16_f32 v151, v110, v111
 v_mfma_f32_32x32x16_bf16 a[64:79], a[128:131], v[136:139], a[64:79]
 ds_read_b128 a[176:179], v11 offset:12288
 v_exp_f32 v113, v113
 v_add_f32 v18, v18, v112
 v_exp_f32 v114, v114
 v_add_f32 v18, v18, v113
 v_cvt_pk_bf16_f32 v152, v112, v113
 s_waitcnt lgkmcnt(4)
 v_mfma_f32_32x32x16_bf16 a[80:95], a[132:135], v[136:139], a[80:95]
 ds_read_b128 a[180:183], v11 offset:13312
 v_exp_f32 v115, v115
 v_add_f32 v18, v18, v114
 v_exp_f32 v116, v116
 v_add_f32 v18, v18, v115
 v_cvt_pk_bf16_f32 v153, v114, v115
 v_add_f32 v18, v18, v116
 v_mfma_f32_32x32x16_bf16 a[96:111], a[136:139], v[136:139], a[96:111]
 ds_read_b128 a[184:187], v11 offset:14336
 v_mov_b32 v28, 0
 v_exp_f32 v117, v117
 v_exp_f32 v118, v118
 v_add_f32 v18, v18, v117
 v_cvt_pk_bf16_f32 v154, v116, v117
 v_add_f32 v18, v18, v118
 v_mfma_f32_32x32x16_bf16 a[112:127], a[140:143], v[136:139], a[112:127]
 ds_read_b128 a[188:191], v11 offset:15360
 v_exp_f32 v119, v119
 v_exp_f32 v120, v120
 v_add_f32 v18, v18, v119
 v_cvt_pk_bf16_f32 v155, v118, v119
 v_exp_f32 v121, v121
 v_mfma_f32_32x32x16_bf16 a[64:79], a[144:147], v[140:143], a[64:79]
 ds_read_b128 a[128:131], v11 offset:24576
 buffer_load_dword v28, v28, s[72:75], 0 offen sc1
 v_add_f32 v18, v18, v120
 v_exp_f32 v122, v122
 v_add_f32 v18, v18, v121
 v_cvt_pk_bf16_f32 v156, v120, v121
 v_mfma_f32_32x32x16_bf16 a[80:95], a[148:151], v[140:143], a[80:95]
 ds_read_b128 a[132:135], v11 offset:25600
 v_exp_f32 v123, v123
 v_add_f32 v18, v18, v122
 v_exp_f32 v124, v124
 v_add_f32 v18, v18, v123
 v_cvt_pk_bf16_f32 v157, v122, v123
 v_mfma_f32_32x32x16_bf16 a[96:111], a[152:155], v[140:143], a[96:111]
 ds_read_b128 a[136:139], v11 offset:26624
 v_exp_f32 v125, v125
 v_add_f32 v18, v18, v124
 v_exp_f32 v126, v126
 v_add_f32 v18, v18, v125
 v_cvt_pk_bf16_f32 v158, v124, v125
 v_mfma_f32_32x32x16_bf16 a[112:127], a[156:159], v[140:143], a[112:127]
 ds_read_b128 a[140:143], v11 offset:27648
 v_exp_f32 v127, v127
 v_add_f32 v18, v18, v126
 v_add_f32 v18, v18, v127
 v_cvt_pk_bf16_f32 v159, v126, v127
L_b_F:
 v_mfma_f32_32x32x16_bf16 a[64:79], a[160:163], v[144:147], a[64:79]
 ds_read_b128 a[144:147], v11 offset:28672
 s_waitcnt lgkmcnt(4)
 v_mfma_f32_32x32x16_bf16 a[80:95], a[164:167], v[144:147], a[80:95]
 ds_read_b128 a[148:151], v11 offset:29696
 v_mfma_f32_32x32x16_bf16 a[96:111], a[168:171], v[144:147], a[96:111]
 ds_read_b128 a[152:155], v11 offset:30720
 v_mfma_f32_32x32x16_bf16 a[112:127], a[172:175], v[144:147], a[112:127]
 ds_read_b128 a[156:159], v11 offset:31744
 v_mfma_f32_32x32x16_bf16 a[64:79], a[176:179], v[148:151], a[64:79]
 v_mfma_f32_32x32x16_bf16 a[80:95], a[180:183], v[148:151], a[80:95]
 v_mfma_f32_32x32x16_bf16 a[96:111], a[184:187], v[148:151], a[96:111]
 v_mfma_f32_32x32x16_bf16 a[112:127], a[188:191], v[148:151], a[112:127]
 v_mfma_f32_32x32x16_bf16 a[64:79], a[128:131], v[152:155], a[64:79]
 s_waitcnt lgkmcnt(0)
 v_mfma_f32_32x32x16_bf16 a[80:95], a[132:135], v[152:155], a[80:95]
 v_mfma_f32_32x32x16_bf16 a[96:111], a[136:139], v[152:155], a[96:111]
 v_mfma_f32_32x32x16_bf16 a[112:127], a[140:143], v[152:155], a[112:127]
 v_mfma_f32_32x32x16_bf16 a[64:79], a[144:147], v[156:159], a[64:79]
 v_mfma_f32_32x32x16_bf16 a[80:95], a[148:151], v[156:159], a[80:95]
 v_mfma_f32_32x32x16_bf16 a[96:111], a[152:155], v[156:159], a[96:111]
 v_mfma_f32_32x32x16_bf16 a[112:127], a[156:159], v[156:159], a[112:127]
 v_mov_b32 v8, v18
 s_nop 1
 v_permlane32_swap_b32 v18, v8
 s_nop 1
 v_add_f32 v18, v18, v8
 s_mov_b32 s52, 0x4e800000
 v_cmp_nge_f32 vcc, s52, v18
 s_nop 1
 s_or_b64 vcc, vcc, s[70:71]
 s_cbranch_vccnz L_b_slow
L_b_epi:
 s_waitcnt vmcnt(0)
 v_readfirstlane_b32 s52, v28
 s_cmp_lt_u32 s52, 256
 s_cbranch_scc1 L_s2spin
L_s2ok:
 s_mul_i32 s56, s31, 163840
 s_add_u32 s56, s56, 52428800
 s_mul_i32 s58, s28, 5120
 s_mov_b32 s35, 0
 v_add_u32 v13, s58, v14
 s_lshl_b32 s59, s32, 3
 s_lshl_b32 s52, s28, 1
 s_add_u32 s59, s59, s52
 s_mul_i32 s53, s31, 73728
 s_mul_i32 s54, s32, 9216
 s_add_u32 s53, s53, s54
 s_add_u32 s53, s53, 58720256
 s_lshl_b32 s54, s52, 7
 s_add_u32 s54, s54, s53
 s_add_u32 s54, s54, 8192
 s_lshl_b32 s52, s52, 10
 s_add_u32 s53, s53, s52
 v_lshlrev_b32 v4, 2, v2
 v_lshlrev_b32 v5, 31, v3
 v_or_b32 v5, v5, v4
 s_mov_b32 s35, 0
 s_mov_b32 s60, s53
 s_mov_b32 s61, s54
 v_rcp_f32 v9, v18
 s_lshl_b32 s53, s31, 13
 s_add_u32 s53, s53, 34603008
 s_sub_u32 s52, 15, s32
 s_lshl_b32 s52, s52, 2
 s_add_u32 s52, s52, s28
 s_lshl_b32 s52, s52, 18
 s_add_u32 s52, s52, s53
 s_add_u32 s53, s52, 4096
 v_mov_b32 v8, v9
 v_accvgpr_read_b32 v160, a64
 v_accvgpr_read_b32 v161, a65
 v_accvgpr_read_b32 v162, a66
 v_accvgpr_read_b32 v163, a67
 v_accvgpr_read_b32 v164, a68
 v_accvgpr_read_b32 v165, a69
 v_accvgpr_read_b32 v166, a70
 v_accvgpr_read_b32 v167, a71
 s_add_u32 m0, s35, s58
 s_nop 0
 buffer_load_dwordx4 v13, s[36:39], s56 offen sc1 lds
 buffer_load_dwordx4 v13, s[36:39], s56 offen offset:1024 sc1 lds
 v_pk_mul_f32 v[160:161], v[160:161], v[8:9]
 v_pk_mul_f32 v[162:163], v[162:163], v[8:9]
 v_pk_mul_f32 v[164:165], v[164:165], v[8:9]
 v_pk_mul_f32 v[166:167], v[166:167], v[8:9]
 v_cvt_pk_bf16_f32 v168, v160, v161
 v_cvt_pk_bf16_f32 v169, v162, v163
 v_cvt_pk_bf16_f32 v170, v164, v165
 v_cvt_pk_bf16_f32 v171, v166, v167
 buffer_store_dwordx4 v[168:171], v14, s[36:39], s52 offen sc1
 v_accvgpr_read_b32 v160, a72
 v_accvgpr_read_b32 v161, a73
 v_accvgpr_read_b32 v162, a74
 v_accvgpr_read_b32 v163, a75
 v_accvgpr_read_b32 v164, a76
 v_accvgpr_read_b32 v165, a77
 v_accvgpr_read_b32 v166, a78
 v_accvgpr_read_b32 v167, a79
 buffer_load_dwordx4 v13, s[36:39], s56 offen offset:2048 sc1 lds
 buffer_load_dwordx4 v13, s[36:39], s56 offen offset:3072 sc1 lds
 s_add_u32 m0, m0, 4096
 s_add_u32 s56, s56, 4096
 v_pk_mul_f32 v[160:161], v[160:161], v[8:9]
 v_pk_mul_f32 v[162:163], v[162:163], v[8:9]
 v_pk_mul_f32 v[164:165], v[164:165], v[8:9]
 v_pk_mul_f32 v[166:167], v[166:167], v[8:9]
 v_cvt_pk_bf16_f32 v172, v160, v161
 v_cvt_pk_bf16_f32 v173, v162, v163
 v_cvt_pk_bf16_f32 v174, v164, v165
 v_cvt_pk_bf16_f32 v175, v166, v167
 buffer_store_dwordx4 v[172:175], v14, s[36:39], s52 offen offset:1024 sc1
 v_accvgpr_read_b32 v160, a80
 v_accvgpr_read_b32 v161, a81
 v_accvgpr_read_b32 v162, a82
 v_accvgpr_read_b32 v163, a83
 v_accvgpr_read_b32 v164, a84
 v_accvgpr_read_b32 v165, a85
 v_accvgpr_read_b32 v166, a86
 v_accvgpr_read_b32 v167, a87
 buffer_load_dwordx4 v13, s[36:39], s56 offen sc1 lds
 s_add_u32 s56, s56, 16384
 s_add_u32 s35, s35, 20480
 s_cmp_eq_u32 s35, 61440
 s_cselect_b32 s35, 0, s35
 buffer_load_dwordx4 v[96:99], v14, s[36:39], s60 offen sc1
 buffer_load_dword v100, v5, s[36:39], s61 offen sc1
 v_pk_mul_f32 v[160:161], v[160:161], v[8:9]
 v_pk_mul_f32 v[162:163], v[162:163], v[8:9]
 v_pk_mul_f32 v[164:165], v[164:165], v[8:9]
 v_pk_mul_f32 v[166:167], v[166:167], v[8:9]
 v_cvt_pk_bf16_f32 v168, v160, v161
 v_cvt_pk_bf16_f32 v169, v162, v163
 v_cvt_pk_bf16_f32 v170, v164, v165
 v_cvt_pk_bf16_f32 v171, v166, v167
 buffer_store_dwordx4 v[168:171], v14, s[36:39], s52 offen offset:2048 sc1
 v_accvgpr_read_b32 v160, a88
 v_accvgpr_read_b32 v161, a89
 v_accvgpr_read_b32 v162, a90
 v_accvgpr_read_b32 v163, a91
 v_accvgpr_read_b32 v164, a92
 v_accvgpr_read_b32 v165, a93
 v_accvgpr_read_b32 v166, a94
 v_accvgpr_read_b32 v167, a95
 buffer_load_dwordx4 v[104:107], v14, s[36:39], s60 offen offset:1024 sc1
 buffer_load_dword v108, v5, s[36:39], s61 offen offset:128 sc1
 s_barrier
 v_pk_mul_f32 v[160:161], v[160:161], v[8:9]
 v_pk_mul_f32 v[162:163], v[162:163], v[8:9]
 v_pk_mul_f32 v[164:165], v[164:165], v[8:9]
 v_pk_mul_f32 v[166:167], v[166:167], v[8:9]
 v_cvt_pk_bf16_f32 v172, v160, v161
 v_cvt_pk_bf16_f32 v173, v162, v163
 v_cvt_pk_bf16_f32 v174, v164, v165
 v_cvt_pk_bf16_f32 v175, v166, v167
 buffer_store_dwordx4 v[172:175], v14, s[36:39], s52 offen offset:3072 sc1
 v_accvgpr_read_b32 v160, a96
 v_accvgpr_read_b32 v161, a97
 v_accvgpr_read_b32 v162, a98
 v_accvgpr_read_b32 v163, a99
 v_accvgpr_read_b32 v164, a100
 v_accvgpr_read_b32 v165, a101
 v_accvgpr_read_b32 v166, a102
 v_accvgpr_read_b32 v167, a103
 s_add_u32 m0, s35, s58
 s_nop 0
 buffer_load_dwordx4 v13, s[36:39], s56 offen sc1 lds
 buffer_load_dwordx4 v13, s[36:39], s56 offen offset:1024 sc1 lds
 v_pk_mul_f32 v[160:161], v[160:161], v[8:9]
 v_pk_mul_f32 v[162:163], v[162:163], v[8:9]
 v_pk_mul_f32 v[164:165], v[164:165], v[8:9]
 v_pk_mul_f32 v[166:167], v[166:167], v[8:9]
 v_cvt_pk_bf16_f32 v168, v160, v161
 v_cvt_pk_bf16_f32 v169, v162, v163
 v_cvt_pk_bf16_f32 v170, v164, v165
 v_cvt_pk_bf16_f32 v171, v166, v167
 buffer_store_dwordx4 v[168:171], v14, s[36:39], s53 offen sc1
 v_accvgpr_read_b32 v160, a104
 v_accvgpr_read_b32 v161, a105
 v_accvgpr_read_b32 v162, a106
 v_accvgpr_read_b32 v163, a107
 v_accvgpr_read_b32 v164, a108
 v_accvgpr_read_b32 v165, a109
 v_accvgpr_read_b32 v166, a110
 v_accvgpr_read_b32 v167, a111
 buffer_load_dwordx4 v13, s[36:39], s56 offen offset:2048 sc1 lds
 buffer_load_dwordx4 v13, s[36:39], s56 offen offset:3072 sc1 lds
 s_add_u32 m0, m0, 4096
 s_add_u32 s56, s56, 4096
 v_pk_mul_f32 v[160:161], v[160:161], v[8:9]
 v_pk_mul_f32 v[162:163], v[162:163], v[8:9]
 v_pk_mul_f32 v[164:165], v[164:165], v[8:9]
 v_pk_mul_f32 v[166:167], v[166:167], v[8:9]
 v_cvt_pk_bf16_f32 v172, v160, v161
 v_cvt_pk_bf16_f32 v173, v162, v163
 v_cvt_pk_bf16_f32 v174, v164, v165
 v_cvt_pk_bf16_f32 v175, v166, v167
 buffer_store_dwordx4 v[172:175], v14, s[36:39], s53 offen offset:1024 sc1
 v_accvgpr_read_b32 v160, a112
 v_accvgpr_read_b32 v161, a113
 v_accvgpr_read_b32 v162, a114
 v_accvgpr_read_b32 v163, a115
 v_accvgpr_read_b32 v164, a116
 v_accvgpr_read_b32 v165, a117
 v_accvgpr_read_b32 v166, a118
 v_accvgpr_read_b32 v167, a119
 buffer_load_dwordx4 v13, s[36:39], s56 offen sc1 lds
 s_add_u32 s56, s56, 16384
 s_add_u32 s35, s35, 20480
 s_cmp_eq_u32 s35, 61440
 s_cselect_b32 s35, 0, s35
 v_pk_mul_f32 v[160:161], v[160:161], v[8:9]
 v_pk_mul_f32 v[162:163], v[162:163], v[8:9]
 v_pk_mul_f32 v[164:165], v[164:165], v[8:9]
 v_pk_mul_f32 v[166:167], v[166:167], v[8:9]
 v_cvt_pk_bf16_f32 v168, v160, v161
 v_cvt_pk_bf16_f32 v169, v162, v163
 v_cvt_pk_bf16_f32 v170, v164, v165
 v_cvt_pk_bf16_f32 v171, v166, v167
 buffer_store_dwordx4 v[168:171], v14, s[36:39], s53 offen offset:2048 sc1
 v_accvgpr_read_b32 v160, a120
 v_accvgpr_read_b32 v161, a121
 v_accvgpr_read_b32 v162, a122
 v_accvgpr_read_b32 v163, a123
 v_accvgpr_read_b32 v164, a124
 v_accvgpr_read_b32 v165, a125
 v_accvgpr_read_b32 v166, a126
 v_accvgpr_read_b32 v167, a127
 v_pk_mul_f32 v[160:161], v[160:161], v[8:9]
 v_pk_mul_f32 v[162:163], v[162:163], v[8:9]
 v_pk_mul_f32 v[164:165], v[164:165], v[8:9]
 v_pk_mul_f32 v[166:167], v[166:167], v[8:9]
 v_cvt_pk_bf16_f32 v172, v160, v161
 v_cvt_pk_bf16_f32 v173, v162, v163
 v_cvt_pk_bf16_f32 v174, v164, v165
 v_cvt_pk_bf16_f32 v175, v166, v167
 buffer_store_dwordx4 v[172:175], v14, s[36:39], s53 offen offset:3072 sc1
 v_mov_b32 v101, 0
 v_mov_b32 v213, 0
 v_mov_b32 v102, 0
 v_mov_b32 v214, 0
 v_mov_b32 v103, 0
 v_mov_b32 v215, 0
 v_mov_b32 v109, 0
 v_mov_b32 v221, 0
 v_mov_b32 v110, 0
 v_mov_b32 v222, 0
 v_mov_b32 v111, 0
 v_mov_b32 v223, 0
 v_lshlrev_b32 v20, 2, v2
 v_add_u32 v20, 8192, v20
 v_min_u32 v6, 19, v2
 v_lshlrev_b32 v6, 4, v6
 v_mul_u32_u24 v7, 320, v3
 v_add_u32 v6, v6, v7
 v_add_u32 v21, 9216, v6
 v_mov_b32 v10, v14
 v_mov_b32 v11, v20
 v_mov_b32 v12, v21
 s_mov_b32 s57, 0
 s_mov_b32 s40, s22
 s_mov_b32 s41, s23
 s_mov_b32 s42, 4718592
 s_mov_b32 s43, 0x20000
 s_lshr_b32 s52, s30, 3
 s_lshl_b32 s61, s29, 2
 s_add_u32 s61, s61, s52
 s_lshl_b32 s61, s61, 1
 s_and_b32 s68, s30, 7
 s_lshl_b32 s62, s68, 1
 s_add_u32 s62, s62, 2
 s_mul_i32 s52, s68, 3
 s_cmp_lt_u32 s68, 2
 s_cselect_b32 s62, s52, s62
 s_lshl_b32 s52, s28, 16
 s_lshl_b32 s63, s61, 18
 s_add_u32 s63, s63, s52
 s_add_u32 s63, s63, 34603008
 s_add_u32 s64, s63, 262144
 s_mul_i32 s65, s28, 1179648
 s_lshl_b32 s53, s62, 10
 s_add_u32 s65, s65, s53
 s_add_u32 s65, s65, 65011712
 s_mov_b32 s67, 71303168
 s_lshl_b32 s52, s33, 2
 s_cmp_eq_u32 s28, 0
 s_cselect_b32 s69, s52, 0x80000000
 v_and_b32 v4, 1, v1
 v_bfe_u32 v5, v1, 1, 1
 v_lshrrev_b32 v6, 2, v1
 v_mul_u32_u24 v5, 320, v5
 v_mul_u32_u24 v6, 640, v6
 v_lshlrev_b32 v7, 4, v4
 v_add3_u32 v5, v5, v6, v7
 v_add_u32 v5, 9504, v5
 v_subrev_u32 v6, s58, v5
 v_cmp_gt_u32 vcc, 5120, v6
 v_mov_b32 v7, 0x100000
 v_mov_b32 v6, 0x3f803f80
 v_cndmask_b32 v252, v7, v5, vcc
 v_cmp_eq_u32 vcc, 0, v4
 v_mov_b32 v253, v252
 s_nop 0
 v_cndmask_b32 v248, 0, v6, vcc
 v_mov_b32 v249, v248
 v_mov_b32 v250, v248
 v_mov_b32 v251, v248
 s_waitcnt vmcnt(10)
 ds_write_b128 v253, v[248:251]
 s_waitcnt lgkmcnt(0)
 s_barrier
 ds_read_b128 v[208:211], v10
 ds_read_b32 v212, v11
 ds_read_b128 v[216:219], v10 offset:1024
 ds_read_b32 v220, v11 offset:128
 s_waitcnt lgkmcnt(0)
 v_mfma_f32_32x32x16_bf16 v[112:127], v[208:211], v[96:99], 0
 v_mfma_f32_32x32x16_bf16 v[112:127], v[212:215], v[100:103], v[112:127]
 v_mfma_f32_32x32x16_bf16 v[128:143], v[208:211], v[104:107], 0
 v_mfma_f32_32x32x16_bf16 v[128:143], v[212:215], v[108:111], v[128:143]
 s_nop 9
 v_max3_f32 v16, v112, v113, v114
 v_max3_f32 v16, v16, v115, v116
 v_max3_f32 v16, v16, v117, v118
 v_max3_f32 v16, v16, v119, v120
 v_max3_f32 v16, v16, v121, v122
 v_max3_f32 v16, v16, v123, v124
 v_max3_f32 v16, v16, v125, v126
 v_max_f32 v16, v16, v127
 v_max3_f32 v17, v128, v129, v130
 v_max3_f32 v17, v17, v131, v132
 v_max3_f32 v17, v17, v133, v134
 v_max3_f32 v17, v17, v135, v136
 v_max3_f32 v17, v17, v137, v138
 v_max3_f32 v17, v17, v139, v140
 v_max3_f32 v17, v17, v141, v142
 v_max_f32 v17, v17, v143
 v_mov_b32 v8, v16
 v_mov_b32 v9, v17
 s_nop 1
 v_permlane32_swap_b32 v16, v8
 v_permlane32_swap_b32 v17, v9
 s_nop 1
 v_max_f32 v16, v16, v8
 v_max_f32 v17, v17, v9
 v_sub_f32 v112, v112, v16
 v_sub_f32 v32, 0, v16
 v_sub_f32 v113, v113, v16
 v_sub_f32 v33, 0, v16
 v_sub_f32 v114, v114, v16
 v_sub_f32 v34, 0, v16
 v_sub_f32 v115, v115, v16
 v_sub_f32 v35, 0, v16
 v_sub_f32 v116, v116, v16
 v_sub_f32 v36, 0, v16
 v_sub_f32 v117, v117, v16
 v_sub_f32 v37, 0, v16
 v_sub_f32 v118, v118, v16
 v_sub_f32 v38, 0, v16
 v_sub_f32 v119, v119, v16
 v_sub_f32 v39, 0, v16
 v_sub_f32 v120, v120, v16
 v_sub_f32 v40, 0, v16
 v_sub_f32 v121, v121, v16
 v_sub_f32 v41, 0, v16
 v_sub_f32 v122, v122, v16
 v_sub_f32 v42, 0, v16
 v_sub_f32 v123, v123, v16
 v_sub_f32 v43, 0, v16
 v_sub_f32 v124, v124, v16
 v_sub_f32 v44, 0, v16
 v_sub_f32 v125, v125, v16
 v_sub_f32 v45, 0, v16
 v_sub_f32 v126, v126, v16
 v_sub_f32 v46, 0, v16
 v_sub_f32 v127, v127, v16
 v_sub_f32 v47, 0, v16
 v_sub_f32 v128, v128, v17
 v_sub_f32 v48, 0, v17
 v_sub_f32 v129, v129, v17
 v_sub_f32 v49, 0, v17
 v_sub_f32 v130, v130, v17
 v_sub_f32 v50, 0, v17
 v_sub_f32 v131, v131, v17
 v_sub_f32 v51, 0, v17
 v_sub_f32 v132, v132, v17
 v_sub_f32 v52, 0, v17
 v_sub_f32 v133, v133, v17
 v_sub_f32 v53, 0, v17
 v_sub_f32 v134, v134, v17
 v_sub_f32 v54, 0, v17
 v_sub_f32 v135, v135, v17
 v_sub_f32 v55, 0, v17
 v_sub_f32 v136, v136, v17
 v_sub_f32 v56, 0, v17
 v_sub_f32 v137, v137, v17
 v_sub_f32 v57, 0, v17
 v_sub_f32 v138, v138, v17
 v_sub_f32 v58, 0, v17
 v_sub_f32 v139, v139, v17
 v_sub_f32 v59, 0, v17
 v_sub_f32 v140, v140, v17
 v_sub_f32 v60, 0, v17
 v_sub_f32 v141, v141, v17
 v_sub_f32 v61, 0, v17
 v_sub_f32 v142, v142, v17
 v_sub_f32 v62, 0, v17
 v_sub_f32 v143, v143, v17
 v_sub_f32 v63, 0, v17
 v_mov_b32 v8, s69
 v_mov_b32 v9, 1
 v_mfma_f32_32x32x16_bf16 v[144:159], v[216:219], v[96:99], v[32:47]
 ds_read_b128 v[208:211], v10 offset:2048
 ds_read_b32 v212, v11 offset:256
 v_exp_f32 v112, v112
 v_exp_f32 v113, v113
 v_exp_f32 v114, v114
 v_exp_f32 v115, v115
 v_cvt_pk_bf16_f32 v176, v112, v113
 v_exp_f32 v116, v116
 v_exp_f32 v117, v117
 v_cvt_pk_bf16_f32 v177, v114, v115
 v_exp_f32 v118, v118
 v_exp_f32 v119, v119
 v_cvt_pk_bf16_f32 v178, v116, v117
 v_exp_f32 v120, v120
 v_mfma_f32_32x32x16_bf16 v[160:175], v[216:219], v[104:107], v[48:63]
 ds_read_b128 v[224:227], v12
 ds_read_b128 v[228:231], v12 offset:640
 v_exp_f32 v121, v121
 v_cvt_pk_bf16_f32 v179, v118, v119
 v_exp_f32 v122, v122
 v_exp_f32 v123, v123
 v_cvt_pk_bf16_f32 v180, v120, v121
 v_exp_f32 v124, v124
 v_exp_f32 v125, v125
 v_cvt_pk_bf16_f32 v181, v122, v123
 v_exp_f32 v126, v126
 v_exp_f32 v127, v127
 v_cvt_pk_bf16_f32 v182, v124, v125
 v_exp_f32 v128, v128
 v_mfma_f32_32x32x16_bf16 v[144:159], v[220:223], v[100:103], v[144:159]
 v_exp_f32 v129, v129
 v_cvt_pk_bf16_f32 v183, v126, v127
 v_exp_f32 v130, v130
 v_exp_f32 v131, v131
 v_cvt_pk_bf16_f32 v184, v128, v129
 v_exp_f32 v132, v132
 v_exp_f32 v133, v133
 v_cvt_pk_bf16_f32 v185, v130, v131
 v_exp_f32 v134, v134
 v_exp_f32 v135, v135
 v_cvt_pk_bf16_f32 v186, v132, v133
 v_exp_f32 v136, v136
 v_mfma_f32_32x32x16_bf16 v[160:175], v[220:223], v[108:111], v[160:175]
 v_exp_f32 v137, v137
 v_cvt_pk_bf16_f32 v187, v134, v135
 v_exp_f32 v138, v138
 v_exp_f32 v139, v139
 v_cvt_pk_bf16_f32 v188, v136, v137
 v_exp_f32 v140, v140
 v_exp_f32 v141, v141
 v_cvt_pk_bf16_f32 v189, v138, v139
 v_exp_f32 v142, v142
 v_exp_f32 v143, v143
 v_cvt_pk_bf16_f32 v190, v140, v141
 s_waitcnt lgkmcnt(0)
 v_cvt_pk_bf16_f32 v191, v142, v143
 v_mfma_f32_32x32x16_bf16 v[112:127], v[208:211], v[96:99], v[32:47]
 s_waitcnt vmcnt(0)
 s_barrier
 ds_read_b128 v[216:219], v10 offset:3072
 ds_read_b32 v220, v11 offset:384
 v_exp_f32 v144, v144
 v_exp_f32 v145, v145
 v_exp_f32 v146, v146
 v_exp_f32 v147, v147
 v_cvt_pk_bf16_f32 v192, v144, v145
 v_exp_f32 v148, v148
 v_mfma_f32_32x32x16_bf16 v[128:143], v[208:211], v[104:107], v[48:63]
 ds_read_b128 v[232:235], v12 offset:1280
 ds_read_b128 v[236:239], v12 offset:1920
 s_mov_b64 exec, 1
 buffer_store_dword v9, v8, s[36:39], s67 offen sc1
 s_mov_b64 exec, -1
 v_exp_f32 v149, v149
 v_cvt_pk_bf16_f32 v193, v146, v147
 v_exp_f32 v150, v150
 v_exp_f32 v151, v151
 v_cvt_pk_bf16_f32 v194, v148, v149
 v_exp_f32 v152, v152
 v_mfma_f32_32x32x16_bf16 v[112:127], v[212:215], v[100:103], v[112:127]
 v_exp_f32 v153, v153
 v_cvt_pk_bf16_f32 v195, v150, v151
 v_exp_f32 v154, v154
 v_exp_f32 v155, v155
 v_cvt_pk_bf16_f32 v196, v152, v153
 v_exp_f32 v156, v156
 v_mfma_f32_32x32x16_bf16 v[128:143], v[212:215], v[108:111], v[128:143]
 v_exp_f32 v157, v157
 v_cvt_pk_bf16_f32 v197, v154, v155
 v_exp_f32 v158, v158
 v_exp_f32 v159, v159
 v_cvt_pk_bf16_f32 v198, v156, v157
 v_exp_f32 v160, v160
 v_mfma_f32_32x32x16_bf16 v[64:79], v[224:227], v[176:179], 0
 v_exp_f32 v161, v161
 v_cvt_pk_bf16_f32 v199, v158, v159
 v_exp_f32 v162, v162
 v_exp_f32 v163, v163
 v_cvt_pk_bf16_f32 v200, v160, v161
 v_exp_f32 v164, v164
 v_mfma_f32_32x32x16_bf16 v[80:95], v[224:227], v[184:187], 0
 v_exp_f32 v165, v165
 v_cvt_pk_bf16_f32 v201, v162, v163
 v_exp_f32 v166, v166
 v_exp_f32 v167, v167
 v_cvt_pk_bf16_f32 v202, v164, v165
 v_exp_f32 v168, v168
 v_mfma_f32_32x32x16_bf16 v[64:79], v[228:231], v[180:183], v[64:79]
 v_exp_f32 v169, v169
 v_cvt_pk_bf16_f32 v203, v166, v167
 v_exp_f32 v170, v170
 v_exp_f32 v171, v171
 v_cvt_pk_bf16_f32 v204, v168, v169
 v_exp_f32 v172, v172
 v_mfma_f32_32x32x16_bf16 v[80:95], v[228:231], v[188:191], v[80:95]
 v_exp_f32 v173, v173
 v_cvt_pk_bf16_f32 v205, v170, v171
 v_exp_f32 v174, v174
 v_exp_f32 v175, v175
 v_cvt_pk_bf16_f32 v206, v172, v173
 s_waitcnt lgkmcnt(0)
 v_cvt_pk_bf16_f32 v207, v174, v175
 v_mfma_f32_32x32x16_bf16 v[144:159], v[216:219], v[96:99], v[32:47]
 ds_read_b128 v[208:211], v10 offset:4096
 ds_read_b32 v212, v11 offset:512
 v_exp_f32 v112, v112
 v_exp_f32 v113, v113
 v_exp_f32 v114, v114
 v_exp_f32 v115, v115
 v_cvt_pk_bf16_f32 v176, v112, v113
 v_exp_f32 v116, v116
 v_mfma_f32_32x32x16_bf16 v[160:175], v[216:219], v[104:107], v[48:63]
 ds_read_b128 v[224:227], v12 offset:2560
 ds_read_b128 v[228:231], v12 offset:3200
 v_exp_f32 v117, v117
 v_cvt_pk_bf16_f32 v177, v114, v115
 v_exp_f32 v118, v118
 v_exp_f32 v119, v119
 v_cvt_pk_bf16_f32 v178, v116, v117
 v_exp_f32 v120, v120
 v_mfma_f32_32x32x16_bf16 v[144:159], v[220:223], v[100:103], v[144:159]
 v_exp_f32 v121, v121
 v_cvt_pk_bf16_f32 v179, v118, v119
 v_exp_f32 v122, v122
 v_exp_f32 v123, v123
 v_cvt_pk_bf16_f32 v180, v120, v121
 v_exp_f32 v124, v124
 v_mfma_f32_32x32x16_bf16 v[160:175], v[220:223], v[108:111], v[160:175]
 v_exp_f32 v125, v125
 v_cvt_pk_bf16_f32 v181, v122, v123
 v_exp_f32 v126, v126
 v_exp_f32 v127, v127
 v_cvt_pk_bf16_f32 v182, v124, v125
 v_exp_f32 v128, v128
 v_mfma_f32_32x32x16_bf16 v[64:79], v[232:235], v[192:195], v[64:79]
 v_exp_f32 v129, v129
 v_cvt_pk_bf16_f32 v183, v126, v127
 v_exp_f32 v130, v130
 v_exp_f32 v131, v131
 v_cvt_pk_bf16_f32 v184, v128, v129
 v_exp_f32 v132, v132
 v_mfma_f32_32x32x16_bf16 v[80:95], v[232:235], v[200:203], v[80:95]
 v_exp_f32 v133, v133
 v_cvt_pk_bf16_f32 v185, v130, v131
 v_exp_f32 v134, v134
 v_exp_f32 v135, v135
 v_cvt_pk_bf16_f32 v186, v132, v133
 v_exp_f32 v136, v136
 v_mfma_f32_32x32x16_bf16 v[64:79], v[236:239], v[196:199], v[64:79]
 v_exp_f32 v137, v137
 v_cvt_pk_bf16_f32 v187, v134, v135
 v_exp_f32 v138, v138
 v_exp_f32 v139, v139
 v_cvt_pk_bf16_f32 v188, v136, v137
 v_exp_f32 v140, v140
 v_mfma_f32_32x32x16_bf16 v[80:95], v[236:239], v[204:207], v[80:95]
 v_exp_f32 v141, v141
 v_cvt_pk_bf16_f32 v189, v138, v139
 v_exp_f32 v142, v142
 v_exp_f32 v143, v143
 v_cvt_pk_bf16_f32 v190, v140, v141
 s_waitcnt lgkmcnt(0)
 v_cvt_pk_bf16_f32 v191, v142, v143
 v_mfma_f32_32x32x16_bf16 v[112:127], v[208:211], v[96:99], v[32:47]
 ds_read_b128 v[216:219], v10 offset:5120
 ds_read_b32 v220, v11 offset:640
 v_exp_f32 v144, v144
 v_exp_f32 v145, v145
 v_exp_f32 v146, v146
 v_exp_f32 v147, v147
 v_cvt_pk_bf16_f32 v192, v144, v145
 v_exp_f32 v148, v148
 v_mfma_f32_32x32x16_bf16 v[128:143], v[208:211], v[104:107], v[48:63]
 ds_read_b128 v[232:235], v12 offset:3840
 ds_read_b128 v[236:239], v12 offset:4480
 v_exp_f32 v149, v149
 v_cvt_pk_bf16_f32 v193, v146, v147
 v_exp_f32 v150, v150
 v_exp_f32 v151, v151
 v_cvt_pk_bf16_f32 v194, v148, v149
 v_exp_f32 v152, v152
 v_mfma_f32_32x32x16_bf16 v[112:127], v[212:215], v[100:103], v[112:127]
 v_exp_f32 v153, v153
 v_cvt_pk_bf16_f32 v195, v150, v151
 v_exp_f32 v154, v154
 v_exp_f32 v155, v155
 v_cvt_pk_bf16_f32 v196, v152, v153
 v_exp_f32 v156, v156
 v_mfma_f32_32x32x16_bf16 v[128:143], v[212:215], v[108:111], v[128:143]
 v_exp_f32 v157, v157
 v_cvt_pk_bf16_f32 v197, v154, v155
 v_exp_f32 v158, v158
 v_exp_f32 v159, v159
 v_cvt_pk_bf16_f32 v198, v156, v157
 v_exp_f32 v160, v160
 v_mfma_f32_32x32x16_bf16 v[64:79], v[224:227], v[176:179], v[64:79]
 v_exp_f32 v161, v161
 v_cvt_pk_bf16_f32 v199, v158, v159
 v_exp_f32 v162, v162
 v_exp_f32 v163, v163
 v_cvt_pk_bf16_f32 v200, v160, v161
 v_exp_f32 v164, v164
 v_mfma_f32_32x32x16_bf16 v[80:95], v[224:227], v[184:187], v[80:95]
 v_exp_f32 v165, v165
 v_cvt_pk_bf16_f32 v201, v162, v163
 v_exp_f32 v166, v166
 v_exp_f32 v167, v167
 v_cvt_pk_bf16_f32 v202, v164, v165
 v_exp_f32 v168, v168
 v_mfma_f32_32x32x16_bf16 v[64:79], v[228:231], v[180:183], v[64:79]
 v_exp_f32 v169, v169
 v_cvt_pk_bf16_f32 v203, v166, v167
 v_exp_f32 v170, v170
 v_exp_f32 v171, v171
 v_cvt_pk_bf16_f32 v204, v168, v169
 v_exp_f32 v172, v172
 v_mfma_f32_32x32x16_bf16 v[80:95], v[228:231], v[188:191], v[80:95]
 v_exp_f32 v173, v173
 v_cvt_pk_bf16_f32 v205, v170, v171
 v_exp_f32 v174, v174
 v_exp_f32 v175, v175
 v_cvt_pk_bf16_f32 v206, v172, v173
 s_waitcnt lgkmcnt(0)
 v_cvt_pk_bf16_f32 v207, v174, v175
 v_mfma_f32_32x32x16_bf16 v[144:159], v[216:219], v[96:99], v[32:47]
 ds_read_b128 v[208:211], v10 offset:6144
 ds_read_b32 v212, v11 offset:768
 buffer_load_dwordx4 v[240:243], v14, s[36:39], s67 offen sc1
 v_exp_f32 v112, v112
 v_exp_f32 v113, v113
 v_exp_f32 v114, v114
 v_exp_f32 v115, v115
 v_cvt_pk_bf16_f32 v176, v112, v113
 v_exp_f32 v116, v116
 v_mfma_f32_32x32x16_bf16 v[160:175], v[216:219], v[104:107], v[48:63]
 ds_read_b128 v[224:227], v12 offset:5120
 ds_read_b128 v[228:231], v12 offset:5760
 v_exp_f32 v117, v117
 v_cvt_pk_bf16_f32 v177, v114, v115
 v_exp_f32 v118, v118
 v_exp_f32 v119, v119
 v_cvt_pk_bf16_f32 v178, v116, v117
 v_exp_f32 v120, v120
 v_mfma_f32_32x32x16_bf16 v[144:159], v[220:223], v[100:103], v[144:159]
 v_exp_f32 v121, v121
 v_cvt_pk_bf16_f32 v179, v118, v119
 v_exp_f32 v122, v122
 v_exp_f32 v123, v123
 v_cvt_pk_bf16_f32 v180, v120, v121
 v_exp_f32 v124, v124
 v_mfma_f32_32x32x16_bf16 v[160:175], v[220:223], v[108:111], v[160:175]
 v_exp_f32 v125, v125
 v_cvt_pk_bf16_f32 v181, v122, v123
 v_exp_f32 v126, v126
 v_exp_f32 v127, v127
 v_cvt_pk_bf16_f32 v182, v124, v125
 v_exp_f32 v128, v128
 v_mfma_f32_32x32x16_bf16 v[64:79], v[232:235], v[192:195], v[64:79]
 v_exp_f32 v129, v129
 v_cvt_pk_bf16_f32 v183, v126, v127
 v_exp_f32 v130, v130
 v_exp_f32 v131, v131
 v_cvt_pk_bf16_f32 v184, v128, v129
 v_exp_f32 v132, v132
 v_mfma_f32_32x32x16_bf16 v[80:95], v[232:235], v[200:203], v[80:95]
 v_exp_f32 v133, v133
 v_cvt_pk_bf16_f32 v185, v130, v131
 v_exp_f32 v134, v134
 v_exp_f32 v135, v135
 v_cvt_pk_bf16_f32 v186, v132, v133
 v_exp_f32 v136, v136
 v_mfma_f32_32x32x16_bf16 v[64:79], v[236:239], v[196:199], v[64:79]
 v_exp_f32 v137, v137
 v_cvt_pk_bf16_f32 v187, v134, v135
 v_exp_f32 v138, v138
 v_exp_f32 v139, v139
 v_cvt_pk_bf16_f32 v188, v136, v137
 v_exp_f32 v140, v140
 v_mfma_f32_32x32x16_bf16 v[80:95], v[236:239], v[204:207], v[80:95]
 v_exp_f32 v141, v141
 v_cvt_pk_bf16_f32 v189, v138, v139
 v_exp_f32 v142, v142
 v_exp_f32 v143, v143
 v_cvt_pk_bf16_f32 v190, v140, v141
 s_waitcnt lgkmcnt(0)
 v_cvt_pk_bf16_f32 v191, v142, v143
 s_waitcnt vmcnt(0)
 v_and_b32 v240, v240, v241
 v_and_b32 v242, v242, v243
 v_and_b32 v240, v240, v242
 v_cmp_ne_u32 vcc, 1, v240
 s_cmp_lg_u64 vcc, 0
 s_cbranch_scc1 L_fbspin
L_fbok:
 s_cmp_lt_u32 s68, 2
 s_cbranch_scc0 L_o_two
 v_mfma_f32_32x32x16_bf16 v[112:127], v[208:211], v[96:99], v[32:47]
 ds_read_b128 v[216:219], v10 offset:7168
 ds_read_b32 v220, v11 offset:896
 s_add_u32 s57, s57, 20480
 s_cmp_eq_u32 s57, 61440
 s_cselect_b32 s57, 0, s57
 buffer_load_dwordx4 a[96:99], v14, s[36:39], s63 offen sc1
 v_exp_f32 v144, v144
 v_exp_f32 v145, v145
 v_exp_f32 v146, v146
 v_exp_f32 v147, v147
 v_cvt_pk_bf16_f32 v192, v144, v145
 v_exp_f32 v148, v148
 v_mfma_f32_32x32x16_bf16 v[128:143], v[208:211], v[104:107], v[48:63]
 ds_read_b128 v[232:235], v12 offset:6400
 ds_read_b128 v[236:239], v12 offset:7040
 buffer_load_dwordx4 a[100:103], v14, s[36:39], s64 offen sc1
 v_exp_f32 v149, v149
 v_cvt_pk_bf16_f32 v193, v146, v147
 v_exp_f32 v150, v150
 v_exp_f32 v151, v151
 v_cvt_pk_bf16_f32 v194, v148, v149
 v_exp_f32 v152, v152
 v_mfma_f32_32x32x16_bf16 v[112:127], v[212:215], v[100:103], v[112:127]
 buffer_load_dwordx4 a[104:107], v14, s[36:39], s65 offen sc1
 v_exp_f32 v153, v153
 v_cvt_pk_bf16_f32 v195, v150, v151
 v_exp_f32 v154, v154
 v_exp_f32 v155, v155
 v_cvt_pk_bf16_f32 v196, v152, v153
 v_exp_f32 v156, v156
 v_mfma_f32_32x32x16_bf16 v[128:143], v[212:215], v[108:111], v[128:143]
 buffer_load_dwordx4 a[108:111], v14, s[36:39], s65 offen offset:1024 sc1
 v_exp_f32 v157, v157
 v_cvt_pk_bf16_f32 v197, v154, v155
 v_exp_f32 v158, v158
 v_exp_f32 v159, v159
 v_cvt_pk_bf16_f32 v198, v156, v157
 v_exp_f32 v160, v160
 v_mfma_f32_32x32x16_bf16 v[64:79], v[224:227], v[176:179], v[64:79]
 buffer_load_dwordx4 a[112:115], v14, s[36:39], s65 offen offset:2048 sc1
 s_add_u32 s65, s65, 18432
 v_exp_f32 v161, v161
 v_cvt_pk_bf16_f32 v199, v158, v159
 v_exp_f32 v162, v162
 v_exp_f32 v163, v163
 v_cvt_pk_bf16_f32 v200, v160, v161
 v_exp_f32 v164, v164
 v_mfma_f32_32x32x16_bf16 v[80:95], v[224:227], v[184:187], v[80:95]
 buffer_load_dwordx4 a[116:119], v14, s[36:39], s63 offen offset:1024 sc1
 v_exp_f32 v165, v165
 v_cvt_pk_bf16_f32 v201, v162, v163
 v_exp_f32 v166, v166
 v_exp_f32 v167, v167
 v_cvt_pk_bf16_f32 v202, v164, v165
 v_exp_f32 v168, v168
 v_mfma_f32_32x32x16_bf16 v[64:79], v[228:231], v[180:183], v[64:79]
 buffer_load_dwordx4 a[120:123], v14, s[36:39], s64 offen offset:1024 sc1
 v_exp_f32 v169, v169
 v_cvt_pk_bf16_f32 v203, v166, v167
 v_exp_f32 v170, v170
 v_exp_f32 v171, v171
 v_cvt_pk_bf16_f32 v204, v168, v169
 v_exp_f32 v172, v172
 v_mfma_f32_32x32x16_bf16 v[80:95], v[228:231], v[188:191], v[80:95]
 v_exp_f32 v173, v173
 v_cvt_pk_bf16_f32 v205, v170, v171
 v_exp_f32 v174, v174
 v_exp_f32 v175, v175
 v_cvt_pk_bf16_f32 v206, v172, v173
 v_add_u32 v10, s57, v14
 v_add_u32 v11, s57, v20
 v_add_u32 v253, s57, v252
 s_waitcnt lgkmcnt(0)
 v_cvt_pk_bf16_f32 v207, v174, v175
 v_mfma_f32_32x32x16_bf16 v[144:159], v[216:219], v[96:99], v[32:47]
 ds_write_b128 v253, v[248:251]
 s_waitcnt lgkmcnt(0)
 s_barrier
 ds_read_b128 v[208:211], v10
 ds_read_b32 v212, v11
 v_exp_f32 v112, v112
 v_exp_f32 v113, v113
 v_exp_f32 v114, v114
 v_exp_f32 v115, v115
 v_cvt_pk_bf16_f32 v176, v112, v113
 v_exp_f32 v116, v116
 v_mfma_f32_32x32x16_bf16 v[160:175], v[216:219], v[104:107], v[48:63]
 ds_read_b128 v[224:227], v12 offset:7680
 ds_read_b128 v[228:231], v12 offset:8320
 s_add_u32 m0, s35, s58
 v_exp_f32 v117, v117
 v_cvt_pk_bf16_f32 v177, v114, v115
 v_exp_f32 v118, v118
 v_exp_f32 v119, v119
 v_cvt_pk_bf16_f32 v178, v116, v117
 v_exp_f32 v120, v120
 v_mfma_f32_32x32x16_bf16 v[144:159], v[220:223], v[100:103], v[144:159]
 buffer_load_dwordx4 v13, s[36:39], s56 offen sc1 lds
 v_exp_f32 v121, v121
 v_cvt_pk_bf16_f32 v179, v118, v119
 v_exp_f32 v122, v122
 v_exp_f32 v123, v123
 v_cvt_pk_bf16_f32 v180, v120, v121
 v_exp_f32 v124, v124
 v_mfma_f32_32x32x16_bf16 v[160:175], v[220:223], v[108:111], v[160:175]
 buffer_load_dwordx4 v13, s[36:39], s56 offen offset:1024 sc1 lds
 v_exp_f32 v125, v125
 v_cvt_pk_bf16_f32 v181, v122, v123
 v_exp_f32 v126, v126
 v_exp_f32 v127, v127
 v_cvt_pk_bf16_f32 v182, v124, v125
 v_exp_f32 v128, v128
 v_mfma_f32_32x32x16_bf16 v[64:79], v[232:235], v[192:195], v[64:79]
 buffer_load_dwordx4 a[124:127], v14, s[36:39], s65 offen sc1
 v_exp_f32 v129, v129
 v_cvt_pk_bf16_f32 v183, v126, v127
 v_exp_f32 v130, v130
 v_exp_f32 v131, v131
 v_cvt_pk_bf16_f32 v184, v128, v129
 v_exp_f32 v132, v132
 v_mfma_f32_32x32x16_bf16 v[80:95], v[232:235], v[200:203], v[80:95]
 buffer_load_dwordx4 a[128:131], v14, s[36:39], s65 offen offset:1024 sc1
 v_exp_f32 v133, v133
 v_cvt_pk_bf16_f32 v185, v130, v131
 v_exp_f32 v134, v134
 v_exp_f32 v135, v135
 v_cvt_pk_bf16_f32 v186, v132, v133
 v_exp_f32 v136, v136
 v_mfma_f32_32x32x16_bf16 v[64:79], v[236:239], v[196:199], v[64:79]
 buffer_load_dwordx4 a[132:135], v14, s[36:39], s65 offen offset:2048 sc1
 s_add_u32 s65, s65, 18432
 v_exp_f32 v137, v137
 v_cvt_pk_bf16_f32 v187, v134, v135
 v_exp_f32 v138, v138
 v_exp_f32 v139, v139
 v_cvt_pk_bf16_f32 v188, v136, v137
 v_exp_f32 v140, v140
 v_mfma_f32_32x32x16_bf16 v[80:95], v[236:239], v[204:207], v[80:95]
 buffer_load_dwordx4 a[136:139], v14, s[36:39], s63 offen offset:2048 sc1
 v_exp_f32 v141, v141
 v_cvt_pk_bf16_f32 v189, v138, v139
 v_exp_f32 v142, v142
 v_exp_f32 v143, v143
 v_cvt_pk_bf16_f32 v190, v140, v141
 s_waitcnt lgkmcnt(0)
 v_cvt_pk_bf16_f32 v191, v142, v143
 v_mfma_f32_32x32x16_bf16 v[112:127], v[208:211], v[96:99], v[32:47]
 ds_read_b128 v[216:219], v10 offset:1024
 ds_read_b32 v220, v11 offset:128
 buffer_load_dwordx4 a[140:143], v14, s[36:39], s64 offen offset:2048 sc1
 v_exp_f32 v144, v144
 v_exp_f32 v145, v145
 v_exp_f32 v146, v146
 v_exp_f32 v147, v147
 v_cvt_pk_bf16_f32 v192, v144, v145
 v_exp_f32 v148, v148
 v_mfma_f32_32x32x16_bf16 v[128:143], v[208:211], v[104:107], v[48:63]
 ds_read_b128 v[232:235], v12 offset:8960
 ds_read_b128 v[236:239], v12 offset:9600
 buffer_load_dwordx4 a[144:147], v14, s[36:39], s65 offen sc1
 v_exp_f32 v149, v149
 v_cvt_pk_bf16_f32 v193, v146, v147
 v_exp_f32 v150, v150
 v_exp_f32 v151, v151
 v_cvt_pk_bf16_f32 v194, v148, v149
 v_exp_f32 v152, v152
 v_mfma_f32_32x32x16_bf16 v[112:127], v[212:215], v[100:103], v[112:127]
 buffer_load_dwordx4 a[148:151], v14, s[36:39], s65 offen offset:1024 sc1
 v_exp_f32 v153, v153
 v_cvt_pk_bf16_f32 v195, v150, v151
 v_exp_f32 v154, v154
 v_exp_f32 v155, v155
 v_cvt_pk_bf16_f32 v196, v152, v153
 v_exp_f32 v156, v156
 v_mfma_f32_32x32x16_bf16 v[128:143], v[212:215], v[108:111], v[128:143]
 buffer_load_dwordx4 v13, s[36:39], s56 offen offset:2048 sc1 lds
 v_exp_f32 v157, v157
 v_cvt_pk_bf16_f32 v197, v154, v155
 v_exp_f32 v158, v158
 v_exp_f32 v159, v159
 v_cvt_pk_bf16_f32 v198, v156, v157
 v_exp_f32 v160, v160
 v_mfma_f32_32x32x16_bf16 v[64:79], v[224:227], v[176:179], v[64:79]
 buffer_load_dwordx4 v13, s[36:39], s56 offen offset:3072 sc1 lds
 s_add_u32 m0, m0, 4096
 s_add_u32 s56, s56, 4096
 v_exp_f32 v161, v161
 v_cvt_pk_bf16_f32 v199, v158, v159
 v_exp_f32 v162, v162
 v_exp_f32 v163, v163
 v_cvt_pk_bf16_f32 v200, v160, v161
 v_exp_f32 v164, v164
 v_mfma_f32_32x32x16_bf16 v[80:95], v[224:227], v[184:187], v[80:95]
 buffer_load_dwordx4 v13, s[36:39], s56 offen sc1 lds
 v_exp_f32 v165, v165
 v_cvt_pk_bf16_f32 v201, v162, v163
 v_exp_f32 v166, v166
 v_exp_f32 v167, v167
 v_cvt_pk_bf16_f32 v202, v164, v165
 v_exp_f32 v168, v168
 v_mfma_f32_32x32x16_bf16 v[64:79], v[228:231], v[180:183], v[64:79]
 s_add_u32 s56, s56, 16384
 s_add_u32 s35, s35, 20480
 s_cmp_eq_u32 s35, 61440
 s_cselect_b32 s35, 0, s35
 buffer_load_dwordx4 a[152:155], v14, s[36:39], s65 offen offset:2048 sc1
 s_add_u32 s65, s65, 18432
 v_exp_f32 v169, v169
 v_cvt_pk_bf16_f32 v203, v166, v167
 v_exp_f32 v170, v170
 v_exp_f32 v171, v171
 v_cvt_pk_bf16_f32 v204, v168, v169
 v_exp_f32 v172, v172
 v_mfma_f32_32x32x16_bf16 v[80:95], v[228:231], v[188:191], v[80:95]
 buffer_load_dwordx4 a[156:159], v14, s[36:39], s63 offen offset:3072 sc1
 s_add_u32 s63, s63, 4096
 v_exp_f32 v173, v173
 v_cvt_pk_bf16_f32 v205, v170, v171
 v_exp_f32 v174, v174
 v_exp_f32 v175, v175
 v_cvt_pk_bf16_f32 v206, v172, v173
 v_add_u32 v12, s57, v21
 s_waitcnt lgkmcnt(0)
 v_cvt_pk_bf16_f32 v207, v174, v175
 v_mfma_f32_32x32x16_bf16 v[144:159], v[216:219], v[96:99], v[32:47]
 ds_read_b128 v[208:211], v10 offset:2048
 ds_read_b32 v212, v11 offset:256
 buffer_load_dwordx4 a[160:163], v14, s[36:39], s64 offen offset:3072 sc1
 s_add_u32 s64, s64, 4096
 v_exp_f32 v112, v112
 v_exp_f32 v113, v113
 v_exp_f32 v114, v114
 v_exp_f32 v115, v115
 v_cvt_pk_bf16_f32 v176, v112, v113
 v_exp_f32 v116, v116
 v_mfma_f32_32x32x16_bf16 v[160:175], v[216:219], v[104:107], v[48:63]
 ds_read_b128 v[224:227], v12
 ds_read_b128 v[228:231], v12 offset:640
 buffer_load_dwordx4 a[164:167], v14, s[36:39], s65 offen sc1
 v_exp_f32 v117, v117
 v_cvt_pk_bf16_f32 v177, v114, v115
 v_exp_f32 v118, v118
 v_exp_f32 v119, v119
 v_cvt_pk_bf16_f32 v178, v116, v117
 v_exp_f32 v120, v120
 v_mfma_f32_32x32x16_bf16 v[144:159], v[220:223], v[100:103], v[144:159]
 buffer_load_dwordx4 a[168:171], v14, s[36:39], s65 offen offset:1024 sc1
 v_exp_f32 v121, v121
 v_cvt_pk_bf16_f32 v179, v118, v119
 v_exp_f32 v122, v122
 v_exp_f32 v123, v123
 v_cvt_pk_bf16_f32 v180, v120, v121
 v_exp_f32 v124, v124
 v_mfma_f32_32x32x16_bf16 v[160:175], v[220:223], v[108:111], v[160:175]
 buffer_load_dwordx4 a[172:175], v14, s[36:39], s65 offen offset:2048 sc1
 s_add_u32 s65, s65, 18432
 v_exp_f32 v125, v125
 v_cvt_pk_bf16_f32 v181, v122, v123
 v_exp_f32 v126, v126
 v_exp_f32 v127, v127
 v_cvt_pk_bf16_f32 v182, v124, v125
 v_exp_f32 v128, v128
 v_mfma_f32_32x32x16_bf16 v[64:79], v[232:235], v[192:195], v[64:79]
 buffer_load_dwordx4 a[176:179], v14, s[36:39], s63 offen sc1
 v_exp_f32 v129, v129
 v_cvt_pk_bf16_f32 v183, v126, v127
 v_exp_f32 v130, v130
 v_exp_f32 v131, v131
 v_cvt_pk_bf16_f32 v184, v128, v129
 v_exp_f32 v132, v132
 v_mfma_f32_32x32x16_bf16 v[80:95], v[232:235], v[200:203], v[80:95]
 buffer_load_dwordx4 a[180:183], v14, s[36:39], s64 offen sc1
 v_exp_f32 v133, v133
 v_cvt_pk_bf16_f32 v185, v130, v131
 v_exp_f32 v134, v134
 v_exp_f32 v135, v135
 v_cvt_pk_bf16_f32 v186, v132, v133
 v_exp_f32 v136, v136
 v_mfma_f32_32x32x16_bf16 v[64:79], v[236:239], v[196:199], v[64:79]
 buffer_load_dwordx4 a[184:187], v14, s[36:39], s65 offen sc1
 v_exp_f32 v137, v137
 v_cvt_pk_bf16_f32 v187, v134, v135
 v_exp_f32 v138, v138
 v_exp_f32 v139, v139
 v_cvt_pk_bf16_f32 v188, v136, v137
 v_exp_f32 v140, v140
 v_mfma_f32_32x32x16_bf16 v[80:95], v[236:239], v[204:207], v[80:95]
 buffer_load_dwordx4 a[188:191], v14, s[36:39], s65 offen offset:1024 sc1
 v_exp_f32 v141, v141
 v_cvt_pk_bf16_f32 v189, v138, v139
 v_exp_f32 v142, v142
 v_exp_f32 v143, v143
 v_cvt_pk_bf16_f32 v190, v140, v141
 s_waitcnt lgkmcnt(0)
 v_cvt_pk_bf16_f32 v191, v142, v143
 v_mfma_f32_32x32x16_bf16 v[112:127], v[208:211], v[96:99], v[32:47]
 ds_read_b128 v[216:219], v10 offset:3072
 ds_read_b32 v220, v11 offset:384
 buffer_load_dwordx4 a[192:195], v14, s[36:39], s65 offen offset:2048 sc1
 s_add_u32 s65, s65, 18432
 v_exp_f32 v144, v144
 v_exp_f32 v145, v145
 v_exp_f32 v146, v146
 v_exp_f32 v147, v147
 v_cvt_pk_bf16_f32 v192, v144, v145
 v_exp_f32 v148, v148
 v_mfma_f32_32x32x16_bf16 v[128:143], v[208:211], v[104:107], v[48:63]
 ds_read_b128 v[232:235], v12 offset:1280
 ds_read_b128 v[236:239], v12 offset:1920
 buffer_load_dwordx4 a[196:199], v14, s[36:39], s63 offen offset:1024 sc1
 v_exp_f32 v149, v149
 v_cvt_pk_bf16_f32 v193, v146, v147
 v_exp_f32 v150, v150
 v_exp_f32 v151, v151
 v_cvt_pk_bf16_f32 v194, v148, v149
 v_exp_f32 v152, v152
 v_mfma_f32_32x32x16_bf16 v[112:127], v[212:215], v[100:103], v[112:127]
 buffer_load_dwordx4 a[200:203], v14, s[36:39], s64 offen offset:1024 sc1
 v_exp_f32 v153, v153
 v_cvt_pk_bf16_f32 v195, v150, v151
 v_exp_f32 v154, v154
 v_exp_f32 v155, v155
 v_cvt_pk_bf16_f32 v196, v152, v153
 v_exp_f32 v156, v156
 v_mfma_f32_32x32x16_bf16 v[128:143], v[212:215], v[108:111], v[128:143]
 buffer_load_dwordx4 a[204:207], v14, s[36:39], s65 offen sc1
 v_exp_f32 v157, v157
 v_cvt_pk_bf16_f32 v197, v154, v155
 v_exp_f32 v158, v158
 v_exp_f32 v159, v159
 v_cvt_pk_bf16_f32 v198, v156, v157
 v_exp_f32 v160, v160
 v_mfma_f32_32x32x16_bf16 v[64:79], v[224:227], v[176:179], v[64:79]
 buffer_load_dwordx4 a[208:211], v14, s[36:39], s65 offen offset:1024 sc1
 v_exp_f32 v161, v161
 v_cvt_pk_bf16_f32 v199, v158, v159
 v_exp_f32 v162, v162
 v_exp_f32 v163, v163
 v_cvt_pk_bf16_f32 v200, v160, v161
 v_exp_f32 v164, v164
 v_mfma_f32_32x32x16_bf16 v[80:95], v[224:227], v[184:187], v[80:95]
 buffer_load_dwordx4 a[212:215], v14, s[36:39], s65 offen offset:2048 sc1
 s_add_u32 s65, s65, 18432
 v_exp_f32 v165, v165
 v_cvt_pk_bf16_f32 v201, v162, v163
 v_exp_f32 v166, v166
 v_exp_f32 v167, v167
 v_cvt_pk_bf16_f32 v202, v164, v165
 v_exp_f32 v168, v168
 v_mfma_f32_32x32x16_bf16 v[64:79], v[228:231], v[180:183], v[64:79]
 buffer_load_dwordx4 a[216:219], v14, s[36:39], s63 offen offset:2048 sc1
 v_exp_f32 v169, v169
 v_cvt_pk_bf16_f32 v203, v166, v167
 v_exp_f32 v170, v170
 v_exp_f32 v171, v171
 v_cvt_pk_bf16_f32 v204, v168, v169
 v_exp_f32 v172, v172
 v_mfma_f32_32x32x16_bf16 v[80:95], v[228:231], v[188:191], v[80:95]
 buffer_load_dwordx4 a[220:223], v14, s[36:39], s64 offen offset:2048 sc1
 v_exp_f32 v173, v173
 v_cvt_pk_bf16_f32 v205, v170, v171
 v_exp_f32 v174, v174
 v_exp_f32 v175, v175
 v_cvt_pk_bf16_f32 v206, v172, v173
 s_waitcnt lgkmcnt(0)
 v_cvt_pk_bf16_f32 v207, v174, v175
 v_mfma_f32_32x32x16_bf16 v[144:159], v[216:219], v[96:99], v[32:47]
 ds_read_b128 v[208:211], v10 offset:4096
 ds_read_b32 v212, v11 offset:512
 buffer_load_dwordx4 a[224:227], v14, s[36:39], s65 offen sc1
 v_exp_f32 v112, v112
 v_exp_f32 v113, v113
 v_exp_f32 v114, v114
 v_exp_f32 v115, v115
 v_cvt_pk_bf16_f32 v176, v112, v113
 v_exp_f32 v116, v116
 v_mfma_f32_32x32x16_bf16 v[160:175], v[216:219], v[104:107], v[48:63]
 ds_read_b128 v[224:227], v12 offset:2560
 ds_read_b128 v[228:231], v12 offset:3200
 buffer_load_dwordx4 a[228:231], v14, s[36:39], s65 offen offset:1024 sc1
 v_exp_f32 v117, v117
 v_cvt_pk_bf16_f32 v177, v114, v115
 v_exp_f32 v118, v118
 v_exp_f32 v119, v119
 v_cvt_pk_bf16_f32 v178, v116, v117
 v_exp_f32 v120, v120
 v_mfma_f32_32x32x16_bf16 v[144:159], v[220:223], v[100:103], v[144:159]
 buffer_load_dwordx4 a[232:235], v14, s[36:39], s65 offen offset:2048 sc1
 s_add_u32 s65, s65, 18432
 v_exp_f32 v121, v121
 v_cvt_pk_bf16_f32 v179, v118, v119
 v_exp_f32 v122, v122
 v_exp_f32 v123, v123
 v_cvt_pk_bf16_f32 v180, v120, v121
 v_exp_f32 v124, v124
 v_mfma_f32_32x32x16_bf16 v[160:175], v[220:223], v[108:111], v[160:175]
 buffer_load_dwordx4 a[236:239], v14, s[36:39], s63 offen offset:3072 sc1
 s_add_u32 s63, s63, 4096
 v_exp_f32 v125, v125
 v_cvt_pk_bf16_f32 v181, v122, v123
 v_exp_f32 v126, v126
 v_exp_f32 v127, v127
 v_cvt_pk_bf16_f32 v182, v124, v125
 v_exp_f32 v128, v128
 v_mfma_f32_32x32x16_bf16 v[64:79], v[232:235], v[192:195], v[64:79]
 buffer_load_dwordx4 a[240:243], v14, s[36:39], s64 offen offset:3072 sc1
 s_add_u32 s64, s64, 4096
 v_exp_f32 v129, v129
 v_cvt_pk_bf16_f32 v183, v126, v127
 v_exp_f32 v130, v130
 v_exp_f32 v131, v131
 v_cvt_pk_bf16_f32 v184, v128, v129
 v_exp_f32 v132, v132
 v_mfma_f32_32x32x16_bf16 v[80:95], v[232:235], v[200:203], v[80:95]
 buffer_load_dwordx4 a[244:247], v14, s[36:39], s65 offen sc1
 v_exp_f32 v133, v133
 v_cvt_pk_bf16_f32 v185, v130, v131
 v_exp_f32 v134, v134
 v_exp_f32 v135, v135
 v_cvt_pk_bf16_f32 v186, v132, v133
 v_exp_f32 v136, v136
 v_mfma_f32_32x32x16_bf16 v[64:79], v[236:239], v[196:199], v[64:79]
 buffer_load_dwordx4 a[248:251], v14, s[36:39], s65 offen offset:1024 sc1
 v_exp_f32 v137, v137
 v_cvt_pk_bf16_f32 v187, v134, v135
 v_exp_f32 v138, v138
 v_exp_f32 v139, v139
 v_cvt_pk_bf16_f32 v188, v136, v137
 v_exp_f32 v140, v140
 v_mfma_f32_32x32x16_bf16 v[80:95], v[236:239], v[204:207], v[80:95]
 buffer_load_dwordx4 a[252:255], v14, s[36:39], s65 offen offset:2048 sc1
 s_add_u32 s65, s65, 18432
 v_exp_f32 v141, v141
 v_cvt_pk_bf16_f32 v189, v138, v139
 v_exp_f32 v142, v142
 v_exp_f32 v143, v143
 v_cvt_pk_bf16_f32 v190, v140, v141
 s_waitcnt lgkmcnt(0)
 v_cvt_pk_bf16_f32 v191, v142, v143
 v_mfma_f32_32x32x16_bf16 v[112:127], v[208:211], v[96:99], v[32:47]
 ds_read_b128 v[216:219], v10 offset:5120
 ds_read_b32 v220, v11 offset:640
 v_exp_f32 v144, v144
 v_exp_f32 v145, v145
 v_exp_f32 v146, v146
 v_mfma_f32_32x32x16_bf16 v[128:143], v[208:211], v[104:107], v[48:63]
 ds_read_b128 v[232:235], v12 offset:3840
 ds_read_b128 v[236:239], v12 offset:4480
 v_exp_f32 v147, v147
 v_cvt_pk_bf16_f32 v192, v144, v145
 v_exp_f32 v148, v148
 v_exp_f32 v149, v149
 s_waitcnt vmcnt(40)
 v_mfma_f32_32x32x16_bf16 a[0:15], a[104:107], a[96:99], 0
 v_cvt_pk_bf16_f32 v193, v146, v147
 v_exp_f32 v150, v150
 v_exp_f32 v151, v151
 v_mfma_f32_32x32x16_bf16 v[112:127], v[212:215], v[100:103], v[112:127]
 v_cvt_pk_bf16_f32 v194, v148, v149
 v_exp_f32 v152, v152
 v_exp_f32 v153, v153
 v_mfma_f32_32x32x16_bf16 a[16:31], a[104:107], a[100:103], 0
 v_cvt_pk_bf16_f32 v195, v150, v151
 v_exp_f32 v154, v154
 v_exp_f32 v155, v155
 v_cvt_pk_bf16_f32 v196, v152, v153
 v_mfma_f32_32x32x16_bf16 v[128:143], v[212:215], v[108:111], v[128:143]
 v_exp_f32 v156, v156
 v_exp_f32 v157, v157
 v_cvt_pk_bf16_f32 v197, v154, v155
 v_mfma_f32_32x32x16_bf16 a[32:47], a[108:111], a[96:99], 0
 v_exp_f32 v158, v158
 v_exp_f32 v159, v159
 v_cvt_pk_bf16_f32 v198, v156, v157
 v_exp_f32 v160, v160
 v_mfma_f32_32x32x16_bf16 v[64:79], v[224:227], v[176:179], v[64:79]
 v_exp_f32 v161, v161
 v_cvt_pk_bf16_f32 v199, v158, v159
 v_exp_f32 v162, v162
 v_mfma_f32_32x32x16_bf16 v[80:95], v[224:227], v[184:187], v[80:95]
 v_exp_f32 v163, v163
 v_cvt_pk_bf16_f32 v200, v160, v161
 v_exp_f32 v164, v164
 v_mfma_f32_32x32x16_bf16 a[48:63], a[108:111], a[100:103], 0
 v_exp_f32 v165, v165
 v_cvt_pk_bf16_f32 v201, v162, v163
 v_exp_f32 v166, v166
 v_exp_f32 v167, v167
 v_mfma_f32_32x32x16_bf16 v[64:79], v[228:231], v[180:183], v[64:79]
 v_cvt_pk_bf16_f32 v202, v164, v165
 v_exp_f32 v168, v168
 v_exp_f32 v169, v169
 v_mfma_f32_32x32x16_bf16 a[64:79], a[112:115], a[96:99], 0
 v_cvt_pk_bf16_f32 v203, v166, v167
 v_exp_f32 v170, v170
 v_exp_f32 v171, v171
 v_mfma_f32_32x32x16_bf16 v[80:95], v[228:231], v[188:191], v[80:95]
 v_cvt_pk_bf16_f32 v204, v168, v169
 v_exp_f32 v172, v172
 v_exp_f32 v173, v173
 v_cvt_pk_bf16_f32 v205, v170, v171
 v_mfma_f32_32x32x16_bf16 a[80:95], a[112:115], a[100:103], 0
 buffer_load_dwordx4 a[96:99], v14, s[36:39], s63 offen sc1
 v_exp_f32 v174, v174
 v_exp_f32 v175, v175
 v_cvt_pk_bf16_f32 v206, v172, v173
 s_waitcnt lgkmcnt(0)
 v_cvt_pk_bf16_f32 v207, v174, v175
 v_mfma_f32_32x32x16_bf16 v[144:159], v[216:219], v[96:99], v[32:47]
 ds_read_b128 v[208:211], v10 offset:6144
 ds_read_b32 v212, v11 offset:768
 v_exp_f32 v112, v112
 v_exp_f32 v113, v113
 v_exp_f32 v114, v114
 v_mfma_f32_32x32x16_bf16 v[160:175], v[216:219], v[104:107], v[48:63]
 ds_read_b128 v[224:227], v12 offset:5120
 ds_read_b128 v[228:231], v12 offset:5760
 buffer_load_dwordx4 a[100:103], v14, s[36:39], s64 offen sc1
 v_exp_f32 v115, v115
 v_cvt_pk_bf16_f32 v176, v112, v113
 v_exp_f32 v116, v116
 v_exp_f32 v117, v117
 s_waitcnt vmcnt(35)
 v_mfma_f32_32x32x16_bf16 a[0:15], a[124:127], a[116:119], a[0:15]
 v_cvt_pk_bf16_f32 v177, v114, v115
 v_exp_f32 v118, v118
 v_exp_f32 v119, v119
 v_mfma_f32_32x32x16_bf16 v[144:159], v[220:223], v[100:103], v[144:159]
 buffer_load_dwordx4 a[104:107], v14, s[36:39], s65 offen sc1
 v_cvt_pk_bf16_f32 v178, v116, v117
 v_exp_f32 v120, v120
 v_exp_f32 v121, v121
 v_mfma_f32_32x32x16_bf16 a[16:31], a[124:127], a[120:123], a[16:31]
 v_cvt_pk_bf16_f32 v179, v118, v119
 v_exp_f32 v122, v122
 v_exp_f32 v123, v123
 v_cvt_pk_bf16_f32 v180, v120, v121
 v_mfma_f32_32x32x16_bf16 v[160:175], v[220:223], v[108:111], v[160:175]
 buffer_load_dwordx4 a[108:111], v14, s[36:39], s65 offen offset:1024 sc1
 v_exp_f32 v124, v124
 v_exp_f32 v125, v125
 v_cvt_pk_bf16_f32 v181, v122, v123
 v_mfma_f32_32x32x16_bf16 a[32:47], a[128:131], a[116:119], a[32:47]
 v_exp_f32 v126, v126
 v_exp_f32 v127, v127
 v_cvt_pk_bf16_f32 v182, v124, v125
 v_exp_f32 v128, v128
 v_mfma_f32_32x32x16_bf16 v[64:79], v[232:235], v[192:195], v[64:79]
 buffer_load_dwordx4 a[112:115], v14, s[36:39], s65 offen offset:2048 sc1
 s_add_u32 s65, s65, 18432
 v_exp_f32 v129, v129
 v_cvt_pk_bf16_f32 v183, v126, v127
 v_exp_f32 v130, v130
 v_mfma_f32_32x32x16_bf16 v[80:95], v[232:235], v[200:203], v[80:95]
 v_exp_f32 v131, v131
 v_cvt_pk_bf16_f32 v184, v128, v129
 v_exp_f32 v132, v132
 v_mfma_f32_32x32x16_bf16 a[48:63], a[128:131], a[120:123], a[48:63]
 v_exp_f32 v133, v133
 v_cvt_pk_bf16_f32 v185, v130, v131
 v_exp_f32 v134, v134
 v_exp_f32 v135, v135
 v_mfma_f32_32x32x16_bf16 v[64:79], v[236:239], v[196:199], v[64:79]
 v_cvt_pk_bf16_f32 v186, v132, v133
 v_exp_f32 v136, v136
 v_exp_f32 v137, v137
 v_mfma_f32_32x32x16_bf16 a[64:79], a[132:135], a[116:119], a[64:79]
 v_cvt_pk_bf16_f32 v187, v134, v135
 v_exp_f32 v138, v138
 v_exp_f32 v139, v139
 v_mfma_f32_32x32x16_bf16 v[80:95], v[236:239], v[204:207], v[80:95]
 v_cvt_pk_bf16_f32 v188, v136, v137
 v_exp_f32 v140, v140
 v_exp_f32 v141, v141
 v_cvt_pk_bf16_f32 v189, v138, v139
 v_mfma_f32_32x32x16_bf16 a[80:95], a[132:135], a[120:123], a[80:95]
 buffer_load_dwordx4 a[116:119], v14, s[36:39], s63 offen offset:1024 sc1
 v_exp_f32 v142, v142
 v_exp_f32 v143, v143
 v_cvt_pk_bf16_f32 v190, v140, v141
 s_waitcnt lgkmcnt(0)
 v_cvt_pk_bf16_f32 v191, v142, v143
 v_mfma_f32_32x32x16_bf16 v[112:127], v[208:211], v[96:99], v[32:47]
 ds_read_b128 v[216:219], v10 offset:7168
 ds_read_b32 v220, v11 offset:896
 v_exp_f32 v144, v144
 v_exp_f32 v145, v145
 v_exp_f32 v146, v146
 v_mfma_f32_32x32x16_bf16 v[128:143], v[208:211], v[104:107], v[48:63]
 ds_read_b128 v[232:235], v12 offset:6400
 ds_read_b128 v[236:239], v12 offset:7040
 s_add_u32 s57, s57, 20480
 s_cmp_eq_u32 s57, 61440
 s_cselect_b32 s57, 0, s57
 buffer_load_dwordx4 a[120:123], v14, s[36:39], s64 offen offset:1024 sc1
 v_exp_f32 v147, v147
 v_cvt_pk_bf16_f32 v192, v144, v145
 v_exp_f32 v148, v148
 v_exp_f32 v149, v149
 s_waitcnt vmcnt(32)
 v_mfma_f32_32x32x16_bf16 a[0:15], a[144:147], a[136:139], a[0:15]
 v_cvt_pk_bf16_f32 v193, v146, v147
 v_exp_f32 v150, v150
 v_exp_f32 v151, v151
 v_mfma_f32_32x32x16_bf16 v[112:127], v[212:215], v[100:103], v[112:127]
 buffer_load_dwordx4 a[124:127], v14, s[36:39], s65 offen sc1
 v_cvt_pk_bf16_f32 v194, v148, v149
 v_exp_f32 v152, v152
 v_exp_f32 v153, v153
 v_mfma_f32_32x32x16_bf16 a[16:31], a[144:147], a[140:143], a[16:31]
 v_cvt_pk_bf16_f32 v195, v150, v151
 v_exp_f32 v154, v154
 v_exp_f32 v155, v155
 v_cvt_pk_bf16_f32 v196, v152, v153
 v_mfma_f32_32x32x16_bf16 v[128:143], v[212:215], v[108:111], v[128:143]
 buffer_load_dwordx4 a[128:131], v14, s[36:39], s65 offen offset:1024 sc1
 v_exp_f32 v156, v156
 v_exp_f32 v157, v157
 v_cvt_pk_bf16_f32 v197, v154, v155
 v_mfma_f32_32x32x16_bf16 a[32:47], a[148:151], a[136:139], a[32:47]
 v_exp_f32 v158, v158
 v_exp_f32 v159, v159
 v_cvt_pk_bf16_f32 v198, v156, v157
 v_exp_f32 v160, v160
 v_mfma_f32_32x32x16_bf16 v[64:79], v[224:227], v[176:179], v[64:79]
 buffer_load_dwordx4 a[132:135], v14, s[36:39], s65 offen offset:2048 sc1
 s_add_u32 s65, s65, 18432
 v_exp_f32 v161, v161
 v_cvt_pk_bf16_f32 v199, v158, v159
 v_exp_f32 v162, v162
 v_mfma_f32_32x32x16_bf16 v[80:95], v[224:227], v[184:187], v[80:95]
 v_exp_f32 v163, v163
 v_cvt_pk_bf16_f32 v200, v160, v161
 v_exp_f32 v164, v164
 v_mfma_f32_32x32x16_bf16 a[48:63], a[148:151], a[140:143], a[48:63]
 v_exp_f32 v165, v165
 v_cvt_pk_bf16_f32 v201, v162, v163
 v_exp_f32 v166, v166
 v_exp_f32 v167, v167
 v_mfma_f32_32x32x16_bf16 v[64:79], v[228:231], v[180:183], v[64:79]
 v_cvt_pk_bf16_f32 v202, v164, v165
 v_exp_f32 v168, v168
 v_exp_f32 v169, v169
 v_mfma_f32_32x32x16_bf16 a[64:79], a[152:155], a[136:139], a[64:79]
 v_cvt_pk_bf16_f32 v203, v166, v167
 v_exp_f32 v170, v170
 v_exp_f32 v171, v171
 v_mfma_f32_32x32x16_bf16 v[80:95], v[228:231], v[188:191], v[80:95]
 v_cvt_pk_bf16_f32 v204, v168, v169
 v_exp_f32 v172, v172
 v_exp_f32 v173, v173
 v_cvt_pk_bf16_f32 v205, v170, v171
 v_mfma_f32_32x32x16_bf16 a[80:95], a[152:155], a[140:143], a[80:95]
 buffer_load_dwordx4 a[136:139], v14, s[36:39], s63 offen offset:2048 sc1
 v_exp_f32 v174, v174
 v_exp_f32 v175, v175
 v_cvt_pk_bf16_f32 v206, v172, v173
 v_add_u32 v10, s57, v14
 v_add_u32 v11, s57, v20
 v_add_u32 v253, s57, v252
 s_waitcnt lgkmcnt(0)
 v_cvt_pk_bf16_f32 v207, v174, v175
 v_mfma_f32_32x32x16_bf16 v[144:159], v[216:219], v[96:99], v[32:47]
 s_waitcnt vmcnt(37)
 ds_write_b128 v253, v[248:251]
 s_waitcnt lgkmcnt(0)
 s_barrier
 ds_read_b128 v[208:211], v10
 ds_read_b32 v212, v11
 v_exp_f32 v112, v112
 v_exp_f32 v113, v113
 v_exp_f32 v114, v114
 v_mfma_f32_32x32x16_bf16 v[160:175], v[216:219], v[104:107], v[48:63]
 ds_read_b128 v[224:227], v12 offset:7680
 ds_read_b128 v[228:231], v12 offset:8320
 buffer_load_dwordx4 a[140:143], v14, s[36:39], s64 offen offset:2048 sc1
 v_exp_f32 v115, v115
 v_cvt_pk_bf16_f32 v176, v112, v113
 v_exp_f32 v116, v116
 v_exp_f32 v117, v117
 s_waitcnt vmcnt(32)
 v_mfma_f32_32x32x16_bf16 a[0:15], a[164:167], a[156:159], a[0:15]
 v_cvt_pk_bf16_f32 v177, v114, v115
 v_exp_f32 v118, v118
 v_exp_f32 v119, v119
 v_mfma_f32_32x32x16_bf16 v[144:159], v[220:223], v[100:103], v[144:159]
 buffer_load_dwordx4 a[144:147], v14, s[36:39], s65 offen sc1
 v_cvt_pk_bf16_f32 v178, v116, v117
 v_exp_f32 v120, v120
 v_exp_f32 v121, v121
 v_mfma_f32_32x32x16_bf16 a[16:31], a[164:167], a[160:163], a[16:31]
 v_cvt_pk_bf16_f32 v179, v118, v119
 v_exp_f32 v122, v122
 v_exp_f32 v123, v123
 v_cvt_pk_bf16_f32 v180, v120, v121
 v_mfma_f32_32x32x16_bf16 v[160:175], v[220:223], v[108:111], v[160:175]
 buffer_load_dwordx4 a[148:151], v14, s[36:39], s65 offen offset:1024 sc1
 v_exp_f32 v124, v124
 v_exp_f32 v125, v125
 v_cvt_pk_bf16_f32 v181, v122, v123
 v_mfma_f32_32x32x16_bf16 a[32:47], a[168:171], a[156:159], a[32:47]
 v_exp_f32 v126, v126
 v_exp_f32 v127, v127
 v_cvt_pk_bf16_f32 v182, v124, v125
 v_exp_f32 v128, v128
 v_mfma_f32_32x32x16_bf16 v[64:79], v[232:235], v[192:195], v[64:79]
 buffer_load_dwordx4 a[152:155], v14, s[36:39], s65 offen offset:2048 sc1
 s_add_u32 s65, s65, 18432
 v_exp_f32 v129, v129
 v_cvt_pk_bf16_f32 v183, v126, v127
 v_exp_f32 v130, v130
 v_mfma_f32_32x32x16_bf16 v[80:95], v[232:235], v[200:203], v[80:95]
 v_exp_f32 v131, v131
 v_cvt_pk_bf16_f32 v184, v128, v129
 v_exp_f32 v132, v132
 v_mfma_f32_32x32x16_bf16 a[48:63], a[168:171], a[160:163], a[48:63]
 s_add_u32 m0, s35, s58
 v_exp_f32 v133, v133
 v_cvt_pk_bf16_f32 v185, v130, v131
 v_exp_f32 v134, v134
 v_exp_f32 v135, v135
 v_mfma_f32_32x32x16_bf16 v[64:79], v[236:239], v[196:199], v[64:79]
 buffer_load_dwordx4 v13, s[36:39], s56 offen sc1 lds
 v_cvt_pk_bf16_f32 v186, v132, v133
 v_exp_f32 v136, v136
 v_exp_f32 v137, v137
 v_mfma_f32_32x32x16_bf16 a[64:79], a[172:175], a[156:159], a[64:79]
 v_cvt_pk_bf16_f32 v187, v134, v135
 v_exp_f32 v138, v138
 v_exp_f32 v139, v139
 v_mfma_f32_32x32x16_bf16 v[80:95], v[236:239], v[204:207], v[80:95]
 buffer_load_dwordx4 v13, s[36:39], s56 offen offset:1024 sc1 lds
 v_cvt_pk_bf16_f32 v188, v136, v137
 v_exp_f32 v140, v140
 v_exp_f32 v141, v141
 v_cvt_pk_bf16_f32 v189, v138, v139
 v_mfma_f32_32x32x16_bf16 a[80:95], a[172:175], a[160:163], a[80:95]
 v_exp_f32 v142, v142
 v_exp_f32 v143, v143
 v_cvt_pk_bf16_f32 v190, v140, v141
 s_waitcnt lgkmcnt(0)
 v_cvt_pk_bf16_f32 v191, v142, v143
 v_mfma_f32_32x32x16_bf16 v[112:127], v[208:211], v[96:99], v[32:47]
 ds_read_b128 v[216:219], v10 offset:1024
 ds_read_b32 v220, v11 offset:128
 buffer_load_dwordx4 a[156:159], v14, s[36:39], s63 offen offset:3072 sc1
 s_add_u32 s63, s63, 4096
 v_exp_f32 v144, v144
 v_exp_f32 v145, v145
 v_exp_f32 v146, v146
 v_mfma_f32_32x32x16_bf16 v[128:143], v[208:211], v[104:107], v[48:63]
 ds_read_b128 v[232:235], v12 offset:8960
 ds_read_b128 v[236:239], v12 offset:9600
 v_exp_f32 v147, v147
 v_cvt_pk_bf16_f32 v192, v144, v145
 v_exp_f32 v148, v148
 v_exp_f32 v149, v149
 s_waitcnt vmcnt(33)
 v_mfma_f32_32x32x16_bf16 a[0:15], a[184:187], a[176:179], a[0:15]
 buffer_load_dwordx4 a[160:163], v14, s[36:39], s64 offen offset:3072 sc1
 s_add_u32 s64, s64, 4096
 v_cvt_pk_bf16_f32 v193, v146, v147
 v_exp_f32 v150, v150
 v_exp_f32 v151, v151
 v_mfma_f32_32x32x16_bf16 v[112:127], v[212:215], v[100:103], v[112:127]
 v_cvt_pk_bf16_f32 v194, v148, v149
 v_exp_f32 v152, v152
 v_exp_f32 v153, v153
 v_mfma_f32_32x32x16_bf16 a[16:31], a[184:187], a[180:183], a[16:31]
 buffer_load_dwordx4 a[164:167], v14, s[36:39], s65 offen sc1
 v_cvt_pk_bf16_f32 v195, v150, v151
 v_exp_f32 v154, v154
 v_exp_f32 v155, v155
 v_cvt_pk_bf16_f32 v196, v152, v153
 v_mfma_f32_32x32x16_bf16 v[128:143], v[212:215], v[108:111], v[128:143]
 v_exp_f32 v156, v156
 v_exp_f32 v157, v157
 v_cvt_pk_bf16_f32 v197, v154, v155
 v_mfma_f32_32x32x16_bf16 a[32:47], a[188:191], a[176:179], a[32:47]
 buffer_load_dwordx4 a[168:171], v14, s[36:39], s65 offen offset:1024 sc1
 v_exp_f32 v158, v158
 v_exp_f32 v159, v159
 v_cvt_pk_bf16_f32 v198, v156, v157
 v_exp_f32 v160, v160
 v_mfma_f32_32x32x16_bf16 v[64:79], v[224:227], v[176:179], v[64:79]
 v_exp_f32 v161, v161
 v_cvt_pk_bf16_f32 v199, v158, v159
 v_exp_f32 v162, v162
 v_mfma_f32_32x32x16_bf16 v[80:95], v[224:227], v[184:187], v[80:95]
 buffer_load_dwordx4 a[172:175], v14, s[36:39], s65 offen offset:2048 sc1
 s_add_u32 s65, s65, 18432
 v_exp_f32 v163, v163
 v_cvt_pk_bf16_f32 v200, v160, v161
 v_exp_f32 v164, v164
 v_mfma_f32_32x32x16_bf16 a[48:63], a[188:191], a[180:183], a[48:63]
 v_exp_f32 v165, v165
 v_cvt_pk_bf16_f32 v201, v162, v163
 v_exp_f32 v166, v166
 v_exp_f32 v167, v167
 v_mfma_f32_32x32x16_bf16 v[64:79], v[228:231], v[180:183], v[64:79]
 buffer_load_dwordx4 v13, s[36:39], s56 offen offset:2048 sc1 lds
 v_cvt_pk_bf16_f32 v202, v164, v165
 v_exp_f32 v168, v168
 v_exp_f32 v169, v169
 v_mfma_f32_32x32x16_bf16 a[64:79], a[192:195], a[176:179], a[64:79]
 v_cvt_pk_bf16_f32 v203, v166, v167
 v_exp_f32 v170, v170
 v_exp_f32 v171, v171
 v_mfma_f32_32x32x16_bf16 v[80:95], v[228:231], v[188:191], v[80:95]
 buffer_load_dwordx4 v13, s[36:39], s56 offen offset:3072 sc1 lds
 s_add_u32 m0, m0, 4096
 s_add_u32 s56, s56, 4096
 v_cvt_pk_bf16_f32 v204, v168, v169
 v_exp_f32 v172, v172
 v_exp_f32 v173, v173
 v_cvt_pk_bf16_f32 v205, v170, v171
 v_mfma_f32_32x32x16_bf16 a[80:95], a[192:195], a[180:183], a[80:95]
 v_exp_f32 v174, v174
 v_exp_f32 v175, v175
 v_cvt_pk_bf16_f32 v206, v172, v173
 v_add_u32 v12, s57, v21
 s_waitcnt lgkmcnt(0)
 v_cvt_pk_bf16_f32 v207, v174, v175
 v_mfma_f32_32x32x16_bf16 v[144:159], v[216:219], v[96:99], v[32:47]
 ds_read_b128 v[208:211], v10 offset:2048
 ds_read_b32 v212, v11 offset:256
 buffer_load_dwordx4 v13, s[36:39], s56 offen sc1 lds
 v_exp_f32 v112, v112
 v_exp_f32 v113, v113
 v_exp_f32 v114, v114
 v_mfma_f32_32x32x16_bf16 v[160:175], v[216:219], v[104:107], v[48:63]
 ds_read_b128 v[224:227], v12
 ds_read_b128 v[228:231], v12 offset:640
 v_exp_f32 v115, v115
 v_cvt_pk_bf16_f32 v176, v112, v113
 v_exp_f32 v116, v116
 v_exp_f32 v117, v117
 s_waitcnt vmcnt(35)
 v_mfma_f32_32x32x16_bf16 a[0:15], a[204:207], a[196:199], a[0:15]
 s_add_u32 s56, s56, 16384
 s_add_u32 s35, s35, 20480
 s_cmp_eq_u32 s35, 61440
 s_cselect_b32 s35, 0, s35
 buffer_load_dwordx4 a[176:179], v14, s[36:39], s63 offen sc1
 v_cvt_pk_bf16_f32 v177, v114, v115
 v_exp_f32 v118, v118
 v_exp_f32 v119, v119
 v_mfma_f32_32x32x16_bf16 v[144:159], v[220:223], v[100:103], v[144:159]
 v_cvt_pk_bf16_f32 v178, v116, v117
 v_exp_f32 v120, v120
 v_exp_f32 v121, v121
 v_mfma_f32_32x32x16_bf16 a[16:31], a[204:207], a[200:203], a[16:31]
 buffer_load_dwordx4 a[180:183], v14, s[36:39], s64 offen sc1
 v_cvt_pk_bf16_f32 v179, v118, v119
 v_exp_f32 v122, v122
 v_exp_f32 v123, v123
 v_cvt_pk_bf16_f32 v180, v120, v121
 v_mfma_f32_32x32x16_bf16 v[160:175], v[220:223], v[108:111], v[160:175]
 v_exp_f32 v124, v124
 v_exp_f32 v125, v125
 v_cvt_pk_bf16_f32 v181, v122, v123
 v_mfma_f32_32x32x16_bf16 a[32:47], a[208:211], a[196:199], a[32:47]
 buffer_load_dwordx4 a[184:187], v14, s[36:39], s65 offen sc1
 v_exp_f32 v126, v126
 v_exp_f32 v127, v127
 v_cvt_pk_bf16_f32 v182, v124, v125
 v_exp_f32 v128, v128
 v_mfma_f32_32x32x16_bf16 v[64:79], v[232:235], v[192:195], v[64:79]
 v_exp_f32 v129, v129
 v_cvt_pk_bf16_f32 v183, v126, v127
 v_exp_f32 v130, v130
 v_mfma_f32_32x32x16_bf16 v[80:95], v[232:235], v[200:203], v[80:95]
 buffer_load_dwordx4 a[188:191], v14, s[36:39], s65 offen offset:1024 sc1
 v_exp_f32 v131, v131
 v_cvt_pk_bf16_f32 v184, v128, v129
 v_exp_f32 v132, v132
 v_mfma_f32_32x32x16_bf16 a[48:63], a[208:211], a[200:203], a[48:63]
 v_exp_f32 v133, v133
 v_cvt_pk_bf16_f32 v185, v130, v131
 v_exp_f32 v134, v134
 v_exp_f32 v135, v135
 v_mfma_f32_32x32x16_bf16 v[64:79], v[236:239], v[196:199], v[64:79]
 buffer_load_dwordx4 a[192:195], v14, s[36:39], s65 offen offset:2048 sc1
 s_add_u32 s65, s65, 18432
 v_cvt_pk_bf16_f32 v186, v132, v133
 v_exp_f32 v136, v136
 v_exp_f32 v137, v137
 v_mfma_f32_32x32x16_bf16 a[64:79], a[212:215], a[196:199], a[64:79]
 v_cvt_pk_bf16_f32 v187, v134, v135
 v_exp_f32 v138, v138
 v_exp_f32 v139, v139
 v_mfma_f32_32x32x16_bf16 v[80:95], v[236:239], v[204:207], v[80:95]
 v_cvt_pk_bf16_f32 v188, v136, v137
 v_exp_f32 v140, v140
 v_exp_f32 v141, v141
 v_cvt_pk_bf16_f32 v189, v138, v139
 v_mfma_f32_32x32x16_bf16 a[80:95], a[212:215], a[200:203], a[80:95]
 buffer_load_dwordx4 a[196:199], v14, s[36:39], s63 offen offset:1024 sc1
 v_exp_f32 v142, v142
 v_exp_f32 v143, v143
 v_cvt_pk_bf16_f32 v190, v140, v141
 s_waitcnt lgkmcnt(0)
 v_cvt_pk_bf16_f32 v191, v142, v143
 v_mfma_f32_32x32x16_bf16 v[112:127], v[208:211], v[96:99], v[32:47]
 ds_read_b128 v[216:219], v10 offset:3072
 ds_read_b32 v220, v11 offset:384
 v_exp_f32 v144, v144
 v_exp_f32 v145, v145
 v_exp_f32 v146, v146
 v_mfma_f32_32x32x16_bf16 v[128:143], v[208:211], v[104:107], v[48:63]
 ds_read_b128 v[232:235], v12 offset:1280
 ds_read_b128 v[236:239], v12 offset:1920
 buffer_load_dwordx4 a[200:203], v14, s[36:39], s64 offen offset:1024 sc1
 v_exp_f32 v147, v147
 v_cvt_pk_bf16_f32 v192, v144, v145
 v_exp_f32 v148, v148
 v_exp_f32 v149, v149
 s_waitcnt vmcnt(37)
 v_mfma_f32_32x32x16_bf16 a[0:15], a[224:227], a[216:219], a[0:15]
 v_cvt_pk_bf16_f32 v193, v146, v147
 v_exp_f32 v150, v150
 v_exp_f32 v151, v151
 v_mfma_f32_32x32x16_bf16 v[112:127], v[212:215], v[100:103], v[112:127]
 buffer_load_dwordx4 a[204:207], v14, s[36:39], s65 offen sc1
 v_cvt_pk_bf16_f32 v194, v148, v149
 v_exp_f32 v152, v152
 v_exp_f32 v153, v153
 v_mfma_f32_32x32x16_bf16 a[16:31], a[224:227], a[220:223], a[16:31]
 v_cvt_pk_bf16_f32 v195, v150, v151
 v_exp_f32 v154, v154
 v_exp_f32 v155, v155
 v_cvt_pk_bf16_f32 v196, v152, v153
 v_mfma_f32_32x32x16_bf16 v[128:143], v[212:215], v[108:111], v[128:143]
 buffer_load_dwordx4 a[208:211], v14, s[36:39], s65 offen offset:1024 sc1
 v_exp_f32 v156, v156
 v_exp_f32 v157, v157
 v_cvt_pk_bf16_f32 v197, v154, v155
 v_mfma_f32_32x32x16_bf16 a[32:47], a[228:231], a[216:219], a[32:47]
 v_exp_f32 v158, v158
 v_exp_f32 v159, v159
 v_cvt_pk_bf16_f32 v198, v156, v157
 v_exp_f32 v160, v160
 v_mfma_f32_32x32x16_bf16 v[64:79], v[224:227], v[176:179], v[64:79]
 buffer_load_dwordx4 a[212:215], v14, s[36:39], s65 offen offset:2048 sc1
 s_add_u32 s65, s65, 18432
 v_exp_f32 v161, v161
 v_cvt_pk_bf16_f32 v199, v158, v159
 v_exp_f32 v162, v162
 v_mfma_f32_32x32x16_bf16 v[80:95], v[224:227], v[184:187], v[80:95]
 v_exp_f32 v163, v163
 v_cvt_pk_bf16_f32 v200, v160, v161
 v_exp_f32 v164, v164
 v_mfma_f32_32x32x16_bf16 a[48:63], a[228:231], a[220:223], a[48:63]
 v_exp_f32 v165, v165
 v_cvt_pk_bf16_f32 v201, v162, v163
 v_exp_f32 v166, v166
 v_exp_f32 v167, v167
 v_mfma_f32_32x32x16_bf16 v[64:79], v[228:231], v[180:183], v[64:79]
 v_cvt_pk_bf16_f32 v202, v164, v165
 v_exp_f32 v168, v168
 v_exp_f32 v169, v169
 v_mfma_f32_32x32x16_bf16 a[64:79], a[232:235], a[216:219], a[64:79]
 v_cvt_pk_bf16_f32 v203, v166, v167
 v_exp_f32 v170, v170
 v_exp_f32 v171, v171
 v_mfma_f32_32x32x16_bf16 v[80:95], v[228:231], v[188:191], v[80:95]
 v_cvt_pk_bf16_f32 v204, v168, v169
 v_exp_f32 v172, v172
 v_exp_f32 v173, v173
 v_cvt_pk_bf16_f32 v205, v170, v171
 v_mfma_f32_32x32x16_bf16 a[80:95], a[232:235], a[220:223], a[80:95]
 buffer_load_dwordx4 a[216:219], v14, s[36:39], s63 offen offset:2048 sc1
 v_exp_f32 v174, v174
 v_exp_f32 v175, v175
 v_cvt_pk_bf16_f32 v206, v172, v173
 s_waitcnt lgkmcnt(0)
 v_cvt_pk_bf16_f32 v207, v174, v175
 v_mfma_f32_32x32x16_bf16 v[144:159], v[216:219], v[96:99], v[32:47]
 ds_read_b128 v[208:211], v10 offset:4096
 ds_read_b32 v212, v11 offset:512
 v_exp_f32 v112, v112
 v_exp_f32 v113, v113
 v_exp_f32 v114, v114
 v_mfma_f32_32x32x16_bf16 v[160:175], v[216:219], v[104:107], v[48:63]
 ds_read_b128 v[224:227], v12 offset:2560
 ds_read_b128 v[228:231], v12 offset:3200
 buffer_load_dwordx4 a[220:223], v14, s[36:39], s64 offen offset:2048 sc1
 v_exp_f32 v115, v115
 v_cvt_pk_bf16_f32 v176, v112, v113
 v_exp_f32 v116, v116
 v_exp_f32 v117, v117
 s_waitcnt vmcnt(37)
 v_mfma_f32_32x32x16_bf16 a[0:15], a[244:247], a[236:239], a[0:15]
 v_cvt_pk_bf16_f32 v177, v114, v115
 v_exp_f32 v118, v118
 v_exp_f32 v119, v119
 v_mfma_f32_32x32x16_bf16 v[144:159], v[220:223], v[100:103], v[144:159]
 buffer_load_dwordx4 a[224:227], v14, s[36:39], s65 offen sc1
 v_cvt_pk_bf16_f32 v178, v116, v117
 v_exp_f32 v120, v120
 v_exp_f32 v121, v121
 v_mfma_f32_32x32x16_bf16 a[16:31], a[244:247], a[240:243], a[16:31]
 v_cvt_pk_bf16_f32 v179, v118, v119
 v_exp_f32 v122, v122
 v_exp_f32 v123, v123
 v_cvt_pk_bf16_f32 v180, v120, v121
 v_mfma_f32_32x32x16_bf16 v[160:175], v[220:223], v[108:111], v[160:175]
 buffer_load_dwordx4 a[228:231], v14, s[36:39], s65 offen offset:1024 sc1
 v_exp_f32 v124, v124
 v_exp_f32 v125, v125
 v_cvt_pk_bf16_f32 v181, v122, v123
 v_mfma_f32_32x32x16_bf16 a[32:47], a[248:251], a[236:239], a[32:47]
 v_exp_f32 v126, v126
 v_exp_f32 v127, v127
 v_cvt_pk_bf16_f32 v182, v124, v125
 v_exp_f32 v128, v128
 v_mfma_f32_32x32x16_bf16 v[64:79], v[232:235], v[192:195], v[64:79]
 buffer_load_dwordx4 a[232:235], v14, s[36:39], s65 offen offset:2048 sc1
 s_add_u32 s65, s65, 18432
 v_exp_f32 v129, v129
 v_cvt_pk_bf16_f32 v183, v126, v127
 v_exp_f32 v130, v130
 v_mfma_f32_32x32x16_bf16 v[80:95], v[232:235], v[200:203], v[80:95]
 v_exp_f32 v131, v131
 v_cvt_pk_bf16_f32 v184, v128, v129
 v_exp_f32 v132, v132
 v_mfma_f32_32x32x16_bf16 a[48:63], a[248:251], a[240:243], a[48:63]
 v_exp_f32 v133, v133
 v_cvt_pk_bf16_f32 v185, v130, v131
 v_exp_f32 v134, v134
 v_exp_f32 v135, v135
 v_mfma_f32_32x32x16_bf16 v[64:79], v[236:239], v[196:199], v[64:79]
 v_cvt_pk_bf16_f32 v186, v132, v133
 v_exp_f32 v136, v136
 v_exp_f32 v137, v137
 v_mfma_f32_32x32x16_bf16 a[64:79], a[252:255], a[236:239], a[64:79]
 v_cvt_pk_bf16_f32 v187, v134, v135
 v_exp_f32 v138, v138
 v_exp_f32 v139, v139
 v_mfma_f32_32x32x16_bf16 v[80:95], v[236:239], v[204:207], v[80:95]
 v_cvt_pk_bf16_f32 v188, v136, v137
 v_exp_f32 v140, v140
 v_exp_f32 v141, v141
 v_cvt_pk_bf16_f32 v189, v138, v139
 v_mfma_f32_32x32x16_bf16 a[80:95], a[252:255], a[240:243], a[80:95]
 buffer_load_dwordx4 a[236:239], v14, s[36:39], s63 offen offset:3072 sc1
 s_add_u32 s63, s63, 4096
 v_exp_f32 v142, v142
 v_exp_f32 v143, v143
 v_cvt_pk_bf16_f32 v190, v140, v141
 s_waitcnt lgkmcnt(0)
 v_cvt_pk_bf16_f32 v191, v142, v143
 v_mfma_f32_32x32x16_bf16 v[112:127], v[208:211], v[96:99], v[32:47]
 ds_read_b128 v[216:219], v10 offset:5120
 ds_read_b32 v220, v11 offset:640
 v_exp_f32 v144, v144
 v_exp_f32 v145, v145
 v_exp_f32 v146, v146
 v_mfma_f32_32x32x16_bf16 v[128:143], v[208:211], v[104:107], v[48:63]
 ds_read_b128 v[232:235], v12 offset:3840
 ds_read_b128 v[236:239], v12 offset:4480
 buffer_load_dwordx4 a[240:243], v14, s[36:39], s64 offen offset:3072 sc1
 s_add_u32 s64, s64, 4096
 v_exp_f32 v147, v147
 v_cvt_pk_bf16_f32 v192, v144, v145
 v_exp_f32 v148, v148
 v_exp_f32 v149, v149
 s_waitcnt vmcnt(37)
 v_mfma_f32_32x32x16_bf16 a[0:15], a[104:107], a[96:99], a[0:15]
 v_cvt_pk_bf16_f32 v193, v146, v147
 v_exp_f32 v150, v150
 v_exp_f32 v151, v151
 v_mfma_f32_32x32x16_bf16 v[112:127], v[212:215], v[100:103], v[112:127]
 buffer_load_dwordx4 a[244:247], v14, s[36:39], s65 offen sc1
 v_cvt_pk_bf16_f32 v194, v148, v149
 v_exp_f32 v152, v152
 v_exp_f32 v153, v153
 v_mfma_f32_32x32x16_bf16 a[16:31], a[104:107], a[100:103], a[16:31]
 v_cvt_pk_bf16_f32 v195, v150, v151
 v_exp_f32 v154, v154
 v_exp_f32 v155, v155
 v_cvt_pk_bf16_f32 v196, v152, v153
 v_mfma_f32_32x32x16_bf16 v[128:143], v[212:215], v[108:111], v[128:143]
 buffer_load_dwordx4 a[248:251], v14, s[36:39], s65 offen offset:1024 sc1
 v_exp_f32 v156, v156
 v_exp_f32 v157, v157
 v_cvt_pk_bf16_f32 v197, v154, v155
 v_mfma_f32_32x32x16_bf16 a[32:47], a[108:111], a[96:99], a[32:47]
 v_exp_f32 v158, v158
 v_exp_f32 v159, v159
 v_cvt_pk_bf16_f32 v198, v156, v157
 v_exp_f32 v160, v160
 v_mfma_f32_32x32x16_bf16 v[64:79], v[224:227], v[176:179], v[64:79]
 buffer_load_dwordx4 a[252:255], v14, s[36:39], s65 offen offset:2048 sc1
 s_add_u32 s65, s65, 18432
 v_exp_f32 v161, v161
 v_cvt_pk_bf16_f32 v199, v158, v159
 v_exp_f32 v162, v162
 v_mfma_f32_32x32x16_bf16 v[80:95], v[224:227], v[184:187], v[80:95]
 v_exp_f32 v163, v163
 v_cvt_pk_bf16_f32 v200, v160, v161
 v_exp_f32 v164, v164
 v_mfma_f32_32x32x16_bf16 a[48:63], a[108:111], a[100:103], a[48:63]
 v_exp_f32 v165, v165
 v_cvt_pk_bf16_f32 v201, v162, v163
 v_exp_f32 v166, v166
 v_exp_f32 v167, v167
 v_mfma_f32_32x32x16_bf16 v[64:79], v[228:231], v[180:183], v[64:79]
 v_cvt_pk_bf16_f32 v202, v164, v165
 v_exp_f32 v168, v168
 v_exp_f32 v169, v169
 v_mfma_f32_32x32x16_bf16 a[64:79], a[112:115], a[96:99], a[64:79]
 v_cvt_pk_bf16_f32 v203, v166, v167
 v_exp_f32 v170, v170
 v_exp_f32 v171, v171
 v_mfma_f32_32x32x16_bf16 v[80:95], v[228:231], v[188:191], v[80:95]
 v_cvt_pk_bf16_f32 v204, v168, v169
 v_exp_f32 v172, v172
 v_exp_f32 v173, v173
 v_cvt_pk_bf16_f32 v205, v170, v171
 v_mfma_f32_32x32x16_bf16 a[80:95], a[112:115], a[100:103], a[80:95]
 buffer_load_dwordx4 a[96:99], v14, s[36:39], s63 offen sc1
 v_exp_f32 v174, v174
 v_exp_f32 v175, v175
 v_cvt_pk_bf16_f32 v206, v172, v173
 s_waitcnt lgkmcnt(0)
 v_cvt_pk_bf16_f32 v207, v174, v175
 v_mfma_f32_32x32x16_bf16 v[144:159], v[216:219], v[96:99], v[32:47]
 ds_read_b128 v[208:211], v10 offset:6144
 ds_read_b32 v212, v11 offset:768
 v_exp_f32 v112, v112
 v_exp_f32 v113, v113
 v_exp_f32 v114, v114
 v_mfma_f32_32x32x16_bf16 v[160:175], v[216:219], v[104:107], v[48:63]
 ds_read_b128 v[224:227], v12 offset:5120
 ds_read_b128 v[228:231], v12 offset:5760
 buffer_load_dwordx4 a[100:103], v14, s[36:39], s64 offen sc1
 v_exp_f32 v115, v115
 v_cvt_pk_bf16_f32 v176, v112, v113
 v_exp_f32 v116, v116
 v_exp_f32 v117, v117
 s_waitcnt vmcnt(37)
 v_mfma_f32_32x32x16_bf16 a[0:15], a[124:127], a[116:119], a[0:15]
 v_cvt_pk_bf16_f32 v177, v114, v115
 v_exp_f32 v118, v118
 v_exp_f32 v119, v119
 v_mfma_f32_32x32x16_bf16 v[144:159], v[220:223], v[100:103], v[144:159]
 buffer_load_dwordx4 a[104:107], v14, s[36:39], s65 offen sc1
 v_cvt_pk_bf16_f32 v178, v116, v117
 v_exp_f32 v120, v120
 v_exp_f32 v121, v121
 v_mfma_f32_32x32x16_bf16 a[16:31], a[124:127], a[120:123], a[16:31]
 v_cvt_pk_bf16_f32 v179, v118, v119
 v_exp_f32 v122, v122
 v_exp_f32 v123, v123
 v_cvt_pk_bf16_f32 v180, v120, v121
 v_mfma_f32_32x32x16_bf16 v[160:175], v[220:223], v[108:111], v[160:175]
 buffer_load_dwordx4 a[108:111], v14, s[36:39], s65 offen offset:1024 sc1
 v_exp_f32 v124, v124
 v_exp_f32 v125, v125
 v_cvt_pk_bf16_f32 v181, v122, v123
 v_mfma_f32_32x32x16_bf16 a[32:47], a[128:131], a[116:119], a[32:47]
 v_exp_f32 v126, v126
 v_exp_f32 v127, v127
 v_cvt_pk_bf16_f32 v182, v124, v125
 v_exp_f32 v128, v128
 v_mfma_f32_32x32x16_bf16 v[64:79], v[232:235], v[192:195], v[64:79]
 buffer_load_dwordx4 a[112:115], v14, s[36:39], s65 offen offset:2048 sc1
 s_add_u32 s65, s65, 18432
 v_exp_f32 v129, v129
 v_cvt_pk_bf16_f32 v183, v126, v127
 v_exp_f32 v130, v130
 v_mfma_f32_32x32x16_bf16 v[80:95], v[232:235], v[200:203], v[80:95]
 v_exp_f32 v131, v131
 v_cvt_pk_bf16_f32 v184, v128, v129
 v_exp_f32 v132, v132
 v_mfma_f32_32x32x16_bf16 a[48:63], a[128:131], a[120:123], a[48:63]
 v_exp_f32 v133, v133
 v_cvt_pk_bf16_f32 v185, v130, v131
 v_exp_f32 v134, v134
 v_exp_f32 v135, v135
 v_mfma_f32_32x32x16_bf16 v[64:79], v[236:239], v[196:199], v[64:79]
 v_cvt_pk_bf16_f32 v186, v132, v133
 v_exp_f32 v136, v136
 v_exp_f32 v137, v137
 v_mfma_f32_32x32x16_bf16 a[64:79], a[132:135], a[116:119], a[64:79]
 v_cvt_pk_bf16_f32 v187, v134, v135
 v_exp_f32 v138, v138
 v_exp_f32 v139, v139
 v_mfma_f32_32x32x16_bf16 v[80:95], v[236:239], v[204:207], v[80:95]
 v_cvt_pk_bf16_f32 v188, v136, v137
 v_exp_f32 v140, v140
 v_exp_f32 v141, v141
 v_cvt_pk_bf16_f32 v189, v138, v139
 v_mfma_f32_32x32x16_bf16 a[80:95], a[132:135], a[120:123], a[80:95]
 buffer_load_dwordx4 a[116:119], v14, s[36:39], s63 offen offset:1024 sc1
 v_exp_f32 v142, v142
 v_exp_f32 v143, v143
 v_cvt_pk_bf16_f32 v190, v140, v141
 s_waitcnt lgkmcnt(0)
 v_cvt_pk_bf16_f32 v191, v142, v143
 v_mfma_f32_32x32x16_bf16 v[112:127], v[208:211], v[96:99], v[32:47]
 ds_read_b128 v[216:219], v10 offset:7168
 ds_read_b32 v220, v11 offset:896
 v_exp_f32 v144, v144
 v_exp_f32 v145, v145
 v_exp_f32 v146, v146
 v_mfma_f32_32x32x16_bf16 v[128:143], v[208:211], v[104:107], v[48:63]
 ds_read_b128 v[232:235], v12 offset:6400
 ds_read_b128 v[236:239], v12 offset:7040
 s_add_u32 s57, s57, 20480
 s_cmp_eq_u32 s57, 61440
 s_cselect_b32 s57, 0, s57
 buffer_load_dwordx4 a[120:123], v14, s[36:39], s64 offen offset:1024 sc1
 v_exp_f32 v147, v147
 v_cvt_pk_bf16_f32 v192, v144, v145
 v_exp_f32 v148, v148
 v_exp_f32 v149, v149
 s_waitcnt vmcnt(37)
 v_mfma_f32_32x32x16_bf16 a[0:15], a[144:147], a[136:139], a[0:15]
 v_cvt_pk_bf16_f32 v193, v146, v147
 v_exp_f32 v150, v150
 v_exp_f32 v151, v151
 v_mfma_f32_32x32x16_bf16 v[112:127], v[212:215], v[100:103], v[112:127]
 buffer_load_dwordx4 a[124:127], v14, s[36:39], s65 offen sc1
 v_cvt_pk_bf16_f32 v194, v148, v149
 v_exp_f32 v152, v152
 v_exp_f32 v153, v153
 v_mfma_f32_32x32x16_bf16 a[16:31], a[144:147], a[140:143], a[16:31]
 v_cvt_pk_bf16_f32 v195, v150, v151
 v_exp_f32 v154, v154
 v_exp_f32 v155, v155
 v_cvt_pk_bf16_f32 v196, v152, v153
 v_mfma_f32_32x32x16_bf16 v[128:143], v[212:215], v[108:111], v[128:143]
 buffer_load_dwordx4 a[128:131], v14, s[36:39], s65 offen offset:1024 sc1
 v_exp_f32 v156, v156
 v_exp_f32 v157, v157
 v_cvt_pk_bf16_f32 v197, v154, v155
 v_mfma_f32_32x32x16_bf16 a[32:47], a[148:151], a[136:139], a[32:47]
 v_exp_f32 v158, v158
 v_exp_f32 v159, v159
 v_cvt_pk_bf16_f32 v198, v156, v157
 v_exp_f32 v160, v160
 v_mfma_f32_32x32x16_bf16 v[64:79], v[224:227], v[176:179], v[64:79]
 buffer_load_dwordx4 a[132:135], v14, s[36:39], s65 offen offset:2048 sc1
 s_add_u32 s65, s65, 18432
 v_exp_f32 v161, v161
 v_cvt_pk_bf16_f32 v199, v158, v159
 v_exp_f32 v162, v162
 v_mfma_f32_32x32x16_bf16 v[80:95], v[224:227], v[184:187], v[80:95]
 v_exp_f32 v163, v163
 v_cvt_pk_bf16_f32 v200, v160, v161
 v_exp_f32 v164, v164
 v_mfma_f32_32x32x16_bf16 a[48:63], a[148:151], a[140:143], a[48:63]
 v_exp_f32 v165, v165
 v_cvt_pk_bf16_f32 v201, v162, v163
 v_exp_f32 v166, v166
 v_exp_f32 v167, v167
 v_mfma_f32_32x32x16_bf16 v[64:79], v[228:231], v[180:183], v[64:79]
 v_cvt_pk_bf16_f32 v202, v164, v165
 v_exp_f32 v168, v168
 v_exp_f32 v169, v169
 v_mfma_f32_32x32x16_bf16 a[64:79], a[152:155], a[136:139], a[64:79]
 v_cvt_pk_bf16_f32 v203, v166, v167
 v_exp_f32 v170, v170
 v_exp_f32 v171, v171
 v_mfma_f32_32x32x16_bf16 v[80:95], v[228:231], v[188:191], v[80:95]
 v_cvt_pk_bf16_f32 v204, v168, v169
 v_exp_f32 v172, v172
 v_exp_f32 v173, v173
 v_cvt_pk_bf16_f32 v205, v170, v171
 v_mfma_f32_32x32x16_bf16 a[80:95], a[152:155], a[140:143], a[80:95]
 buffer_load_dwordx4 a[136:139], v14, s[36:39], s63 offen offset:2048 sc1
 v_exp_f32 v174, v174
 v_exp_f32 v175, v175
 v_cvt_pk_bf16_f32 v206, v172, v173
 v_add_u32 v10, s57, v14
 v_add_u32 v11, s57, v20
 v_add_u32 v253, s57, v252
 s_waitcnt lgkmcnt(0)
 v_cvt_pk_bf16_f32 v207, v174, v175
 v_mfma_f32_32x32x16_bf16 v[144:159], v[216:219], v[96:99], v[32:47]
 s_waitcnt vmcnt(31)
 ds_write_b128 v253, v[248:251]
 s_waitcnt lgkmcnt(0)
 s_barrier
 ds_read_b128 v[208:211], v10
 ds_read_b32 v212, v11
 v_exp_f32 v112, v112
 v_exp_f32 v113, v113
 v_exp_f32 v114, v114
 v_mfma_f32_32x32x16_bf16 v[160:175], v[216:219], v[104:107], v[48:63]
 ds_read_b128 v[224:227], v12 offset:7680
 ds_read_b128 v[228:231], v12 offset:8320
 buffer_load_dwordx4 a[140:143], v14, s[36:39], s64 offen offset:2048 sc1
 v_exp_f32 v115, v115
 v_cvt_pk_bf16_f32 v176, v112, v113
 v_exp_f32 v116, v116
 v_exp_f32 v117, v117
 s_waitcnt vmcnt(35)
 v_mfma_f32_32x32x16_bf16 a[0:15], a[164:167], a[156:159], a[0:15]
 v_cvt_pk_bf16_f32 v177, v114, v115
 v_exp_f32 v118, v118
 v_exp_f32 v119, v119
 v_mfma_f32_32x32x16_bf16 v[144:159], v[220:223], v[100:103], v[144:159]
 buffer_load_dwordx4 a[144:147], v14, s[36:39], s65 offen sc1
 v_cvt_pk_bf16_f32 v178, v116, v117
 v_exp_f32 v120, v120
 v_exp_f32 v121, v121
 v_mfma_f32_32x32x16_bf16 a[16:31], a[164:167], a[160:163], a[16:31]
 v_cvt_pk_bf16_f32 v179, v118, v119
 v_exp_f32 v122, v122
 v_exp_f32 v123, v123
 v_cvt_pk_bf16_f32 v180, v120, v121
 v_mfma_f32_32x32x16_bf16 v[160:175], v[220:223], v[108:111], v[160:175]
 buffer_load_dwordx4 a[148:151], v14, s[36:39], s65 offen offset:1024 sc1
 v_exp_f32 v124, v124
 v_exp_f32 v125, v125
 v_cvt_pk_bf16_f32 v181, v122, v123
 v_mfma_f32_32x32x16_bf16 a[32:47], a[168:171], a[156:159], a[32:47]
 v_exp_f32 v126, v126
 v_exp_f32 v127, v127
 v_cvt_pk_bf16_f32 v182, v124, v125
 v_exp_f32 v128, v128
 v_mfma_f32_32x32x16_bf16 v[64:79], v[232:235], v[192:195], v[64:79]
 buffer_load_dwordx4 a[152:155], v14, s[36:39], s65 offen offset:2048 sc1
 s_add_u32 s65, s65, 18432
 v_exp_f32 v129, v129
 v_cvt_pk_bf16_f32 v183, v126, v127
 v_exp_f32 v130, v130
 v_mfma_f32_32x32x16_bf16 v[80:95], v[232:235], v[200:203], v[80:95]
 v_exp_f32 v131, v131
 v_cvt_pk_bf16_f32 v184, v128, v129
 v_exp_f32 v132, v132
 v_mfma_f32_32x32x16_bf16 a[48:63], a[168:171], a[160:163], a[48:63]
 s_add_u32 m0, s35, s58
 v_exp_f32 v133, v133
 v_cvt_pk_bf16_f32 v185, v130, v131
 v_exp_f32 v134, v134
 v_exp_f32 v135, v135
 v_mfma_f32_32x32x16_bf16 v[64:79], v[236:239], v[196:199], v[64:79]
 buffer_load_dwordx4 v13, s[36:39], s56 offen sc1 lds
 v_cvt_pk_bf16_f32 v186, v132, v133
 v_exp_f32 v136, v136
 v_exp_f32 v137, v137
 v_mfma_f32_32x32x16_bf16 a[64:79], a[172:175], a[156:159], a[64:79]
 v_cvt_pk_bf16_f32 v187, v134, v135
 v_exp_f32 v138, v138
 v_exp_f32 v139, v139
 v_mfma_f32_32x32x16_bf16 v[80:95], v[236:239], v[204:207], v[80:95]
 buffer_load_dwordx4 v13, s[36:39], s56 offen offset:1024 sc1 lds
 v_cvt_pk_bf16_f32 v188, v136, v137
 v_exp_f32 v140, v140
 v_exp_f32 v141, v141
 v_cvt_pk_bf16_f32 v189, v138, v139
 v_mfma_f32_32x32x16_bf16 a[80:95], a[172:175], a[160:163], a[80:95]
 v_exp_f32 v142, v142
 v_exp_f32 v143, v143
 v_cvt_pk_bf16_f32 v190, v140, v141
 s_waitcnt lgkmcnt(0)
 v_cvt_pk_bf16_f32 v191, v142, v143
 v_mfma_f32_32x32x16_bf16 v[112:127], v[208:211], v[96:99], v[32:47]
 ds_read_b128 v[216:219], v10 offset:1024
 ds_read_b32 v220, v11 offset:128
 buffer_load_dwordx4 a[156:159], v14, s[36:39], s63 offen offset:3072 sc1
 s_add_u32 s63, s63, 4096
 v_exp_f32 v144, v144
 v_exp_f32 v145, v145
 v_exp_f32 v146, v146
 v_mfma_f32_32x32x16_bf16 v[128:143], v[208:211], v[104:107], v[48:63]
 ds_read_b128 v[232:235], v12 offset:8960
 ds_read_b128 v[236:239], v12 offset:9600
 v_exp_f32 v147, v147
 v_cvt_pk_bf16_f32 v192, v144, v145
 v_exp_f32 v148, v148
 v_exp_f32 v149, v149
 s_waitcnt vmcnt(33)
 v_mfma_f32_32x32x16_bf16 a[0:15], a[184:187], a[176:179], a[0:15]
 buffer_load_dwordx4 a[160:163], v14, s[36:39], s64 offen offset:3072 sc1
 s_add_u32 s64, s64, 4096
 v_cvt_pk_bf16_f32 v193, v146, v147
 v_exp_f32 v150, v150
 v_exp_f32 v151, v151
 v_mfma_f32_32x32x16_bf16 v[112:127], v[212:215], v[100:103], v[112:127]
 v_cvt_pk_bf16_f32 v194, v148, v149
 v_exp_f32 v152, v152
 v_exp_f32 v153, v153
 v_mfma_f32_32x32x16_bf16 a[16:31], a[184:187], a[180:183], a[16:31]
 buffer_load_dwordx4 a[164:167], v14, s[36:39], s65 offen sc1
 v_cvt_pk_bf16_f32 v195, v150, v151
 v_exp_f32 v154, v154
 v_exp_f32 v155, v155
 v_cvt_pk_bf16_f32 v196, v152, v153
 v_mfma_f32_32x32x16_bf16 v[128:143], v[212:215], v[108:111], v[128:143]
 v_exp_f32 v156, v156
 v_exp_f32 v157, v157
 v_cvt_pk_bf16_f32 v197, v154, v155
 v_mfma_f32_32x32x16_bf16 a[32:47], a[188:191], a[176:179], a[32:47]
 buffer_load_dwordx4 a[168:171], v14, s[36:39], s65 offen offset:1024 sc1
 v_exp_f32 v158, v158
 v_exp_f32 v159, v159
 v_cvt_pk_bf16_f32 v198, v156, v157
 v_exp_f32 v160, v160
 v_mfma_f32_32x32x16_bf16 v[64:79], v[224:227], v[176:179], v[64:79]
 v_exp_f32 v161, v161
 v_cvt_pk_bf16_f32 v199, v158, v159
 v_exp_f32 v162, v162
 v_mfma_f32_32x32x16_bf16 v[80:95], v[224:227], v[184:187], v[80:95]
 buffer_load_dwordx4 a[172:175], v14, s[36:39], s65 offen offset:2048 sc1
 s_add_u32 s65, s65, 18432
 v_exp_f32 v163, v163
 v_cvt_pk_bf16_f32 v200, v160, v161
 v_exp_f32 v164, v164
 v_mfma_f32_32x32x16_bf16 a[48:63], a[188:191], a[180:183], a[48:63]
 v_exp_f32 v165, v165
 v_cvt_pk_bf16_f32 v201, v162, v163
 v_exp_f32 v166, v166
 v_exp_f32 v167, v167
 v_mfma_f32_32x32x16_bf16 v[64:79], v[228:231], v[180:183], v[64:79]
 buffer_load_dwordx4 v13, s[36:39], s56 offen offset:2048 sc1 lds
 v_cvt_pk_bf16_f32 v202, v164, v165
 v_exp_f32 v168, v168
 v_exp_f32 v169, v169
 v_mfma_f32_32x32x16_bf16 a[64:79], a[192:195], a[176:179], a[64:79]
 v_cvt_pk_bf16_f32 v203, v166, v167
 v_exp_f32 v170, v170
 v_exp_f32 v171, v171
 v_mfma_f32_32x32x16_bf16 v[80:95], v[228:231], v[188:191], v[80:95]
 buffer_load_dwordx4 v13, s[36:39], s56 offen offset:3072 sc1 lds
 s_add_u32 m0, m0, 4096
 s_add_u32 s56, s56, 4096
 v_cvt_pk_bf16_f32 v204, v168, v169
 v_exp_f32 v172, v172
 v_exp_f32 v173, v173
 v_cvt_pk_bf16_f32 v205, v170, v171
 v_mfma_f32_32x32x16_bf16 a[80:95], a[192:195], a[180:183], a[80:95]
 v_exp_f32 v174, v174
 v_exp_f32 v175, v175
 v_cvt_pk_bf16_f32 v206, v172, v173
 v_add_u32 v12, s57, v21
 s_waitcnt lgkmcnt(0)
 v_cvt_pk_bf16_f32 v207, v174, v175
 s_mov_b32 s66, 3
L_m_t:
 v_mfma_f32_32x32x16_bf16 v[144:159], v[216:219], v[96:99], v[32:47]
 ds_read_b128 v[208:211], v10 offset:2048
 ds_read_b32 v212, v11 offset:256
 buffer_load_dwordx4 v13, s[36:39], s56 offen sc1 lds
 v_exp_f32 v112, v112
 v_exp_f32 v113, v113
 v_exp_f32 v114, v114
 v_mfma_f32_32x32x16_bf16 v[160:175], v[216:219], v[104:107], v[48:63]
 ds_read_b128 v[224:227], v12
 ds_read_b128 v[228:231], v12 offset:640
 v_exp_f32 v115, v115
 v_cvt_pk_bf16_f32 v176, v112, v113
 v_exp_f32 v116, v116
 v_exp_f32 v117, v117
 s_waitcnt vmcnt(35)
 v_mfma_f32_32x32x16_bf16 a[0:15], a[204:207], a[196:199], a[0:15]
 s_add_u32 s56, s56, 16384
 s_add_u32 s35, s35, 20480
 s_cmp_eq_u32 s35, 61440
 s_cselect_b32 s35, 0, s35
 s_sub_u32 s66, s66, 1
 buffer_load_dwordx4 a[176:179], v14, s[36:39], s63 offen sc1
 v_cvt_pk_bf16_f32 v177, v114, v115
 v_exp_f32 v118, v118
 v_exp_f32 v119, v119
 v_mfma_f32_32x32x16_bf16 v[144:159], v[220:223], v[100:103], v[144:159]
 v_cvt_pk_bf16_f32 v178, v116, v117
 v_exp_f32 v120, v120
 v_exp_f32 v121, v121
 v_mfma_f32_32x32x16_bf16 a[16:31], a[204:207], a[200:203], a[16:31]
 buffer_load_dwordx4 a[180:183], v14, s[36:39], s64 offen sc1
 v_cvt_pk_bf16_f32 v179, v118, v119
 v_exp_f32 v122, v122
 v_exp_f32 v123, v123
 v_cvt_pk_bf16_f32 v180, v120, v121
 v_mfma_f32_32x32x16_bf16 v[160:175], v[220:223], v[108:111], v[160:175]
 v_exp_f32 v124, v124
 v_exp_f32 v125, v125
 v_cvt_pk_bf16_f32 v181, v122, v123
 v_mfma_f32_32x32x16_bf16 a[32:47], a[208:211], a[196:199], a[32:47]
 buffer_load_dwordx4 a[184:187], v14, s[36:39], s65 offen sc1
 v_exp_f32 v126, v126
 v_exp_f32 v127, v127
 v_cvt_pk_bf16_f32 v182, v124, v125
 v_exp_f32 v128, v128
 v_mfma_f32_32x32x16_bf16 v[64:79], v[232:235], v[192:195], v[64:79]
 v_exp_f32 v129, v129
 v_cvt_pk_bf16_f32 v183, v126, v127
 v_exp_f32 v130, v130
 v_mfma_f32_32x32x16_bf16 v[80:95], v[232:235], v[200:203], v[80:95]
 buffer_load_dwordx4 a[188:191], v14, s[36:39], s65 offen offset:1024 sc1
 v_exp_f32 v131, v131
 v_cvt_pk_bf16_f32 v184, v128, v129
 v_exp_f32 v132, v132
 v_mfma_f32_32x32x16_bf16 a[48:63], a[208:211], a[200:203], a[48:63]
 v_exp_f32 v133, v133
 v_cvt_pk_bf16_f32 v185, v130, v131
 v_exp_f32 v134, v134
 v_exp_f32 v135, v135
 v_mfma_f32_32x32x16_bf16 v[64:79], v[236:239], v[196:199], v[64:79]
 buffer_load_dwordx4 a[192:195], v14, s[36:39], s65 offen offset:2048 sc1
 s_add_u32 s65, s65, 18432
 v_cvt_pk_bf16_f32 v186, v132, v133
 v_exp_f32 v136, v136
 v_exp_f32 v137, v137
 v_mfma_f32_32x32x16_bf16 a[64:79], a[212:215], a[196:199], a[64:79]
 v_cvt_pk_bf16_f32 v187, v134, v135
 v_exp_f32 v138, v138
 v_exp_f32 v139, v139
 v_mfma_f32_32x32x16_bf16 v[80:95], v[236:239], v[204:207], v[80:95]
 v_cvt_pk_bf16_f32 v188, v136, v137
 v_exp_f32 v140, v140
 v_exp_f32 v141, v141
 v_cvt_pk_bf16_f32 v189, v138, v139
 v_mfma_f32_32x32x16_bf16 a[80:95], a[212:215], a[200:203], a[80:95]
 buffer_load_dwordx4 a[196:199], v14, s[36:39], s63 offen offset:1024 sc1
 v_exp_f32 v142, v142
 v_exp_f32 v143, v143
 v_cvt_pk_bf16_f32 v190, v140, v141
 s_waitcnt lgkmcnt(0)
 v_cvt_pk_bf16_f32 v191, v142, v143
 v_mfma_f32_32x32x16_bf16 v[112:127], v[208:211], v[96:99], v[32:47]
 ds_read_b128 v[216:219], v10 offset:3072
 ds_read_b32 v220, v11 offset:384
 v_exp_f32 v144, v144
 v_exp_f32 v145, v145
 v_exp_f32 v146, v146
 v_mfma_f32_32x32x16_bf16 v[128:143], v[208:211], v[104:107], v[48:63]
 ds_read_b128 v[232:235], v12 offset:1280
 ds_read_b128 v[236:239], v12 offset:1920
 buffer_load_dwordx4 a[200:203], v14, s[36:39], s64 offen offset:1024 sc1
 v_exp_f32 v147, v147
 v_cvt_pk_bf16_f32 v192, v144, v145
 v_exp_f32 v148, v148
 v_exp_f32 v149, v149
 s_waitcnt vmcnt(37)
 v_mfma_f32_32x32x16_bf16 a[0:15], a[224:227], a[216:219], a[0:15]
 v_cvt_pk_bf16_f32 v193, v146, v147
 v_exp_f32 v150, v150
 v_exp_f32 v151, v151
 v_mfma_f32_32x32x16_bf16 v[112:127], v[212:215], v[100:103], v[112:127]
 buffer_load_dwordx4 a[204:207], v14, s[36:39], s65 offen sc1
 v_cvt_pk_bf16_f32 v194, v148, v149
 v_exp_f32 v152, v152
 v_exp_f32 v153, v153
 v_mfma_f32_32x32x16_bf16 a[16:31], a[224:227], a[220:223], a[16:31]
 v_cvt_pk_bf16_f32 v195, v150, v151
 v_exp_f32 v154, v154
 v_exp_f32 v155, v155
 v_cvt_pk_bf16_f32 v196, v152, v153
 v_mfma_f32_32x32x16_bf16 v[128:143], v[212:215], v[108:111], v[128:143]
 buffer_load_dwordx4 a[208:211], v14, s[36:39], s65 offen offset:1024 sc1
 v_exp_f32 v156, v156
 v_exp_f32 v157, v157
 v_cvt_pk_bf16_f32 v197, v154, v155
 v_mfma_f32_32x32x16_bf16 a[32:47], a[228:231], a[216:219], a[32:47]
 v_exp_f32 v158, v158
 v_exp_f32 v159, v159
 v_cvt_pk_bf16_f32 v198, v156, v157
 v_exp_f32 v160, v160
 v_mfma_f32_32x32x16_bf16 v[64:79], v[224:227], v[176:179], v[64:79]
 buffer_load_dwordx4 a[212:215], v14, s[36:39], s65 offen offset:2048 sc1
 s_add_u32 s65, s65, 18432
 v_exp_f32 v161, v161
 v_cvt_pk_bf16_f32 v199, v158, v159
 v_exp_f32 v162, v162
 v_mfma_f32_32x32x16_bf16 v[80:95], v[224:227], v[184:187], v[80:95]
 v_exp_f32 v163, v163
 v_cvt_pk_bf16_f32 v200, v160, v161
 v_exp_f32 v164, v164
 v_mfma_f32_32x32x16_bf16 a[48:63], a[228:231], a[220:223], a[48:63]
 v_exp_f32 v165, v165
 v_cvt_pk_bf16_f32 v201, v162, v163
 v_exp_f32 v166, v166
 v_exp_f32 v167, v167
 v_mfma_f32_32x32x16_bf16 v[64:79], v[228:231], v[180:183], v[64:79]
 v_cvt_pk_bf16_f32 v202, v164, v165
 v_exp_f32 v168, v168
 v_exp_f32 v169, v169
 v_mfma_f32_32x32x16_bf16 a[64:79], a[232:235], a[216:219], a[64:79]
 v_cvt_pk_bf16_f32 v203, v166, v167
 v_exp_f32 v170, v170
 v_exp_f32 v171, v171
 v_mfma_f32_32x32x16_bf16 v[80:95], v[228:231], v[188:191], v[80:95]
 v_cvt_pk_bf16_f32 v204, v168, v169
 v_exp_f32 v172, v172
 v_exp_f32 v173, v173
 v_cvt_pk_bf16_f32 v205, v170, v171
 v_mfma_f32_32x32x16_bf16 a[80:95], a[232:235], a[220:223], a[80:95]
 buffer_load_dwordx4 a[216:219], v14, s[36:39], s63 offen offset:2048 sc1
 v_exp_f32 v174, v174
 v_exp_f32 v175, v175
 v_cvt_pk_bf16_f32 v206, v172, v173
 s_waitcnt lgkmcnt(0)
 v_cvt_pk_bf16_f32 v207, v174, v175
 v_mfma_f32_32x32x16_bf16 v[144:159], v[216:219], v[96:99], v[32:47]
 ds_read_b128 v[208:211], v10 offset:4096
 ds_read_b32 v212, v11 offset:512
 v_exp_f32 v112, v112
 v_exp_f32 v113, v113
 v_exp_f32 v114, v114
 v_mfma_f32_32x32x16_bf16 v[160:175], v[216:219], v[104:107], v[48:63]
 ds_read_b128 v[224:227], v12 offset:2560
 ds_read_b128 v[228:231], v12 offset:3200
 buffer_load_dwordx4 a[220:223], v14, s[36:39], s64 offen offset:2048 sc1
 v_exp_f32 v115, v115
 v_cvt_pk_bf16_f32 v176, v112, v113
 v_exp_f32 v116, v116
 v_exp_f32 v117, v117
 s_waitcnt vmcnt(37)
 v_mfma_f32_32x32x16_bf16 a[0:15], a[244:247], a[236:239], a[0:15]
 v_cvt_pk_bf16_f32 v177, v114, v115
 v_exp_f32 v118, v118
 v_exp_f32 v119, v119
 v_mfma_f32_32x32x16_bf16 v[144:159], v[220:223], v[100:103], v[144:159]
 buffer_load_dwordx4 a[224:227], v14, s[36:39], s65 offen sc1
 v_cvt_pk_bf16_f32 v178, v116, v117
 v_exp_f32 v120, v120
 v_exp_f32 v121, v121
 v_mfma_f32_32x32x16_bf16 a[16:31], a[244:247], a[240:243], a[16:31]
 v_cvt_pk_bf16_f32 v179, v118, v119
 v_exp_f32 v122, v122
 v_exp_f32 v123, v123
 v_cvt_pk_bf16_f32 v180, v120, v121
 v_mfma_f32_32x32x16_bf16 v[160:175], v[220:223], v[108:111], v[160:175]
 buffer_load_dwordx4 a[228:231], v14, s[36:39], s65 offen offset:1024 sc1
 v_exp_f32 v124, v124
 v_exp_f32 v125, v125
 v_cvt_pk_bf16_f32 v181, v122, v123
 v_mfma_f32_32x32x16_bf16 a[32:47], a[248:251], a[236:239], a[32:47]
 v_exp_f32 v126, v126
 v_exp_f32 v127, v127
 v_cvt_pk_bf16_f32 v182, v124, v125
 v_exp_f32 v128, v128
 v_mfma_f32_32x32x16_bf16 v[64:79], v[232:235], v[192:195], v[64:79]
 buffer_load_dwordx4 a[232:235], v14, s[36:39], s65 offen offset:2048 sc1
 s_add_u32 s65, s65, 18432
 v_exp_f32 v129, v129
 v_cvt_pk_bf16_f32 v183, v126, v127
 v_exp_f32 v130, v130
 v_mfma_f32_32x32x16_bf16 v[80:95], v[232:235], v[200:203], v[80:95]
 v_exp_f32 v131, v131
 v_cvt_pk_bf16_f32 v184, v128, v129
 v_exp_f32 v132, v132
 v_mfma_f32_32x32x16_bf16 a[48:63], a[248:251], a[240:243], a[48:63]
 v_exp_f32 v133, v133
 v_cvt_pk_bf16_f32 v185, v130, v131
 v_exp_f32 v134, v134
 v_exp_f32 v135, v135
 v_mfma_f32_32x32x16_bf16 v[64:79], v[236:239], v[196:199], v[64:79]
 v_cvt_pk_bf16_f32 v186, v132, v133
 v_exp_f32 v136, v136
 v_exp_f32 v137, v137
 v_mfma_f32_32x32x16_bf16 a[64:79], a[252:255], a[236:239], a[64:79]
 v_cvt_pk_bf16_f32 v187, v134, v135
 v_exp_f32 v138, v138
 v_exp_f32 v139, v139
 v_mfma_f32_32x32x16_bf16 v[80:95], v[236:239], v[204:207], v[80:95]
 v_cvt_pk_bf16_f32 v188, v136, v137
 v_exp_f32 v140, v140
 v_exp_f32 v141, v141
 v_cvt_pk_bf16_f32 v189, v138, v139
 v_mfma_f32_32x32x16_bf16 a[80:95], a[252:255], a[240:243], a[80:95]
 buffer_load_dwordx4 a[236:239], v14, s[36:39], s63 offen offset:3072 sc1
 s_add_u32 s63, s63, 4096
 v_exp_f32 v142, v142
 v_exp_f32 v143, v143
 v_cvt_pk_bf16_f32 v190, v140, v141
 s_waitcnt lgkmcnt(0)
 v_cvt_pk_bf16_f32 v191, v142, v143
 v_mfma_f32_32x32x16_bf16 v[112:127], v[208:211], v[96:99], v[32:47]
 ds_read_b128 v[216:219], v10 offset:5120
 ds_read_b32 v220, v11 offset:640
 v_exp_f32 v144, v144
 v_exp_f32 v145, v145
 v_exp_f32 v146, v146
 v_mfma_f32_32x32x16_bf16 v[128:143], v[208:211], v[104:107], v[48:63]
 ds_read_b128 v[232:235], v12 offset:3840
 ds_read_b128 v[236:239], v12 offset:4480
 buffer_load_dwordx4 a[240:243], v14, s[36:39], s64 offen offset:3072 sc1
 s_add_u32 s64, s64, 4096
 v_exp_f32 v147, v147
 v_cvt_pk_bf16_f32 v192, v144, v145
 v_exp_f32 v148, v148
 v_exp_f32 v149, v149
 s_waitcnt vmcnt(37)
 v_mfma_f32_32x32x16_bf16 a[0:15], a[104:107], a[96:99], a[0:15]
 v_cvt_pk_bf16_f32 v193, v146, v147
 v_exp_f32 v150, v150
 v_exp_f32 v151, v151
 v_mfma_f32_32x32x16_bf16 v[112:127], v[212:215], v[100:103], v[112:127]
 buffer_load_dwordx4 a[244:247], v14, s[36:39], s65 offen sc1
 v_cvt_pk_bf16_f32 v194, v148, v149
 v_exp_f32 v152, v152
 v_exp_f32 v153, v153
 v_mfma_f32_32x32x16_bf16 a[16:31], a[104:107], a[100:103], a[16:31]
 v_cvt_pk_bf16_f32 v195, v150, v151
 v_exp_f32 v154, v154
 v_exp_f32 v155, v155
 v_cvt_pk_bf16_f32 v196, v152, v153
 v_mfma_f32_32x32x16_bf16 v[128:143], v[212:215], v[108:111], v[128:143]
 buffer_load_dwordx4 a[248:251], v14, s[36:39], s65 offen offset:1024 sc1
 v_exp_f32 v156, v156
 v_exp_f32 v157, v157
 v_cvt_pk_bf16_f32 v197, v154, v155
 v_mfma_f32_32x32x16_bf16 a[32:47], a[108:111], a[96:99], a[32:47]
 v_exp_f32 v158, v158
 v_exp_f32 v159, v159
 v_cvt_pk_bf16_f32 v198, v156, v157
 v_exp_f32 v160, v160
 v_mfma_f32_32x32x16_bf16 v[64:79], v[224:227], v[176:179], v[64:79]
 buffer_load_dwordx4 a[252:255], v14, s[36:39], s65 offen offset:2048 sc1
 s_add_u32 s65, s65, 18432
 v_exp_f32 v161, v161
 v_cvt_pk_bf16_f32 v199, v158, v159
 v_exp_f32 v162, v162
 v_mfma_f32_32x32x16_bf16 v[80:95], v[224:227], v[184:187], v[80:95]
 v_exp_f32 v163, v163
 v_cvt_pk_bf16_f32 v200, v160, v161
 v_exp_f32 v164, v164
 v_mfma_f32_32x32x16_bf16 a[48:63], a[108:111], a[100:103], a[48:63]
 v_exp_f32 v165, v165
 v_cvt_pk_bf16_f32 v201, v162, v163
 v_exp_f32 v166, v166
 v_exp_f32 v167, v167
 v_mfma_f32_32x32x16_bf16 v[64:79], v[228:231], v[180:183], v[64:79]
 v_cvt_pk_bf16_f32 v202, v164, v165
 v_exp_f32 v168, v168
 v_exp_f32 v169, v169
 v_mfma_f32_32x32x16_bf16 a[64:79], a[112:115], a[96:99], a[64:79]
 v_cvt_pk_bf16_f32 v203, v166, v167
 v_exp_f32 v170, v170
 v_exp_f32 v171, v171
 v_mfma_f32_32x32x16_bf16 v[80:95], v[228:231], v[188:191], v[80:95]
 v_cvt_pk_bf16_f32 v204, v168, v169
 v_exp_f32 v172, v172
 v_exp_f32 v173, v173
 v_cvt_pk_bf16_f32 v205, v170, v171
 v_mfma_f32_32x32x16_bf16 a[80:95], a[112:115], a[100:103], a[80:95]
 buffer_load_dwordx4 a[96:99], v14, s[36:39], s63 offen sc1
 v_exp_f32 v174, v174
 v_exp_f32 v175, v175
 v_cvt_pk_bf16_f32 v206, v172, v173
 s_waitcnt lgkmcnt(0)
 v_cvt_pk_bf16_f32 v207, v174, v175
 v_mfma_f32_32x32x16_bf16 v[144:159], v[216:219], v[96:99], v[32:47]
 ds_read_b128 v[208:211], v10 offset:6144
 ds_read_b32 v212, v11 offset:768
 v_exp_f32 v112, v112
 v_exp_f32 v113, v113
 v_exp_f32 v114, v114
 v_mfma_f32_32x32x16_bf16 v[160:175], v[216:219], v[104:107], v[48:63]
 ds_read_b128 v[224:227], v12 offset:5120
 ds_read_b128 v[228:231], v12 offset:5760
 buffer_load_dwordx4 a[100:103], v14, s[36:39], s64 offen sc1
 v_exp_f32 v115, v115
 v_cvt_pk_bf16_f32 v176, v112, v113
 v_exp_f32 v116, v116
 v_exp_f32 v117, v117
 s_waitcnt vmcnt(37)
 v_mfma_f32_32x32x16_bf16 a[0:15], a[124:127], a[116:119], a[0:15]
 v_cvt_pk_bf16_f32 v177, v114, v115
 v_exp_f32 v118, v118
 v_exp_f32 v119, v119
 v_mfma_f32_32x32x16_bf16 v[144:159], v[220:223], v[100:103], v[144:159]
 buffer_load_dwordx4 a[104:107], v14, s[36:39], s65 offen sc1
 v_cvt_pk_bf16_f32 v178, v116, v117
 v_exp_f32 v120, v120
 v_exp_f32 v121, v121
 v_mfma_f32_32x32x16_bf16 a[16:31], a[124:127], a[120:123], a[16:31]
 v_cvt_pk_bf16_f32 v179, v118, v119
 v_exp_f32 v122, v122
 v_exp_f32 v123, v123
 v_cvt_pk_bf16_f32 v180, v120, v121
 v_mfma_f32_32x32x16_bf16 v[160:175], v[220:223], v[108:111], v[160:175]
 buffer_load_dwordx4 a[108:111], v14, s[36:39], s65 offen offset:1024 sc1
 v_exp_f32 v124, v124
 v_exp_f32 v125, v125
 v_cvt_pk_bf16_f32 v181, v122, v123
 v_mfma_f32_32x32x16_bf16 a[32:47], a[128:131], a[116:119], a[32:47]
 v_exp_f32 v126, v126
 v_exp_f32 v127, v127
 v_cvt_pk_bf16_f32 v182, v124, v125
 v_exp_f32 v128, v128
 v_mfma_f32_32x32x16_bf16 v[64:79], v[232:235], v[192:195], v[64:79]
 buffer_load_dwordx4 a[112:115], v14, s[36:39], s65 offen offset:2048 sc1
 s_add_u32 s65, s65, 18432
 v_exp_f32 v129, v129
 v_cvt_pk_bf16_f32 v183, v126, v127
 v_exp_f32 v130, v130
 v_mfma_f32_32x32x16_bf16 v[80:95], v[232:235], v[200:203], v[80:95]
 v_exp_f32 v131, v131
 v_cvt_pk_bf16_f32 v184, v128, v129
 v_exp_f32 v132, v132
 v_mfma_f32_32x32x16_bf16 a[48:63], a[128:131], a[120:123], a[48:63]
 v_exp_f32 v133, v133
 v_cvt_pk_bf16_f32 v185, v130, v131
 v_exp_f32 v134, v134
 v_exp_f32 v135, v135
 v_mfma_f32_32x32x16_bf16 v[64:79], v[236:239], v[196:199], v[64:79]
 v_cvt_pk_bf16_f32 v186, v132, v133
 v_exp_f32 v136, v136
 v_exp_f32 v137, v137
 v_mfma_f32_32x32x16_bf16 a[64:79], a[132:135], a[116:119], a[64:79]
 v_cvt_pk_bf16_f32 v187, v134, v135
 v_exp_f32 v138, v138
 v_exp_f32 v139, v139
 v_mfma_f32_32x32x16_bf16 v[80:95], v[236:239], v[204:207], v[80:95]
 v_cvt_pk_bf16_f32 v188, v136, v137
 v_exp_f32 v140, v140
 v_exp_f32 v141, v141
 v_cvt_pk_bf16_f32 v189, v138, v139
 v_mfma_f32_32x32x16_bf16 a[80:95], a[132:135], a[120:123], a[80:95]
 buffer_load_dwordx4 a[116:119], v14, s[36:39], s63 offen offset:1024 sc1
 v_exp_f32 v142, v142
 v_exp_f32 v143, v143
 v_cvt_pk_bf16_f32 v190, v140, v141
 s_waitcnt lgkmcnt(0)
 v_cvt_pk_bf16_f32 v191, v142, v143
 v_mfma_f32_32x32x16_bf16 v[112:127], v[208:211], v[96:99], v[32:47]
 ds_read_b128 v[216:219], v10 offset:7168
 ds_read_b32 v220, v11 offset:896
 v_exp_f32 v144, v144
 v_exp_f32 v145, v145
 v_exp_f32 v146, v146
 v_mfma_f32_32x32x16_bf16 v[128:143], v[208:211], v[104:107], v[48:63]
 ds_read_b128 v[232:235], v12 offset:6400
 ds_read_b128 v[236:239], v12 offset:7040
 s_add_u32 s57, s57, 20480
 s_cmp_eq_u32 s57, 61440
 s_cselect_b32 s57, 0, s57
 buffer_load_dwordx4 a[120:123], v14, s[36:39], s64 offen offset:1024 sc1
 v_exp_f32 v147, v147
 v_cvt_pk_bf16_f32 v192, v144, v145
 v_exp_f32 v148, v148
 v_exp_f32 v149, v149
 s_waitcnt vmcnt(37)
 v_mfma_f32_32x32x16_bf16 a[0:15], a[144:147], a[136:139], a[0:15]
 v_cvt_pk_bf16_f32 v193, v146, v147
 v_exp_f32 v150, v150
 v_exp_f32 v151, v151
 v_mfma_f32_32x32x16_bf16 v[112:127], v[212:215], v[100:103], v[112:127]
 buffer_load_dwordx4 a[124:127], v14, s[36:39], s65 offen sc1
 v_cvt_pk_bf16_f32 v194, v148, v149
 v_exp_f32 v152, v152
 v_exp_f32 v153, v153
 v_mfma_f32_32x32x16_bf16 a[16:31], a[144:147], a[140:143], a[16:31]
 v_cvt_pk_bf16_f32 v195, v150, v151
 v_exp_f32 v154, v154
 v_exp_f32 v155, v155
 v_cvt_pk_bf16_f32 v196, v152, v153
 v_mfma_f32_32x32x16_bf16 v[128:143], v[212:215], v[108:111], v[128:143]
 buffer_load_dwordx4 a[128:131], v14, s[36:39], s65 offen offset:1024 sc1
 v_exp_f32 v156, v156
 v_exp_f32 v157, v157
 v_cvt_pk_bf16_f32 v197, v154, v155
 v_mfma_f32_32x32x16_bf16 a[32:47], a[148:151], a[136:139], a[32:47]
 v_exp_f32 v158, v158
 v_exp_f32 v159, v159
 v_cvt_pk_bf16_f32 v198, v156, v157
 v_exp_f32 v160, v160
 v_mfma_f32_32x32x16_bf16 v[64:79], v[224:227], v[176:179], v[64:79]
 buffer_load_dwordx4 a[132:135], v14, s[36:39], s65 offen offset:2048 sc1
 s_add_u32 s65, s65, 18432
 v_exp_f32 v161, v161
 v_cvt_pk_bf16_f32 v199, v158, v159
 v_exp_f32 v162, v162
 v_mfma_f32_32x32x16_bf16 v[80:95], v[224:227], v[184:187], v[80:95]
 v_exp_f32 v163, v163
 v_cvt_pk_bf16_f32 v200, v160, v161
 v_exp_f32 v164, v164
 v_mfma_f32_32x32x16_bf16 a[48:63], a[148:151], a[140:143], a[48:63]
 v_exp_f32 v165, v165
 v_cvt_pk_bf16_f32 v201, v162, v163
 v_exp_f32 v166, v166
 v_exp_f32 v167, v167
 v_mfma_f32_32x32x16_bf16 v[64:79], v[228:231], v[180:183], v[64:79]
 v_cvt_pk_bf16_f32 v202, v164, v165
 v_exp_f32 v168, v168
 v_exp_f32 v169, v169
 v_mfma_f32_32x32x16_bf16 a[64:79], a[152:155], a[136:139], a[64:79]
 v_cvt_pk_bf16_f32 v203, v166, v167
 v_exp_f32 v170, v170
 v_exp_f32 v171, v171
 v_mfma_f32_32x32x16_bf16 v[80:95], v[228:231], v[188:191], v[80:95]
 v_cvt_pk_bf16_f32 v204, v168, v169
 v_exp_f32 v172, v172
 v_exp_f32 v173, v173
 v_cvt_pk_bf16_f32 v205, v170, v171
 v_mfma_f32_32x32x16_bf16 a[80:95], a[152:155], a[140:143], a[80:95]
 buffer_load_dwordx4 a[136:139], v14, s[36:39], s63 offen offset:2048 sc1
 v_exp_f32 v174, v174
 v_exp_f32 v175, v175
 v_cvt_pk_bf16_f32 v206, v172, v173
 v_add_u32 v10, s57, v14
 v_add_u32 v11, s57, v20
 v_add_u32 v253, s57, v252
 s_waitcnt lgkmcnt(0)
 v_cvt_pk_bf16_f32 v207, v174, v175
 v_mfma_f32_32x32x16_bf16 v[144:159], v[216:219], v[96:99], v[32:47]
 s_waitcnt vmcnt(31)
 ds_write_b128 v253, v[248:251]
 s_waitcnt lgkmcnt(0)
 s_barrier
 ds_read_b128 v[208:211], v10
 ds_read_b32 v212, v11
 v_exp_f32 v112, v112
 v_exp_f32 v113, v113
 v_exp_f32 v114, v114
 v_mfma_f32_32x32x16_bf16 v[160:175], v[216:219], v[104:107], v[48:63]
 ds_read_b128 v[224:227], v12 offset:7680
 ds_read_b128 v[228:231], v12 offset:8320
 buffer_load_dwordx4 a[140:143], v14, s[36:39], s64 offen offset:2048 sc1
 v_exp_f32 v115, v115
 v_cvt_pk_bf16_f32 v176, v112, v113
 v_exp_f32 v116, v116
 v_exp_f32 v117, v117
 s_waitcnt vmcnt(35)
 v_mfma_f32_32x32x16_bf16 a[0:15], a[164:167], a[156:159], a[0:15]
 v_cvt_pk_bf16_f32 v177, v114, v115
 v_exp_f32 v118, v118
 v_exp_f32 v119, v119
 v_mfma_f32_32x32x16_bf16 v[144:159], v[220:223], v[100:103], v[144:159]
 buffer_load_dwordx4 a[144:147], v14, s[36:39], s65 offen sc1
 v_cvt_pk_bf16_f32 v178, v116, v117
 v_exp_f32 v120, v120
 v_exp_f32 v121, v121
 v_mfma_f32_32x32x16_bf16 a[16:31], a[164:167], a[160:163], a[16:31]
 v_cvt_pk_bf16_f32 v179, v118, v119
 v_exp_f32 v122, v122
 v_exp_f32 v123, v123
 v_cvt_pk_bf16_f32 v180, v120, v121
 v_mfma_f32_32x32x16_bf16 v[160:175], v[220:223], v[108:111], v[160:175]
 buffer_load_dwordx4 a[148:151], v14, s[36:39], s65 offen offset:1024 sc1
 v_exp_f32 v124, v124
 v_exp_f32 v125, v125
 v_cvt_pk_bf16_f32 v181, v122, v123
 v_mfma_f32_32x32x16_bf16 a[32:47], a[168:171], a[156:159], a[32:47]
 v_exp_f32 v126, v126
 v_exp_f32 v127, v127
 v_cvt_pk_bf16_f32 v182, v124, v125
 v_exp_f32 v128, v128
 v_mfma_f32_32x32x16_bf16 v[64:79], v[232:235], v[192:195], v[64:79]
 buffer_load_dwordx4 a[152:155], v14, s[36:39], s65 offen offset:2048 sc1
 s_add_u32 s65, s65, 18432
 v_exp_f32 v129, v129
 v_cvt_pk_bf16_f32 v183, v126, v127
 v_exp_f32 v130, v130
 v_mfma_f32_32x32x16_bf16 v[80:95], v[232:235], v[200:203], v[80:95]
 v_exp_f32 v131, v131
 v_cvt_pk_bf16_f32 v184, v128, v129
 v_exp_f32 v132, v132
 v_mfma_f32_32x32x16_bf16 a[48:63], a[168:171], a[160:163], a[48:63]
 s_add_u32 m0, s35, s58
 v_exp_f32 v133, v133
 v_cvt_pk_bf16_f32 v185, v130, v131
 v_exp_f32 v134, v134
 v_exp_f32 v135, v135
 v_mfma_f32_32x32x16_bf16 v[64:79], v[236:239], v[196:199], v[64:79]
 buffer_load_dwordx4 v13, s[36:39], s56 offen sc1 lds
 v_cvt_pk_bf16_f32 v186, v132, v133
 v_exp_f32 v136, v136
 v_exp_f32 v137, v137
 v_mfma_f32_32x32x16_bf16 a[64:79], a[172:175], a[156:159], a[64:79]
 v_cvt_pk_bf16_f32 v187, v134, v135
 v_exp_f32 v138, v138
 v_exp_f32 v139, v139
 v_mfma_f32_32x32x16_bf16 v[80:95], v[236:239], v[204:207], v[80:95]
 buffer_load_dwordx4 v13, s[36:39], s56 offen offset:1024 sc1 lds
 v_cvt_pk_bf16_f32 v188, v136, v137
 v_exp_f32 v140, v140
 v_exp_f32 v141, v141
 v_cvt_pk_bf16_f32 v189, v138, v139
 v_mfma_f32_32x32x16_bf16 a[80:95], a[172:175], a[160:163], a[80:95]
 v_exp_f32 v142, v142
 v_exp_f32 v143, v143
 v_cvt_pk_bf16_f32 v190, v140, v141
 s_waitcnt lgkmcnt(0)
 v_cvt_pk_bf16_f32 v191, v142, v143
 v_mfma_f32_32x32x16_bf16 v[112:127], v[208:211], v[96:99], v[32:47]
 ds_read_b128 v[216:219], v10 offset:1024
 ds_read_b32 v220, v11 offset:128
 buffer_load_dwordx4 a[156:159], v14, s[36:39], s63 offen offset:3072 sc1
 s_add_u32 s63, s63, 4096
 v_exp_f32 v144, v144
 v_exp_f32 v145, v145
 v_exp_f32 v146, v146
 v_mfma_f32_32x32x16_bf16 v[128:143], v[208:211], v[104:107], v[48:63]
 ds_read_b128 v[232:235], v12 offset:8960
 ds_read_b128 v[236:239], v12 offset:9600
 v_exp_f32 v147, v147
 v_cvt_pk_bf16_f32 v192, v144, v145
 v_exp_f32 v148, v148
 v_exp_f32 v149, v149
 s_waitcnt vmcnt(33)
 v_mfma_f32_32x32x16_bf16 a[0:15], a[184:187], a[176:179], a[0:15]
 buffer_load_dwordx4 a[160:163], v14, s[36:39], s64 offen offset:3072 sc1
 s_add_u32 s64, s64, 4096
 v_cvt_pk_bf16_f32 v193, v146, v147
 v_exp_f32 v150, v150
 v_exp_f32 v151, v151
 v_mfma_f32_32x32x16_bf16 v[112:127], v[212:215], v[100:103], v[112:127]
 v_cvt_pk_bf16_f32 v194, v148, v149
 v_exp_f32 v152, v152
 v_exp_f32 v153, v153
 v_mfma_f32_32x32x16_bf16 a[16:31], a[184:187], a[180:183], a[16:31]
 buffer_load_dwordx4 a[164:167], v14, s[36:39], s65 offen sc1
 v_cvt_pk_bf16_f32 v195, v150, v151
 v_exp_f32 v154, v154
 v_exp_f32 v155, v155
 v_cvt_pk_bf16_f32 v196, v152, v153
 v_mfma_f32_32x32x16_bf16 v[128:143], v[212:215], v[108:111], v[128:143]
 v_exp_f32 v156, v156
 v_exp_f32 v157, v157
 v_cvt_pk_bf16_f32 v197, v154, v155
 v_mfma_f32_32x32x16_bf16 a[32:47], a[188:191], a[176:179], a[32:47]
 buffer_load_dwordx4 a[168:171], v14, s[36:39], s65 offen offset:1024 sc1
 v_exp_f32 v158, v158
 v_exp_f32 v159, v159
 v_cvt_pk_bf16_f32 v198, v156, v157
 v_exp_f32 v160, v160
 v_mfma_f32_32x32x16_bf16 v[64:79], v[224:227], v[176:179], v[64:79]
 v_exp_f32 v161, v161
 v_cvt_pk_bf16_f32 v199, v158, v159
 v_exp_f32 v162, v162
 v_mfma_f32_32x32x16_bf16 v[80:95], v[224:227], v[184:187], v[80:95]
 buffer_load_dwordx4 a[172:175], v14, s[36:39], s65 offen offset:2048 sc1
 s_add_u32 s65, s65, 18432
 v_exp_f32 v163, v163
 v_cvt_pk_bf16_f32 v200, v160, v161
 v_exp_f32 v164, v164
 v_mfma_f32_32x32x16_bf16 a[48:63], a[188:191], a[180:183], a[48:63]
 v_exp_f32 v165, v165
 v_cvt_pk_bf16_f32 v201, v162, v163
 v_exp_f32 v166, v166
 v_exp_f32 v167, v167
 v_mfma_f32_32x32x16_bf16 v[64:79], v[228:231], v[180:183], v[64:79]
 buffer_load_dwordx4 v13, s[36:39], s56 offen offset:2048 sc1 lds
 v_cvt_pk_bf16_f32 v202, v164, v165
 v_exp_f32 v168, v168
 v_exp_f32 v169, v169
 v_mfma_f32_32x32x16_bf16 a[64:79], a[192:195], a[176:179], a[64:79]
 v_cvt_pk_bf16_f32 v203, v166, v167
 v_exp_f32 v170, v170
 v_exp_f32 v171, v171
 v_mfma_f32_32x32x16_bf16 v[80:95], v[228:231], v[188:191], v[80:95]
 buffer_load_dwordx4 v13, s[36:39], s56 offen offset:3072 sc1 lds
 s_add_u32 m0, m0, 4096
 s_add_u32 s56, s56, 4096
 v_cvt_pk_bf16_f32 v204, v168, v169
 v_exp_f32 v172, v172
 v_exp_f32 v173, v173
 v_cvt_pk_bf16_f32 v205, v170, v171
 v_mfma_f32_32x32x16_bf16 a[80:95], a[192:195], a[180:183], a[80:95]
 v_exp_f32 v174, v174
 v_exp_f32 v175, v175
 v_cvt_pk_bf16_f32 v206, v172, v173
 v_add_u32 v12, s57, v21
 s_waitcnt lgkmcnt(0)
 v_cvt_pk_bf16_f32 v207, v174, v175
 s_cmp_lg_u32 s66, 0
 s_cbranch_scc1 L_m_t
 v_mfma_f32_32x32x16_bf16 v[144:159], v[216:219], v[96:99], v[32:47]
 ds_read_b128 v[208:211], v10 offset:2048
 ds_read_b32 v212, v11 offset:256
 buffer_load_dwordx4 v13, s[36:39], s56 offen sc1 lds
 v_exp_f32 v112, v112
 v_exp_f32 v113, v113
 v_exp_f32 v114, v114
 v_mfma_f32_32x32x16_bf16 v[160:175], v[216:219], v[104:107], v[48:63]
 ds_read_b128 v[224:227], v12
 ds_read_b128 v[228:231], v12 offset:640
 v_exp_f32 v115, v115
 v_cvt_pk_bf16_f32 v176, v112, v113
 v_exp_f32 v116, v116
 v_exp_f32 v117, v117
 s_waitcnt vmcnt(35)
 v_mfma_f32_32x32x16_bf16 a[0:15], a[204:207], a[196:199], a[0:15]
 s_add_u32 s56, s56, 16384
 s_add_u32 s35, s35, 20480
 s_cmp_eq_u32 s35, 61440
 s_cselect_b32 s35, 0, s35
 s_sub_u32 s66, s66, 1
 buffer_load_dwordx4 a[176:179], v14, s[36:39], s63 offen sc1
 v_cvt_pk_bf16_f32 v177, v114, v115
 v_exp_f32 v118, v118
 v_exp_f32 v119, v119
 v_mfma_f32_32x32x16_bf16 v[144:159], v[220:223], v[100:103], v[144:159]
 v_cvt_pk_bf16_f32 v178, v116, v117
 v_exp_f32 v120, v120
 v_exp_f32 v121, v121
 v_mfma_f32_32x32x16_bf16 a[16:31], a[204:207], a[200:203], a[16:31]
 buffer_load_dwordx4 a[180:183], v14, s[36:39], s64 offen sc1
 v_cvt_pk_bf16_f32 v179, v118, v119
 v_exp_f32 v122, v122
 v_exp_f32 v123, v123
 v_cvt_pk_bf16_f32 v180, v120, v121
 v_mfma_f32_32x32x16_bf16 v[160:175], v[220:223], v[108:111], v[160:175]
 v_exp_f32 v124, v124
 v_exp_f32 v125, v125
 v_cvt_pk_bf16_f32 v181, v122, v123
 v_mfma_f32_32x32x16_bf16 a[32:47], a[208:211], a[196:199], a[32:47]
 buffer_load_dwordx4 a[184:187], v14, s[36:39], s65 offen sc1
 v_exp_f32 v126, v126
 v_exp_f32 v127, v127
 v_cvt_pk_bf16_f32 v182, v124, v125
 v_exp_f32 v128, v128
 v_mfma_f32_32x32x16_bf16 v[64:79], v[232:235], v[192:195], v[64:79]
 v_exp_f32 v129, v129
 v_cvt_pk_bf16_f32 v183, v126, v127
 v_exp_f32 v130, v130
 v_mfma_f32_32x32x16_bf16 v[80:95], v[232:235], v[200:203], v[80:95]
 buffer_load_dwordx4 a[188:191], v14, s[36:39], s65 offen offset:1024 sc1
 v_exp_f32 v131, v131
 v_cvt_pk_bf16_f32 v184, v128, v129
 v_exp_f32 v132, v132
 v_mfma_f32_32x32x16_bf16 a[48:63], a[208:211], a[200:203], a[48:63]
 v_exp_f32 v133, v133
 v_cvt_pk_bf16_f32 v185, v130, v131
 v_exp_f32 v134, v134
 v_exp_f32 v135, v135
 v_mfma_f32_32x32x16_bf16 v[64:79], v[236:239], v[196:199], v[64:79]
 buffer_load_dwordx4 a[192:195], v14, s[36:39], s65 offen offset:2048 sc1
 s_add_u32 s65, s65, 18432
 v_cvt_pk_bf16_f32 v186, v132, v133
 v_exp_f32 v136, v136
 v_exp_f32 v137, v137
 v_mfma_f32_32x32x16_bf16 a[64:79], a[212:215], a[196:199], a[64:79]
 v_cvt_pk_bf16_f32 v187, v134, v135
 v_exp_f32 v138, v138
 v_exp_f32 v139, v139
 v_mfma_f32_32x32x16_bf16 v[80:95], v[236:239], v[204:207], v[80:95]
 v_cvt_pk_bf16_f32 v188, v136, v137
 v_exp_f32 v140, v140
 v_exp_f32 v141, v141
 v_cvt_pk_bf16_f32 v189, v138, v139
 v_mfma_f32_32x32x16_bf16 a[80:95], a[212:215], a[200:203], a[80:95]
 buffer_load_dwordx4 a[196:199], v14, s[36:39], s63 offen offset:1024 sc1
 v_exp_f32 v142, v142
 v_exp_f32 v143, v143
 v_cvt_pk_bf16_f32 v190, v140, v141
 s_waitcnt lgkmcnt(0)
 v_cvt_pk_bf16_f32 v191, v142, v143
 v_mfma_f32_32x32x16_bf16 v[112:127], v[208:211], v[96:99], v[32:47]
 ds_read_b128 v[216:219], v10 offset:3072
 ds_read_b32 v220, v11 offset:384
 v_exp_f32 v144, v144
 v_exp_f32 v145, v145
 v_exp_f32 v146, v146
 v_mfma_f32_32x32x16_bf16 v[128:143], v[208:211], v[104:107], v[48:63]
 ds_read_b128 v[232:235], v12 offset:1280
 ds_read_b128 v[236:239], v12 offset:1920
 buffer_load_dwordx4 a[200:203], v14, s[36:39], s64 offen offset:1024 sc1
 v_exp_f32 v147, v147
 v_cvt_pk_bf16_f32 v192, v144, v145
 v_exp_f32 v148, v148
 v_exp_f32 v149, v149
 s_waitcnt vmcnt(37)
 v_mfma_f32_32x32x16_bf16 a[0:15], a[224:227], a[216:219], a[0:15]
 v_cvt_pk_bf16_f32 v193, v146, v147
 v_exp_f32 v150, v150
 v_exp_f32 v151, v151
 v_mfma_f32_32x32x16_bf16 v[112:127], v[212:215], v[100:103], v[112:127]
 buffer_load_dwordx4 a[204:207], v14, s[36:39], s65 offen sc1
 v_cvt_pk_bf16_f32 v194, v148, v149
 v_exp_f32 v152, v152
 v_exp_f32 v153, v153
 v_mfma_f32_32x32x16_bf16 a[16:31], a[224:227], a[220:223], a[16:31]
 v_cvt_pk_bf16_f32 v195, v150, v151
 v_exp_f32 v154, v154
 v_exp_f32 v155, v155
 v_cvt_pk_bf16_f32 v196, v152, v153
 v_mfma_f32_32x32x16_bf16 v[128:143], v[212:215], v[108:111], v[128:143]
 buffer_load_dwordx4 a[208:211], v14, s[36:39], s65 offen offset:1024 sc1
 v_exp_f32 v156, v156
 v_exp_f32 v157, v157
 v_cvt_pk_bf16_f32 v197, v154, v155
 v_mfma_f32_32x32x16_bf16 a[32:47], a[228:231], a[216:219], a[32:47]
 v_exp_f32 v158, v158
 v_exp_f32 v159, v159
 v_cvt_pk_bf16_f32 v198, v156, v157
 v_exp_f32 v160, v160
 v_mfma_f32_32x32x16_bf16 v[64:79], v[224:227], v[176:179], v[64:79]
 buffer_load_dwordx4 a[212:215], v14, s[36:39], s65 offen offset:2048 sc1
 s_add_u32 s65, s65, 18432
 v_exp_f32 v161, v161
 v_cvt_pk_bf16_f32 v199, v158, v159
 v_exp_f32 v162, v162
 v_mfma_f32_32x32x16_bf16 v[80:95], v[224:227], v[184:187], v[80:95]
 v_exp_f32 v163, v163
 v_cvt_pk_bf16_f32 v200, v160, v161
 v_exp_f32 v164, v164
 v_mfma_f32_32x32x16_bf16 a[48:63], a[228:231], a[220:223], a[48:63]
 v_exp_f32 v165, v165
 v_cvt_pk_bf16_f32 v201, v162, v163
 v_exp_f32 v166, v166
 v_exp_f32 v167, v167
 v_mfma_f32_32x32x16_bf16 v[64:79], v[228:231], v[180:183], v[64:79]
 v_cvt_pk_bf16_f32 v202, v164, v165
 v_exp_f32 v168, v168
 v_exp_f32 v169, v169
 v_mfma_f32_32x32x16_bf16 a[64:79], a[232:235], a[216:219], a[64:79]
 v_cvt_pk_bf16_f32 v203, v166, v167
 v_exp_f32 v170, v170
 v_exp_f32 v171, v171
 v_mfma_f32_32x32x16_bf16 v[80:95], v[228:231], v[188:191], v[80:95]
 v_cvt_pk_bf16_f32 v204, v168, v169
 v_exp_f32 v172, v172
 v_exp_f32 v173, v173
 v_cvt_pk_bf16_f32 v205, v170, v171
 v_mfma_f32_32x32x16_bf16 a[80:95], a[232:235], a[220:223], a[80:95]
 buffer_load_dwordx4 a[216:219], v14, s[36:39], s63 offen offset:2048 sc1
 v_exp_f32 v174, v174
 v_exp_f32 v175, v175
 v_cvt_pk_bf16_f32 v206, v172, v173
 s_waitcnt lgkmcnt(0)
 v_cvt_pk_bf16_f32 v207, v174, v175
 v_mfma_f32_32x32x16_bf16 v[144:159], v[216:219], v[96:99], v[32:47]
 ds_read_b128 v[208:211], v10 offset:4096
 ds_read_b32 v212, v11 offset:512
 v_exp_f32 v112, v112
 v_exp_f32 v113, v113
 v_exp_f32 v114, v114
 v_mfma_f32_32x32x16_bf16 v[160:175], v[216:219], v[104:107], v[48:63]
 ds_read_b128 v[224:227], v12 offset:2560
 ds_read_b128 v[228:231], v12 offset:3200
 buffer_load_dwordx4 a[220:223], v14, s[36:39], s64 offen offset:2048 sc1
 v_exp_f32 v115, v115
 v_cvt_pk_bf16_f32 v176, v112, v113
 v_exp_f32 v116, v116
 v_exp_f32 v117, v117
 s_waitcnt vmcnt(37)
 v_mfma_f32_32x32x16_bf16 a[0:15], a[244:247], a[236:239], a[0:15]
 v_cvt_pk_bf16_f32 v177, v114, v115
 v_exp_f32 v118, v118
 v_exp_f32 v119, v119
 v_mfma_f32_32x32x16_bf16 v[144:159], v[220:223], v[100:103], v[144:159]
 buffer_load_dwordx4 a[224:227], v14, s[36:39], s65 offen sc1
 v_cvt_pk_bf16_f32 v178, v116, v117
 v_exp_f32 v120, v120
 v_exp_f32 v121, v121
 v_mfma_f32_32x32x16_bf16 a[16:31], a[244:247], a[240:243], a[16:31]
 v_cvt_pk_bf16_f32 v179, v118, v119
 v_exp_f32 v122, v122
 v_exp_f32 v123, v123
 v_cvt_pk_bf16_f32 v180, v120, v121
 v_mfma_f32_32x32x16_bf16 v[160:175], v[220:223], v[108:111], v[160:175]
 buffer_load_dwordx4 a[228:231], v14, s[36:39], s65 offen offset:1024 sc1
 v_exp_f32 v124, v124
 v_exp_f32 v125, v125
 v_cvt_pk_bf16_f32 v181, v122, v123
 v_mfma_f32_32x32x16_bf16 a[32:47], a[248:251], a[236:239], a[32:47]
 v_exp_f32 v126, v126
 v_exp_f32 v127, v127
 v_cvt_pk_bf16_f32 v182, v124, v125
 v_exp_f32 v128, v128
 v_mfma_f32_32x32x16_bf16 v[64:79], v[232:235], v[192:195], v[64:79]
 buffer_load_dwordx4 a[232:235], v14, s[36:39], s65 offen offset:2048 sc1
 s_add_u32 s65, s65, 18432
 v_exp_f32 v129, v129
 v_cvt_pk_bf16_f32 v183, v126, v127
 v_exp_f32 v130, v130
 v_mfma_f32_32x32x16_bf16 v[80:95], v[232:235], v[200:203], v[80:95]
 v_exp_f32 v131, v131
 v_cvt_pk_bf16_f32 v184, v128, v129
 v_exp_f32 v132, v132
 v_mfma_f32_32x32x16_bf16 a[48:63], a[248:251], a[240:243], a[48:63]
 s_lshl_b32 s52, s30, 2
 s_add_u32 s52, s52, s28
 s_mul_i32 s52, s52, 5248
 s_add_u32 s52, s52, 69730304
 v_lshlrev_b32 v245, 7, v1
 buffer_load_dword v244, v245, s[36:39], s52 offen
 v_exp_f32 v133, v133
 v_cvt_pk_bf16_f32 v185, v130, v131
 v_exp_f32 v134, v134
 v_exp_f32 v135, v135
 v_mfma_f32_32x32x16_bf16 v[64:79], v[236:239], v[196:199], v[64:79]
 v_cvt_pk_bf16_f32 v186, v132, v133
 v_exp_f32 v136, v136
 v_exp_f32 v137, v137
 v_mfma_f32_32x32x16_bf16 a[64:79], a[252:255], a[236:239], a[64:79]
 v_cvt_pk_bf16_f32 v187, v134, v135
 v_exp_f32 v138, v138
 v_exp_f32 v139, v139
 v_mfma_f32_32x32x16_bf16 v[80:95], v[236:239], v[204:207], v[80:95]
 v_cvt_pk_bf16_f32 v188, v136, v137
 v_exp_f32 v140, v140
 v_exp_f32 v141, v141
 v_cvt_pk_bf16_f32 v189, v138, v139
 v_mfma_f32_32x32x16_bf16 a[80:95], a[252:255], a[240:243], a[80:95]
 buffer_load_dwordx4 a[236:239], v14, s[36:39], s63 offen offset:3072 sc1
 s_add_u32 s63, s63, 4096
 v_exp_f32 v142, v142
 v_exp_f32 v143, v143
 v_cvt_pk_bf16_f32 v190, v140, v141
 s_waitcnt lgkmcnt(0)
 v_cvt_pk_bf16_f32 v191, v142, v143
 v_mfma_f32_32x32x16_bf16 v[112:127], v[208:211], v[96:99], v[32:47]
 ds_read_b128 v[216:219], v10 offset:5120
 ds_read_b32 v220, v11 offset:640
 v_exp_f32 v144, v144
 v_exp_f32 v145, v145
 v_exp_f32 v146, v146
 v_mfma_f32_32x32x16_bf16 v[128:143], v[208:211], v[104:107], v[48:63]
 ds_read_b128 v[232:235], v12 offset:3840
 ds_read_b128 v[236:239], v12 offset:4480
 buffer_load_dwordx4 a[240:243], v14, s[36:39], s64 offen offset:3072 sc1
 s_add_u32 s64, s64, 4096
 v_exp_f32 v147, v147
 v_cvt_pk_bf16_f32 v192, v144, v145
 v_exp_f32 v148, v148
 v_exp_f32 v149, v149
 s_waitcnt vmcnt(38)
 v_mfma_f32_32x32x16_bf16 a[0:15], a[104:107], a[96:99], a[0:15]
 v_cvt_pk_bf16_f32 v193, v146, v147
 v_exp_f32 v150, v150
 v_exp_f32 v151, v151
 v_mfma_f32_32x32x16_bf16 v[112:127], v[212:215], v[100:103], v[112:127]
 buffer_load_dwordx4 a[244:247], v14, s[36:39], s65 offen sc1
 v_cvt_pk_bf16_f32 v194, v148, v149
 v_exp_f32 v152, v152
 v_exp_f32 v153, v153
 v_mfma_f32_32x32x16_bf16 a[16:31], a[104:107], a[100:103], a[16:31]
 v_cvt_pk_bf16_f32 v195, v150, v151
 v_exp_f32 v154, v154
 v_exp_f32 v155, v155
 v_cvt_pk_bf16_f32 v196, v152, v153
 v_mfma_f32_32x32x16_bf16 v[128:143], v[212:215], v[108:111], v[128:143]
 buffer_load_dwordx4 a[248:251], v14, s[36:39], s65 offen offset:1024 sc1
 v_exp_f32 v156, v156
 v_exp_f32 v157, v157
 v_cvt_pk_bf16_f32 v197, v154, v155
 v_mfma_f32_32x32x16_bf16 a[32:47], a[108:111], a[96:99], a[32:47]
 v_exp_f32 v158, v158
 v_exp_f32 v159, v159
 v_cvt_pk_bf16_f32 v198, v156, v157
 v_exp_f32 v160, v160
 v_mfma_f32_32x32x16_bf16 v[64:79], v[224:227], v[176:179], v[64:79]
 buffer_load_dwordx4 a[252:255], v14, s[36:39], s65 offen offset:2048 sc1
 s_add_u32 s65, s65, 18432
 v_exp_f32 v161, v161
 v_cvt_pk_bf16_f32 v199, v158, v159
 v_exp_f32 v162, v162
 v_mfma_f32_32x32x16_bf16 v[80:95], v[224:227], v[184:187], v[80:95]
 v_exp_f32 v163, v163
 v_cvt_pk_bf16_f32 v200, v160, v161
 v_exp_f32 v164, v164
 v_mfma_f32_32x32x16_bf16 a[48:63], a[108:111], a[100:103], a[48:63]
 v_exp_f32 v165, v165
 v_cvt_pk_bf16_f32 v201, v162, v163
 v_exp_f32 v166, v166
 v_exp_f32 v167, v167
 v_mfma_f32_32x32x16_bf16 v[64:79], v[228:231], v[180:183], v[64:79]
 v_cvt_pk_bf16_f32 v202, v164, v165
 v_exp_f32 v168, v168
 v_exp_f32 v169, v169
 v_mfma_f32_32x32x16_bf16 a[64:79], a[112:115], a[96:99], a[64:79]
 v_cvt_pk_bf16_f32 v203, v166, v167
 v_exp_f32 v170, v170
 v_exp_f32 v171, v171
 v_mfma_f32_32x32x16_bf16 v[80:95], v[228:231], v[188:191], v[80:95]
 v_cvt_pk_bf16_f32 v204, v168, v169
 v_exp_f32 v172, v172
 v_exp_f32 v173, v173
 v_cvt_pk_bf16_f32 v205, v170, v171
 v_mfma_f32_32x32x16_bf16 a[80:95], a[112:115], a[100:103], a[80:95]
 buffer_load_dwordx4 a[96:99], v14, s[36:39], s63 offen sc1
 v_exp_f32 v174, v174
 v_exp_f32 v175, v175
 v_cvt_pk_bf16_f32 v206, v172, v173
 s_waitcnt lgkmcnt(0)
 v_cvt_pk_bf16_f32 v207, v174, v175
 v_mfma_f32_32x32x16_bf16 v[144:159], v[216:219], v[96:99], v[32:47]
 ds_read_b128 v[208:211], v10 offset:6144
 ds_read_b32 v212, v11 offset:768
 v_exp_f32 v112, v112
 v_exp_f32 v113, v113
 v_exp_f32 v114, v114
 v_mfma_f32_32x32x16_bf16 v[160:175], v[216:219], v[104:107], v[48:63]
 ds_read_b128 v[224:227], v12 offset:5120
 ds_read_b128 v[228:231], v12 offset:5760
 buffer_load_dwordx4 a[100:103], v14, s[36:39], s64 offen sc1
 v_exp_f32 v115, v115
 v_cvt_pk_bf16_f32 v176, v112, v113
 v_exp_f32 v116, v116
 v_exp_f32 v117, v117
 s_waitcnt vmcnt(38)
 v_mfma_f32_32x32x16_bf16 a[0:15], a[124:127], a[116:119], a[0:15]
 v_cvt_pk_bf16_f32 v177, v114, v115
 v_exp_f32 v118, v118
 v_exp_f32 v119, v119
 v_mfma_f32_32x32x16_bf16 v[144:159], v[220:223], v[100:103], v[144:159]
 buffer_load_dwordx4 a[104:107], v14, s[36:39], s65 offen sc1
 v_cvt_pk_bf16_f32 v178, v116, v117
 v_exp_f32 v120, v120
 v_exp_f32 v121, v121
 v_mfma_f32_32x32x16_bf16 a[16:31], a[124:127], a[120:123], a[16:31]
 v_cvt_pk_bf16_f32 v179, v118, v119
 v_exp_f32 v122, v122
 v_exp_f32 v123, v123
 v_cvt_pk_bf16_f32 v180, v120, v121
 v_mfma_f32_32x32x16_bf16 v[160:175], v[220:223], v[108:111], v[160:175]
 buffer_load_dwordx4 a[108:111], v14, s[36:39], s65 offen offset:1024 sc1
 v_exp_f32 v124, v124
 v_exp_f32 v125, v125
 v_cvt_pk_bf16_f32 v181, v122, v123
 v_mfma_f32_32x32x16_bf16 a[32:47], a[128:131], a[116:119], a[32:47]
 v_exp_f32 v126, v126
 v_exp_f32 v127, v127
 v_cvt_pk_bf16_f32 v182, v124, v125
 v_exp_f32 v128, v128
 v_mfma_f32_32x32x16_bf16 v[64:79], v[232:235], v[192:195], v[64:79]
 buffer_load_dwordx4 a[112:115], v14, s[36:39], s65 offen offset:2048 sc1
 s_add_u32 s65, s65, 18432
 v_exp_f32 v129, v129
 v_cvt_pk_bf16_f32 v183, v126, v127
 v_exp_f32 v130, v130
 v_mfma_f32_32x32x16_bf16 v[80:95], v[232:235], v[200:203], v[80:95]
 v_exp_f32 v131, v131
 v_cvt_pk_bf16_f32 v184, v128, v129
 v_exp_f32 v132, v132
 v_mfma_f32_32x32x16_bf16 a[48:63], a[128:131], a[120:123], a[48:63]
 v_exp_f32 v133, v133
 v_cvt_pk_bf16_f32 v185, v130, v131
 v_exp_f32 v134, v134
 v_exp_f32 v135, v135
 v_mfma_f32_32x32x16_bf16 v[64:79], v[236:239], v[196:199], v[64:79]
 v_cvt_pk_bf16_f32 v186, v132, v133
 v_exp_f32 v136, v136
 v_exp_f32 v137, v137
 v_mfma_f32_32x32x16_bf16 a[64:79], a[132:135], a[116:119], a[64:79]
 v_cvt_pk_bf16_f32 v187, v134, v135
 v_exp_f32 v138, v138
 v_exp_f32 v139, v139
 v_mfma_f32_32x32x16_bf16 v[80:95], v[236:239], v[204:207], v[80:95]
 v_cvt_pk_bf16_f32 v188, v136, v137
 v_exp_f32 v140, v140
 v_exp_f32 v141, v141
 v_cvt_pk_bf16_f32 v189, v138, v139
 v_mfma_f32_32x32x16_bf16 a[80:95], a[132:135], a[120:123], a[80:95]
 buffer_load_dwordx4 a[116:119], v14, s[36:39], s63 offen offset:1024 sc1
 v_exp_f32 v142, v142
 v_exp_f32 v143, v143
 v_cvt_pk_bf16_f32 v190, v140, v141
 s_waitcnt lgkmcnt(0)
 v_cvt_pk_bf16_f32 v191, v142, v143
 v_mfma_f32_32x32x16_bf16 v[112:127], v[208:211], v[96:99], v[32:47]
 ds_read_b128 v[216:219], v10 offset:7168
 ds_read_b32 v220, v11 offset:896
 v_exp_f32 v144, v144
 v_exp_f32 v145, v145
 v_exp_f32 v146, v146
 v_mfma_f32_32x32x16_bf16 v[128:143], v[208:211], v[104:107], v[48:63]
 ds_read_b128 v[232:235], v12 offset:6400
 ds_read_b128 v[236:239], v12 offset:7040
 s_add_u32 s57, s57, 20480
 s_cmp_eq_u32 s57, 61440
 s_cselect_b32 s57, 0, s57
 buffer_load_dwordx4 a[120:123], v14, s[36:39], s64 offen offset:1024 sc1
 v_exp_f32 v147, v147
 v_cvt_pk_bf16_f32 v192, v144, v145
 v_exp_f32 v148, v148
 v_exp_f32 v149, v149
 s_waitcnt vmcnt(38)
 v_mfma_f32_32x32x16_bf16 a[0:15], a[144:147], a[136:139], a[0:15]
 v_cvt_pk_bf16_f32 v193, v146, v147
 v_exp_f32 v150, v150
 v_exp_f32 v151, v151
 v_mfma_f32_32x32x16_bf16 v[112:127], v[212:215], v[100:103], v[112:127]
 buffer_load_dwordx4 a[124:127], v14, s[36:39], s65 offen sc1
 v_cvt_pk_bf16_f32 v194, v148, v149
 v_exp_f32 v152, v152
 v_exp_f32 v153, v153
 v_mfma_f32_32x32x16_bf16 a[16:31], a[144:147], a[140:143], a[16:31]
 v_cvt_pk_bf16_f32 v195, v150, v151
 v_exp_f32 v154, v154
 v_exp_f32 v155, v155
 v_cvt_pk_bf16_f32 v196, v152, v153
 v_mfma_f32_32x32x16_bf16 v[128:143], v[212:215], v[108:111], v[128:143]
 buffer_load_dwordx4 a[128:131], v14, s[36:39], s65 offen offset:1024 sc1
 v_exp_f32 v156, v156
 v_exp_f32 v157, v157
 v_cvt_pk_bf16_f32 v197, v154, v155
 v_mfma_f32_32x32x16_bf16 a[32:47], a[148:151], a[136:139], a[32:47]
 v_exp_f32 v158, v158
 v_exp_f32 v159, v159
 v_cvt_pk_bf16_f32 v198, v156, v157
 v_exp_f32 v160, v160
 v_mfma_f32_32x32x16_bf16 v[64:79], v[224:227], v[176:179], v[64:79]
 buffer_load_dwordx4 a[132:135], v14, s[36:39], s65 offen offset:2048 sc1
 s_add_u32 s65, s65, 18432
 v_exp_f32 v161, v161
 v_cvt_pk_bf16_f32 v199, v158, v159
 v_exp_f32 v162, v162
 v_mfma_f32_32x32x16_bf16 v[80:95], v[224:227], v[184:187], v[80:95]
 v_exp_f32 v163, v163
 v_cvt_pk_bf16_f32 v200, v160, v161
 v_exp_f32 v164, v164
 v_mfma_f32_32x32x16_bf16 a[48:63], a[148:151], a[140:143], a[48:63]
 v_exp_f32 v165, v165
 v_cvt_pk_bf16_f32 v201, v162, v163
 v_exp_f32 v166, v166
 v_exp_f32 v167, v167
 v_mfma_f32_32x32x16_bf16 v[64:79], v[228:231], v[180:183], v[64:79]
 v_cvt_pk_bf16_f32 v202, v164, v165
 v_exp_f32 v168, v168
 v_exp_f32 v169, v169
 v_mfma_f32_32x32x16_bf16 a[64:79], a[152:155], a[136:139], a[64:79]
 v_cvt_pk_bf16_f32 v203, v166, v167
 v_exp_f32 v170, v170
 v_exp_f32 v171, v171
 v_mfma_f32_32x32x16_bf16 v[80:95], v[228:231], v[188:191], v[80:95]
 v_cvt_pk_bf16_f32 v204, v168, v169
 v_exp_f32 v172, v172
 v_exp_f32 v173, v173
 v_cvt_pk_bf16_f32 v205, v170, v171
 v_mfma_f32_32x32x16_bf16 a[80:95], a[152:155], a[140:143], a[80:95]
 buffer_load_dwordx4 a[136:139], v14, s[36:39], s63 offen offset:2048 sc1
 v_exp_f32 v174, v174
 v_exp_f32 v175, v175
 v_cvt_pk_bf16_f32 v206, v172, v173
 v_add_u32 v10, s57, v14
 v_add_u32 v11, s57, v20
 v_add_u32 v253, s57, v252
 s_waitcnt lgkmcnt(0)
 v_cvt_pk_bf16_f32 v207, v174, v175
 v_mfma_f32_32x32x16_bf16 v[144:159], v[216:219], v[96:99], v[32:47]
 s_waitcnt vmcnt(32)
 ds_write_b128 v253, v[248:251]
 s_waitcnt lgkmcnt(0)
 s_barrier
 ds_read_b128 v[208:211], v10
 ds_read_b32 v212, v11
 v_exp_f32 v112, v112
 v_exp_f32 v113, v113
 v_exp_f32 v114, v114
 v_mfma_f32_32x32x16_bf16 v[160:175], v[216:219], v[104:107], v[48:63]
 ds_read_b128 v[224:227], v12 offset:7680
 ds_read_b128 v[228:231], v12 offset:8320
 buffer_load_dwordx4 a[140:143], v14, s[36:39], s64 offen offset:2048 sc1
 v_exp_f32 v115, v115
 v_cvt_pk_bf16_f32 v176, v112, v113
 v_exp_f32 v116, v116
 v_exp_f32 v117, v117
 s_waitcnt vmcnt(36)
 v_mfma_f32_32x32x16_bf16 a[0:15], a[164:167], a[156:159], a[0:15]
 v_cvt_pk_bf16_f32 v177, v114, v115
 v_exp_f32 v118, v118
 v_exp_f32 v119, v119
 v_mfma_f32_32x32x16_bf16 v[144:159], v[220:223], v[100:103], v[144:159]
 buffer_load_dwordx4 a[144:147], v14, s[36:39], s65 offen sc1
 v_cvt_pk_bf16_f32 v178, v116, v117
 v_exp_f32 v120, v120
 v_exp_f32 v121, v121
 v_mfma_f32_32x32x16_bf16 a[16:31], a[164:167], a[160:163], a[16:31]
 v_cvt_pk_bf16_f32 v179, v118, v119
 v_exp_f32 v122, v122
 v_exp_f32 v123, v123
 v_cvt_pk_bf16_f32 v180, v120, v121
 v_mfma_f32_32x32x16_bf16 v[160:175], v[220:223], v[108:111], v[160:175]
 buffer_load_dwordx4 a[148:151], v14, s[36:39], s65 offen offset:1024 sc1
 v_exp_f32 v124, v124
 v_exp_f32 v125, v125
 v_cvt_pk_bf16_f32 v181, v122, v123
 v_mfma_f32_32x32x16_bf16 a[32:47], a[168:171], a[156:159], a[32:47]
 v_exp_f32 v126, v126
 v_exp_f32 v127, v127
 v_cvt_pk_bf16_f32 v182, v124, v125
 v_exp_f32 v128, v128
 v_mfma_f32_32x32x16_bf16 v[64:79], v[232:235], v[192:195], v[64:79]
 buffer_load_dwordx4 a[152:155], v14, s[36:39], s65 offen offset:2048 sc1
 s_add_u32 s65, s65, 18432
 v_exp_f32 v129, v129
 v_cvt_pk_bf16_f32 v183, v126, v127
 v_exp_f32 v130, v130
 v_mfma_f32_32x32x16_bf16 v[80:95], v[232:235], v[200:203], v[80:95]
 v_exp_f32 v131, v131
 v_cvt_pk_bf16_f32 v184, v128, v129
 v_exp_f32 v132, v132
 v_mfma_f32_32x32x16_bf16 a[48:63], a[168:171], a[160:163], a[48:63]
 v_exp_f32 v133, v133
 v_cvt_pk_bf16_f32 v185, v130, v131
 v_exp_f32 v134, v134
 v_exp_f32 v135, v135
 v_mfma_f32_32x32x16_bf16 v[64:79], v[236:239], v[196:199], v[64:79]
 v_cvt_pk_bf16_f32 v186, v132, v133
 v_exp_f32 v136, v136
 v_exp_f32 v137, v137
 v_mfma_f32_32x32x16_bf16 a[64:79], a[172:175], a[156:159], a[64:79]
 v_cvt_pk_bf16_f32 v187, v134, v135
 v_exp_f32 v138, v138
 v_exp_f32 v139, v139
 v_mfma_f32_32x32x16_bf16 v[80:95], v[236:239], v[204:207], v[80:95]
 v_cvt_pk_bf16_f32 v188, v136, v137
 v_exp_f32 v140, v140
 v_exp_f32 v141, v141
 v_cvt_pk_bf16_f32 v189, v138, v139
 v_mfma_f32_32x32x16_bf16 a[80:95], a[172:175], a[160:163], a[80:95]
 buffer_load_dwordx4 a[156:159], v14, s[36:39], s63 offen offset:3072 sc1
 s_add_u32 s63, s63, 4096
 v_exp_f32 v142, v142
 v_exp_f32 v143, v143
 v_cvt_pk_bf16_f32 v190, v140, v141
 s_waitcnt lgkmcnt(0)
 v_cvt_pk_bf16_f32 v191, v142, v143
 v_mfma_f32_32x32x16_bf16 v[112:127], v[208:211], v[96:99], v[32:47]
 ds_read_b128 v[216:219], v10 offset:1024
 ds_read_b32 v220, v11 offset:128
 v_exp_f32 v144, v144
 v_exp_f32 v145, v145
 v_exp_f32 v146, v146
 v_mfma_f32_32x32x16_bf16 v[128:143], v[208:211], v[104:107], v[48:63]
 ds_read_b128 v[232:235], v12 offset:8960
 ds_read_b128 v[236:239], v12 offset:9600
 buffer_load_dwordx4 a[160:163], v14, s[36:39], s64 offen offset:3072 sc1
 s_add_u32 s64, s64, 4096
 v_exp_f32 v147, v147
 v_cvt_pk_bf16_f32 v192, v144, v145
 v_exp_f32 v148, v148
 v_exp_f32 v149, v149
 s_waitcnt vmcnt(33)
 v_mfma_f32_32x32x16_bf16 a[0:15], a[184:187], a[176:179], a[0:15]
 v_cvt_pk_bf16_f32 v193, v146, v147
 v_exp_f32 v150, v150
 v_exp_f32 v151, v151
 v_mfma_f32_32x32x16_bf16 v[112:127], v[212:215], v[100:103], v[112:127]
 buffer_load_dwordx4 a[164:167], v14, s[36:39], s65 offen sc1
 v_cvt_pk_bf16_f32 v194, v148, v149
 v_exp_f32 v152, v152
 v_exp_f32 v153, v153
 v_mfma_f32_32x32x16_bf16 a[16:31], a[184:187], a[180:183], a[16:31]
 v_cvt_pk_bf16_f32 v195, v150, v151
 v_exp_f32 v154, v154
 v_exp_f32 v155, v155
 v_cvt_pk_bf16_f32 v196, v152, v153
 v_mfma_f32_32x32x16_bf16 v[128:143], v[212:215], v[108:111], v[128:143]
 buffer_load_dwordx4 a[168:171], v14, s[36:39], s65 offen offset:1024 sc1
 v_exp_f32 v156, v156
 v_exp_f32 v157, v157
 v_cvt_pk_bf16_f32 v197, v154, v155
 v_mfma_f32_32x32x16_bf16 a[32:47], a[188:191], a[176:179], a[32:47]
 v_exp_f32 v158, v158
 v_exp_f32 v159, v159
 v_cvt_pk_bf16_f32 v198, v156, v157
 v_exp_f32 v160, v160
 v_mfma_f32_32x32x16_bf16 v[64:79], v[224:227], v[176:179], v[64:79]
 buffer_load_dwordx4 a[172:175], v14, s[36:39], s65 offen offset:2048 sc1
 s_add_u32 s65, s65, 18432
 v_exp_f32 v161, v161
 v_cvt_pk_bf16_f32 v199, v158, v159
 v_exp_f32 v162, v162
 v_mfma_f32_32x32x16_bf16 v[80:95], v[224:227], v[184:187], v[80:95]
 v_exp_f32 v163, v163
 v_cvt_pk_bf16_f32 v200, v160, v161
 v_exp_f32 v164, v164
 v_mfma_f32_32x32x16_bf16 a[48:63], a[188:191], a[180:183], a[48:63]
 v_exp_f32 v165, v165
 v_cvt_pk_bf16_f32 v201, v162, v163
 v_exp_f32 v166, v166
 v_exp_f32 v167, v167
 v_mfma_f32_32x32x16_bf16 v[64:79], v[228:231], v[180:183], v[64:79]
 v_cvt_pk_bf16_f32 v202, v164, v165
 v_exp_f32 v168, v168
 v_exp_f32 v169, v169
 v_mfma_f32_32x32x16_bf16 a[64:79], a[192:195], a[176:179], a[64:79]
 v_cvt_pk_bf16_f32 v203, v166, v167
 v_exp_f32 v170, v170
 v_exp_f32 v171, v171
 v_mfma_f32_32x32x16_bf16 v[80:95], v[228:231], v[188:191], v[80:95]
 v_cvt_pk_bf16_f32 v204, v168, v169
 v_exp_f32 v172, v172
 v_exp_f32 v173, v173
 v_cvt_pk_bf16_f32 v205, v170, v171
 v_mfma_f32_32x32x16_bf16 a[80:95], a[192:195], a[180:183], a[80:95]
 buffer_load_dwordx4 a[176:179], v14, s[36:39], s63 offen sc1
 v_exp_f32 v174, v174
 v_exp_f32 v175, v175
 v_cvt_pk_bf16_f32 v206, v172, v173
 v_add_u32 v12, s57, v21
 s_waitcnt lgkmcnt(0)
 v_cvt_pk_bf16_f32 v207, v174, v175
 v_mfma_f32_32x32x16_bf16 v[144:159], v[216:219], v[96:99], v[32:47]
 ds_read_b128 v[208:211], v10 offset:2048
 ds_read_b32 v212, v11 offset:256
 v_exp_f32 v112, v112
 v_exp_f32 v113, v113
 v_exp_f32 v114, v114
 v_mfma_f32_32x32x16_bf16 v[160:175], v[216:219], v[104:107], v[48:63]
 ds_read_b128 v[224:227], v12
 ds_read_b128 v[228:231], v12 offset:640
 buffer_load_dwordx4 a[180:183], v14, s[36:39], s64 offen sc1
 v_exp_f32 v115, v115
 v_cvt_pk_bf16_f32 v176, v112, v113
 v_exp_f32 v116, v116
 v_exp_f32 v117, v117
 s_waitcnt vmcnt(33)
 v_mfma_f32_32x32x16_bf16 a[0:15], a[204:207], a[196:199], a[0:15]
 v_cvt_pk_bf16_f32 v177, v114, v115
 v_exp_f32 v118, v118
 v_exp_f32 v119, v119
 v_mfma_f32_32x32x16_bf16 v[144:159], v[220:223], v[100:103], v[144:159]
 buffer_load_dwordx4 a[184:187], v14, s[36:39], s65 offen sc1
 v_cvt_pk_bf16_f32 v178, v116, v117
 v_exp_f32 v120, v120
 v_exp_f32 v121, v121
 v_mfma_f32_32x32x16_bf16 a[16:31], a[204:207], a[200:203], a[16:31]
 v_cvt_pk_bf16_f32 v179, v118, v119
 v_exp_f32 v122, v122
 v_exp_f32 v123, v123
 v_cvt_pk_bf16_f32 v180, v120, v121
 v_mfma_f32_32x32x16_bf16 v[160:175], v[220:223], v[108:111], v[160:175]
 buffer_load_dwordx4 a[188:191], v14, s[36:39], s65 offen offset:1024 sc1
 v_exp_f32 v124, v124
 v_exp_f32 v125, v125
 v_cvt_pk_bf16_f32 v181, v122, v123
 v_mfma_f32_32x32x16_bf16 a[32:47], a[208:211], a[196:199], a[32:47]
 v_exp_f32 v126, v126
 v_exp_f32 v127, v127
 v_cvt_pk_bf16_f32 v182, v124, v125
 v_exp_f32 v128, v128
 v_mfma_f32_32x32x16_bf16 v[64:79], v[232:235], v[192:195], v[64:79]
 buffer_load_dwordx4 a[192:195], v14, s[36:39], s65 offen offset:2048 sc1
 s_add_u32 s65, s65, 18432
 v_exp_f32 v129, v129
 v_cvt_pk_bf16_f32 v183, v126, v127
 v_exp_f32 v130, v130
 v_mfma_f32_32x32x16_bf16 v[80:95], v[232:235], v[200:203], v[80:95]
 v_exp_f32 v131, v131
 v_cvt_pk_bf16_f32 v184, v128, v129
 v_exp_f32 v132, v132
 v_mfma_f32_32x32x16_bf16 a[48:63], a[208:211], a[200:203], a[48:63]
 v_exp_f32 v133, v133
 v_cvt_pk_bf16_f32 v185, v130, v131
 v_exp_f32 v134, v134
 v_exp_f32 v135, v135
 v_mfma_f32_32x32x16_bf16 v[64:79], v[236:239], v[196:199], v[64:79]
 v_cvt_pk_bf16_f32 v186, v132, v133
 v_exp_f32 v136, v136
 v_exp_f32 v137, v137
 v_mfma_f32_32x32x16_bf16 a[64:79], a[212:215], a[196:199], a[64:79]
 v_cvt_pk_bf16_f32 v187, v134, v135
 v_exp_f32 v138, v138
 v_exp_f32 v139, v139
 v_mfma_f32_32x32x16_bf16 v[80:95], v[236:239], v[204:207], v[80:95]
 v_cvt_pk_bf16_f32 v188, v136, v137
 v_exp_f32 v140, v140
 v_exp_f32 v141, v141
 v_cvt_pk_bf16_f32 v189, v138, v139
 v_mfma_f32_32x32x16_bf16 a[80:95], a[212:215], a[200:203], a[80:95]
 buffer_load_dwordx4 a[196:199], v14, s[36:39], s63 offen offset:1024 sc1
 v_exp_f32 v142, v142
 v_exp_f32 v143, v143
 v_cvt_pk_bf16_f32 v190, v140, v141
 s_waitcnt lgkmcnt(0)
 v_cvt_pk_bf16_f32 v191, v142, v143
 v_mfma_f32_32x32x16_bf16 v[112:127], v[208:211], v[96:99], v[32:47]
 ds_read_b128 v[216:219], v10 offset:3072
 ds_read_b32 v220, v11 offset:384
 v_exp_f32 v144, v144
 v_exp_f32 v145, v145
 v_exp_f32 v146, v146
 v_mfma_f32_32x32x16_bf16 v[128:143], v[208:211], v[104:107], v[48:63]
 ds_read_b128 v[232:235], v12 offset:1280
 ds_read_b128 v[236:239], v12 offset:1920
 buffer_load_dwordx4 a[200:203], v14, s[36:39], s64 offen offset:1024 sc1
 v_exp_f32 v147, v147
 v_cvt_pk_bf16_f32 v192, v144, v145
 v_exp_f32 v148, v148
 v_exp_f32 v149, v149
 s_waitcnt vmcnt(33)
 v_mfma_f32_32x32x16_bf16 a[0:15], a[224:227], a[216:219], a[0:15]
 v_cvt_pk_bf16_f32 v193, v146, v147
 v_exp_f32 v150, v150
 v_exp_f32 v151, v151
 v_mfma_f32_32x32x16_bf16 v[112:127], v[212:215], v[100:103], v[112:127]
 buffer_load_dwordx4 a[204:207], v14, s[36:39], s65 offen sc1
 v_cvt_pk_bf16_f32 v194, v148, v149
 v_exp_f32 v152, v152
 v_exp_f32 v153, v153
 v_mfma_f32_32x32x16_bf16 a[16:31], a[224:227], a[220:223], a[16:31]
 v_cvt_pk_bf16_f32 v195, v150, v151
 v_exp_f32 v154, v154
 v_exp_f32 v155, v155
 v_cvt_pk_bf16_f32 v196, v152, v153
 v_mfma_f32_32x32x16_bf16 v[128:143], v[212:215], v[108:111], v[128:143]
 buffer_load_dwordx4 a[208:211], v14, s[36:39], s65 offen offset:1024 sc1
 v_exp_f32 v156, v156
 v_exp_f32 v157, v157
 v_cvt_pk_bf16_f32 v197, v154, v155
 v_mfma_f32_32x32x16_bf16 a[32:47], a[228:231], a[216:219], a[32:47]
 v_exp_f32 v158, v158
 v_exp_f32 v159, v159
 v_cvt_pk_bf16_f32 v198, v156, v157
 v_exp_f32 v160, v160
 v_mfma_f32_32x32x16_bf16 v[64:79], v[224:227], v[176:179], v[64:79]
 buffer_load_dwordx4 a[212:215], v14, s[36:39], s65 offen offset:2048 sc1
 s_add_u32 s65, s65, 18432
 v_exp_f32 v161, v161
 v_cvt_pk_bf16_f32 v199, v158, v159
 v_exp_f32 v162, v162
 v_mfma_f32_32x32x16_bf16 v[80:95], v[224:227], v[184:187], v[80:95]
 v_exp_f32 v163, v163
 v_cvt_pk_bf16_f32 v200, v160, v161
 v_exp_f32 v164, v164
 v_mfma_f32_32x32x16_bf16 a[48:63], a[228:231], a[220:223], a[48:63]
 v_exp_f32 v165, v165
 v_cvt_pk_bf16_f32 v201, v162, v163
 v_exp_f32 v166, v166
 v_exp_f32 v167, v167
 v_mfma_f32_32x32x16_bf16 v[64:79], v[228:231], v[180:183], v[64:79]
 v_cvt_pk_bf16_f32 v202, v164, v165
 v_exp_f32 v168, v168
 v_exp_f32 v169, v169
 v_mfma_f32_32x32x16_bf16 a[64:79], a[232:235], a[216:219], a[64:79]
 v_cvt_pk_bf16_f32 v203, v166, v167
 v_exp_f32 v170, v170
 v_exp_f32 v171, v171
 v_mfma_f32_32x32x16_bf16 v[80:95], v[228:231], v[188:191], v[80:95]
 v_cvt_pk_bf16_f32 v204, v168, v169
 v_exp_f32 v172, v172
 v_exp_f32 v173, v173
 v_cvt_pk_bf16_f32 v205, v170, v171
 v_mfma_f32_32x32x16_bf16 a[80:95], a[232:235], a[220:223], a[80:95]
 buffer_load_dwordx4 a[216:219], v14, s[36:39], s63 offen offset:2048 sc1
 v_exp_f32 v174, v174
 v_exp_f32 v175, v175
 v_cvt_pk_bf16_f32 v206, v172, v173
 s_waitcnt lgkmcnt(0)
 v_cvt_pk_bf16_f32 v207, v174, v175
 v_mfma_f32_32x32x16_bf16 v[144:159], v[216:219], v[96:99], v[32:47]
 ds_read_b128 v[208:211], v10 offset:4096
 ds_read_b32 v212, v11 offset:512
 v_exp_f32 v112, v112
 v_exp_f32 v113, v113
 v_exp_f32 v114, v114
 v_mfma_f32_32x32x16_bf16 v[160:175], v[216:219], v[104:107], v[48:63]
 ds_read_b128 v[224:227], v12 offset:2560
 ds_read_b128 v[228:231], v12 offset:3200
 buffer_load_dwordx4 a[220:223], v14, s[36:39], s64 offen offset:2048 sc1
 v_exp_f32 v115, v115
 v_cvt_pk_bf16_f32 v176, v112, v113
 v_exp_f32 v116, v116
 v_exp_f32 v117, v117
 s_waitcnt vmcnt(32)
 v_mfma_f32_32x32x16_bf16 a[0:15], a[244:247], a[236:239], a[0:15]
 v_cvt_pk_bf16_f32 v177, v114, v115
 v_exp_f32 v118, v118
 v_exp_f32 v119, v119
 v_mfma_f32_32x32x16_bf16 v[144:159], v[220:223], v[100:103], v[144:159]
 buffer_load_dwordx4 a[224:227], v14, s[36:39], s65 offen sc1
 v_cvt_pk_bf16_f32 v178, v116, v117
 v_exp_f32 v120, v120
 v_exp_f32 v121, v121
 v_mfma_f32_32x32x16_bf16 a[16:31], a[244:247], a[240:243], a[16:31]
 v_cvt_pk_bf16_f32 v179, v118, v119
 v_exp_f32 v122, v122
 v_exp_f32 v123, v123
 v_cvt_pk_bf16_f32 v180, v120, v121
 v_mfma_f32_32x32x16_bf16 v[160:175], v[220:223], v[108:111], v[160:175]
 buffer_load_dwordx4 a[228:231], v14, s[36:39], s65 offen offset:1024 sc1
 v_exp_f32 v124, v124
 v_exp_f32 v125, v125
 v_cvt_pk_bf16_f32 v181, v122, v123
 v_mfma_f32_32x32x16_bf16 a[32:47], a[248:251], a[236:239], a[32:47]
 v_exp_f32 v126, v126
 v_exp_f32 v127, v127
 v_cvt_pk_bf16_f32 v182, v124, v125
 v_exp_f32 v128, v128
 v_mfma_f32_32x32x16_bf16 v[64:79], v[232:235], v[192:195], v[64:79]
 buffer_load_dwordx4 a[232:235], v14, s[36:39], s65 offen offset:2048 sc1
 s_add_u32 s65, s65, 18432
 v_exp_f32 v129, v129
 v_cvt_pk_bf16_f32 v183, v126, v127
 v_exp_f32 v130, v130
 v_mfma_f32_32x32x16_bf16 v[80:95], v[232:235], v[200:203], v[80:95]
 v_exp_f32 v131, v131
 v_cvt_pk_bf16_f32 v184, v128, v129
 v_exp_f32 v132, v132
 v_mfma_f32_32x32x16_bf16 a[48:63], a[248:251], a[240:243], a[48:63]
 v_exp_f32 v133, v133
 v_cvt_pk_bf16_f32 v185, v130, v131
 v_exp_f32 v134, v134
 v_exp_f32 v135, v135
 v_mfma_f32_32x32x16_bf16 v[64:79], v[236:239], v[196:199], v[64:79]
 v_cvt_pk_bf16_f32 v186, v132, v133
 v_exp_f32 v136, v136
 v_exp_f32 v137, v137
 v_mfma_f32_32x32x16_bf16 a[64:79], a[252:255], a[236:239], a[64:79]
 v_cvt_pk_bf16_f32 v187, v134, v135
 v_exp_f32 v138, v138
 v_exp_f32 v139, v139
 v_mfma_f32_32x32x16_bf16 v[80:95], v[236:239], v[204:207], v[80:95]
 v_cvt_pk_bf16_f32 v188, v136, v137
 v_exp_f32 v140, v140
 v_exp_f32 v141, v141
 v_cvt_pk_bf16_f32 v189, v138, v139
 v_mfma_f32_32x32x16_bf16 a[80:95], a[252:255], a[240:243], a[80:95]
 buffer_load_dwordx4 a[236:239], v14, s[36:39], s63 offen offset:3072 sc1
 s_add_u32 s63, s63, 4096
 v_exp_f32 v142, v142
 v_exp_f32 v143, v143
 v_cvt_pk_bf16_f32 v190, v140, v141
 s_waitcnt lgkmcnt(0)
 v_cvt_pk_bf16_f32 v191, v142, v143
 v_mfma_f32_32x32x16_bf16 v[112:127], v[208:211], v[96:99], v[32:47]
 ds_read_b128 v[216:219], v10 offset:5120
 ds_read_b32 v220, v11 offset:640
 v_exp_f32 v144, v144
 v_exp_f32 v145, v145
 v_exp_f32 v146, v146
 v_mfma_f32_32x32x16_bf16 v[128:143], v[208:211], v[104:107], v[48:63]
 ds_read_b128 v[232:235], v12 offset:3840
 ds_read_b128 v[236:239], v12 offset:4480
 buffer_load_dwordx4 a[240:243], v14, s[36:39], s64 offen offset:3072 sc1
 s_add_u32 s64, s64, 4096
 v_exp_f32 v147, v147
 v_cvt_pk_bf16_f32 v192, v144, v145
 v_exp_f32 v148, v148
 v_exp_f32 v149, v149
 s_waitcnt vmcnt(32)
 v_mfma_f32_32x32x16_bf16 a[0:15], a[104:107], a[96:99], a[0:15]
 v_cvt_pk_bf16_f32 v193, v146, v147
 v_exp_f32 v150, v150
 v_exp_f32 v151, v151
 v_mfma_f32_32x32x16_bf16 v[112:127], v[212:215], v[100:103], v[112:127]
 buffer_load_dwordx4 a[244:247], v14, s[36:39], s65 offen sc1
 v_cvt_pk_bf16_f32 v194, v148, v149
 v_exp_f32 v152, v152
 v_exp_f32 v153, v153
 v_mfma_f32_32x32x16_bf16 a[16:31], a[104:107], a[100:103], a[16:31]
 v_cvt_pk_bf16_f32 v195, v150, v151
 v_exp_f32 v154, v154
 v_exp_f32 v155, v155
 v_cvt_pk_bf16_f32 v196, v152, v153
 v_mfma_f32_32x32x16_bf16 v[128:143], v[212:215], v[108:111], v[128:143]
 buffer_load_dwordx4 a[248:251], v14, s[36:39], s65 offen offset:1024 sc1
 v_exp_f32 v156, v156
 v_exp_f32 v157, v157
 v_cvt_pk_bf16_f32 v197, v154, v155
 v_mfma_f32_32x32x16_bf16 a[32:47], a[108:111], a[96:99], a[32:47]
 v_exp_f32 v158, v158
 v_exp_f32 v159, v159
 v_cvt_pk_bf16_f32 v198, v156, v157
 v_exp_f32 v160, v160
 v_mfma_f32_32x32x16_bf16 v[64:79], v[224:227], v[176:179], v[64:79]
 buffer_load_dwordx4 a[252:255], v14, s[36:39], s65 offen offset:2048 sc1
 s_add_u32 s65, s65, 18432
 v_exp_f32 v161, v161
 v_cvt_pk_bf16_f32 v199, v158, v159
 v_exp_f32 v162, v162
 v_mfma_f32_32x32x16_bf16 v[80:95], v[224:227], v[184:187], v[80:95]
 v_exp_f32 v163, v163
 v_cvt_pk_bf16_f32 v200, v160, v161
 v_exp_f32 v164, v164
 v_mfma_f32_32x32x16_bf16 a[48:63], a[108:111], a[100:103], a[48:63]
 v_exp_f32 v165, v165
 v_cvt_pk_bf16_f32 v201, v162, v163
 v_exp_f32 v166, v166
 v_exp_f32 v167, v167
 v_mfma_f32_32x32x16_bf16 v[64:79], v[228:231], v[180:183], v[64:79]
 v_cvt_pk_bf16_f32 v202, v164, v165
 v_exp_f32 v168, v168
 v_exp_f32 v169, v169
 v_mfma_f32_32x32x16_bf16 a[64:79], a[112:115], a[96:99], a[64:79]
 v_cvt_pk_bf16_f32 v203, v166, v167
 v_exp_f32 v170, v170
 v_exp_f32 v171, v171
 v_mfma_f32_32x32x16_bf16 v[80:95], v[228:231], v[188:191], v[80:95]
 v_cvt_pk_bf16_f32 v204, v168, v169
 v_exp_f32 v172, v172
 v_exp_f32 v173, v173
 v_cvt_pk_bf16_f32 v205, v170, v171
 v_mfma_f32_32x32x16_bf16 a[80:95], a[112:115], a[100:103], a[80:95]
 buffer_load_dwordx4 a[96:99], v14, s[36:39], s63 offen sc1
 v_exp_f32 v174, v174
 v_exp_f32 v175, v175
 v_cvt_pk_bf16_f32 v206, v172, v173
 s_waitcnt lgkmcnt(0)
 v_cvt_pk_bf16_f32 v207, v174, v175
 v_mfma_f32_32x32x16_bf16 v[144:159], v[216:219], v[96:99], v[32:47]
 ds_read_b128 v[208:211], v10 offset:6144
 ds_read_b32 v212, v11 offset:768
 v_exp_f32 v112, v112
 v_exp_f32 v113, v113
 v_exp_f32 v114, v114
 v_mfma_f32_32x32x16_bf16 v[160:175], v[216:219], v[104:107], v[48:63]
 ds_read_b128 v[224:227], v12 offset:5120
 ds_read_b128 v[228:231], v12 offset:5760
 buffer_load_dwordx4 a[100:103], v14, s[36:39], s64 offen sc1
 v_exp_f32 v115, v115
 v_cvt_pk_bf16_f32 v176, v112, v113
 v_exp_f32 v116, v116
 v_exp_f32 v117, v117
 s_waitcnt vmcnt(32)
 v_mfma_f32_32x32x16_bf16 a[0:15], a[124:127], a[116:119], a[0:15]
 v_cvt_pk_bf16_f32 v177, v114, v115
 v_exp_f32 v118, v118
 v_exp_f32 v119, v119
 v_mfma_f32_32x32x16_bf16 v[144:159], v[220:223], v[100:103], v[144:159]
 buffer_load_dwordx4 a[104:107], v14, s[36:39], s65 offen sc1
 v_cvt_pk_bf16_f32 v178, v116, v117
 v_exp_f32 v120, v120
 v_exp_f32 v121, v121
 v_mfma_f32_32x32x16_bf16 a[16:31], a[124:127], a[120:123], a[16:31]
 v_cvt_pk_bf16_f32 v179, v118, v119
 v_exp_f32 v122, v122
 v_exp_f32 v123, v123
 v_cvt_pk_bf16_f32 v180, v120, v121
 v_mfma_f32_32x32x16_bf16 v[160:175], v[220:223], v[108:111], v[160:175]
 buffer_load_dwordx4 a[108:111], v14, s[36:39], s65 offen offset:1024 sc1
 v_exp_f32 v124, v124
 v_exp_f32 v125, v125
 v_cvt_pk_bf16_f32 v181, v122, v123
 v_mfma_f32_32x32x16_bf16 a[32:47], a[128:131], a[116:119], a[32:47]
 v_exp_f32 v126, v126
 v_exp_f32 v127, v127
 v_cvt_pk_bf16_f32 v182, v124, v125
 v_exp_f32 v128, v128
 v_mfma_f32_32x32x16_bf16 v[64:79], v[232:235], v[192:195], v[64:79]
 buffer_load_dwordx4 a[112:115], v14, s[36:39], s65 offen offset:2048 sc1
 s_add_u32 s65, s65, 18432
 v_exp_f32 v129, v129
 v_cvt_pk_bf16_f32 v183, v126, v127
 v_exp_f32 v130, v130
 v_mfma_f32_32x32x16_bf16 v[80:95], v[232:235], v[200:203], v[80:95]
 v_exp_f32 v131, v131
 v_cvt_pk_bf16_f32 v184, v128, v129
 v_exp_f32 v132, v132
 v_mfma_f32_32x32x16_bf16 a[48:63], a[128:131], a[120:123], a[48:63]
 v_exp_f32 v133, v133
 v_cvt_pk_bf16_f32 v185, v130, v131
 v_exp_f32 v134, v134
 v_exp_f32 v135, v135
 v_mfma_f32_32x32x16_bf16 v[64:79], v[236:239], v[196:199], v[64:79]
 v_cvt_pk_bf16_f32 v186, v132, v133
 v_exp_f32 v136, v136
 v_exp_f32 v137, v137
 v_mfma_f32_32x32x16_bf16 a[64:79], a[132:135], a[116:119], a[64:79]
 v_cvt_pk_bf16_f32 v187, v134, v135
 v_exp_f32 v138, v138
 v_exp_f32 v139, v139
 v_mfma_f32_32x32x16_bf16 v[80:95], v[236:239], v[204:207], v[80:95]
 v_cvt_pk_bf16_f32 v188, v136, v137
 v_exp_f32 v140, v140
 v_exp_f32 v141, v141
 v_cvt_pk_bf16_f32 v189, v138, v139
 v_mfma_f32_32x32x16_bf16 a[80:95], a[132:135], a[120:123], a[80:95]
 buffer_load_dwordx4 a[116:119], v14, s[36:39], s63 offen offset:1024 sc1
 v_exp_f32 v142, v142
 v_exp_f32 v143, v143
 v_cvt_pk_bf16_f32 v190, v140, v141
 s_waitcnt lgkmcnt(0)
 v_cvt_pk_bf16_f32 v191, v142, v143
 v_mfma_f32_32x32x16_bf16 v[112:127], v[208:211], v[96:99], v[32:47]
 ds_read_b128 v[216:219], v10 offset:7168
 ds_read_b32 v220, v11 offset:896
 v_exp_f32 v144, v144
 v_exp_f32 v145, v145
 v_exp_f32 v146, v146
 v_mfma_f32_32x32x16_bf16 v[128:143], v[208:211], v[104:107], v[48:63]
 ds_read_b128 v[232:235], v12 offset:6400
 ds_read_b128 v[236:239], v12 offset:7040
 buffer_load_dwordx4 a[120:123], v14, s[36:39], s64 offen offset:1024 sc1
 v_exp_f32 v147, v147
 v_cvt_pk_bf16_f32 v192, v144, v145
 v_exp_f32 v148, v148
 v_exp_f32 v149, v149
 s_waitcnt vmcnt(32)
 v_mfma_f32_32x32x16_bf16 a[0:15], a[144:147], a[136:139], a[0:15]
 v_cvt_pk_bf16_f32 v193, v146, v147
 v_exp_f32 v150, v150
 v_exp_f32 v151, v151
 v_mfma_f32_32x32x16_bf16 v[112:127], v[212:215], v[100:103], v[112:127]
 buffer_load_dwordx4 a[124:127], v14, s[36:39], s65 offen sc1
 v_cvt_pk_bf16_f32 v194, v148, v149
 v_exp_f32 v152, v152
 v_exp_f32 v153, v153
 v_mfma_f32_32x32x16_bf16 a[16:31], a[144:147], a[140:143], a[16:31]
 v_cvt_pk_bf16_f32 v195, v150, v151
 v_exp_f32 v154, v154
 v_exp_f32 v155, v155
 v_cvt_pk_bf16_f32 v196, v152, v153
 v_mfma_f32_32x32x16_bf16 v[128:143], v[212:215], v[108:111], v[128:143]
 buffer_load_dwordx4 a[128:131], v14, s[36:39], s65 offen offset:1024 sc1
 v_exp_f32 v156, v156
 v_exp_f32 v157, v157
 v_cvt_pk_bf16_f32 v197, v154, v155
 v_mfma_f32_32x32x16_bf16 a[32:47], a[148:151], a[136:139], a[32:47]
 v_exp_f32 v158, v158
 v_exp_f32 v159, v159
 v_cvt_pk_bf16_f32 v198, v156, v157
 v_exp_f32 v160, v160
 v_mfma_f32_32x32x16_bf16 v[64:79], v[224:227], v[176:179], v[64:79]
 buffer_load_dwordx4 a[132:135], v14, s[36:39], s65 offen offset:2048 sc1
 s_add_u32 s65, s65, 18432
 v_exp_f32 v161, v161
 v_cvt_pk_bf16_f32 v199, v158, v159
 v_exp_f32 v162, v162
 v_mfma_f32_32x32x16_bf16 v[80:95], v[224:227], v[184:187], v[80:95]
 v_exp_f32 v163, v163
 v_cvt_pk_bf16_f32 v200, v160, v161
 v_exp_f32 v164, v164
 v_mfma_f32_32x32x16_bf16 a[48:63], a[148:151], a[140:143], a[48:63]
 v_exp_f32 v165, v165
 v_cvt_pk_bf16_f32 v201, v162, v163
 v_exp_f32 v166, v166
 v_exp_f32 v167, v167
 v_mfma_f32_32x32x16_bf16 v[64:79], v[228:231], v[180:183], v[64:79]
 v_cvt_pk_bf16_f32 v202, v164, v165
 v_exp_f32 v168, v168
 v_exp_f32 v169, v169
 v_mfma_f32_32x32x16_bf16 a[64:79], a[152:155], a[136:139], a[64:79]
 v_cvt_pk_bf16_f32 v203, v166, v167
 v_exp_f32 v170, v170
 v_exp_f32 v171, v171
 v_mfma_f32_32x32x16_bf16 v[80:95], v[228:231], v[188:191], v[80:95]
 v_cvt_pk_bf16_f32 v204, v168, v169
 v_exp_f32 v172, v172
 v_exp_f32 v173, v173
 v_cvt_pk_bf16_f32 v205, v170, v171
 v_mfma_f32_32x32x16_bf16 a[80:95], a[152:155], a[140:143], a[80:95]
 buffer_load_dwordx4 a[136:139], v14, s[36:39], s63 offen offset:2048 sc1
 v_exp_f32 v174, v174
 v_exp_f32 v175, v175
 v_cvt_pk_bf16_f32 v206, v172, v173
 s_waitcnt lgkmcnt(0)
 v_cvt_pk_bf16_f32 v207, v174, v175
 v_mfma_f32_32x32x16_bf16 v[144:159], v[216:219], v[96:99], v[32:47]
 ds_read_b128 v[224:227], v12 offset:7680
 ds_read_b128 v[228:231], v12 offset:8320
 v_exp_f32 v112, v112
 v_exp_f32 v113, v113
 v_exp_f32 v114, v114
 v_mfma_f32_32x32x16_bf16 v[160:175], v[216:219], v[104:107], v[48:63]
 buffer_load_dwordx4 a[140:143], v14, s[36:39], s64 offen offset:2048 sc1
 v_exp_f32 v115, v115
 v_cvt_pk_bf16_f32 v176, v112, v113
 v_exp_f32 v116, v116
 v_exp_f32 v117, v117
 s_waitcnt vmcnt(32)
 v_mfma_f32_32x32x16_bf16 a[0:15], a[164:167], a[156:159], a[0:15]
 v_cvt_pk_bf16_f32 v177, v114, v115
 v_exp_f32 v118, v118
 v_exp_f32 v119, v119
 v_mfma_f32_32x32x16_bf16 v[144:159], v[220:223], v[100:103], v[144:159]
 buffer_load_dwordx4 a[144:147], v14, s[36:39], s65 offen sc1
 v_cvt_pk_bf16_f32 v178, v116, v117
 v_exp_f32 v120, v120
 v_exp_f32 v121, v121
 v_mfma_f32_32x32x16_bf16 a[16:31], a[164:167], a[160:163], a[16:31]
 v_cvt_pk_bf16_f32 v179, v118, v119
 v_exp_f32 v122, v122
 v_exp_f32 v123, v123
 v_cvt_pk_bf16_f32 v180, v120, v121
 v_mfma_f32_32x32x16_bf16 v[160:175], v[220:223], v[108:111], v[160:175]
 buffer_load_dwordx4 a[148:151], v14, s[36:39], s65 offen offset:1024 sc1
 v_exp_f32 v124, v124
 v_exp_f32 v125, v125
 v_cvt_pk_bf16_f32 v181, v122, v123
 v_mfma_f32_32x32x16_bf16 a[32:47], a[168:171], a[156:159], a[32:47]
 v_exp_f32 v126, v126
 v_exp_f32 v127, v127
 v_cvt_pk_bf16_f32 v182, v124, v125
 v_exp_f32 v128, v128
 v_mfma_f32_32x32x16_bf16 v[64:79], v[232:235], v[192:195], v[64:79]
 buffer_load_dwordx4 a[152:155], v14, s[36:39], s65 offen offset:2048 sc1
 s_add_u32 s65, s65, 18432
 v_exp_f32 v129, v129
 v_cvt_pk_bf16_f32 v183, v126, v127
 v_exp_f32 v130, v130
 v_mfma_f32_32x32x16_bf16 v[80:95], v[232:235], v[200:203], v[80:95]
 v_exp_f32 v131, v131
 v_cvt_pk_bf16_f32 v184, v128, v129
 v_exp_f32 v132, v132
 v_mfma_f32_32x32x16_bf16 a[48:63], a[168:171], a[160:163], a[48:63]
 v_exp_f32 v133, v133
 v_cvt_pk_bf16_f32 v185, v130, v131
 v_exp_f32 v134, v134
 v_exp_f32 v135, v135
 v_mfma_f32_32x32x16_bf16 v[64:79], v[236:239], v[196:199], v[64:79]
 v_cvt_pk_bf16_f32 v186, v132, v133
 v_exp_f32 v136, v136
 v_exp_f32 v137, v137
 v_mfma_f32_32x32x16_bf16 a[64:79], a[172:175], a[156:159], a[64:79]
 v_cvt_pk_bf16_f32 v187, v134, v135
 v_exp_f32 v138, v138
 v_exp_f32 v139, v139
 v_mfma_f32_32x32x16_bf16 v[80:95], v[236:239], v[204:207], v[80:95]
 v_cvt_pk_bf16_f32 v188, v136, v137
 v_exp_f32 v140, v140
 v_exp_f32 v141, v141
 v_cvt_pk_bf16_f32 v189, v138, v139
 v_mfma_f32_32x32x16_bf16 a[80:95], a[172:175], a[160:163], a[80:95]
 buffer_load_dwordx4 a[156:159], v14, s[36:39], s63 offen offset:3072 sc1
 s_add_u32 s63, s63, 4096
 v_exp_f32 v142, v142
 v_exp_f32 v143, v143
 v_cvt_pk_bf16_f32 v190, v140, v141
 s_waitcnt lgkmcnt(0)
 v_cvt_pk_bf16_f32 v191, v142, v143
 v_mfma_f32_32x32x16_bf16 v[64:79], v[224:227], v[176:179], v[64:79]
 ds_read_b128 v[232:235], v12 offset:8960
 ds_read_b128 v[236:239], v12 offset:9600
 v_exp_f32 v144, v144
 v_exp_f32 v145, v145
 v_exp_f32 v146, v146
 v_exp_f32 v147, v147
 s_waitcnt vmcnt(31)
 v_mfma_f32_32x32x16_bf16 a[0:15], a[184:187], a[176:179], a[0:15]
 buffer_load_dwordx4 a[160:163], v14, s[36:39], s64 offen offset:3072 sc1
 s_add_u32 s64, s64, 4096
 v_cvt_pk_bf16_f32 v192, v144, v145
 v_exp_f32 v148, v148
 v_exp_f32 v149, v149
 v_cvt_pk_bf16_f32 v193, v146, v147
 v_exp_f32 v150, v150
 v_mfma_f32_32x32x16_bf16 v[80:95], v[224:227], v[184:187], v[80:95]
 v_exp_f32 v151, v151
 v_cvt_pk_bf16_f32 v194, v148, v149
 v_exp_f32 v152, v152
 v_exp_f32 v153, v153
 v_cvt_pk_bf16_f32 v195, v150, v151
 v_mfma_f32_32x32x16_bf16 a[16:31], a[184:187], a[180:183], a[16:31]
 buffer_load_dwordx4 a[164:167], v14, s[36:39], s65 offen sc1
 v_exp_f32 v154, v154
 v_exp_f32 v155, v155
 v_cvt_pk_bf16_f32 v196, v152, v153
 v_exp_f32 v156, v156
 v_exp_f32 v157, v157
 v_mfma_f32_32x32x16_bf16 a[32:47], a[188:191], a[176:179], a[32:47]
 v_cvt_pk_bf16_f32 v197, v154, v155
 v_exp_f32 v158, v158
 v_exp_f32 v159, v159
 v_cvt_pk_bf16_f32 v198, v156, v157
 v_exp_f32 v160, v160
 v_mfma_f32_32x32x16_bf16 v[64:79], v[228:231], v[180:183], v[64:79]
 buffer_load_dwordx4 a[168:171], v14, s[36:39], s65 offen offset:1024 sc1
 v_exp_f32 v161, v161
 v_cvt_pk_bf16_f32 v199, v158, v159
 v_exp_f32 v162, v162
 v_exp_f32 v163, v163
 v_mfma_f32_32x32x16_bf16 a[48:63], a[188:191], a[180:183], a[48:63]
 v_cvt_pk_bf16_f32 v200, v160, v161
 v_exp_f32 v164, v164
 v_exp_f32 v165, v165
 v_cvt_pk_bf16_f32 v201, v162, v163
 v_exp_f32 v166, v166
 v_mfma_f32_32x32x16_bf16 v[80:95], v[228:231], v[188:191], v[80:95]
 buffer_load_dwordx4 a[172:175], v14, s[36:39], s65 offen offset:2048 sc1
 s_add_u32 s65, s65, 18432
 v_exp_f32 v167, v167
 v_cvt_pk_bf16_f32 v202, v164, v165
 v_exp_f32 v168, v168
 v_exp_f32 v169, v169
 v_cvt_pk_bf16_f32 v203, v166, v167
 v_mfma_f32_32x32x16_bf16 a[64:79], a[192:195], a[176:179], a[64:79]
 v_exp_f32 v170, v170
 v_exp_f32 v171, v171
 v_cvt_pk_bf16_f32 v204, v168, v169
 v_exp_f32 v172, v172
 v_exp_f32 v173, v173
 v_mfma_f32_32x32x16_bf16 a[80:95], a[192:195], a[180:183], a[80:95]
 buffer_load_dwordx4 a[176:179], v14, s[36:39], s63 offen sc1
 v_cvt_pk_bf16_f32 v205, v170, v171
 v_exp_f32 v174, v174
 v_exp_f32 v175, v175
 v_cvt_pk_bf16_f32 v206, v172, v173
 s_waitcnt lgkmcnt(0)
 v_cvt_pk_bf16_f32 v207, v174, v175
 v_mfma_f32_32x32x16_bf16 v[64:79], v[232:235], v[192:195], v[64:79]
 v_mfma_f32_32x32x16_bf16 v[80:95], v[232:235], v[200:203], v[80:95]
 buffer_load_dwordx4 a[180:183], v14, s[36:39], s64 offen sc1
 v_mfma_f32_32x32x16_bf16 v[64:79], v[236:239], v[196:199], v[64:79]
 buffer_load_dwordx4 a[184:187], v14, s[36:39], s65 offen sc1
 v_mfma_f32_32x32x16_bf16 v[80:95], v[236:239], v[204:207], v[80:95]
 buffer_load_dwordx4 a[188:191], v14, s[36:39], s65 offen offset:1024 sc1
 buffer_load_dwordx4 a[192:195], v14, s[36:39], s65 offen offset:2048 sc1
 s_add_u32 s65, s65, 18432
 s_nop 10
 v_mov_b32 v16, v74
 v_mov_b32 v8, v74
 v_mov_b32 v17, v90
 v_mov_b32 v9, v90
 s_nop 1
 v_permlane32_swap_b32 v16, v8
 v_permlane32_swap_b32 v17, v9
 s_nop 1
 s_mov_b32 s52, 0x4e800000
 v_cmp_nge_f32 vcc, s52, v16
 v_cmp_nge_f32 s[70:71], s52, v17
 s_mov_b32 s66, 3
 s_or_b64 vcc, vcc, s[70:71]
 s_cbranch_vccnz L_a_slow
L_a_epi_t:
 v_rcp_f32 v16, v16
 v_rcp_f32 v17, v17
 s_mul_i32 s52, s59, 36864
 s_add_u32 s52, s52, 61865984
 s_lshl_b32 s53, s31, 10
 s_add_u32 s54, s52, s53
 s_lshr_b32 s53, s31, 3
 s_add_u32 s53, s53, 32
 s_lshl_b32 s53, s53, 10
 s_add_u32 s55, s52, s53
 s_bfe_u32 s53, s31, 65538
 s_lshl_b32 s53, s53, 9
 s_add_u32 s55, s55, s53
 s_and_b32 s53, s31, 3
 s_lshl_b32 s53, s53, 2
 s_add_u32 s55, s55, s53
 v_lshlrev_b32 v4, 4, v2
 v_lshlrev_b32 v5, 31, v3
 v_or_b32 v5, v5, v4
 v_mul_f32 v64, v64, v16
 v_mul_f32 v65, v65, v16
 v_mul_f32 v66, v66, v16
 v_mul_f32 v67, v67, v16
 v_mul_f32 v68, v68, v16
 v_mul_f32 v69, v69, v16
 v_mul_f32 v70, v70, v16
 v_mul_f32 v71, v71, v16
 v_mul_f32 v72, v72, v16
 v_mul_f32 v73, v73, v16
 v_cvt_pk_bf16_f32 v64, v64, v65
 v_cvt_pk_bf16_f32 v65, v66, v67
 v_cvt_pk_bf16_f32 v66, v68, v69
 v_cvt_pk_bf16_f32 v67, v70, v71
 v_cvt_pk_bf16_f32 v68, v72, v73
 buffer_store_dwordx4 v[64:67], v14, s[36:39], s54 offen sc1
 buffer_store_dword v68, v5, s[36:39], s55 offen sc1
 s_add_u32 s54, s54, 36864
 s_add_u32 s55, s55, 36864
 v_mul_f32 v80, v80, v17
 v_mul_f32 v81, v81, v17
 v_mul_f32 v82, v82, v17
 v_mul_f32 v83, v83, v17
 v_mul_f32 v84, v84, v17
 v_mul_f32 v85, v85, v17
 v_mul_f32 v86, v86, v17
 v_mul_f32 v87, v87, v17
 v_mul_f32 v88, v88, v17
 v_mul_f32 v89, v89, v17
 v_cvt_pk_bf16_f32 v80, v80, v81
 v_cvt_pk_bf16_f32 v81, v82, v83
 v_cvt_pk_bf16_f32 v82, v84, v85
 v_cvt_pk_bf16_f32 v83, v86, v87
 v_cvt_pk_bf16_f32 v84, v88, v89
 buffer_store_dwordx4 v[80:83], v14, s[36:39], s54 offen sc1
 buffer_store_dword v84, v5, s[36:39], s55 offen sc1
 v_mov_b32 v8, s69
 v_mov_b32 v9, 1
 s_lshl_b32 s34, s68, 1
 s_lshr_b32 s52, s28, 1
 s_mul_i32 s60, s52, 331776
 s_lshl_b32 s53, s34, 10
 s_add_u32 s60, s60, s53
 s_add_u32 s60, s60, 69730304
 s_waitcnt vmcnt(39)
 v_mfma_f32_32x32x16_bf16 a[0:15], a[204:207], a[196:199], a[0:15]
 v_mfma_f32_32x32x16_bf16 a[16:31], a[204:207], a[200:203], a[16:31]
 v_mfma_f32_32x32x16_bf16 a[32:47], a[208:211], a[196:199], a[32:47]
 v_mfma_f32_32x32x16_bf16 a[48:63], a[208:211], a[200:203], a[48:63]
 v_mfma_f32_32x32x16_bf16 a[64:79], a[212:215], a[196:199], a[64:79]
 v_mfma_f32_32x32x16_bf16 a[80:95], a[212:215], a[200:203], a[80:95]
 s_waitcnt vmcnt(34)
 v_mfma_f32_32x32x16_bf16 a[0:15], a[224:227], a[216:219], a[0:15]
 buffer_load_dwordx4 a[196:199], v14, s[36:39], s63 offen offset:1024 sc1
 v_mfma_f32_32x32x16_bf16 a[16:31], a[224:227], a[220:223], a[16:31]
 buffer_load_dwordx4 a[200:203], v14, s[36:39], s64 offen offset:1024 sc1
 v_mfma_f32_32x32x16_bf16 a[32:47], a[228:231], a[216:219], a[32:47]
 buffer_load_dwordx4 a[204:207], v14, s[36:39], s65 offen sc1
 v_mfma_f32_32x32x16_bf16 a[48:63], a[228:231], a[220:223], a[48:63]
 buffer_load_dwordx4 a[208:211], v14, s[36:39], s65 offen offset:1024 sc1
 v_mfma_f32_32x32x16_bf16 a[64:79], a[232:235], a[216:219], a[64:79]
 buffer_load_dwordx4 a[212:215], v14, s[36:39], s65 offen offset:2048 sc1
 s_add_u32 s65, s65, 18432
 v_mfma_f32_32x32x16_bf16 a[80:95], a[232:235], a[220:223], a[80:95]
 s_waitcnt vmcnt(34)
 v_mfma_f32_32x32x16_bf16 a[0:15], a[244:247], a[236:239], a[0:15]
 buffer_load_dwordx4 a[216:219], v14, s[36:39], s63 offen offset:2048 sc1
 v_mfma_f32_32x32x16_bf16 a[16:31], a[244:247], a[240:243], a[16:31]
 buffer_load_dwordx4 a[220:223], v14, s[36:39], s64 offen offset:2048 sc1
 v_mfma_f32_32x32x16_bf16 a[32:47], a[248:251], a[236:239], a[32:47]
 buffer_load_dwordx4 a[224:227], v14, s[36:39], s65 offen sc1
 v_mfma_f32_32x32x16_bf16 a[48:63], a[248:251], a[240:243], a[48:63]
 buffer_load_dwordx4 a[228:231], v14, s[36:39], s65 offen offset:1024 sc1
 v_mfma_f32_32x32x16_bf16 a[64:79], a[252:255], a[236:239], a[64:79]
 buffer_load_dwordx4 a[232:235], v14, s[36:39], s65 offen offset:2048 sc1
 s_add_u32 s65, s65, 18432
 v_mfma_f32_32x32x16_bf16 a[80:95], a[252:255], a[240:243], a[80:95]
 s_waitcnt vmcnt(34)
 v_mfma_f32_32x32x16_bf16 a[0:15], a[104:107], a[96:99], a[0:15]
 buffer_load_dwordx4 a[236:239], v14, s[36:39], s63 offen offset:3072 sc1
 s_add_u32 s63, s63, 4096
 v_mfma_f32_32x32x16_bf16 a[16:31], a[104:107], a[100:103], a[16:31]
 buffer_load_dwordx4 a[240:243], v14, s[36:39], s64 offen offset:3072 sc1
 s_add_u32 s64, s64, 4096
 v_mfma_f32_32x32x16_bf16 a[32:47], a[108:111], a[96:99], a[32:47]
 buffer_load_dwordx4 a[244:247], v14, s[36:39], s65 offen sc1
 v_mfma_f32_32x32x16_bf16 a[48:63], a[108:111], a[100:103], a[48:63]
 buffer_load_dwordx4 a[248:251], v14, s[36:39], s65 offen offset:1024 sc1
 v_mfma_f32_32x32x16_bf16 a[64:79], a[112:115], a[96:99], a[64:79]
 buffer_load_dwordx4 a[252:255], v14, s[36:39], s65 offen offset:2048 sc1
 s_add_u32 s65, s65, 18432
 v_mfma_f32_32x32x16_bf16 a[80:95], a[112:115], a[100:103], a[80:95]
 buffer_load_dwordx4 v[32:35], v14, s[36:39], s60 offen sc1
 s_waitcnt vmcnt(35)
 v_mfma_f32_32x32x16_bf16 a[0:15], a[124:127], a[116:119], a[0:15]
 v_mfma_f32_32x32x16_bf16 a[16:31], a[124:127], a[120:123], a[16:31]
 buffer_load_dwordx4 v[36:39], v14, s[36:39], s60 offen offset:1024 sc1
 s_add_u32 s60, s60, 18432
 v_mfma_f32_32x32x16_bf16 a[32:47], a[128:131], a[116:119], a[32:47]
 v_mfma_f32_32x32x16_bf16 a[48:63], a[128:131], a[120:123], a[48:63]
 buffer_load_dwordx4 v[40:43], v14, s[36:39], s60 offen sc1
 v_mfma_f32_32x32x16_bf16 a[64:79], a[132:135], a[116:119], a[64:79]
 v_mfma_f32_32x32x16_bf16 a[80:95], a[132:135], a[120:123], a[80:95]
 buffer_load_dwordx4 v[44:47], v14, s[36:39], s60 offen offset:1024 sc1
 s_add_u32 s60, s60, 18432
 s_waitcnt vmcnt(33)
 s_waitcnt vmcnt(19)
 s_barrier
 s_mov_b64 exec, 1
 buffer_store_dword v9, v8, s[36:39], s67 offen offset:1024 sc1
 s_mov_b64 exec, -1
 v_mfma_f32_32x32x16_bf16 a[0:15], a[144:147], a[136:139], a[0:15]
 v_mfma_f32_32x32x16_bf16 a[16:31], a[144:147], a[140:143], a[16:31]
 buffer_load_dwordx4 v[48:51], v14, s[36:39], s60 offen sc1
 v_mfma_f32_32x32x16_bf16 a[32:47], a[148:151], a[136:139], a[32:47]
 v_mfma_f32_32x32x16_bf16 a[48:63], a[148:151], a[140:143], a[48:63]
 buffer_load_dwordx4 v[52:55], v14, s[36:39], s60 offen offset:1024 sc1
 s_add_u32 s60, s60, 18432
 v_mfma_f32_32x32x16_bf16 a[64:79], a[152:155], a[136:139], a[64:79]
 v_mfma_f32_32x32x16_bf16 a[80:95], a[152:155], a[140:143], a[80:95]
 buffer_load_dwordx4 v[56:59], v14, s[36:39], s60 offen sc1
 s_waitcnt vmcnt(32)
 v_mfma_f32_32x32x16_bf16 a[0:15], a[164:167], a[156:159], a[0:15]
 v_mfma_f32_32x32x16_bf16 a[16:31], a[164:167], a[160:163], a[16:31]
 buffer_load_dwordx4 v[60:63], v14, s[36:39], s60 offen offset:1024 sc1
 s_add_u32 s60, s60, 18432
 v_mfma_f32_32x32x16_bf16 a[32:47], a[168:171], a[156:159], a[32:47]
 v_mfma_f32_32x32x16_bf16 a[48:63], a[168:171], a[160:163], a[48:63]
 buffer_load_dwordx4 v[64:67], v14, s[36:39], s60 offen sc1
 v_mfma_f32_32x32x16_bf16 a[64:79], a[172:175], a[156:159], a[64:79]
 v_mfma_f32_32x32x16_bf16 a[80:95], a[172:175], a[160:163], a[80:95]
 buffer_load_dwordx4 v[68:71], v14, s[36:39], s60 offen offset:1024 sc1
 s_add_u32 s60, s60, 18432
 s_waitcnt vmcnt(30)
 v_mfma_f32_32x32x16_bf16 a[0:15], a[184:187], a[176:179], a[0:15]
 v_mfma_f32_32x32x16_bf16 a[16:31], a[184:187], a[180:183], a[16:31]
 buffer_load_dwordx4 v[72:75], v14, s[36:39], s60 offen sc1
 v_mfma_f32_32x32x16_bf16 a[32:47], a[188:191], a[176:179], a[32:47]
 v_mfma_f32_32x32x16_bf16 a[48:63], a[188:191], a[180:183], a[48:63]
 buffer_load_dwordx4 v[76:79], v14, s[36:39], s60 offen offset:1024 sc1
 s_add_u32 s60, s60, 18432
 v_mfma_f32_32x32x16_bf16 a[64:79], a[192:195], a[176:179], a[64:79]
 v_mfma_f32_32x32x16_bf16 a[80:95], a[192:195], a[180:183], a[80:95]
 buffer_load_dwordx4 v[80:83], v14, s[36:39], s60 offen sc1
 s_waitcnt vmcnt(24)
 v_mfma_f32_32x32x16_bf16 a[0:15], a[204:207], a[196:199], a[0:15]
 v_mfma_f32_32x32x16_bf16 a[16:31], a[204:207], a[200:203], a[16:31]
 buffer_load_dwordx4 v[84:87], v14, s[36:39], s60 offen offset:1024 sc1
 s_add_u32 s60, s60, 18432
 v_mfma_f32_32x32x16_bf16 a[32:47], a[208:211], a[196:199], a[32:47]
 v_mfma_f32_32x32x16_bf16 a[48:63], a[208:211], a[200:203], a[48:63]
 buffer_load_dwordx4 v[88:91], v14, s[36:39], s60 offen sc1
 v_mfma_f32_32x32x16_bf16 a[64:79], a[212:215], a[196:199], a[64:79]
 v_mfma_f32_32x32x16_bf16 a[80:95], a[212:215], a[200:203], a[80:95]
 buffer_load_dwordx4 v[92:95], v14, s[36:39], s60 offen offset:1024 sc1
 s_add_u32 s60, s60, 18432
 s_waitcnt vmcnt(22)
 v_mfma_f32_32x32x16_bf16 a[0:15], a[224:227], a[216:219], a[0:15]
 v_mfma_f32_32x32x16_bf16 a[16:31], a[224:227], a[220:223], a[16:31]
 buffer_load_dwordx4 v[96:99], v14, s[36:39], s60 offen sc1
 v_mfma_f32_32x32x16_bf16 a[32:47], a[228:231], a[216:219], a[32:47]
 v_mfma_f32_32x32x16_bf16 a[48:63], a[228:231], a[220:223], a[48:63]
 buffer_load_dwordx4 v[100:103], v14, s[36:39], s60 offen offset:1024 sc1
 s_add_u32 s60, s60, 18432
 v_mfma_f32_32x32x16_bf16 a[64:79], a[232:235], a[216:219], a[64:79]
 v_mfma_f32_32x32x16_bf16 a[80:95], a[232:235], a[220:223], a[80:95]
 buffer_load_dwordx4 v[104:107], v14, s[36:39], s60 offen sc1
 s_waitcnt vmcnt(20)
 v_mfma_f32_32x32x16_bf16 a[0:15], a[244:247], a[236:239], a[0:15]
 v_mfma_f32_32x32x16_bf16 a[16:31], a[244:247], a[240:243], a[16:31]
 buffer_load_dwordx4 v[108:111], v14, s[36:39], s60 offen offset:1024 sc1
 s_add_u32 s60, s60, 18432
 v_mfma_f32_32x32x16_bf16 a[32:47], a[248:251], a[236:239], a[32:47]
 v_mfma_f32_32x32x16_bf16 a[48:63], a[248:251], a[240:243], a[48:63]
 buffer_load_dwordx4 a[96:99], v14, s[36:39], s60 offen sc1
 v_mfma_f32_32x32x16_bf16 a[64:79], a[252:255], a[236:239], a[64:79]
 v_mfma_f32_32x32x16_bf16 a[80:95], a[252:255], a[240:243], a[80:95]
 buffer_load_dwordx4 a[100:103], v14, s[36:39], s60 offen offset:1024 sc1
 s_add_u32 s60, s60, 18432
 s_nop 3
 s_lshl_b32 s52, s28, 12
 s_add_u32 s52, s52, 61440
 v_add_u32 v6, s52, v14
 v_add_u32 v7, 65536, v6
 ds_write_b128 v6, a[0:3]
 buffer_load_dwordx4 a[104:107], v14, s[36:39], s60 offen sc1
 ds_write_b128 v6, a[4:7] offset:1024
 buffer_load_dwordx4 a[108:111], v14, s[36:39], s60 offen offset:1024 sc1
 s_add_u32 s60, s60, 18432
 ds_write_b128 v6, a[8:11] offset:2048
 buffer_load_dwordx4 a[112:115], v14, s[36:39], s60 offen sc1
 ds_write_b128 v6, a[12:15] offset:3072
 buffer_load_dwordx4 a[116:119], v14, s[36:39], s60 offen offset:1024 sc1
 s_add_u32 s60, s60, 18432
 ds_write_b128 v6, a[16:19] offset:16384
 buffer_load_dwordx4 a[120:123], v14, s[36:39], s60 offen sc1
 ds_write_b128 v6, a[20:23] offset:17408
 buffer_load_dwordx4 a[124:127], v14, s[36:39], s60 offen offset:1024 sc1
 s_add_u32 s60, s60, 18432
 ds_write_b128 v6, a[24:27] offset:18432
 buffer_load_dwordx4 a[128:131], v14, s[36:39], s60 offen sc1
 ds_write_b128 v6, a[28:31] offset:19456
 buffer_load_dwordx4 a[132:135], v14, s[36:39], s60 offen offset:1024 sc1
 s_add_u32 s60, s60, 18432
 ds_write_b128 v6, a[32:35] offset:32768
 buffer_load_dwordx4 a[136:139], v14, s[36:39], s60 offen sc1
 ds_write_b128 v6, a[36:39] offset:33792
 buffer_load_dwordx4 a[140:143], v14, s[36:39], s60 offen offset:1024 sc1
 s_add_u32 s60, s60, 18432
 ds_write_b128 v6, a[40:43] offset:34816
 buffer_load_dwordx4 a[144:147], v14, s[36:39], s60 offen sc1
 ds_write_b128 v6, a[44:47] offset:35840
 buffer_load_dwordx4 a[148:151], v14, s[36:39], s60 offen offset:1024 sc1
 s_add_u32 s60, s60, 18432
 ds_write_b128 v6, a[48:51] offset:49152
 buffer_load_dwordx4 a[152:155], v14, s[36:39], s60 offen sc1
 ds_write_b128 v6, a[52:55] offset:50176
 buffer_load_dwordx4 a[156:159], v14, s[36:39], s60 offen offset:1024 sc1
 s_add_u32 s60, s60, 18432
 ds_write_b128 v6, a[56:59] offset:51200
 ds_write_b128 v6, a[60:63] offset:52224
 ds_write_b128 v7, a[64:67]
 ds_write_b128 v7, a[68:71] offset:1024
 ds_write_b128 v7, a[72:75] offset:2048
 ds_write_b128 v7, a[76:79] offset:3072
 ds_write_b128 v7, a[80:83] offset:16384
 ds_write_b128 v7, a[84:87] offset:17408
 ds_write_b128 v7, a[88:91] offset:18432
 ds_write_b128 v7, a[92:95] offset:19456
 s_and_b32 s52, s28, 1
 s_lshr_b32 s53, s28, 1
 s_lshl_b32 s54, s52, 14
 s_lshl_b32 s55, s53, 11
 s_add_u32 s54, s54, s55
 s_add_u32 s54, s54, 61440
 v_add_u32 v6, s54, v14
 v_add_u32 v7, 65536, v6
 s_add_u32 s52, s52, s61
 s_mul_i32 s52, s52, 73728
 s_lshl_b32 s53, s53, 5
 s_add_u32 s52, s52, s53
 s_lshl_b32 s53, s62, 6
 s_add_u32 s54, s52, s53
 v_mul_u32_u24 v4, 2304, v2
 v_lshl_add_u32 v4, v3, 4, v4
 buffer_load_dwordx4 v[240:243], v14, s[36:39], s67 offen offset:1024 sc1
 s_waitcnt lgkmcnt(0)
 s_barrier
 ds_read_b128 v[200:203], v6
 ds_read_b128 v[204:207], v6 offset:1024
 ds_read_b128 v[208:211], v6 offset:4096
 ds_read_b128 v[212:215], v6 offset:5120
 ds_read_b128 v[216:219], v6 offset:8192
 ds_read_b128 v[220:223], v6 offset:9216
 ds_read_b128 v[224:227], v6 offset:12288
 ds_read_b128 v[228:231], v6 offset:13312
 ds_read_b128 v[112:115], v6 offset:32768
 ds_read_b128 v[116:119], v6 offset:33792
 ds_read_b128 v[120:123], v6 offset:36864
 ds_read_b128 v[124:127], v6 offset:37888
 ds_read_b128 v[128:131], v6 offset:40960
 ds_read_b128 v[132:135], v6 offset:41984
 ds_read_b128 v[136:139], v6 offset:45056
 ds_read_b128 v[140:143], v6 offset:46080
 s_waitcnt lgkmcnt(8)
 v_pk_add_f32 v[200:201], v[200:201], v[208:209]
 v_pk_add_f32 v[216:217], v[216:217], v[224:225]
 v_pk_add_f32 v[202:203], v[202:203], v[210:211]
 v_pk_add_f32 v[218:219], v[218:219], v[226:227]
 v_pk_add_f32 v[204:205], v[204:205], v[212:213]
 v_pk_add_f32 v[220:221], v[220:221], v[228:229]
 v_pk_add_f32 v[206:207], v[206:207], v[214:215]
 v_pk_add_f32 v[222:223], v[222:223], v[230:231]
 v_pk_add_f32 v[200:201], v[200:201], v[216:217]
 v_pk_add_f32 v[202:203], v[202:203], v[218:219]
 v_pk_add_f32 v[204:205], v[204:205], v[220:221]
 v_pk_add_f32 v[206:207], v[206:207], v[222:223]
 v_cvt_pk_bf16_f32 v232, v200, v201
 v_cvt_pk_bf16_f32 v233, v202, v203
 v_cvt_pk_bf16_f32 v234, v204, v205
 v_cvt_pk_bf16_f32 v235, v206, v207
 s_nop 1
 v_permlane32_swap_b32 v232, v234
 v_permlane32_swap_b32 v233, v235
 buffer_store_dwordx4 v[232:235], v4, s[40:43], s54 offen offset:1152
 ds_read_b128 v[200:203], v7
 ds_read_b128 v[204:207], v7 offset:1024
 ds_read_b128 v[208:211], v7 offset:4096
 ds_read_b128 v[212:215], v7 offset:5120
 ds_read_b128 v[216:219], v7 offset:8192
 ds_read_b128 v[220:223], v7 offset:9216
 ds_read_b128 v[224:227], v7 offset:12288
 ds_read_b128 v[228:231], v7 offset:13312
 s_waitcnt lgkmcnt(8)
 v_pk_add_f32 v[112:113], v[112:113], v[120:121]
 v_pk_add_f32 v[128:129], v[128:129], v[136:137]
 v_pk_add_f32 v[114:115], v[114:115], v[122:123]
 v_pk_add_f32 v[130:131], v[130:131], v[138:139]
 v_pk_add_f32 v[116:117], v[116:117], v[124:125]
 v_pk_add_f32 v[132:133], v[132:133], v[140:141]
 v_pk_add_f32 v[118:119], v[118:119], v[126:127]
 v_pk_add_f32 v[134:135], v[134:135], v[142:143]
 v_pk_add_f32 v[112:113], v[112:113], v[128:129]
 v_pk_add_f32 v[114:115], v[114:115], v[130:131]
 v_pk_add_f32 v[116:117], v[116:117], v[132:133]
 v_pk_add_f32 v[118:119], v[118:119], v[134:135]
 v_cvt_pk_bf16_f32 v236, v112, v113
 v_cvt_pk_bf16_f32 v237, v114, v115
 v_cvt_pk_bf16_f32 v238, v116, v117
 v_cvt_pk_bf16_f32 v239, v118, v119
 s_nop 1
 v_permlane32_swap_b32 v236, v238
 v_permlane32_swap_b32 v237, v239
 buffer_store_dwordx4 v[236:239], v4, s[40:43], s54 offen offset:1216
 s_waitcnt lgkmcnt(0)
 v_pk_add_f32 v[200:201], v[200:201], v[208:209]
 v_pk_add_f32 v[216:217], v[216:217], v[224:225]
 v_pk_add_f32 v[202:203], v[202:203], v[210:211]
 v_pk_add_f32 v[218:219], v[218:219], v[226:227]
 v_pk_add_f32 v[204:205], v[204:205], v[212:213]
 v_pk_add_f32 v[220:221], v[220:221], v[228:229]
 v_pk_add_f32 v[206:207], v[206:207], v[214:215]
 v_pk_add_f32 v[222:223], v[222:223], v[230:231]
 v_pk_add_f32 v[200:201], v[200:201], v[216:217]
 v_pk_add_f32 v[202:203], v[202:203], v[218:219]
 v_pk_add_f32 v[204:205], v[204:205], v[220:221]
 v_pk_add_f32 v[206:207], v[206:207], v[222:223]
 v_cvt_pk_bf16_f32 v232, v200, v201
 v_cvt_pk_bf16_f32 v233, v202, v203
 v_cvt_pk_bf16_f32 v234, v204, v205
 v_cvt_pk_bf16_f32 v235, v206, v207
 s_nop 1
 v_permlane32_swap_b32 v232, v234
 v_permlane32_swap_b32 v233, v235
 buffer_store_dwordx4 v[232:235], v4, s[40:43], s54 offen offset:1280
 s_and_b32 s52, s28, 1
 s_add_u32 s52, s52, s61
 s_mul_i32 s63, s52, 36864
 s_lshr_b32 s53, s28, 1
 s_mul_i32 s53, s53, 18432
 s_add_u32 s63, s63, s53
 s_add_u32 s63, s63, 61865984
 s_waitcnt vmcnt(3)
 v_and_b32 v240, v240, v241
 v_and_b32 v242, v242, v243
 v_and_b32 v240, v240, v242
 v_cmp_ne_u32 vcc, 1, v240
 s_cmp_lg_u64 vcc, 0
 s_cbranch_scc1 L_faspin_t2
L_faok_t2:
 buffer_load_dwordx4 v[112:115], v14, s[36:39], s63 offen sc1
 buffer_load_dwordx4 v[116:119], v14, s[36:39], s63 offen offset:1024 sc1
 buffer_load_dwordx4 v[120:123], v14, s[36:39], s63 offen offset:2048 sc1
 buffer_load_dwordx4 v[124:127], v14, s[36:39], s63 offen offset:3072 sc1
 s_add_u32 s63, s63, 4096
 buffer_load_dwordx4 v[128:131], v14, s[36:39], s63 offen sc1
 buffer_load_dwordx4 v[132:135], v14, s[36:39], s63 offen offset:1024 sc1
 buffer_load_dwordx4 v[136:139], v14, s[36:39], s63 offen offset:2048 sc1
 buffer_load_dwordx4 v[140:143], v14, s[36:39], s63 offen offset:3072 sc1
 s_add_u32 s63, s63, 4096
 buffer_load_dwordx4 v[144:147], v14, s[36:39], s63 offen sc1
 buffer_load_dwordx4 v[148:151], v14, s[36:39], s63 offen offset:1024 sc1
 buffer_load_dwordx4 v[152:155], v14, s[36:39], s63 offen offset:2048 sc1
 buffer_load_dwordx4 v[156:159], v14, s[36:39], s63 offen offset:3072 sc1
 s_add_u32 s63, s63, 4096
 buffer_load_dwordx4 v[160:163], v14, s[36:39], s63 offen sc1
 buffer_load_dwordx4 v[164:167], v14, s[36:39], s63 offen offset:1024 sc1
 buffer_load_dwordx4 v[168:171], v14, s[36:39], s63 offen offset:2048 sc1
 buffer_load_dwordx4 v[172:175], v14, s[36:39], s63 offen offset:3072 sc1
 s_add_u32 s63, s63, 4096
 buffer_load_dwordx4 v[176:179], v14, s[36:39], s63 offen sc1
 buffer_load_dwordx4 v[180:183], v14, s[36:39], s63 offen offset:1024 sc1
 s_lshl_b32 s54, s28, 13
 v_add_u32 v6, s54, v14
 s_xor_b32 s54, s54, 16384
 v_add_u32 v7, s54, v14
 s_mul_i32 s52, s52, 73728
 s_lshr_b32 s53, s28, 1
 s_lshl_b32 s53, s53, 5
 s_add_u32 s52, s52, s53
 s_lshl_b32 s53, s34, 6
 s_add_u32 s54, s52, s53
 s_waitcnt vmcnt(16)
 v_mfma_f32_32x32x16_bf16 v[184:199], v[32:35], v[112:115], 0
 v_mfma_f32_32x32x16_bf16 v[200:215], v[36:39], v[112:115], 0
 v_mfma_f32_32x32x16_bf16 v[184:199], v[40:43], v[116:119], v[184:199]
 v_mfma_f32_32x32x16_bf16 v[200:215], v[44:47], v[116:119], v[200:215]
 s_waitcnt vmcnt(14)
 v_mfma_f32_32x32x16_bf16 v[184:199], v[48:51], v[120:123], v[184:199]
 v_mfma_f32_32x32x16_bf16 v[200:215], v[52:55], v[120:123], v[200:215]
 v_mfma_f32_32x32x16_bf16 v[184:199], v[56:59], v[124:127], v[184:199]
 v_mfma_f32_32x32x16_bf16 v[200:215], v[60:63], v[124:127], v[200:215]
 s_waitcnt vmcnt(12)
 v_mfma_f32_32x32x16_bf16 v[184:199], v[64:67], v[128:131], v[184:199]
 v_mfma_f32_32x32x16_bf16 v[200:215], v[68:71], v[128:131], v[200:215]
 v_mfma_f32_32x32x16_bf16 v[184:199], v[72:75], v[132:135], v[184:199]
 v_mfma_f32_32x32x16_bf16 v[200:215], v[76:79], v[132:135], v[200:215]
 s_waitcnt vmcnt(10)
 v_mfma_f32_32x32x16_bf16 v[184:199], v[80:83], v[136:139], v[184:199]
 v_mfma_f32_32x32x16_bf16 v[200:215], v[84:87], v[136:139], v[200:215]
 v_mfma_f32_32x32x16_bf16 v[184:199], v[88:91], v[140:143], v[184:199]
 v_mfma_f32_32x32x16_bf16 v[200:215], v[92:95], v[140:143], v[200:215]
 s_waitcnt vmcnt(8)
 v_mfma_f32_32x32x16_bf16 v[184:199], v[96:99], v[144:147], v[184:199]
 v_mfma_f32_32x32x16_bf16 v[200:215], v[100:103], v[144:147], v[200:215]
 v_mfma_f32_32x32x16_bf16 v[184:199], v[104:107], v[148:151], v[184:199]
 v_mfma_f32_32x32x16_bf16 v[200:215], v[108:111], v[148:151], v[200:215]
 s_waitcnt vmcnt(6)
 v_mfma_f32_32x32x16_bf16 v[184:199], a[96:99], v[152:155], v[184:199]
 v_mfma_f32_32x32x16_bf16 v[200:215], a[100:103], v[152:155], v[200:215]
 v_mfma_f32_32x32x16_bf16 v[184:199], a[104:107], v[156:159], v[184:199]
 v_mfma_f32_32x32x16_bf16 v[200:215], a[108:111], v[156:159], v[200:215]
 s_waitcnt vmcnt(4)
 v_mfma_f32_32x32x16_bf16 v[184:199], a[112:115], v[160:163], v[184:199]
 v_mfma_f32_32x32x16_bf16 v[200:215], a[116:119], v[160:163], v[200:215]
 v_mfma_f32_32x32x16_bf16 v[184:199], a[120:123], v[164:167], v[184:199]
 v_mfma_f32_32x32x16_bf16 v[200:215], a[124:127], v[164:167], v[200:215]
 s_waitcnt vmcnt(2)
 v_mfma_f32_32x32x16_bf16 v[184:199], a[128:131], v[168:171], v[184:199]
 v_mfma_f32_32x32x16_bf16 v[200:215], a[132:135], v[168:171], v[200:215]
 v_mfma_f32_32x32x16_bf16 v[184:199], a[136:139], v[172:175], v[184:199]
 v_mfma_f32_32x32x16_bf16 v[200:215], a[140:143], v[172:175], v[200:215]
 s_waitcnt vmcnt(0)
 v_mfma_f32_32x32x16_bf16 v[184:199], a[144:147], v[176:179], v[184:199]
 v_mfma_f32_32x32x16_bf16 v[200:215], a[148:151], v[176:179], v[200:215]
 v_mfma_f32_32x32x16_bf16 v[184:199], a[152:155], v[180:183], v[184:199]
 v_mfma_f32_32x32x16_bf16 v[200:215], a[156:159], v[180:183], v[200:215]
 s_cmp_ge_u32 s28, 2
 s_nop 9
 s_cbranch_scc1 L_x1_t2
 ds_write_b128 v6, v[192:195]
 ds_write_b128 v6, v[196:199] offset:1024
 ds_write_b128 v6, v[208:211] offset:2048
 ds_write_b128 v6, v[212:215] offset:3072
 s_waitcnt lgkmcnt(0)
 s_barrier
 ds_read_b128 v[112:115], v7
 ds_read_b128 v[116:119], v7 offset:1024
 ds_read_b128 v[120:123], v7 offset:2048
 ds_read_b128 v[124:127], v7 offset:3072
 s_waitcnt lgkmcnt(2)
 v_pk_add_f32 v[184:185], v[184:185], v[112:113]
 v_pk_add_f32 v[186:187], v[186:187], v[114:115]
 v_pk_add_f32 v[188:189], v[188:189], v[116:117]
 v_pk_add_f32 v[190:191], v[190:191], v[118:119]
 v_cvt_pk_bf16_f32 v144, v184, v185
 v_cvt_pk_bf16_f32 v145, v186, v187
 v_cvt_pk_bf16_f32 v146, v188, v189
 v_cvt_pk_bf16_f32 v147, v190, v191
 s_nop 1
 v_permlane32_swap_b32 v144, v146
 v_permlane32_swap_b32 v145, v147
 buffer_store_dwordx4 v[144:147], v4, s[40:43], s54 offen
 s_waitcnt lgkmcnt(0)
 v_pk_add_f32 v[200:201], v[200:201], v[120:121]
 v_pk_add_f32 v[202:203], v[202:203], v[122:123]
 v_pk_add_f32 v[204:205], v[204:205], v[124:125]
 v_pk_add_f32 v[206:207], v[206:207], v[126:127]
 v_cvt_pk_bf16_f32 v148, v200, v201
 v_cvt_pk_bf16_f32 v149, v202, v203
 v_cvt_pk_bf16_f32 v150, v204, v205
 v_cvt_pk_bf16_f32 v151, v206, v207
 s_nop 1
 v_permlane32_swap_b32 v148, v150
 v_permlane32_swap_b32 v149, v151
 buffer_store_dwordx4 v[148:151], v4, s[40:43], s54 offen offset:64
 s_branch L_fin
L_x1_t2:
 ds_write_b128 v6, v[184:187]
 ds_write_b128 v6, v[188:191] offset:1024
 ds_write_b128 v6, v[200:203] offset:2048
 ds_write_b128 v6, v[204:207] offset:3072
 s_waitcnt lgkmcnt(0)
 s_barrier
 ds_read_b128 v[112:115], v7
 ds_read_b128 v[116:119], v7 offset:1024
 ds_read_b128 v[120:123], v7 offset:2048
 ds_read_b128 v[124:127], v7 offset:3072
 s_waitcnt lgkmcnt(2)
 v_pk_add_f32 v[192:193], v[192:193], v[112:113]
 v_pk_add_f32 v[194:195], v[194:195], v[114:115]
 v_pk_add_f32 v[196:197], v[196:197], v[116:117]
 v_pk_add_f32 v[198:199], v[198:199], v[118:119]
 v_cvt_pk_bf16_f32 v144, v192, v193
 v_cvt_pk_bf16_f32 v145, v194, v195
 v_cvt_pk_bf16_f32 v146, v196, v197
 v_cvt_pk_bf16_f32 v147, v198, v199
 s_nop 1
 v_permlane32_swap_b32 v144, v146
 v_permlane32_swap_b32 v145, v147
 buffer_store_dwordx4 v[144:147], v4, s[40:43], s54 offen
 s_waitcnt lgkmcnt(0)
 v_pk_add_f32 v[208:209], v[208:209], v[120:121]
 v_pk_add_f32 v[210:211], v[210:211], v[122:123]
 v_pk_add_f32 v[212:213], v[212:213], v[124:125]
 v_pk_add_f32 v[214:215], v[214:215], v[126:127]
 v_cvt_pk_bf16_f32 v148, v208, v209
 v_cvt_pk_bf16_f32 v149, v210, v211
 v_cvt_pk_bf16_f32 v150, v212, v213
 v_cvt_pk_bf16_f32 v151, v214, v215
 s_nop 1
 v_permlane32_swap_b32 v148, v150
 v_permlane32_swap_b32 v149, v151
 buffer_store_dwordx4 v[148:151], v4, s[40:43], s54 offen offset:64
 s_branch L_fin
L_o_two:
 v_mfma_f32_32x32x16_bf16 v[112:127], v[208:211], v[96:99], v[32:47]
 ds_read_b128 v[216:219], v10 offset:7168
 ds_read_b32 v220, v11 offset:896
 s_add_u32 s57, s57, 20480
 s_cmp_eq_u32 s57, 61440
 s_cselect_b32 s57, 0, s57
 buffer_load_dwordx4 a[96:99], v14, s[36:39], s63 offen sc1
 v_exp_f32 v144, v144
 v_exp_f32 v145, v145
 v_exp_f32 v146, v146
 v_exp_f32 v147, v147
 v_cvt_pk_bf16_f32 v192, v144, v145
 v_exp_f32 v148, v148
 v_mfma_f32_32x32x16_bf16 v[128:143], v[208:211], v[104:107], v[48:63]
 ds_read_b128 v[232:235], v12 offset:6400
 ds_read_b128 v[236:239], v12 offset:7040
 buffer_load_dwordx4 a[100:103], v14, s[36:39], s64 offen sc1
 v_exp_f32 v149, v149
 v_cvt_pk_bf16_f32 v193, v146, v147
 v_exp_f32 v150, v150
 v_exp_f32 v151, v151
 v_cvt_pk_bf16_f32 v194, v148, v149
 v_exp_f32 v152, v152
 v_mfma_f32_32x32x16_bf16 v[112:127], v[212:215], v[100:103], v[112:127]
 buffer_load_dwordx4 a[104:107], v14, s[36:39], s65 offen sc1
 v_exp_f32 v153, v153
 v_cvt_pk_bf16_f32 v195, v150, v151
 v_exp_f32 v154, v154
 v_exp_f32 v155, v155
 v_cvt_pk_bf16_f32 v196, v152, v153
 v_exp_f32 v156, v156
 v_mfma_f32_32x32x16_bf16 v[128:143], v[212:215], v[108:111], v[128:143]
 buffer_load_dwordx4 a[108:111], v14, s[36:39], s65 offen offset:1024 sc1
 s_add_u32 s65, s65, 18432
 v_exp_f32 v157, v157
 v_cvt_pk_bf16_f32 v197, v154, v155
 v_exp_f32 v158, v158
 v_exp_f32 v159, v159
 v_cvt_pk_bf16_f32 v198, v156, v157
 v_exp_f32 v160, v160
 v_mfma_f32_32x32x16_bf16 v[64:79], v[224:227], v[176:179], v[64:79]
 buffer_load_dwordx4 a[112:115], v14, s[36:39], s63 offen offset:1024 sc1
 v_exp_f32 v161, v161
 v_cvt_pk_bf16_f32 v199, v158, v159
 v_exp_f32 v162, v162
 v_exp_f32 v163, v163
 v_cvt_pk_bf16_f32 v200, v160, v161
 v_exp_f32 v164, v164
 v_mfma_f32_32x32x16_bf16 v[80:95], v[224:227], v[184:187], v[80:95]
 buffer_load_dwordx4 a[116:119], v14, s[36:39], s64 offen offset:1024 sc1
 v_exp_f32 v165, v165
 v_cvt_pk_bf16_f32 v201, v162, v163
 v_exp_f32 v166, v166
 v_exp_f32 v167, v167
 v_cvt_pk_bf16_f32 v202, v164, v165
 v_exp_f32 v168, v168
 v_mfma_f32_32x32x16_bf16 v[64:79], v[228:231], v[180:183], v[64:79]
 v_exp_f32 v169, v169
 v_cvt_pk_bf16_f32 v203, v166, v167
 v_exp_f32 v170, v170
 v_exp_f32 v171, v171
 v_cvt_pk_bf16_f32 v204, v168, v169
 v_exp_f32 v172, v172
 v_mfma_f32_32x32x16_bf16 v[80:95], v[228:231], v[188:191], v[80:95]
 v_exp_f32 v173, v173
 v_cvt_pk_bf16_f32 v205, v170, v171
 v_exp_f32 v174, v174
 v_exp_f32 v175, v175
 v_cvt_pk_bf16_f32 v206, v172, v173
 v_add_u32 v10, s57, v14
 v_add_u32 v11, s57, v20
 v_add_u32 v253, s57, v252
 s_waitcnt lgkmcnt(0)
 v_cvt_pk_bf16_f32 v207, v174, v175
 v_mfma_f32_32x32x16_bf16 v[144:159], v[216:219], v[96:99], v[32:47]
 ds_write_b128 v253, v[248:251]
 s_waitcnt lgkmcnt(0)
 s_barrier
 ds_read_b128 v[208:211], v10
 ds_read_b32 v212, v11
 v_exp_f32 v112, v112
 v_exp_f32 v113, v113
 v_exp_f32 v114, v114
 v_exp_f32 v115, v115
 v_cvt_pk_bf16_f32 v176, v112, v113
 v_exp_f32 v116, v116
 v_mfma_f32_32x32x16_bf16 v[160:175], v[216:219], v[104:107], v[48:63]
 ds_read_b128 v[224:227], v12 offset:7680
 ds_read_b128 v[228:231], v12 offset:8320
 s_add_u32 m0, s35, s58
 v_exp_f32 v117, v117
 v_cvt_pk_bf16_f32 v177, v114, v115
 v_exp_f32 v118, v118
 v_exp_f32 v119, v119
 v_cvt_pk_bf16_f32 v178, v116, v117
 v_exp_f32 v120, v120
 v_mfma_f32_32x32x16_bf16 v[144:159], v[220:223], v[100:103], v[144:159]
 buffer_load_dwordx4 v13, s[36:39], s56 offen sc1 lds
 v_exp_f32 v121, v121
 v_cvt_pk_bf16_f32 v179, v118, v119
 v_exp_f32 v122, v122
 v_exp_f32 v123, v123
 v_cvt_pk_bf16_f32 v180, v120, v121
 v_exp_f32 v124, v124
 v_mfma_f32_32x32x16_bf16 v[160:175], v[220:223], v[108:111], v[160:175]
 buffer_load_dwordx4 v13, s[36:39], s56 offen offset:1024 sc1 lds
 v_exp_f32 v125, v125
 v_cvt_pk_bf16_f32 v181, v122, v123
 v_exp_f32 v126, v126
 v_exp_f32 v127, v127
 v_cvt_pk_bf16_f32 v182, v124, v125
 v_exp_f32 v128, v128
 v_mfma_f32_32x32x16_bf16 v[64:79], v[232:235], v[192:195], v[64:79]
 buffer_load_dwordx4 a[120:123], v14, s[36:39], s65 offen sc1
 v_exp_f32 v129, v129
 v_cvt_pk_bf16_f32 v183, v126, v127
 v_exp_f32 v130, v130
 v_exp_f32 v131, v131
 v_cvt_pk_bf16_f32 v184, v128, v129
 v_exp_f32 v132, v132
 v_mfma_f32_32x32x16_bf16 v[80:95], v[232:235], v[200:203], v[80:95]
 buffer_load_dwordx4 a[124:127], v14, s[36:39], s65 offen offset:1024 sc1
 s_add_u32 s65, s65, 18432
 v_exp_f32 v133, v133
 v_cvt_pk_bf16_f32 v185, v130, v131
 v_exp_f32 v134, v134
 v_exp_f32 v135, v135
 v_cvt_pk_bf16_f32 v186, v132, v133
 v_exp_f32 v136, v136
 v_mfma_f32_32x32x16_bf16 v[64:79], v[236:239], v[196:199], v[64:79]
 buffer_load_dwordx4 a[128:131], v14, s[36:39], s63 offen offset:2048 sc1
 v_exp_f32 v137, v137
 v_cvt_pk_bf16_f32 v187, v134, v135
 v_exp_f32 v138, v138
 v_exp_f32 v139, v139
 v_cvt_pk_bf16_f32 v188, v136, v137
 v_exp_f32 v140, v140
 v_mfma_f32_32x32x16_bf16 v[80:95], v[236:239], v[204:207], v[80:95]
 buffer_load_dwordx4 a[132:135], v14, s[36:39], s64 offen offset:2048 sc1
 v_exp_f32 v141, v141
 v_cvt_pk_bf16_f32 v189, v138, v139
 v_exp_f32 v142, v142
 v_exp_f32 v143, v143
 v_cvt_pk_bf16_f32 v190, v140, v141
 s_waitcnt lgkmcnt(0)
 v_cvt_pk_bf16_f32 v191, v142, v143
 v_mfma_f32_32x32x16_bf16 v[112:127], v[208:211], v[96:99], v[32:47]
 ds_read_b128 v[216:219], v10 offset:1024
 ds_read_b32 v220, v11 offset:128
 buffer_load_dwordx4 a[136:139], v14, s[36:39], s65 offen sc1
 v_exp_f32 v144, v144
 v_exp_f32 v145, v145
 v_exp_f32 v146, v146
 v_exp_f32 v147, v147
 v_cvt_pk_bf16_f32 v192, v144, v145
 v_exp_f32 v148, v148
 v_mfma_f32_32x32x16_bf16 v[128:143], v[208:211], v[104:107], v[48:63]
 ds_read_b128 v[232:235], v12 offset:8960
 ds_read_b128 v[236:239], v12 offset:9600
 buffer_load_dwordx4 a[140:143], v14, s[36:39], s65 offen offset:1024 sc1
 s_add_u32 s65, s65, 18432
 v_exp_f32 v149, v149
 v_cvt_pk_bf16_f32 v193, v146, v147
 v_exp_f32 v150, v150
 v_exp_f32 v151, v151
 v_cvt_pk_bf16_f32 v194, v148, v149
 v_exp_f32 v152, v152
 v_mfma_f32_32x32x16_bf16 v[112:127], v[212:215], v[100:103], v[112:127]
 buffer_load_dwordx4 v13, s[36:39], s56 offen offset:2048 sc1 lds
 v_exp_f32 v153, v153
 v_cvt_pk_bf16_f32 v195, v150, v151
 v_exp_f32 v154, v154
 v_exp_f32 v155, v155
 v_cvt_pk_bf16_f32 v196, v152, v153
 v_exp_f32 v156, v156
 v_mfma_f32_32x32x16_bf16 v[128:143], v[212:215], v[108:111], v[128:143]
 buffer_load_dwordx4 v13, s[36:39], s56 offen offset:3072 sc1 lds
 s_add_u32 m0, m0, 4096
 s_add_u32 s56, s56, 4096
 v_exp_f32 v157, v157
 v_cvt_pk_bf16_f32 v197, v154, v155
 v_exp_f32 v158, v158
 v_exp_f32 v159, v159
 v_cvt_pk_bf16_f32 v198, v156, v157
 v_exp_f32 v160, v160
 v_mfma_f32_32x32x16_bf16 v[64:79], v[224:227], v[176:179], v[64:79]
 buffer_load_dwordx4 v13, s[36:39], s56 offen sc1 lds
 v_exp_f32 v161, v161
 v_cvt_pk_bf16_f32 v199, v158, v159
 v_exp_f32 v162, v162
 v_exp_f32 v163, v163
 v_cvt_pk_bf16_f32 v200, v160, v161
 v_exp_f32 v164, v164
 v_mfma_f32_32x32x16_bf16 v[80:95], v[224:227], v[184:187], v[80:95]
 s_add_u32 s56, s56, 16384
 s_add_u32 s35, s35, 20480
 s_cmp_eq_u32 s35, 61440
 s_cselect_b32 s35, 0, s35
 buffer_load_dwordx4 a[144:147], v14, s[36:39], s63 offen offset:3072 sc1
 s_add_u32 s63, s63, 4096
 v_exp_f32 v165, v165
 v_cvt_pk_bf16_f32 v201, v162, v163
 v_exp_f32 v166, v166
 v_exp_f32 v167, v167
 v_cvt_pk_bf16_f32 v202, v164, v165
 v_exp_f32 v168, v168
 v_mfma_f32_32x32x16_bf16 v[64:79], v[228:231], v[180:183], v[64:79]
 buffer_load_dwordx4 a[148:151], v14, s[36:39], s64 offen offset:3072 sc1
 s_add_u32 s64, s64, 4096
 v_exp_f32 v169, v169
 v_cvt_pk_bf16_f32 v203, v166, v167
 v_exp_f32 v170, v170
 v_exp_f32 v171, v171
 v_cvt_pk_bf16_f32 v204, v168, v169
 v_exp_f32 v172, v172
 v_mfma_f32_32x32x16_bf16 v[80:95], v[228:231], v[188:191], v[80:95]
 buffer_load_dwordx4 a[152:155], v14, s[36:39], s65 offen sc1
 v_exp_f32 v173, v173
 v_cvt_pk_bf16_f32 v205, v170, v171
 v_exp_f32 v174, v174
 v_exp_f32 v175, v175
 v_cvt_pk_bf16_f32 v206, v172, v173
 v_add_u32 v12, s57, v21
 s_waitcnt lgkmcnt(0)
 v_cvt_pk_bf16_f32 v207, v174, v175
 v_mfma_f32_32x32x16_bf16 v[144:159], v[216:219], v[96:99], v[32:47]
 ds_read_b128 v[208:211], v10 offset:2048
 ds_read_b32 v212, v11 offset:256
 buffer_load_dwordx4 a[156:159], v14, s[36:39], s65 offen offset:1024 sc1
 s_add_u32 s65, s65, 18432
 v_exp_f32 v112, v112
 v_exp_f32 v113, v113
 v_exp_f32 v114, v114
 v_exp_f32 v115, v115
 v_cvt_pk_bf16_f32 v176, v112, v113
 v_exp_f32 v116, v116
 v_mfma_f32_32x32x16_bf16 v[160:175], v[216:219], v[104:107], v[48:63]
 ds_read_b128 v[224:227], v12
 ds_read_b128 v[228:231], v12 offset:640
 buffer_load_dwordx4 a[160:163], v14, s[36:39], s63 offen sc1
 v_exp_f32 v117, v117
 v_cvt_pk_bf16_f32 v177, v114, v115
 v_exp_f32 v118, v118
 v_exp_f32 v119, v119
 v_cvt_pk_bf16_f32 v178, v116, v117
 v_exp_f32 v120, v120
 v_mfma_f32_32x32x16_bf16 v[144:159], v[220:223], v[100:103], v[144:159]
 buffer_load_dwordx4 a[164:167], v14, s[36:39], s64 offen sc1
 v_exp_f32 v121, v121
 v_cvt_pk_bf16_f32 v179, v118, v119
 v_exp_f32 v122, v122
 v_exp_f32 v123, v123
 v_cvt_pk_bf16_f32 v180, v120, v121
 v_exp_f32 v124, v124
 v_mfma_f32_32x32x16_bf16 v[160:175], v[220:223], v[108:111], v[160:175]
 buffer_load_dwordx4 a[168:171], v14, s[36:39], s65 offen sc1
 v_exp_f32 v125, v125
 v_cvt_pk_bf16_f32 v181, v122, v123
 v_exp_f32 v126, v126
 v_exp_f32 v127, v127
 v_cvt_pk_bf16_f32 v182, v124, v125
 v_exp_f32 v128, v128
 v_mfma_f32_32x32x16_bf16 v[64:79], v[232:235], v[192:195], v[64:79]
 buffer_load_dwordx4 a[172:175], v14, s[36:39], s65 offen offset:1024 sc1
 s_add_u32 s65, s65, 18432
 v_exp_f32 v129, v129
 v_cvt_pk_bf16_f32 v183, v126, v127
 v_exp_f32 v130, v130
 v_exp_f32 v131, v131
 v_cvt_pk_bf16_f32 v184, v128, v129
 v_exp_f32 v132, v132
 v_mfma_f32_32x32x16_bf16 v[80:95], v[232:235], v[200:203], v[80:95]
 buffer_load_dwordx4 a[176:179], v14, s[36:39], s63 offen offset:1024 sc1
 v_exp_f32 v133, v133
 v_cvt_pk_bf16_f32 v185, v130, v131
 v_exp_f32 v134, v134
 v_exp_f32 v135, v135
 v_cvt_pk_bf16_f32 v186, v132, v133
 v_exp_f32 v136, v136
 v_mfma_f32_32x32x16_bf16 v[64:79], v[236:239], v[196:199], v[64:79]
 buffer_load_dwordx4 a[180:183], v14, s[36:39], s64 offen offset:1024 sc1
 v_exp_f32 v137, v137
 v_cvt_pk_bf16_f32 v187, v134, v135
 v_exp_f32 v138, v138
 v_exp_f32 v139, v139
 v_cvt_pk_bf16_f32 v188, v136, v137
 v_exp_f32 v140, v140
 v_mfma_f32_32x32x16_bf16 v[80:95], v[236:239], v[204:207], v[80:95]
 buffer_load_dwordx4 a[184:187], v14, s[36:39], s65 offen sc1
 v_exp_f32 v141, v141
 v_cvt_pk_bf16_f32 v189, v138, v139
 v_exp_f32 v142, v142
 v_exp_f32 v143, v143
 v_cvt_pk_bf16_f32 v190, v140, v141
 s_waitcnt lgkmcnt(0)
 v_cvt_pk_bf16_f32 v191, v142, v143
 v_mfma_f32_32x32x16_bf16 v[112:127], v[208:211], v[96:99], v[32:47]
 ds_read_b128 v[216:219], v10 offset:3072
 ds_read_b32 v220, v11 offset:384
 buffer_load_dwordx4 a[188:191], v14, s[36:39], s65 offen offset:1024 sc1
 s_add_u32 s65, s65, 18432
 v_exp_f32 v144, v144
 v_exp_f32 v145, v145
 v_exp_f32 v146, v146
 v_exp_f32 v147, v147
 v_cvt_pk_bf16_f32 v192, v144, v145
 v_exp_f32 v148, v148
 v_mfma_f32_32x32x16_bf16 v[128:143], v[208:211], v[104:107], v[48:63]
 ds_read_b128 v[232:235], v12 offset:1280
 ds_read_b128 v[236:239], v12 offset:1920
 buffer_load_dwordx4 a[192:195], v14, s[36:39], s63 offen offset:2048 sc1
 v_exp_f32 v149, v149
 v_cvt_pk_bf16_f32 v193, v146, v147
 v_exp_f32 v150, v150
 v_exp_f32 v151, v151
 v_cvt_pk_bf16_f32 v194, v148, v149
 v_exp_f32 v152, v152
 v_mfma_f32_32x32x16_bf16 v[112:127], v[212:215], v[100:103], v[112:127]
 buffer_load_dwordx4 a[196:199], v14, s[36:39], s64 offen offset:2048 sc1
 v_exp_f32 v153, v153
 v_cvt_pk_bf16_f32 v195, v150, v151
 v_exp_f32 v154, v154
 v_exp_f32 v155, v155
 v_cvt_pk_bf16_f32 v196, v152, v153
 v_exp_f32 v156, v156
 v_mfma_f32_32x32x16_bf16 v[128:143], v[212:215], v[108:111], v[128:143]
 buffer_load_dwordx4 a[200:203], v14, s[36:39], s65 offen sc1
 v_exp_f32 v157, v157
 v_cvt_pk_bf16_f32 v197, v154, v155
 v_exp_f32 v158, v158
 v_exp_f32 v159, v159
 v_cvt_pk_bf16_f32 v198, v156, v157
 v_exp_f32 v160, v160
 v_mfma_f32_32x32x16_bf16 v[64:79], v[224:227], v[176:179], v[64:79]
 buffer_load_dwordx4 a[204:207], v14, s[36:39], s65 offen offset:1024 sc1
 s_add_u32 s65, s65, 18432
 v_exp_f32 v161, v161
 v_cvt_pk_bf16_f32 v199, v158, v159
 v_exp_f32 v162, v162
 v_exp_f32 v163, v163
 v_cvt_pk_bf16_f32 v200, v160, v161
 v_exp_f32 v164, v164
 v_mfma_f32_32x32x16_bf16 v[80:95], v[224:227], v[184:187], v[80:95]
 buffer_load_dwordx4 a[208:211], v14, s[36:39], s63 offen offset:3072 sc1
 s_add_u32 s63, s63, 4096
 v_exp_f32 v165, v165
 v_cvt_pk_bf16_f32 v201, v162, v163
 v_exp_f32 v166, v166
 v_exp_f32 v167, v167
 v_cvt_pk_bf16_f32 v202, v164, v165
 v_exp_f32 v168, v168
 v_mfma_f32_32x32x16_bf16 v[64:79], v[228:231], v[180:183], v[64:79]
 buffer_load_dwordx4 a[212:215], v14, s[36:39], s64 offen offset:3072 sc1
 s_add_u32 s64, s64, 4096
 v_exp_f32 v169, v169
 v_cvt_pk_bf16_f32 v203, v166, v167
 v_exp_f32 v170, v170
 v_exp_f32 v171, v171
 v_cvt_pk_bf16_f32 v204, v168, v169
 v_exp_f32 v172, v172
 v_mfma_f32_32x32x16_bf16 v[80:95], v[228:231], v[188:191], v[80:95]
 v_exp_f32 v173, v173
 v_cvt_pk_bf16_f32 v205, v170, v171
 v_exp_f32 v174, v174
 v_exp_f32 v175, v175
 v_cvt_pk_bf16_f32 v206, v172, v173
 s_waitcnt lgkmcnt(0)
 v_cvt_pk_bf16_f32 v207, v174, v175
 v_mfma_f32_32x32x16_bf16 v[144:159], v[216:219], v[96:99], v[32:47]
 ds_read_b128 v[208:211], v10 offset:4096
 ds_read_b32 v212, v11 offset:512
 buffer_load_dwordx4 a[216:219], v14, s[36:39], s65 offen sc1
 v_exp_f32 v112, v112
 v_exp_f32 v113, v113
 v_exp_f32 v114, v114
 v_exp_f32 v115, v115
 v_cvt_pk_bf16_f32 v176, v112, v113
 v_exp_f32 v116, v116
 v_mfma_f32_32x32x16_bf16 v[160:175], v[216:219], v[104:107], v[48:63]
 ds_read_b128 v[224:227], v12 offset:2560
 ds_read_b128 v[228:231], v12 offset:3200
 buffer_load_dwordx4 a[220:223], v14, s[36:39], s65 offen offset:1024 sc1
 s_add_u32 s65, s65, 18432
 v_exp_f32 v117, v117
 v_cvt_pk_bf16_f32 v177, v114, v115
 v_exp_f32 v118, v118
 v_exp_f32 v119, v119
 v_cvt_pk_bf16_f32 v178, v116, v117
 v_exp_f32 v120, v120
 v_mfma_f32_32x32x16_bf16 v[144:159], v[220:223], v[100:103], v[144:159]
 v_exp_f32 v121, v121
 v_cvt_pk_bf16_f32 v179, v118, v119
 v_exp_f32 v122, v122
 v_exp_f32 v123, v123
 v_cvt_pk_bf16_f32 v180, v120, v121
 v_exp_f32 v124, v124
 v_mfma_f32_32x32x16_bf16 v[160:175], v[220:223], v[108:111], v[160:175]
 v_exp_f32 v125, v125
 v_cvt_pk_bf16_f32 v181, v122, v123
 v_exp_f32 v126, v126
 v_exp_f32 v127, v127
 v_cvt_pk_bf16_f32 v182, v124, v125
 v_exp_f32 v128, v128
 v_mfma_f32_32x32x16_bf16 v[64:79], v[232:235], v[192:195], v[64:79]
 v_exp_f32 v129, v129
 v_cvt_pk_bf16_f32 v183, v126, v127
 v_exp_f32 v130, v130
 v_exp_f32 v131, v131
 v_cvt_pk_bf16_f32 v184, v128, v129
 v_exp_f32 v132, v132
 v_mfma_f32_32x32x16_bf16 v[80:95], v[232:235], v[200:203], v[80:95]
 v_exp_f32 v133, v133
 v_cvt_pk_bf16_f32 v185, v130, v131
 v_exp_f32 v134, v134
 v_exp_f32 v135, v135
 v_cvt_pk_bf16_f32 v186, v132, v133
 v_exp_f32 v136, v136
 v_mfma_f32_32x32x16_bf16 v[64:79], v[236:239], v[196:199], v[64:79]
 v_exp_f32 v137, v137
 v_cvt_pk_bf16_f32 v187, v134, v135
 v_exp_f32 v138, v138
 v_exp_f32 v139, v139
 v_cvt_pk_bf16_f32 v188, v136, v137
 v_exp_f32 v140, v140
 v_mfma_f32_32x32x16_bf16 v[80:95], v[236:239], v[204:207], v[80:95]
 v_exp_f32 v141, v141
 v_cvt_pk_bf16_f32 v189, v138, v139
 v_exp_f32 v142, v142
 v_exp_f32 v143, v143
 v_cvt_pk_bf16_f32 v190, v140, v141
 s_waitcnt lgkmcnt(0)
 v_cvt_pk_bf16_f32 v191, v142, v143
 v_mfma_f32_32x32x16_bf16 v[112:127], v[208:211], v[96:99], v[32:47]
 ds_read_b128 v[216:219], v10 offset:5120
 ds_read_b32 v220, v11 offset:640
 v_exp_f32 v144, v144
 v_exp_f32 v145, v145
 v_exp_f32 v146, v146
 v_exp_f32 v147, v147
 v_mfma_f32_32x32x16_bf16 v[128:143], v[208:211], v[104:107], v[48:63]
 ds_read_b128 v[232:235], v12 offset:3840
 ds_read_b128 v[236:239], v12 offset:4480
 v_cvt_pk_bf16_f32 v192, v144, v145
 v_exp_f32 v148, v148
 v_exp_f32 v149, v149
 v_cvt_pk_bf16_f32 v193, v146, v147
 s_waitcnt vmcnt(33)
 v_mfma_f32_32x32x16_bf16 a[0:15], a[104:107], a[96:99], 0
 v_exp_f32 v150, v150
 v_exp_f32 v151, v151
 v_cvt_pk_bf16_f32 v194, v148, v149
 v_exp_f32 v152, v152
 v_mfma_f32_32x32x16_bf16 v[112:127], v[212:215], v[100:103], v[112:127]
 v_exp_f32 v153, v153
 v_cvt_pk_bf16_f32 v195, v150, v151
 v_exp_f32 v154, v154
 v_exp_f32 v155, v155
 v_mfma_f32_32x32x16_bf16 v[128:143], v[212:215], v[108:111], v[128:143]
 v_cvt_pk_bf16_f32 v196, v152, v153
 v_exp_f32 v156, v156
 v_exp_f32 v157, v157
 v_mfma_f32_32x32x16_bf16 a[16:31], a[104:107], a[100:103], 0
 v_cvt_pk_bf16_f32 v197, v154, v155
 v_exp_f32 v158, v158
 v_exp_f32 v159, v159
 v_cvt_pk_bf16_f32 v198, v156, v157
 v_exp_f32 v160, v160
 v_mfma_f32_32x32x16_bf16 v[64:79], v[224:227], v[176:179], v[64:79]
 v_exp_f32 v161, v161
 v_cvt_pk_bf16_f32 v199, v158, v159
 v_exp_f32 v162, v162
 v_exp_f32 v163, v163
 v_mfma_f32_32x32x16_bf16 v[80:95], v[224:227], v[184:187], v[80:95]
 v_cvt_pk_bf16_f32 v200, v160, v161
 v_exp_f32 v164, v164
 v_exp_f32 v165, v165
 v_mfma_f32_32x32x16_bf16 a[32:47], a[108:111], a[96:99], 0
 v_cvt_pk_bf16_f32 v201, v162, v163
 v_exp_f32 v166, v166
 v_exp_f32 v167, v167
 v_cvt_pk_bf16_f32 v202, v164, v165
 v_exp_f32 v168, v168
 v_mfma_f32_32x32x16_bf16 v[64:79], v[228:231], v[180:183], v[64:79]
 v_exp_f32 v169, v169
 v_cvt_pk_bf16_f32 v203, v166, v167
 v_exp_f32 v170, v170
 v_mfma_f32_32x32x16_bf16 v[80:95], v[228:231], v[188:191], v[80:95]
 v_exp_f32 v171, v171
 v_cvt_pk_bf16_f32 v204, v168, v169
 v_exp_f32 v172, v172
 v_exp_f32 v173, v173
 v_mfma_f32_32x32x16_bf16 a[48:63], a[108:111], a[100:103], 0
 buffer_load_dwordx4 a[96:99], v14, s[36:39], s63 offen sc1
 v_cvt_pk_bf16_f32 v205, v170, v171
 v_exp_f32 v174, v174
 v_exp_f32 v175, v175
 v_cvt_pk_bf16_f32 v206, v172, v173
 s_waitcnt lgkmcnt(0)
 v_cvt_pk_bf16_f32 v207, v174, v175
 v_mfma_f32_32x32x16_bf16 v[144:159], v[216:219], v[96:99], v[32:47]
 ds_read_b128 v[208:211], v10 offset:6144
 ds_read_b32 v212, v11 offset:768
 v_exp_f32 v112, v112
 v_exp_f32 v113, v113
 v_exp_f32 v114, v114
 v_exp_f32 v115, v115
 v_mfma_f32_32x32x16_bf16 v[160:175], v[216:219], v[104:107], v[48:63]
 ds_read_b128 v[224:227], v12 offset:5120
 ds_read_b128 v[228:231], v12 offset:5760
 buffer_load_dwordx4 a[100:103], v14, s[36:39], s64 offen sc1
 v_cvt_pk_bf16_f32 v176, v112, v113
 v_exp_f32 v116, v116
 v_exp_f32 v117, v117
 v_cvt_pk_bf16_f32 v177, v114, v115
 s_waitcnt vmcnt(29)
 v_mfma_f32_32x32x16_bf16 a[0:15], a[120:123], a[112:115], a[0:15]
 v_exp_f32 v118, v118
 v_exp_f32 v119, v119
 v_cvt_pk_bf16_f32 v178, v116, v117
 v_exp_f32 v120, v120
 v_mfma_f32_32x32x16_bf16 v[144:159], v[220:223], v[100:103], v[144:159]
 buffer_load_dwordx4 a[104:107], v14, s[36:39], s65 offen sc1
 v_exp_f32 v121, v121
 v_cvt_pk_bf16_f32 v179, v118, v119
 v_exp_f32 v122, v122
 v_exp_f32 v123, v123
 v_mfma_f32_32x32x16_bf16 v[160:175], v[220:223], v[108:111], v[160:175]
 v_cvt_pk_bf16_f32 v180, v120, v121
 v_exp_f32 v124, v124
 v_exp_f32 v125, v125
 v_mfma_f32_32x32x16_bf16 a[16:31], a[120:123], a[116:119], a[16:31]
 buffer_load_dwordx4 a[108:111], v14, s[36:39], s65 offen offset:1024 sc1
 s_add_u32 s65, s65, 18432
 v_cvt_pk_bf16_f32 v181, v122, v123
 v_exp_f32 v126, v126
 v_exp_f32 v127, v127
 v_cvt_pk_bf16_f32 v182, v124, v125
 v_exp_f32 v128, v128
 v_mfma_f32_32x32x16_bf16 v[64:79], v[232:235], v[192:195], v[64:79]
 v_exp_f32 v129, v129
 v_cvt_pk_bf16_f32 v183, v126, v127
 v_exp_f32 v130, v130
 v_exp_f32 v131, v131
 v_mfma_f32_32x32x16_bf16 v[80:95], v[232:235], v[200:203], v[80:95]
 v_cvt_pk_bf16_f32 v184, v128, v129
 v_exp_f32 v132, v132
 v_exp_f32 v133, v133
 v_mfma_f32_32x32x16_bf16 a[32:47], a[124:127], a[112:115], a[32:47]
 v_cvt_pk_bf16_f32 v185, v130, v131
 v_exp_f32 v134, v134
 v_exp_f32 v135, v135
 v_cvt_pk_bf16_f32 v186, v132, v133
 v_exp_f32 v136, v136
 v_mfma_f32_32x32x16_bf16 v[64:79], v[236:239], v[196:199], v[64:79]
 v_exp_f32 v137, v137
 v_cvt_pk_bf16_f32 v187, v134, v135
 v_exp_f32 v138, v138
 v_mfma_f32_32x32x16_bf16 v[80:95], v[236:239], v[204:207], v[80:95]
 v_exp_f32 v139, v139
 v_cvt_pk_bf16_f32 v188, v136, v137
 v_exp_f32 v140, v140
 v_exp_f32 v141, v141
 v_mfma_f32_32x32x16_bf16 a[48:63], a[124:127], a[116:119], a[48:63]
 buffer_load_dwordx4 a[112:115], v14, s[36:39], s63 offen offset:1024 sc1
 v_cvt_pk_bf16_f32 v189, v138, v139
 v_exp_f32 v142, v142
 v_exp_f32 v143, v143
 v_cvt_pk_bf16_f32 v190, v140, v141
 s_waitcnt lgkmcnt(0)
 v_cvt_pk_bf16_f32 v191, v142, v143
 v_mfma_f32_32x32x16_bf16 v[112:127], v[208:211], v[96:99], v[32:47]
 ds_read_b128 v[216:219], v10 offset:7168
 ds_read_b32 v220, v11 offset:896
 v_exp_f32 v144, v144
 v_exp_f32 v145, v145
 v_exp_f32 v146, v146
 v_exp_f32 v147, v147
 v_mfma_f32_32x32x16_bf16 v[128:143], v[208:211], v[104:107], v[48:63]
 ds_read_b128 v[232:235], v12 offset:6400
 ds_read_b128 v[236:239], v12 offset:7040
 s_add_u32 s57, s57, 20480
 s_cmp_eq_u32 s57, 61440
 s_cselect_b32 s57, 0, s57
 buffer_load_dwordx4 a[116:119], v14, s[36:39], s64 offen offset:1024 sc1
 v_cvt_pk_bf16_f32 v192, v144, v145
 v_exp_f32 v148, v148
 v_exp_f32 v149, v149
 v_cvt_pk_bf16_f32 v193, v146, v147
 s_waitcnt vmcnt(29)
 v_mfma_f32_32x32x16_bf16 a[0:15], a[136:139], a[128:131], a[0:15]
 v_exp_f32 v150, v150
 v_exp_f32 v151, v151
 v_cvt_pk_bf16_f32 v194, v148, v149
 v_exp_f32 v152, v152
 v_mfma_f32_32x32x16_bf16 v[112:127], v[212:215], v[100:103], v[112:127]
 buffer_load_dwordx4 a[120:123], v14, s[36:39], s65 offen sc1
 v_exp_f32 v153, v153
 v_cvt_pk_bf16_f32 v195, v150, v151
 v_exp_f32 v154, v154
 v_exp_f32 v155, v155
 v_mfma_f32_32x32x16_bf16 v[128:143], v[212:215], v[108:111], v[128:143]
 v_cvt_pk_bf16_f32 v196, v152, v153
 v_exp_f32 v156, v156
 v_exp_f32 v157, v157
 v_mfma_f32_32x32x16_bf16 a[16:31], a[136:139], a[132:135], a[16:31]
 buffer_load_dwordx4 a[124:127], v14, s[36:39], s65 offen offset:1024 sc1
 s_add_u32 s65, s65, 18432
 v_cvt_pk_bf16_f32 v197, v154, v155
 v_exp_f32 v158, v158
 v_exp_f32 v159, v159
 v_cvt_pk_bf16_f32 v198, v156, v157
 v_exp_f32 v160, v160
 v_mfma_f32_32x32x16_bf16 v[64:79], v[224:227], v[176:179], v[64:79]
 v_exp_f32 v161, v161
 v_cvt_pk_bf16_f32 v199, v158, v159
 v_exp_f32 v162, v162
 v_exp_f32 v163, v163
 v_mfma_f32_32x32x16_bf16 v[80:95], v[224:227], v[184:187], v[80:95]
 v_cvt_pk_bf16_f32 v200, v160, v161
 v_exp_f32 v164, v164
 v_exp_f32 v165, v165
 v_mfma_f32_32x32x16_bf16 a[32:47], a[140:143], a[128:131], a[32:47]
 v_cvt_pk_bf16_f32 v201, v162, v163
 v_exp_f32 v166, v166
 v_exp_f32 v167, v167
 v_cvt_pk_bf16_f32 v202, v164, v165
 v_exp_f32 v168, v168
 v_mfma_f32_32x32x16_bf16 v[64:79], v[228:231], v[180:183], v[64:79]
 v_exp_f32 v169, v169
 v_cvt_pk_bf16_f32 v203, v166, v167
 v_exp_f32 v170, v170
 v_mfma_f32_32x32x16_bf16 v[80:95], v[228:231], v[188:191], v[80:95]
 v_exp_f32 v171, v171
 v_cvt_pk_bf16_f32 v204, v168, v169
 v_exp_f32 v172, v172
 v_exp_f32 v173, v173
 v_mfma_f32_32x32x16_bf16 a[48:63], a[140:143], a[132:135], a[48:63]
 buffer_load_dwordx4 a[128:131], v14, s[36:39], s63 offen offset:2048 sc1
 v_cvt_pk_bf16_f32 v205, v170, v171
 v_exp_f32 v174, v174
 v_exp_f32 v175, v175
 v_cvt_pk_bf16_f32 v206, v172, v173
 v_add_u32 v10, s57, v14
 v_add_u32 v11, s57, v20
 v_add_u32 v253, s57, v252
 s_waitcnt lgkmcnt(0)
 v_cvt_pk_bf16_f32 v207, v174, v175
 v_mfma_f32_32x32x16_bf16 v[144:159], v[216:219], v[96:99], v[32:47]
 s_waitcnt vmcnt(29)
 ds_write_b128 v253, v[248:251]
 s_waitcnt lgkmcnt(0)
 s_barrier
 ds_read_b128 v[208:211], v10
 ds_read_b32 v212, v11
 v_exp_f32 v112, v112
 v_exp_f32 v113, v113
 v_exp_f32 v114, v114
 v_exp_f32 v115, v115
 v_mfma_f32_32x32x16_bf16 v[160:175], v[216:219], v[104:107], v[48:63]
 ds_read_b128 v[224:227], v12 offset:7680
 ds_read_b128 v[228:231], v12 offset:8320
 buffer_load_dwordx4 a[132:135], v14, s[36:39], s64 offen offset:2048 sc1
 v_cvt_pk_bf16_f32 v176, v112, v113
 v_exp_f32 v116, v116
 v_exp_f32 v117, v117
 v_cvt_pk_bf16_f32 v177, v114, v115
 s_waitcnt vmcnt(26)
 v_mfma_f32_32x32x16_bf16 a[0:15], a[152:155], a[144:147], a[0:15]
 v_exp_f32 v118, v118
 v_exp_f32 v119, v119
 v_cvt_pk_bf16_f32 v178, v116, v117
 v_exp_f32 v120, v120
 v_mfma_f32_32x32x16_bf16 v[144:159], v[220:223], v[100:103], v[144:159]
 buffer_load_dwordx4 a[136:139], v14, s[36:39], s65 offen sc1
 v_exp_f32 v121, v121
 v_cvt_pk_bf16_f32 v179, v118, v119
 v_exp_f32 v122, v122
 v_exp_f32 v123, v123
 v_mfma_f32_32x32x16_bf16 v[160:175], v[220:223], v[108:111], v[160:175]
 v_cvt_pk_bf16_f32 v180, v120, v121
 v_exp_f32 v124, v124
 v_exp_f32 v125, v125
 v_mfma_f32_32x32x16_bf16 a[16:31], a[152:155], a[148:151], a[16:31]
 buffer_load_dwordx4 a[140:143], v14, s[36:39], s65 offen offset:1024 sc1
 s_add_u32 s65, s65, 18432
 v_cvt_pk_bf16_f32 v181, v122, v123
 v_exp_f32 v126, v126
 v_exp_f32 v127, v127
 v_cvt_pk_bf16_f32 v182, v124, v125
 v_exp_f32 v128, v128
 v_mfma_f32_32x32x16_bf16 v[64:79], v[232:235], v[192:195], v[64:79]
 v_exp_f32 v129, v129
 v_cvt_pk_bf16_f32 v183, v126, v127
 v_exp_f32 v130, v130
 v_exp_f32 v131, v131
 v_mfma_f32_32x32x16_bf16 v[80:95], v[232:235], v[200:203], v[80:95]
 s_add_u32 m0, s35, s58
 v_cvt_pk_bf16_f32 v184, v128, v129
 v_exp_f32 v132, v132
 v_exp_f32 v133, v133
 v_mfma_f32_32x32x16_bf16 a[32:47], a[156:159], a[144:147], a[32:47]
 buffer_load_dwordx4 v13, s[36:39], s56 offen sc1 lds
 v_cvt_pk_bf16_f32 v185, v130, v131
 v_exp_f32 v134, v134
 v_exp_f32 v135, v135
 v_cvt_pk_bf16_f32 v186, v132, v133
 v_exp_f32 v136, v136
 v_mfma_f32_32x32x16_bf16 v[64:79], v[236:239], v[196:199], v[64:79]
 v_exp_f32 v137, v137
 v_cvt_pk_bf16_f32 v187, v134, v135
 v_exp_f32 v138, v138
 v_mfma_f32_32x32x16_bf16 v[80:95], v[236:239], v[204:207], v[80:95]
 buffer_load_dwordx4 v13, s[36:39], s56 offen offset:1024 sc1 lds
 v_exp_f32 v139, v139
 v_cvt_pk_bf16_f32 v188, v136, v137
 v_exp_f32 v140, v140
 v_exp_f32 v141, v141
 v_mfma_f32_32x32x16_bf16 a[48:63], a[156:159], a[148:151], a[48:63]
 v_cvt_pk_bf16_f32 v189, v138, v139
 v_exp_f32 v142, v142
 v_exp_f32 v143, v143
 v_cvt_pk_bf16_f32 v190, v140, v141
 s_waitcnt lgkmcnt(0)
 v_cvt_pk_bf16_f32 v191, v142, v143
 v_mfma_f32_32x32x16_bf16 v[112:127], v[208:211], v[96:99], v[32:47]
 ds_read_b128 v[216:219], v10 offset:1024
 ds_read_b32 v220, v11 offset:128
 buffer_load_dwordx4 a[144:147], v14, s[36:39], s63 offen offset:3072 sc1
 s_add_u32 s63, s63, 4096
 v_exp_f32 v144, v144
 v_exp_f32 v145, v145
 v_exp_f32 v146, v146
 v_exp_f32 v147, v147
 v_mfma_f32_32x32x16_bf16 v[128:143], v[208:211], v[104:107], v[48:63]
 ds_read_b128 v[232:235], v12 offset:8960
 ds_read_b128 v[236:239], v12 offset:9600
 v_cvt_pk_bf16_f32 v192, v144, v145
 v_exp_f32 v148, v148
 v_exp_f32 v149, v149
 v_cvt_pk_bf16_f32 v193, v146, v147
 s_waitcnt vmcnt(27)
 v_mfma_f32_32x32x16_bf16 a[0:15], a[168:171], a[160:163], a[0:15]
 buffer_load_dwordx4 a[148:151], v14, s[36:39], s64 offen offset:3072 sc1
 s_add_u32 s64, s64, 4096
 v_exp_f32 v150, v150
 v_exp_f32 v151, v151
 v_cvt_pk_bf16_f32 v194, v148, v149
 v_exp_f32 v152, v152
 v_mfma_f32_32x32x16_bf16 v[112:127], v[212:215], v[100:103], v[112:127]
 v_exp_f32 v153, v153
 v_cvt_pk_bf16_f32 v195, v150, v151
 v_exp_f32 v154, v154
 v_exp_f32 v155, v155
 v_mfma_f32_32x32x16_bf16 v[128:143], v[212:215], v[108:111], v[128:143]
 buffer_load_dwordx4 a[152:155], v14, s[36:39], s65 offen sc1
 v_cvt_pk_bf16_f32 v196, v152, v153
 v_exp_f32 v156, v156
 v_exp_f32 v157, v157
 v_mfma_f32_32x32x16_bf16 a[16:31], a[168:171], a[164:167], a[16:31]
 v_cvt_pk_bf16_f32 v197, v154, v155
 v_exp_f32 v158, v158
 v_exp_f32 v159, v159
 v_cvt_pk_bf16_f32 v198, v156, v157
 v_exp_f32 v160, v160
 v_mfma_f32_32x32x16_bf16 v[64:79], v[224:227], v[176:179], v[64:79]
 buffer_load_dwordx4 a[156:159], v14, s[36:39], s65 offen offset:1024 sc1
 s_add_u32 s65, s65, 18432
 v_exp_f32 v161, v161
 v_cvt_pk_bf16_f32 v199, v158, v159
 v_exp_f32 v162, v162
 v_exp_f32 v163, v163
 v_mfma_f32_32x32x16_bf16 v[80:95], v[224:227], v[184:187], v[80:95]
 v_cvt_pk_bf16_f32 v200, v160, v161
 v_exp_f32 v164, v164
 v_exp_f32 v165, v165
 v_mfma_f32_32x32x16_bf16 a[32:47], a[172:175], a[160:163], a[32:47]
 buffer_load_dwordx4 v13, s[36:39], s56 offen offset:2048 sc1 lds
 v_cvt_pk_bf16_f32 v201, v162, v163
 v_exp_f32 v166, v166
 v_exp_f32 v167, v167
 v_cvt_pk_bf16_f32 v202, v164, v165
 v_exp_f32 v168, v168
 v_mfma_f32_32x32x16_bf16 v[64:79], v[228:231], v[180:183], v[64:79]
 v_exp_f32 v169, v169
 v_cvt_pk_bf16_f32 v203, v166, v167
 v_exp_f32 v170, v170
 v_mfma_f32_32x32x16_bf16 v[80:95], v[228:231], v[188:191], v[80:95]
 buffer_load_dwordx4 v13, s[36:39], s56 offen offset:3072 sc1 lds
 s_add_u32 m0, m0, 4096
 s_add_u32 s56, s56, 4096
 v_exp_f32 v171, v171
 v_cvt_pk_bf16_f32 v204, v168, v169
 v_exp_f32 v172, v172
 v_exp_f32 v173, v173
 v_mfma_f32_32x32x16_bf16 a[48:63], a[172:175], a[164:167], a[48:63]
 v_cvt_pk_bf16_f32 v205, v170, v171
 v_exp_f32 v174, v174
 v_exp_f32 v175, v175
 v_cvt_pk_bf16_f32 v206, v172, v173
 v_add_u32 v12, s57, v21
 s_waitcnt lgkmcnt(0)
 v_cvt_pk_bf16_f32 v207, v174, v175
 v_mfma_f32_32x32x16_bf16 v[144:159], v[216:219], v[96:99], v[32:47]
 ds_read_b128 v[208:211], v10 offset:2048
 ds_read_b32 v212, v11 offset:256
 buffer_load_dwordx4 v13, s[36:39], s56 offen sc1 lds
 v_exp_f32 v112, v112
 v_exp_f32 v113, v113
 v_exp_f32 v114, v114
 v_exp_f32 v115, v115
 v_mfma_f32_32x32x16_bf16 v[160:175], v[216:219], v[104:107], v[48:63]
 ds_read_b128 v[224:227], v12
 ds_read_b128 v[228:231], v12 offset:640
 v_cvt_pk_bf16_f32 v176, v112, v113
 v_exp_f32 v116, v116
 v_exp_f32 v117, v117
 v_cvt_pk_bf16_f32 v177, v114, v115
 s_waitcnt vmcnt(29)
 v_mfma_f32_32x32x16_bf16 a[0:15], a[184:187], a[176:179], a[0:15]
 s_add_u32 s56, s56, 16384
 s_add_u32 s35, s35, 20480
 s_cmp_eq_u32 s35, 61440
 s_cselect_b32 s35, 0, s35
 buffer_load_dwordx4 a[160:163], v14, s[36:39], s63 offen sc1
 v_exp_f32 v118, v118
 v_exp_f32 v119, v119
 v_cvt_pk_bf16_f32 v178, v116, v117
 v_exp_f32 v120, v120
 v_mfma_f32_32x32x16_bf16 v[144:159], v[220:223], v[100:103], v[144:159]
 v_exp_f32 v121, v121
 v_cvt_pk_bf16_f32 v179, v118, v119
 v_exp_f32 v122, v122
 v_exp_f32 v123, v123
 v_mfma_f32_32x32x16_bf16 v[160:175], v[220:223], v[108:111], v[160:175]
 buffer_load_dwordx4 a[164:167], v14, s[36:39], s64 offen sc1
 v_cvt_pk_bf16_f32 v180, v120, v121
 v_exp_f32 v124, v124
 v_exp_f32 v125, v125
 v_mfma_f32_32x32x16_bf16 a[16:31], a[184:187], a[180:183], a[16:31]
 v_cvt_pk_bf16_f32 v181, v122, v123
 v_exp_f32 v126, v126
 v_exp_f32 v127, v127
 v_cvt_pk_bf16_f32 v182, v124, v125
 v_exp_f32 v128, v128
 v_mfma_f32_32x32x16_bf16 v[64:79], v[232:235], v[192:195], v[64:79]
 buffer_load_dwordx4 a[168:171], v14, s[36:39], s65 offen sc1
 v_exp_f32 v129, v129
 v_cvt_pk_bf16_f32 v183, v126, v127
 v_exp_f32 v130, v130
 v_exp_f32 v131, v131
 v_mfma_f32_32x32x16_bf16 v[80:95], v[232:235], v[200:203], v[80:95]
 v_cvt_pk_bf16_f32 v184, v128, v129
 v_exp_f32 v132, v132
 v_exp_f32 v133, v133
 v_mfma_f32_32x32x16_bf16 a[32:47], a[188:191], a[176:179], a[32:47]
 buffer_load_dwordx4 a[172:175], v14, s[36:39], s65 offen offset:1024 sc1
 s_add_u32 s65, s65, 18432
 v_cvt_pk_bf16_f32 v185, v130, v131
 v_exp_f32 v134, v134
 v_exp_f32 v135, v135
 v_cvt_pk_bf16_f32 v186, v132, v133
 v_exp_f32 v136, v136
 v_mfma_f32_32x32x16_bf16 v[64:79], v[236:239], v[196:199], v[64:79]
 v_exp_f32 v137, v137
 v_cvt_pk_bf16_f32 v187, v134, v135
 v_exp_f32 v138, v138
 v_mfma_f32_32x32x16_bf16 v[80:95], v[236:239], v[204:207], v[80:95]
 v_exp_f32 v139, v139
 v_cvt_pk_bf16_f32 v188, v136, v137
 v_exp_f32 v140, v140
 v_exp_f32 v141, v141
 v_mfma_f32_32x32x16_bf16 a[48:63], a[188:191], a[180:183], a[48:63]
 buffer_load_dwordx4 a[176:179], v14, s[36:39], s63 offen offset:1024 sc1
 v_cvt_pk_bf16_f32 v189, v138, v139
 v_exp_f32 v142, v142
 v_exp_f32 v143, v143
 v_cvt_pk_bf16_f32 v190, v140, v141
 s_waitcnt lgkmcnt(0)
 v_cvt_pk_bf16_f32 v191, v142, v143
 v_mfma_f32_32x32x16_bf16 v[112:127], v[208:211], v[96:99], v[32:47]
 ds_read_b128 v[216:219], v10 offset:3072
 ds_read_b32 v220, v11 offset:384
 v_exp_f32 v144, v144
 v_exp_f32 v145, v145
 v_exp_f32 v146, v146
 v_exp_f32 v147, v147
 v_mfma_f32_32x32x16_bf16 v[128:143], v[208:211], v[104:107], v[48:63]
 ds_read_b128 v[232:235], v12 offset:1280
 ds_read_b128 v[236:239], v12 offset:1920
 buffer_load_dwordx4 a[180:183], v14, s[36:39], s64 offen offset:1024 sc1
 v_cvt_pk_bf16_f32 v192, v144, v145
 v_exp_f32 v148, v148
 v_exp_f32 v149, v149
 v_cvt_pk_bf16_f32 v193, v146, v147
 s_waitcnt vmcnt(31)
 v_mfma_f32_32x32x16_bf16 a[0:15], a[200:203], a[192:195], a[0:15]
 v_exp_f32 v150, v150
 v_exp_f32 v151, v151
 v_cvt_pk_bf16_f32 v194, v148, v149
 v_exp_f32 v152, v152
 v_mfma_f32_32x32x16_bf16 v[112:127], v[212:215], v[100:103], v[112:127]
 buffer_load_dwordx4 a[184:187], v14, s[36:39], s65 offen sc1
 v_exp_f32 v153, v153
 v_cvt_pk_bf16_f32 v195, v150, v151
 v_exp_f32 v154, v154
 v_exp_f32 v155, v155
 v_mfma_f32_32x32x16_bf16 v[128:143], v[212:215], v[108:111], v[128:143]
 v_cvt_pk_bf16_f32 v196, v152, v153
 v_exp_f32 v156, v156
 v_exp_f32 v157, v157
 v_mfma_f32_32x32x16_bf16 a[16:31], a[200:203], a[196:199], a[16:31]
 buffer_load_dwordx4 a[188:191], v14, s[36:39], s65 offen offset:1024 sc1
 s_add_u32 s65, s65, 18432
 v_cvt_pk_bf16_f32 v197, v154, v155
 v_exp_f32 v158, v158
 v_exp_f32 v159, v159
 v_cvt_pk_bf16_f32 v198, v156, v157
 v_exp_f32 v160, v160
 v_mfma_f32_32x32x16_bf16 v[64:79], v[224:227], v[176:179], v[64:79]
 v_exp_f32 v161, v161
 v_cvt_pk_bf16_f32 v199, v158, v159
 v_exp_f32 v162, v162
 v_exp_f32 v163, v163
 v_mfma_f32_32x32x16_bf16 v[80:95], v[224:227], v[184:187], v[80:95]
 v_cvt_pk_bf16_f32 v200, v160, v161
 v_exp_f32 v164, v164
 v_exp_f32 v165, v165
 v_mfma_f32_32x32x16_bf16 a[32:47], a[204:207], a[192:195], a[32:47]
 v_cvt_pk_bf16_f32 v201, v162, v163
 v_exp_f32 v166, v166
 v_exp_f32 v167, v167
 v_cvt_pk_bf16_f32 v202, v164, v165
 v_exp_f32 v168, v168
 v_mfma_f32_32x32x16_bf16 v[64:79], v[228:231], v[180:183], v[64:79]
 v_exp_f32 v169, v169
 v_cvt_pk_bf16_f32 v203, v166, v167
 v_exp_f32 v170, v170
 v_mfma_f32_32x32x16_bf16 v[80:95], v[228:231], v[188:191], v[80:95]
 v_exp_f32 v171, v171
 v_cvt_pk_bf16_f32 v204, v168, v169
 v_exp_f32 v172, v172
 v_exp_f32 v173, v173
 v_mfma_f32_32x32x16_bf16 a[48:63], a[204:207], a[196:199], a[48:63]
 buffer_load_dwordx4 a[192:195], v14, s[36:39], s63 offen offset:2048 sc1
 v_cvt_pk_bf16_f32 v205, v170, v171
 v_exp_f32 v174, v174
 v_exp_f32 v175, v175
 v_cvt_pk_bf16_f32 v206, v172, v173
 s_waitcnt lgkmcnt(0)
 v_cvt_pk_bf16_f32 v207, v174, v175
 v_mfma_f32_32x32x16_bf16 v[144:159], v[216:219], v[96:99], v[32:47]
 ds_read_b128 v[208:211], v10 offset:4096
 ds_read_b32 v212, v11 offset:512
 v_exp_f32 v112, v112
 v_exp_f32 v113, v113
 v_exp_f32 v114, v114
 v_exp_f32 v115, v115
 v_mfma_f32_32x32x16_bf16 v[160:175], v[216:219], v[104:107], v[48:63]
 ds_read_b128 v[224:227], v12 offset:2560
 ds_read_b128 v[228:231], v12 offset:3200
 buffer_load_dwordx4 a[196:199], v14, s[36:39], s64 offen offset:2048 sc1
 v_cvt_pk_bf16_f32 v176, v112, v113
 v_exp_f32 v116, v116
 v_exp_f32 v117, v117
 v_cvt_pk_bf16_f32 v177, v114, v115
 s_waitcnt vmcnt(31)
 v_mfma_f32_32x32x16_bf16 a[0:15], a[216:219], a[208:211], a[0:15]
 v_exp_f32 v118, v118
 v_exp_f32 v119, v119
 v_cvt_pk_bf16_f32 v178, v116, v117
 v_exp_f32 v120, v120
 v_mfma_f32_32x32x16_bf16 v[144:159], v[220:223], v[100:103], v[144:159]
 buffer_load_dwordx4 a[200:203], v14, s[36:39], s65 offen sc1
 v_exp_f32 v121, v121
 v_cvt_pk_bf16_f32 v179, v118, v119
 v_exp_f32 v122, v122
 v_exp_f32 v123, v123
 v_mfma_f32_32x32x16_bf16 v[160:175], v[220:223], v[108:111], v[160:175]
 v_cvt_pk_bf16_f32 v180, v120, v121
 v_exp_f32 v124, v124
 v_exp_f32 v125, v125
 v_mfma_f32_32x32x16_bf16 a[16:31], a[216:219], a[212:215], a[16:31]
 buffer_load_dwordx4 a[204:207], v14, s[36:39], s65 offen offset:1024 sc1
 s_add_u32 s65, s65, 18432
 v_cvt_pk_bf16_f32 v181, v122, v123
 v_exp_f32 v126, v126
 v_exp_f32 v127, v127
 v_cvt_pk_bf16_f32 v182, v124, v125
 v_exp_f32 v128, v128
 v_mfma_f32_32x32x16_bf16 v[64:79], v[232:235], v[192:195], v[64:79]
 v_exp_f32 v129, v129
 v_cvt_pk_bf16_f32 v183, v126, v127
 v_exp_f32 v130, v130
 v_exp_f32 v131, v131
 v_mfma_f32_32x32x16_bf16 v[80:95], v[232:235], v[200:203], v[80:95]
 v_cvt_pk_bf16_f32 v184, v128, v129
 v_exp_f32 v132, v132
 v_exp_f32 v133, v133
 v_mfma_f32_32x32x16_bf16 a[32:47], a[220:223], a[208:211], a[32:47]
 v_cvt_pk_bf16_f32 v185, v130, v131
 v_exp_f32 v134, v134
 v_exp_f32 v135, v135
 v_cvt_pk_bf16_f32 v186, v132, v133
 v_exp_f32 v136, v136
 v_mfma_f32_32x32x16_bf16 v[64:79], v[236:239], v[196:199], v[64:79]
 v_exp_f32 v137, v137
 v_cvt_pk_bf16_f32 v187, v134, v135
 v_exp_f32 v138, v138
 v_mfma_f32_32x32x16_bf16 v[80:95], v[236:239], v[204:207], v[80:95]
 v_exp_f32 v139, v139
 v_cvt_pk_bf16_f32 v188, v136, v137
 v_exp_f32 v140, v140
 v_exp_f32 v141, v141
 v_mfma_f32_32x32x16_bf16 a[48:63], a[220:223], a[212:215], a[48:63]
 buffer_load_dwordx4 a[208:211], v14, s[36:39], s63 offen offset:3072 sc1
 s_add_u32 s63, s63, 4096
 v_cvt_pk_bf16_f32 v189, v138, v139
 v_exp_f32 v142, v142
 v_exp_f32 v143, v143
 v_cvt_pk_bf16_f32 v190, v140, v141
 s_waitcnt lgkmcnt(0)
 v_cvt_pk_bf16_f32 v191, v142, v143
 v_mfma_f32_32x32x16_bf16 v[112:127], v[208:211], v[96:99], v[32:47]
 ds_read_b128 v[216:219], v10 offset:5120
 ds_read_b32 v220, v11 offset:640
 v_exp_f32 v144, v144
 v_exp_f32 v145, v145
 v_exp_f32 v146, v146
 v_exp_f32 v147, v147
 v_mfma_f32_32x32x16_bf16 v[128:143], v[208:211], v[104:107], v[48:63]
 ds_read_b128 v[232:235], v12 offset:3840
 ds_read_b128 v[236:239], v12 offset:4480
 buffer_load_dwordx4 a[212:215], v14, s[36:39], s64 offen offset:3072 sc1
 s_add_u32 s64, s64, 4096
 v_cvt_pk_bf16_f32 v192, v144, v145
 v_exp_f32 v148, v148
 v_exp_f32 v149, v149
 v_cvt_pk_bf16_f32 v193, v146, v147
 s_waitcnt vmcnt(31)
 v_mfma_f32_32x32x16_bf16 a[0:15], a[104:107], a[96:99], a[0:15]
 v_exp_f32 v150, v150
 v_exp_f32 v151, v151
 v_cvt_pk_bf16_f32 v194, v148, v149
 v_exp_f32 v152, v152
 v_mfma_f32_32x32x16_bf16 v[112:127], v[212:215], v[100:103], v[112:127]
 buffer_load_dwordx4 a[216:219], v14, s[36:39], s65 offen sc1
 v_exp_f32 v153, v153
 v_cvt_pk_bf16_f32 v195, v150, v151
 v_exp_f32 v154, v154
 v_exp_f32 v155, v155
 v_mfma_f32_32x32x16_bf16 v[128:143], v[212:215], v[108:111], v[128:143]
 v_cvt_pk_bf16_f32 v196, v152, v153
 v_exp_f32 v156, v156
 v_exp_f32 v157, v157
 v_mfma_f32_32x32x16_bf16 a[16:31], a[104:107], a[100:103], a[16:31]
 buffer_load_dwordx4 a[220:223], v14, s[36:39], s65 offen offset:1024 sc1
 s_add_u32 s65, s65, 18432
 v_cvt_pk_bf16_f32 v197, v154, v155
 v_exp_f32 v158, v158
 v_exp_f32 v159, v159
 v_cvt_pk_bf16_f32 v198, v156, v157
 v_exp_f32 v160, v160
 v_mfma_f32_32x32x16_bf16 v[64:79], v[224:227], v[176:179], v[64:79]
 v_exp_f32 v161, v161
 v_cvt_pk_bf16_f32 v199, v158, v159
 v_exp_f32 v162, v162
 v_exp_f32 v163, v163
 v_mfma_f32_32x32x16_bf16 v[80:95], v[224:227], v[184:187], v[80:95]
 v_cvt_pk_bf16_f32 v200, v160, v161
 v_exp_f32 v164, v164
 v_exp_f32 v165, v165
 v_mfma_f32_32x32x16_bf16 a[32:47], a[108:111], a[96:99], a[32:47]
 v_cvt_pk_bf16_f32 v201, v162, v163
 v_exp_f32 v166, v166
 v_exp_f32 v167, v167
 v_cvt_pk_bf16_f32 v202, v164, v165
 v_exp_f32 v168, v168
 v_mfma_f32_32x32x16_bf16 v[64:79], v[228:231], v[180:183], v[64:79]
 v_exp_f32 v169, v169
 v_cvt_pk_bf16_f32 v203, v166, v167
 v_exp_f32 v170, v170
 v_mfma_f32_32x32x16_bf16 v[80:95], v[228:231], v[188:191], v[80:95]
 v_exp_f32 v171, v171
 v_cvt_pk_bf16_f32 v204, v168, v169
 v_exp_f32 v172, v172
 v_exp_f32 v173, v173
 v_mfma_f32_32x32x16_bf16 a[48:63], a[108:111], a[100:103], a[48:63]
 buffer_load_dwordx4 a[96:99], v14, s[36:39], s63 offen sc1
 v_cvt_pk_bf16_f32 v205, v170, v171
 v_exp_f32 v174, v174
 v_exp_f32 v175, v175
 v_cvt_pk_bf16_f32 v206, v172, v173
 s_waitcnt lgkmcnt(0)
 v_cvt_pk_bf16_f32 v207, v174, v175
 v_mfma_f32_32x32x16_bf16 v[144:159], v[216:219], v[96:99], v[32:47]
 ds_read_b128 v[208:211], v10 offset:6144
 ds_read_b32 v212, v11 offset:768
 v_exp_f32 v112, v112
 v_exp_f32 v113, v113
 v_exp_f32 v114, v114
 v_exp_f32 v115, v115
 v_mfma_f32_32x32x16_bf16 v[160:175], v[216:219], v[104:107], v[48:63]
 ds_read_b128 v[224:227], v12 offset:5120
 ds_read_b128 v[228:231], v12 offset:5760
 buffer_load_dwordx4 a[100:103], v14, s[36:39], s64 offen sc1
 v_cvt_pk_bf16_f32 v176, v112, v113
 v_exp_f32 v116, v116
 v_exp_f32 v117, v117
 v_cvt_pk_bf16_f32 v177, v114, v115
 s_waitcnt vmcnt(31)
 v_mfma_f32_32x32x16_bf16 a[0:15], a[120:123], a[112:115], a[0:15]
 v_exp_f32 v118, v118
 v_exp_f32 v119, v119
 v_cvt_pk_bf16_f32 v178, v116, v117
 v_exp_f32 v120, v120
 v_mfma_f32_32x32x16_bf16 v[144:159], v[220:223], v[100:103], v[144:159]
 buffer_load_dwordx4 a[104:107], v14, s[36:39], s65 offen sc1
 v_exp_f32 v121, v121
 v_cvt_pk_bf16_f32 v179, v118, v119
 v_exp_f32 v122, v122
 v_exp_f32 v123, v123
 v_mfma_f32_32x32x16_bf16 v[160:175], v[220:223], v[108:111], v[160:175]
 v_cvt_pk_bf16_f32 v180, v120, v121
 v_exp_f32 v124, v124
 v_exp_f32 v125, v125
 v_mfma_f32_32x32x16_bf16 a[16:31], a[120:123], a[116:119], a[16:31]
 buffer_load_dwordx4 a[108:111], v14, s[36:39], s65 offen offset:1024 sc1
 s_add_u32 s65, s65, 18432
 v_cvt_pk_bf16_f32 v181, v122, v123
 v_exp_f32 v126, v126
 v_exp_f32 v127, v127
 v_cvt_pk_bf16_f32 v182, v124, v125
 v_exp_f32 v128, v128
 v_mfma_f32_32x32x16_bf16 v[64:79], v[232:235], v[192:195], v[64:79]
 v_exp_f32 v129, v129
 v_cvt_pk_bf16_f32 v183, v126, v127
 v_exp_f32 v130, v130
 v_exp_f32 v131, v131
 v_mfma_f32_32x32x16_bf16 v[80:95], v[232:235], v[200:203], v[80:95]
 v_cvt_pk_bf16_f32 v184, v128, v129
 v_exp_f32 v132, v132
 v_exp_f32 v133, v133
 v_mfma_f32_32x32x16_bf16 a[32:47], a[124:127], a[112:115], a[32:47]
 v_cvt_pk_bf16_f32 v185, v130, v131
 v_exp_f32 v134, v134
 v_exp_f32 v135, v135
 v_cvt_pk_bf16_f32 v186, v132, v133
 v_exp_f32 v136, v136
 v_mfma_f32_32x32x16_bf16 v[64:79], v[236:239], v[196:199], v[64:79]
 v_exp_f32 v137, v137
 v_cvt_pk_bf16_f32 v187, v134, v135
 v_exp_f32 v138, v138
 v_mfma_f32_32x32x16_bf16 v[80:95], v[236:239], v[204:207], v[80:95]
 v_exp_f32 v139, v139
 v_cvt_pk_bf16_f32 v188, v136, v137
 v_exp_f32 v140, v140
 v_exp_f32 v141, v141
 v_mfma_f32_32x32x16_bf16 a[48:63], a[124:127], a[116:119], a[48:63]
 buffer_load_dwordx4 a[112:115], v14, s[36:39], s63 offen offset:1024 sc1
 v_cvt_pk_bf16_f32 v189, v138, v139
 v_exp_f32 v142, v142
 v_exp_f32 v143, v143
 v_cvt_pk_bf16_f32 v190, v140, v141
 s_waitcnt lgkmcnt(0)
 v_cvt_pk_bf16_f32 v191, v142, v143
 v_mfma_f32_32x32x16_bf16 v[112:127], v[208:211], v[96:99], v[32:47]
 ds_read_b128 v[216:219], v10 offset:7168
 ds_read_b32 v220, v11 offset:896
 v_exp_f32 v144, v144
 v_exp_f32 v145, v145
 v_exp_f32 v146, v146
 v_exp_f32 v147, v147
 v_mfma_f32_32x32x16_bf16 v[128:143], v[208:211], v[104:107], v[48:63]
 ds_read_b128 v[232:235], v12 offset:6400
 ds_read_b128 v[236:239], v12 offset:7040
 s_add_u32 s57, s57, 20480
 s_cmp_eq_u32 s57, 61440
 s_cselect_b32 s57, 0, s57
 buffer_load_dwordx4 a[116:119], v14, s[36:39], s64 offen offset:1024 sc1
 v_cvt_pk_bf16_f32 v192, v144, v145
 v_exp_f32 v148, v148
 v_exp_f32 v149, v149
 v_cvt_pk_bf16_f32 v193, v146, v147
 s_waitcnt vmcnt(31)
 v_mfma_f32_32x32x16_bf16 a[0:15], a[136:139], a[128:131], a[0:15]
 v_exp_f32 v150, v150
 v_exp_f32 v151, v151
 v_cvt_pk_bf16_f32 v194, v148, v149
 v_exp_f32 v152, v152
 v_mfma_f32_32x32x16_bf16 v[112:127], v[212:215], v[100:103], v[112:127]
 buffer_load_dwordx4 a[120:123], v14, s[36:39], s65 offen sc1
 v_exp_f32 v153, v153
 v_cvt_pk_bf16_f32 v195, v150, v151
 v_exp_f32 v154, v154
 v_exp_f32 v155, v155
 v_mfma_f32_32x32x16_bf16 v[128:143], v[212:215], v[108:111], v[128:143]
 v_cvt_pk_bf16_f32 v196, v152, v153
 v_exp_f32 v156, v156
 v_exp_f32 v157, v157
 v_mfma_f32_32x32x16_bf16 a[16:31], a[136:139], a[132:135], a[16:31]
 buffer_load_dwordx4 a[124:127], v14, s[36:39], s65 offen offset:1024 sc1
 s_add_u32 s65, s65, 18432
 v_cvt_pk_bf16_f32 v197, v154, v155
 v_exp_f32 v158, v158
 v_exp_f32 v159, v159
 v_cvt_pk_bf16_f32 v198, v156, v157
 v_exp_f32 v160, v160
 v_mfma_f32_32x32x16_bf16 v[64:79], v[224:227], v[176:179], v[64:79]
 v_exp_f32 v161, v161
 v_cvt_pk_bf16_f32 v199, v158, v159
 v_exp_f32 v162, v162
 v_exp_f32 v163, v163
 v_mfma_f32_32x32x16_bf16 v[80:95], v[224:227], v[184:187], v[80:95]
 v_cvt_pk_bf16_f32 v200, v160, v161
 v_exp_f32 v164, v164
 v_exp_f32 v165, v165
 v_mfma_f32_32x32x16_bf16 a[32:47], a[140:143], a[128:131], a[32:47]
 v_cvt_pk_bf16_f32 v201, v162, v163
 v_exp_f32 v166, v166
 v_exp_f32 v167, v167
 v_cvt_pk_bf16_f32 v202, v164, v165
 v_exp_f32 v168, v168
 v_mfma_f32_32x32x16_bf16 v[64:79], v[228:231], v[180:183], v[64:79]
 v_exp_f32 v169, v169
 v_cvt_pk_bf16_f32 v203, v166, v167
 v_exp_f32 v170, v170
 v_mfma_f32_32x32x16_bf16 v[80:95], v[228:231], v[188:191], v[80:95]
 v_exp_f32 v171, v171
 v_cvt_pk_bf16_f32 v204, v168, v169
 v_exp_f32 v172, v172
 v_exp_f32 v173, v173
 v_mfma_f32_32x32x16_bf16 a[48:63], a[140:143], a[132:135], a[48:63]
 buffer_load_dwordx4 a[128:131], v14, s[36:39], s63 offen offset:2048 sc1
 v_cvt_pk_bf16_f32 v205, v170, v171
 v_exp_f32 v174, v174
 v_exp_f32 v175, v175
 v_cvt_pk_bf16_f32 v206, v172, v173
 v_add_u32 v10, s57, v14
 v_add_u32 v11, s57, v20
 v_add_u32 v253, s57, v252
 s_waitcnt lgkmcnt(0)
 v_cvt_pk_bf16_f32 v207, v174, v175
 v_mfma_f32_32x32x16_bf16 v[144:159], v[216:219], v[96:99], v[32:47]
 s_waitcnt vmcnt(25)
 ds_write_b128 v253, v[248:251]
 s_waitcnt lgkmcnt(0)
 s_barrier
 ds_read_b128 v[208:211], v10
 ds_read_b32 v212, v11
 v_exp_f32 v112, v112
 v_exp_f32 v113, v113
 v_exp_f32 v114, v114
 v_exp_f32 v115, v115
 v_mfma_f32_32x32x16_bf16 v[160:175], v[216:219], v[104:107], v[48:63]
 ds_read_b128 v[224:227], v12 offset:7680
 ds_read_b128 v[228:231], v12 offset:8320
 buffer_load_dwordx4 a[132:135], v14, s[36:39], s64 offen offset:2048 sc1
 v_cvt_pk_bf16_f32 v176, v112, v113
 v_exp_f32 v116, v116
 v_exp_f32 v117, v117
 v_cvt_pk_bf16_f32 v177, v114, v115
 s_waitcnt vmcnt(29)
 v_mfma_f32_32x32x16_bf16 a[0:15], a[152:155], a[144:147], a[0:15]
 v_exp_f32 v118, v118
 v_exp_f32 v119, v119
 v_cvt_pk_bf16_f32 v178, v116, v117
 v_exp_f32 v120, v120
 v_mfma_f32_32x32x16_bf16 v[144:159], v[220:223], v[100:103], v[144:159]
 buffer_load_dwordx4 a[136:139], v14, s[36:39], s65 offen sc1
 v_exp_f32 v121, v121
 v_cvt_pk_bf16_f32 v179, v118, v119
 v_exp_f32 v122, v122
 v_exp_f32 v123, v123
 v_mfma_f32_32x32x16_bf16 v[160:175], v[220:223], v[108:111], v[160:175]
 v_cvt_pk_bf16_f32 v180, v120, v121
 v_exp_f32 v124, v124
 v_exp_f32 v125, v125
 v_mfma_f32_32x32x16_bf16 a[16:31], a[152:155], a[148:151], a[16:31]
 buffer_load_dwordx4 a[140:143], v14, s[36:39], s65 offen offset:1024 sc1
 s_add_u32 s65, s65, 18432
 v_cvt_pk_bf16_f32 v181, v122, v123
 v_exp_f32 v126, v126
 v_exp_f32 v127, v127
 v_cvt_pk_bf16_f32 v182, v124, v125
 v_exp_f32 v128, v128
 v_mfma_f32_32x32x16_bf16 v[64:79], v[232:235], v[192:195], v[64:79]
 v_exp_f32 v129, v129
 v_cvt_pk_bf16_f32 v183, v126, v127
 v_exp_f32 v130, v130
 v_exp_f32 v131, v131
 v_mfma_f32_32x32x16_bf16 v[80:95], v[232:235], v[200:203], v[80:95]
 s_add_u32 m0, s35, s58
 v_cvt_pk_bf16_f32 v184, v128, v129
 v_exp_f32 v132, v132
 v_exp_f32 v133, v133
 v_mfma_f32_32x32x16_bf16 a[32:47], a[156:159], a[144:147], a[32:47]
 buffer_load_dwordx4 v13, s[36:39], s56 offen sc1 lds
 v_cvt_pk_bf16_f32 v185, v130, v131
 v_exp_f32 v134, v134
 v_exp_f32 v135, v135
 v_cvt_pk_bf16_f32 v186, v132, v133
 v_exp_f32 v136, v136
 v_mfma_f32_32x32x16_bf16 v[64:79], v[236:239], v[196:199], v[64:79]
 v_exp_f32 v137, v137
 v_cvt_pk_bf16_f32 v187, v134, v135
 v_exp_f32 v138, v138
 v_mfma_f32_32x32x16_bf16 v[80:95], v[236:239], v[204:207], v[80:95]
 buffer_load_dwordx4 v13, s[36:39], s56 offen offset:1024 sc1 lds
 v_exp_f32 v139, v139
 v_cvt_pk_bf16_f32 v188, v136, v137
 v_exp_f32 v140, v140
 v_exp_f32 v141, v141
 v_mfma_f32_32x32x16_bf16 a[48:63], a[156:159], a[148:151], a[48:63]
 v_cvt_pk_bf16_f32 v189, v138, v139
 v_exp_f32 v142, v142
 v_exp_f32 v143, v143
 v_cvt_pk_bf16_f32 v190, v140, v141
 s_waitcnt lgkmcnt(0)
 v_cvt_pk_bf16_f32 v191, v142, v143
 v_mfma_f32_32x32x16_bf16 v[112:127], v[208:211], v[96:99], v[32:47]
 ds_read_b128 v[216:219], v10 offset:1024
 ds_read_b32 v220, v11 offset:128
 buffer_load_dwordx4 a[144:147], v14, s[36:39], s63 offen offset:3072 sc1
 s_add_u32 s63, s63, 4096
 v_exp_f32 v144, v144
 v_exp_f32 v145, v145
 v_exp_f32 v146, v146
 v_exp_f32 v147, v147
 v_mfma_f32_32x32x16_bf16 v[128:143], v[208:211], v[104:107], v[48:63]
 ds_read_b128 v[232:235], v12 offset:8960
 ds_read_b128 v[236:239], v12 offset:9600
 v_cvt_pk_bf16_f32 v192, v144, v145
 v_exp_f32 v148, v148
 v_exp_f32 v149, v149
 v_cvt_pk_bf16_f32 v193, v146, v147
 s_waitcnt vmcnt(27)
 v_mfma_f32_32x32x16_bf16 a[0:15], a[168:171], a[160:163], a[0:15]
 buffer_load_dwordx4 a[148:151], v14, s[36:39], s64 offen offset:3072 sc1
 s_add_u32 s64, s64, 4096
 v_exp_f32 v150, v150
 v_exp_f32 v151, v151
 v_cvt_pk_bf16_f32 v194, v148, v149
 v_exp_f32 v152, v152
 v_mfma_f32_32x32x16_bf16 v[112:127], v[212:215], v[100:103], v[112:127]
 v_exp_f32 v153, v153
 v_cvt_pk_bf16_f32 v195, v150, v151
 v_exp_f32 v154, v154
 v_exp_f32 v155, v155
 v_mfma_f32_32x32x16_bf16 v[128:143], v[212:215], v[108:111], v[128:143]
 buffer_load_dwordx4 a[152:155], v14, s[36:39], s65 offen sc1
 v_cvt_pk_bf16_f32 v196, v152, v153
 v_exp_f32 v156, v156
 v_exp_f32 v157, v157
 v_mfma_f32_32x32x16_bf16 a[16:31], a[168:171], a[164:167], a[16:31]
 v_cvt_pk_bf16_f32 v197, v154, v155
 v_exp_f32 v158, v158
 v_exp_f32 v159, v159
 v_cvt_pk_bf16_f32 v198, v156, v157
 v_exp_f32 v160, v160
 v_mfma_f32_32x32x16_bf16 v[64:79], v[224:227], v[176:179], v[64:79]
 buffer_load_dwordx4 a[156:159], v14, s[36:39], s65 offen offset:1024 sc1
 s_add_u32 s65, s65, 18432
 v_exp_f32 v161, v161
 v_cvt_pk_bf16_f32 v199, v158, v159
 v_exp_f32 v162, v162
 v_exp_f32 v163, v163
 v_mfma_f32_32x32x16_bf16 v[80:95], v[224:227], v[184:187], v[80:95]
 v_cvt_pk_bf16_f32 v200, v160, v161
 v_exp_f32 v164, v164
 v_exp_f32 v165, v165
 v_mfma_f32_32x32x16_bf16 a[32:47], a[172:175], a[160:163], a[32:47]
 buffer_load_dwordx4 v13, s[36:39], s56 offen offset:2048 sc1 lds
 v_cvt_pk_bf16_f32 v201, v162, v163
 v_exp_f32 v166, v166
 v_exp_f32 v167, v167
 v_cvt_pk_bf16_f32 v202, v164, v165
 v_exp_f32 v168, v168
 v_mfma_f32_32x32x16_bf16 v[64:79], v[228:231], v[180:183], v[64:79]
 v_exp_f32 v169, v169
 v_cvt_pk_bf16_f32 v203, v166, v167
 v_exp_f32 v170, v170
 v_mfma_f32_32x32x16_bf16 v[80:95], v[228:231], v[188:191], v[80:95]
 buffer_load_dwordx4 v13, s[36:39], s56 offen offset:3072 sc1 lds
 s_add_u32 m0, m0, 4096
 s_add_u32 s56, s56, 4096
 v_exp_f32 v171, v171
 v_cvt_pk_bf16_f32 v204, v168, v169
 v_exp_f32 v172, v172
 v_exp_f32 v173, v173
 v_mfma_f32_32x32x16_bf16 a[48:63], a[172:175], a[164:167], a[48:63]
 v_cvt_pk_bf16_f32 v205, v170, v171
 v_exp_f32 v174, v174
 v_exp_f32 v175, v175
 v_cvt_pk_bf16_f32 v206, v172, v173
 v_add_u32 v12, s57, v21
 s_waitcnt lgkmcnt(0)
 v_cvt_pk_bf16_f32 v207, v174, v175
 s_mov_b32 s66, 3
L_m_d:
 v_mfma_f32_32x32x16_bf16 v[144:159], v[216:219], v[96:99], v[32:47]
 ds_read_b128 v[208:211], v10 offset:2048
 ds_read_b32 v212, v11 offset:256
 buffer_load_dwordx4 v13, s[36:39], s56 offen sc1 lds
 v_exp_f32 v112, v112
 v_exp_f32 v113, v113
 v_exp_f32 v114, v114
 v_exp_f32 v115, v115
 v_mfma_f32_32x32x16_bf16 v[160:175], v[216:219], v[104:107], v[48:63]
 ds_read_b128 v[224:227], v12
 ds_read_b128 v[228:231], v12 offset:640
 v_cvt_pk_bf16_f32 v176, v112, v113
 v_exp_f32 v116, v116
 v_exp_f32 v117, v117
 v_cvt_pk_bf16_f32 v177, v114, v115
 s_waitcnt vmcnt(29)
 v_mfma_f32_32x32x16_bf16 a[0:15], a[184:187], a[176:179], a[0:15]
 s_add_u32 s56, s56, 16384
 s_add_u32 s35, s35, 20480
 s_cmp_eq_u32 s35, 61440
 s_cselect_b32 s35, 0, s35
 s_sub_u32 s66, s66, 1
 buffer_load_dwordx4 a[160:163], v14, s[36:39], s63 offen sc1
 v_exp_f32 v118, v118
 v_exp_f32 v119, v119
 v_cvt_pk_bf16_f32 v178, v116, v117
 v_exp_f32 v120, v120
 v_mfma_f32_32x32x16_bf16 v[144:159], v[220:223], v[100:103], v[144:159]
 v_exp_f32 v121, v121
 v_cvt_pk_bf16_f32 v179, v118, v119
 v_exp_f32 v122, v122
 v_exp_f32 v123, v123
 v_mfma_f32_32x32x16_bf16 v[160:175], v[220:223], v[108:111], v[160:175]
 buffer_load_dwordx4 a[164:167], v14, s[36:39], s64 offen sc1
 v_cvt_pk_bf16_f32 v180, v120, v121
 v_exp_f32 v124, v124
 v_exp_f32 v125, v125
 v_mfma_f32_32x32x16_bf16 a[16:31], a[184:187], a[180:183], a[16:31]
 v_cvt_pk_bf16_f32 v181, v122, v123
 v_exp_f32 v126, v126
 v_exp_f32 v127, v127
 v_cvt_pk_bf16_f32 v182, v124, v125
 v_exp_f32 v128, v128
 v_mfma_f32_32x32x16_bf16 v[64:79], v[232:235], v[192:195], v[64:79]
 buffer_load_dwordx4 a[168:171], v14, s[36:39], s65 offen sc1
 v_exp_f32 v129, v129
 v_cvt_pk_bf16_f32 v183, v126, v127
 v_exp_f32 v130, v130
 v_exp_f32 v131, v131
 v_mfma_f32_32x32x16_bf16 v[80:95], v[232:235], v[200:203], v[80:95]
 v_cvt_pk_bf16_f32 v184, v128, v129
 v_exp_f32 v132, v132
 v_exp_f32 v133, v133
 v_mfma_f32_32x32x16_bf16 a[32:47], a[188:191], a[176:179], a[32:47]
 buffer_load_dwordx4 a[172:175], v14, s[36:39], s65 offen offset:1024 sc1
 s_add_u32 s65, s65, 18432
 v_cvt_pk_bf16_f32 v185, v130, v131
 v_exp_f32 v134, v134
 v_exp_f32 v135, v135
 v_cvt_pk_bf16_f32 v186, v132, v133
 v_exp_f32 v136, v136
 v_mfma_f32_32x32x16_bf16 v[64:79], v[236:239], v[196:199], v[64:79]
 v_exp_f32 v137, v137
 v_cvt_pk_bf16_f32 v187, v134, v135
 v_exp_f32 v138, v138
 v_mfma_f32_32x32x16_bf16 v[80:95], v[236:239], v[204:207], v[80:95]
 v_exp_f32 v139, v139
 v_cvt_pk_bf16_f32 v188, v136, v137
 v_exp_f32 v140, v140
 v_exp_f32 v141, v141
 v_mfma_f32_32x32x16_bf16 a[48:63], a[188:191], a[180:183], a[48:63]
 buffer_load_dwordx4 a[176:179], v14, s[36:39], s63 offen offset:1024 sc1
 v_cvt_pk_bf16_f32 v189, v138, v139
 v_exp_f32 v142, v142
 v_exp_f32 v143, v143
 v_cvt_pk_bf16_f32 v190, v140, v141
 s_waitcnt lgkmcnt(0)
 v_cvt_pk_bf16_f32 v191, v142, v143
 v_mfma_f32_32x32x16_bf16 v[112:127], v[208:211], v[96:99], v[32:47]
 ds_read_b128 v[216:219], v10 offset:3072
 ds_read_b32 v220, v11 offset:384
 v_exp_f32 v144, v144
 v_exp_f32 v145, v145
 v_exp_f32 v146, v146
 v_exp_f32 v147, v147
 v_mfma_f32_32x32x16_bf16 v[128:143], v[208:211], v[104:107], v[48:63]
 ds_read_b128 v[232:235], v12 offset:1280
 ds_read_b128 v[236:239], v12 offset:1920
 buffer_load_dwordx4 a[180:183], v14, s[36:39], s64 offen offset:1024 sc1
 v_cvt_pk_bf16_f32 v192, v144, v145
 v_exp_f32 v148, v148
 v_exp_f32 v149, v149
 v_cvt_pk_bf16_f32 v193, v146, v147
 s_waitcnt vmcnt(31)
 v_mfma_f32_32x32x16_bf16 a[0:15], a[200:203], a[192:195], a[0:15]
 v_exp_f32 v150, v150
 v_exp_f32 v151, v151
 v_cvt_pk_bf16_f32 v194, v148, v149
 v_exp_f32 v152, v152
 v_mfma_f32_32x32x16_bf16 v[112:127], v[212:215], v[100:103], v[112:127]
 buffer_load_dwordx4 a[184:187], v14, s[36:39], s65 offen sc1
 v_exp_f32 v153, v153
 v_cvt_pk_bf16_f32 v195, v150, v151
 v_exp_f32 v154, v154
 v_exp_f32 v155, v155
 v_mfma_f32_32x32x16_bf16 v[128:143], v[212:215], v[108:111], v[128:143]
 v_cvt_pk_bf16_f32 v196, v152, v153
 v_exp_f32 v156, v156
 v_exp_f32 v157, v157
 v_mfma_f32_32x32x16_bf16 a[16:31], a[200:203], a[196:199], a[16:31]
 buffer_load_dwordx4 a[188:191], v14, s[36:39], s65 offen offset:1024 sc1
 s_add_u32 s65, s65, 18432
 v_cvt_pk_bf16_f32 v197, v154, v155
 v_exp_f32 v158, v158
 v_exp_f32 v159, v159
 v_cvt_pk_bf16_f32 v198, v156, v157
 v_exp_f32 v160, v160
 v_mfma_f32_32x32x16_bf16 v[64:79], v[224:227], v[176:179], v[64:79]
 v_exp_f32 v161, v161
 v_cvt_pk_bf16_f32 v199, v158, v159
 v_exp_f32 v162, v162
 v_exp_f32 v163, v163
 v_mfma_f32_32x32x16_bf16 v[80:95], v[224:227], v[184:187], v[80:95]
 v_cvt_pk_bf16_f32 v200, v160, v161
 v_exp_f32 v164, v164
 v_exp_f32 v165, v165
 v_mfma_f32_32x32x16_bf16 a[32:47], a[204:207], a[192:195], a[32:47]
 v_cvt_pk_bf16_f32 v201, v162, v163
 v_exp_f32 v166, v166
 v_exp_f32 v167, v167
 v_cvt_pk_bf16_f32 v202, v164, v165
 v_exp_f32 v168, v168
 v_mfma_f32_32x32x16_bf16 v[64:79], v[228:231], v[180:183], v[64:79]
 v_exp_f32 v169, v169
 v_cvt_pk_bf16_f32 v203, v166, v167
 v_exp_f32 v170, v170
 v_mfma_f32_32x32x16_bf16 v[80:95], v[228:231], v[188:191], v[80:95]
 v_exp_f32 v171, v171
 v_cvt_pk_bf16_f32 v204, v168, v169
 v_exp_f32 v172, v172
 v_exp_f32 v173, v173
 v_mfma_f32_32x32x16_bf16 a[48:63], a[204:207], a[196:199], a[48:63]
 buffer_load_dwordx4 a[192:195], v14, s[36:39], s63 offen offset:2048 sc1
 v_cvt_pk_bf16_f32 v205, v170, v171
 v_exp_f32 v174, v174
 v_exp_f32 v175, v175
 v_cvt_pk_bf16_f32 v206, v172, v173
 s_waitcnt lgkmcnt(0)
 v_cvt_pk_bf16_f32 v207, v174, v175
 v_mfma_f32_32x32x16_bf16 v[144:159], v[216:219], v[96:99], v[32:47]
 ds_read_b128 v[208:211], v10 offset:4096
 ds_read_b32 v212, v11 offset:512
 v_exp_f32 v112, v112
 v_exp_f32 v113, v113
 v_exp_f32 v114, v114
 v_exp_f32 v115, v115
 v_mfma_f32_32x32x16_bf16 v[160:175], v[216:219], v[104:107], v[48:63]
 ds_read_b128 v[224:227], v12 offset:2560
 ds_read_b128 v[228:231], v12 offset:3200
 buffer_load_dwordx4 a[196:199], v14, s[36:39], s64 offen offset:2048 sc1
 v_cvt_pk_bf16_f32 v176, v112, v113
 v_exp_f32 v116, v116
 v_exp_f32 v117, v117
 v_cvt_pk_bf16_f32 v177, v114, v115
 s_waitcnt vmcnt(31)
 v_mfma_f32_32x32x16_bf16 a[0:15], a[216:219], a[208:211], a[0:15]
 v_exp_f32 v118, v118
 v_exp_f32 v119, v119
 v_cvt_pk_bf16_f32 v178, v116, v117
 v_exp_f32 v120, v120
 v_mfma_f32_32x32x16_bf16 v[144:159], v[220:223], v[100:103], v[144:159]
 buffer_load_dwordx4 a[200:203], v14, s[36:39], s65 offen sc1
 v_exp_f32 v121, v121
 v_cvt_pk_bf16_f32 v179, v118, v119
 v_exp_f32 v122, v122
 v_exp_f32 v123, v123
 v_mfma_f32_32x32x16_bf16 v[160:175], v[220:223], v[108:111], v[160:175]
 v_cvt_pk_bf16_f32 v180, v120, v121
 v_exp_f32 v124, v124
 v_exp_f32 v125, v125
 v_mfma_f32_32x32x16_bf16 a[16:31], a[216:219], a[212:215], a[16:31]
 buffer_load_dwordx4 a[204:207], v14, s[36:39], s65 offen offset:1024 sc1
 s_add_u32 s65, s65, 18432
 v_cvt_pk_bf16_f32 v181, v122, v123
 v_exp_f32 v126, v126
 v_exp_f32 v127, v127
 v_cvt_pk_bf16_f32 v182, v124, v125
 v_exp_f32 v128, v128
 v_mfma_f32_32x32x16_bf16 v[64:79], v[232:235], v[192:195], v[64:79]
 v_exp_f32 v129, v129
 v_cvt_pk_bf16_f32 v183, v126, v127
 v_exp_f32 v130, v130
 v_exp_f32 v131, v131
 v_mfma_f32_32x32x16_bf16 v[80:95], v[232:235], v[200:203], v[80:95]
 v_cvt_pk_bf16_f32 v184, v128, v129
 v_exp_f32 v132, v132
 v_exp_f32 v133, v133
 v_mfma_f32_32x32x16_bf16 a[32:47], a[220:223], a[208:211], a[32:47]
 v_cvt_pk_bf16_f32 v185, v130, v131
 v_exp_f32 v134, v134
 v_exp_f32 v135, v135
 v_cvt_pk_bf16_f32 v186, v132, v133
 v_exp_f32 v136, v136
 v_mfma_f32_32x32x16_bf16 v[64:79], v[236:239], v[196:199], v[64:79]
 v_exp_f32 v137, v137
 v_cvt_pk_bf16_f32 v187, v134, v135
 v_exp_f32 v138, v138
 v_mfma_f32_32x32x16_bf16 v[80:95], v[236:239], v[204:207], v[80:95]
 v_exp_f32 v139, v139
 v_cvt_pk_bf16_f32 v188, v136, v137
 v_exp_f32 v140, v140
 v_exp_f32 v141, v141
 v_mfma_f32_32x32x16_bf16 a[48:63], a[220:223], a[212:215], a[48:63]
 buffer_load_dwordx4 a[208:211], v14, s[36:39], s63 offen offset:3072 sc1
 s_add_u32 s63, s63, 4096
 v_cvt_pk_bf16_f32 v189, v138, v139
 v_exp_f32 v142, v142
 v_exp_f32 v143, v143
 v_cvt_pk_bf16_f32 v190, v140, v141
 s_waitcnt lgkmcnt(0)
 v_cvt_pk_bf16_f32 v191, v142, v143
 v_mfma_f32_32x32x16_bf16 v[112:127], v[208:211], v[96:99], v[32:47]
 ds_read_b128 v[216:219], v10 offset:5120
 ds_read_b32 v220, v11 offset:640
 v_exp_f32 v144, v144
 v_exp_f32 v145, v145
 v_exp_f32 v146, v146
 v_exp_f32 v147, v147
 v_mfma_f32_32x32x16_bf16 v[128:143], v[208:211], v[104:107], v[48:63]
 ds_read_b128 v[232:235], v12 offset:3840
 ds_read_b128 v[236:239], v12 offset:4480
 buffer_load_dwordx4 a[212:215], v14, s[36:39], s64 offen offset:3072 sc1
 s_add_u32 s64, s64, 4096
 v_cvt_pk_bf16_f32 v192, v144, v145
 v_exp_f32 v148, v148
 v_exp_f32 v149, v149
 v_cvt_pk_bf16_f32 v193, v146, v147
 s_waitcnt vmcnt(31)
 v_mfma_f32_32x32x16_bf16 a[0:15], a[104:107], a[96:99], a[0:15]
 v_exp_f32 v150, v150
 v_exp_f32 v151, v151
 v_cvt_pk_bf16_f32 v194, v148, v149
 v_exp_f32 v152, v152
 v_mfma_f32_32x32x16_bf16 v[112:127], v[212:215], v[100:103], v[112:127]
 buffer_load_dwordx4 a[216:219], v14, s[36:39], s65 offen sc1
 v_exp_f32 v153, v153
 v_cvt_pk_bf16_f32 v195, v150, v151
 v_exp_f32 v154, v154
 v_exp_f32 v155, v155
 v_mfma_f32_32x32x16_bf16 v[128:143], v[212:215], v[108:111], v[128:143]
 v_cvt_pk_bf16_f32 v196, v152, v153
 v_exp_f32 v156, v156
 v_exp_f32 v157, v157
 v_mfma_f32_32x32x16_bf16 a[16:31], a[104:107], a[100:103], a[16:31]
 buffer_load_dwordx4 a[220:223], v14, s[36:39], s65 offen offset:1024 sc1
 s_add_u32 s65, s65, 18432
 v_cvt_pk_bf16_f32 v197, v154, v155
 v_exp_f32 v158, v158
 v_exp_f32 v159, v159
 v_cvt_pk_bf16_f32 v198, v156, v157
 v_exp_f32 v160, v160
 v_mfma_f32_32x32x16_bf16 v[64:79], v[224:227], v[176:179], v[64:79]
 v_exp_f32 v161, v161
 v_cvt_pk_bf16_f32 v199, v158, v159
 v_exp_f32 v162, v162
 v_exp_f32 v163, v163
 v_mfma_f32_32x32x16_bf16 v[80:95], v[224:227], v[184:187], v[80:95]
 v_cvt_pk_bf16_f32 v200, v160, v161
 v_exp_f32 v164, v164
 v_exp_f32 v165, v165
 v_mfma_f32_32x32x16_bf16 a[32:47], a[108:111], a[96:99], a[32:47]
 v_cvt_pk_bf16_f32 v201, v162, v163
 v_exp_f32 v166, v166
 v_exp_f32 v167, v167
 v_cvt_pk_bf16_f32 v202, v164, v165
 v_exp_f32 v168, v168
 v_mfma_f32_32x32x16_bf16 v[64:79], v[228:231], v[180:183], v[64:79]
 v_exp_f32 v169, v169
 v_cvt_pk_bf16_f32 v203, v166, v167
 v_exp_f32 v170, v170
 v_mfma_f32_32x32x16_bf16 v[80:95], v[228:231], v[188:191], v[80:95]
 v_exp_f32 v171, v171
 v_cvt_pk_bf16_f32 v204, v168, v169
 v_exp_f32 v172, v172
 v_exp_f32 v173, v173
 v_mfma_f32_32x32x16_bf16 a[48:63], a[108:111], a[100:103], a[48:63]
 buffer_load_dwordx4 a[96:99], v14, s[36:39], s63 offen sc1
 v_cvt_pk_bf16_f32 v205, v170, v171
 v_exp_f32 v174, v174
 v_exp_f32 v175, v175
 v_cvt_pk_bf16_f32 v206, v172, v173
 s_waitcnt lgkmcnt(0)
 v_cvt_pk_bf16_f32 v207, v174, v175
 v_mfma_f32_32x32x16_bf16 v[144:159], v[216:219], v[96:99], v[32:47]
 ds_read_b128 v[208:211], v10 offset:6144
 ds_read_b32 v212, v11 offset:768
 v_exp_f32 v112, v112
 v_exp_f32 v113, v113
 v_exp_f32 v114, v114
 v_exp_f32 v115, v115
 v_mfma_f32_32x32x16_bf16 v[160:175], v[216:219], v[104:107], v[48:63]
 ds_read_b128 v[224:227], v12 offset:5120
 ds_read_b128 v[228:231], v12 offset:5760
 buffer_load_dwordx4 a[100:103], v14, s[36:39], s64 offen sc1
 v_cvt_pk_bf16_f32 v176, v112, v113
 v_exp_f32 v116, v116
 v_exp_f32 v117, v117
 v_cvt_pk_bf16_f32 v177, v114, v115
 s_waitcnt vmcnt(31)
 v_mfma_f32_32x32x16_bf16 a[0:15], a[120:123], a[112:115], a[0:15]
 v_exp_f32 v118, v118
 v_exp_f32 v119, v119
 v_cvt_pk_bf16_f32 v178, v116, v117
 v_exp_f32 v120, v120
 v_mfma_f32_32x32x16_bf16 v[144:159], v[220:223], v[100:103], v[144:159]
 buffer_load_dwordx4 a[104:107], v14, s[36:39], s65 offen sc1
 v_exp_f32 v121, v121
 v_cvt_pk_bf16_f32 v179, v118, v119
 v_exp_f32 v122, v122
 v_exp_f32 v123, v123
 v_mfma_f32_32x32x16_bf16 v[160:175], v[220:223], v[108:111], v[160:175]
 v_cvt_pk_bf16_f32 v180, v120, v121
 v_exp_f32 v124, v124
 v_exp_f32 v125, v125
 v_mfma_f32_32x32x16_bf16 a[16:31], a[120:123], a[116:119], a[16:31]
 buffer_load_dwordx4 a[108:111], v14, s[36:39], s65 offen offset:1024 sc1
 s_add_u32 s65, s65, 18432
 v_cvt_pk_bf16_f32 v181, v122, v123
 v_exp_f32 v126, v126
 v_exp_f32 v127, v127
 v_cvt_pk_bf16_f32 v182, v124, v125
 v_exp_f32 v128, v128
 v_mfma_f32_32x32x16_bf16 v[64:79], v[232:235], v[192:195], v[64:79]
 v_exp_f32 v129, v129
 v_cvt_pk_bf16_f32 v183, v126, v127
 v_exp_f32 v130, v130
 v_exp_f32 v131, v131
 v_mfma_f32_32x32x16_bf16 v[80:95], v[232:235], v[200:203], v[80:95]
 v_cvt_pk_bf16_f32 v184, v128, v129
 v_exp_f32 v132, v132
 v_exp_f32 v133, v133
 v_mfma_f32_32x32x16_bf16 a[32:47], a[124:127], a[112:115], a[32:47]
 v_cvt_pk_bf16_f32 v185, v130, v131
 v_exp_f32 v134, v134
 v_exp_f32 v135, v135
 v_cvt_pk_bf16_f32 v186, v132, v133
 v_exp_f32 v136, v136
 v_mfma_f32_32x32x16_bf16 v[64:79], v[236:239], v[196:199], v[64:79]
 v_exp_f32 v137, v137
 v_cvt_pk_bf16_f32 v187, v134, v135
 v_exp_f32 v138, v138
 v_mfma_f32_32x32x16_bf16 v[80:95], v[236:239], v[204:207], v[80:95]
 v_exp_f32 v139, v139
 v_cvt_pk_bf16_f32 v188, v136, v137
 v_exp_f32 v140, v140
 v_exp_f32 v141, v141
 v_mfma_f32_32x32x16_bf16 a[48:63], a[124:127], a[116:119], a[48:63]
 buffer_load_dwordx4 a[112:115], v14, s[36:39], s63 offen offset:1024 sc1
 v_cvt_pk_bf16_f32 v189, v138, v139
 v_exp_f32 v142, v142
 v_exp_f32 v143, v143
 v_cvt_pk_bf16_f32 v190, v140, v141
 s_waitcnt lgkmcnt(0)
 v_cvt_pk_bf16_f32 v191, v142, v143
 v_mfma_f32_32x32x16_bf16 v[112:127], v[208:211], v[96:99], v[32:47]
 ds_read_b128 v[216:219], v10 offset:7168
 ds_read_b32 v220, v11 offset:896
 v_exp_f32 v144, v144
 v_exp_f32 v145, v145
 v_exp_f32 v146, v146
 v_exp_f32 v147, v147
 v_mfma_f32_32x32x16_bf16 v[128:143], v[208:211], v[104:107], v[48:63]
 ds_read_b128 v[232:235], v12 offset:6400
 ds_read_b128 v[236:239], v12 offset:7040
 s_add_u32 s57, s57, 20480
 s_cmp_eq_u32 s57, 61440
 s_cselect_b32 s57, 0, s57
 buffer_load_dwordx4 a[116:119], v14, s[36:39], s64 offen offset:1024 sc1
 v_cvt_pk_bf16_f32 v192, v144, v145
 v_exp_f32 v148, v148
 v_exp_f32 v149, v149
 v_cvt_pk_bf16_f32 v193, v146, v147
 s_waitcnt vmcnt(31)
 v_mfma_f32_32x32x16_bf16 a[0:15], a[136:139], a[128:131], a[0:15]
 v_exp_f32 v150, v150
 v_exp_f32 v151, v151
 v_cvt_pk_bf16_f32 v194, v148, v149
 v_exp_f32 v152, v152
 v_mfma_f32_32x32x16_bf16 v[112:127], v[212:215], v[100:103], v[112:127]
 buffer_load_dwordx4 a[120:123], v14, s[36:39], s65 offen sc1
 v_exp_f32 v153, v153
 v_cvt_pk_bf16_f32 v195, v150, v151
 v_exp_f32 v154, v154
 v_exp_f32 v155, v155
 v_mfma_f32_32x32x16_bf16 v[128:143], v[212:215], v[108:111], v[128:143]
 v_cvt_pk_bf16_f32 v196, v152, v153
 v_exp_f32 v156, v156
 v_exp_f32 v157, v157
 v_mfma_f32_32x32x16_bf16 a[16:31], a[136:139], a[132:135], a[16:31]
 buffer_load_dwordx4 a[124:127], v14, s[36:39], s65 offen offset:1024 sc1
 s_add_u32 s65, s65, 18432
 v_cvt_pk_bf16_f32 v197, v154, v155
 v_exp_f32 v158, v158
 v_exp_f32 v159, v159
 v_cvt_pk_bf16_f32 v198, v156, v157
 v_exp_f32 v160, v160
 v_mfma_f32_32x32x16_bf16 v[64:79], v[224:227], v[176:179], v[64:79]
 v_exp_f32 v161, v161
 v_cvt_pk_bf16_f32 v199, v158, v159
 v_exp_f32 v162, v162
 v_exp_f32 v163, v163
 v_mfma_f32_32x32x16_bf16 v[80:95], v[224:227], v[184:187], v[80:95]
 v_cvt_pk_bf16_f32 v200, v160, v161
 v_exp_f32 v164, v164
 v_exp_f32 v165, v165
 v_mfma_f32_32x32x16_bf16 a[32:47], a[140:143], a[128:131], a[32:47]
 v_cvt_pk_bf16_f32 v201, v162, v163
 v_exp_f32 v166, v166
 v_exp_f32 v167, v167
 v_cvt_pk_bf16_f32 v202, v164, v165
 v_exp_f32 v168, v168
 v_mfma_f32_32x32x16_bf16 v[64:79], v[228:231], v[180:183], v[64:79]
 v_exp_f32 v169, v169
 v_cvt_pk_bf16_f32 v203, v166, v167
 v_exp_f32 v170, v170
 v_mfma_f32_32x32x16_bf16 v[80:95], v[228:231], v[188:191], v[80:95]
 v_exp_f32 v171, v171
 v_cvt_pk_bf16_f32 v204, v168, v169
 v_exp_f32 v172, v172
 v_exp_f32 v173, v173
 v_mfma_f32_32x32x16_bf16 a[48:63], a[140:143], a[132:135], a[48:63]
 buffer_load_dwordx4 a[128:131], v14, s[36:39], s63 offen offset:2048 sc1
 v_cvt_pk_bf16_f32 v205, v170, v171
 v_exp_f32 v174, v174
 v_exp_f32 v175, v175
 v_cvt_pk_bf16_f32 v206, v172, v173
 v_add_u32 v10, s57, v14
 v_add_u32 v11, s57, v20
 v_add_u32 v253, s57, v252
 s_waitcnt lgkmcnt(0)
 v_cvt_pk_bf16_f32 v207, v174, v175
 v_mfma_f32_32x32x16_bf16 v[144:159], v[216:219], v[96:99], v[32:47]
 s_waitcnt vmcnt(25)
 ds_write_b128 v253, v[248:251]
 s_waitcnt lgkmcnt(0)
 s_barrier
 ds_read_b128 v[208:211], v10
 ds_read_b32 v212, v11
 v_exp_f32 v112, v112
 v_exp_f32 v113, v113
 v_exp_f32 v114, v114
 v_exp_f32 v115, v115
 v_mfma_f32_32x32x16_bf16 v[160:175], v[216:219], v[104:107], v[48:63]
 ds_read_b128 v[224:227], v12 offset:7680
 ds_read_b128 v[228:231], v12 offset:8320
 buffer_load_dwordx4 a[132:135], v14, s[36:39], s64 offen offset:2048 sc1
 v_cvt_pk_bf16_f32 v176, v112, v113
 v_exp_f32 v116, v116
 v_exp_f32 v117, v117
 v_cvt_pk_bf16_f32 v177, v114, v115
 s_waitcnt vmcnt(29)
 v_mfma_f32_32x32x16_bf16 a[0:15], a[152:155], a[144:147], a[0:15]
 v_exp_f32 v118, v118
 v_exp_f32 v119, v119
 v_cvt_pk_bf16_f32 v178, v116, v117
 v_exp_f32 v120, v120
 v_mfma_f32_32x32x16_bf16 v[144:159], v[220:223], v[100:103], v[144:159]
 buffer_load_dwordx4 a[136:139], v14, s[36:39], s65 offen sc1
 v_exp_f32 v121, v121
 v_cvt_pk_bf16_f32 v179, v118, v119
 v_exp_f32 v122, v122
 v_exp_f32 v123, v123
 v_mfma_f32_32x32x16_bf16 v[160:175], v[220:223], v[108:111], v[160:175]
 v_cvt_pk_bf16_f32 v180, v120, v121
 v_exp_f32 v124, v124
 v_exp_f32 v125, v125
 v_mfma_f32_32x32x16_bf16 a[16:31], a[152:155], a[148:151], a[16:31]
 buffer_load_dwordx4 a[140:143], v14, s[36:39], s65 offen offset:1024 sc1
 s_add_u32 s65, s65, 18432
 v_cvt_pk_bf16_f32 v181, v122, v123
 v_exp_f32 v126, v126
 v_exp_f32 v127, v127
 v_cvt_pk_bf16_f32 v182, v124, v125
 v_exp_f32 v128, v128
 v_mfma_f32_32x32x16_bf16 v[64:79], v[232:235], v[192:195], v[64:79]
 v_exp_f32 v129, v129
 v_cvt_pk_bf16_f32 v183, v126, v127
 v_exp_f32 v130, v130
 v_exp_f32 v131, v131
 v_mfma_f32_32x32x16_bf16 v[80:95], v[232:235], v[200:203], v[80:95]
 s_add_u32 m0, s35, s58
 v_cvt_pk_bf16_f32 v184, v128, v129
 v_exp_f32 v132, v132
 v_exp_f32 v133, v133
 v_mfma_f32_32x32x16_bf16 a[32:47], a[156:159], a[144:147], a[32:47]
 buffer_load_dwordx4 v13, s[36:39], s56 offen sc1 lds
 v_cvt_pk_bf16_f32 v185, v130, v131
 v_exp_f32 v134, v134
 v_exp_f32 v135, v135
 v_cvt_pk_bf16_f32 v186, v132, v133
 v_exp_f32 v136, v136
 v_mfma_f32_32x32x16_bf16 v[64:79], v[236:239], v[196:199], v[64:79]
 v_exp_f32 v137, v137
 v_cvt_pk_bf16_f32 v187, v134, v135
 v_exp_f32 v138, v138
 v_mfma_f32_32x32x16_bf16 v[80:95], v[236:239], v[204:207], v[80:95]
 buffer_load_dwordx4 v13, s[36:39], s56 offen offset:1024 sc1 lds
 v_exp_f32 v139, v139
 v_cvt_pk_bf16_f32 v188, v136, v137
 v_exp_f32 v140, v140
 v_exp_f32 v141, v141
 v_mfma_f32_32x32x16_bf16 a[48:63], a[156:159], a[148:151], a[48:63]
 v_cvt_pk_bf16_f32 v189, v138, v139
 v_exp_f32 v142, v142
 v_exp_f32 v143, v143
 v_cvt_pk_bf16_f32 v190, v140, v141
 s_waitcnt lgkmcnt(0)
 v_cvt_pk_bf16_f32 v191, v142, v143
 v_mfma_f32_32x32x16_bf16 v[112:127], v[208:211], v[96:99], v[32:47]
 ds_read_b128 v[216:219], v10 offset:1024
 ds_read_b32 v220, v11 offset:128
 buffer_load_dwordx4 a[144:147], v14, s[36:39], s63 offen offset:3072 sc1
 s_add_u32 s63, s63, 4096
 v_exp_f32 v144, v144
 v_exp_f32 v145, v145
 v_exp_f32 v146, v146
 v_exp_f32 v147, v147
 v_mfma_f32_32x32x16_bf16 v[128:143], v[208:211], v[104:107], v[48:63]
 ds_read_b128 v[232:235], v12 offset:8960
 ds_read_b128 v[236:239], v12 offset:9600
 v_cvt_pk_bf16_f32 v192, v144, v145
 v_exp_f32 v148, v148
 v_exp_f32 v149, v149
 v_cvt_pk_bf16_f32 v193, v146, v147
 s_waitcnt vmcnt(27)
 v_mfma_f32_32x32x16_bf16 a[0:15], a[168:171], a[160:163], a[0:15]
 buffer_load_dwordx4 a[148:151], v14, s[36:39], s64 offen offset:3072 sc1
 s_add_u32 s64, s64, 4096
 v_exp_f32 v150, v150
 v_exp_f32 v151, v151
 v_cvt_pk_bf16_f32 v194, v148, v149
 v_exp_f32 v152, v152
 v_mfma_f32_32x32x16_bf16 v[112:127], v[212:215], v[100:103], v[112:127]
 v_exp_f32 v153, v153
 v_cvt_pk_bf16_f32 v195, v150, v151
 v_exp_f32 v154, v154
 v_exp_f32 v155, v155
 v_mfma_f32_32x32x16_bf16 v[128:143], v[212:215], v[108:111], v[128:143]
 buffer_load_dwordx4 a[152:155], v14, s[36:39], s65 offen sc1
 v_cvt_pk_bf16_f32 v196, v152, v153
 v_exp_f32 v156, v156
 v_exp_f32 v157, v157
 v_mfma_f32_32x32x16_bf16 a[16:31], a[168:171], a[164:167], a[16:31]
 v_cvt_pk_bf16_f32 v197, v154, v155
 v_exp_f32 v158, v158
 v_exp_f32 v159, v159
 v_cvt_pk_bf16_f32 v198, v156, v157
 v_exp_f32 v160, v160
 v_mfma_f32_32x32x16_bf16 v[64:79], v[224:227], v[176:179], v[64:79]
 buffer_load_dwordx4 a[156:159], v14, s[36:39], s65 offen offset:1024 sc1
 s_add_u32 s65, s65, 18432
 v_exp_f32 v161, v161
 v_cvt_pk_bf16_f32 v199, v158, v159
 v_exp_f32 v162, v162
 v_exp_f32 v163, v163
 v_mfma_f32_32x32x16_bf16 v[80:95], v[224:227], v[184:187], v[80:95]
 v_cvt_pk_bf16_f32 v200, v160, v161
 v_exp_f32 v164, v164
 v_exp_f32 v165, v165
 v_mfma_f32_32x32x16_bf16 a[32:47], a[172:175], a[160:163], a[32:47]
 buffer_load_dwordx4 v13, s[36:39], s56 offen offset:2048 sc1 lds
 v_cvt_pk_bf16_f32 v201, v162, v163
 v_exp_f32 v166, v166
 v_exp_f32 v167, v167
 v_cvt_pk_bf16_f32 v202, v164, v165
 v_exp_f32 v168, v168
 v_mfma_f32_32x32x16_bf16 v[64:79], v[228:231], v[180:183], v[64:79]
 v_exp_f32 v169, v169
 v_cvt_pk_bf16_f32 v203, v166, v167
 v_exp_f32 v170, v170
 v_mfma_f32_32x32x16_bf16 v[80:95], v[228:231], v[188:191], v[80:95]
 buffer_load_dwordx4 v13, s[36:39], s56 offen offset:3072 sc1 lds
 s_add_u32 m0, m0, 4096
 s_add_u32 s56, s56, 4096
 v_exp_f32 v171, v171
 v_cvt_pk_bf16_f32 v204, v168, v169
 v_exp_f32 v172, v172
 v_exp_f32 v173, v173
 v_mfma_f32_32x32x16_bf16 a[48:63], a[172:175], a[164:167], a[48:63]
 v_cvt_pk_bf16_f32 v205, v170, v171
 v_exp_f32 v174, v174
 v_exp_f32 v175, v175
 v_cvt_pk_bf16_f32 v206, v172, v173
 v_add_u32 v12, s57, v21
 s_waitcnt lgkmcnt(0)
 v_cvt_pk_bf16_f32 v207, v174, v175
 s_cmp_lg_u32 s66, 0
 s_cbranch_scc1 L_m_d
 v_mfma_f32_32x32x16_bf16 v[144:159], v[216:219], v[96:99], v[32:47]
 ds_read_b128 v[208:211], v10 offset:2048
 ds_read_b32 v212, v11 offset:256
 buffer_load_dwordx4 v13, s[36:39], s56 offen sc1 lds
 v_exp_f32 v112, v112
 v_exp_f32 v113, v113
 v_exp_f32 v114, v114
 v_exp_f32 v115, v115
 v_mfma_f32_32x32x16_bf16 v[160:175], v[216:219], v[104:107], v[48:63]
 ds_read_b128 v[224:227], v12
 ds_read_b128 v[228:231], v12 offset:640
 v_cvt_pk_bf16_f32 v176, v112, v113
 v_exp_f32 v116, v116
 v_exp_f32 v117, v117
 v_cvt_pk_bf16_f32 v177, v114, v115
 s_waitcnt vmcnt(29)
 v_mfma_f32_32x32x16_bf16 a[0:15], a[184:187], a[176:179], a[0:15]
 s_add_u32 s56, s56, 16384
 s_add_u32 s35, s35, 20480
 s_cmp_eq_u32 s35, 61440
 s_cselect_b32 s35, 0, s35
 s_sub_u32 s66, s66, 1
 buffer_load_dwordx4 a[160:163], v14, s[36:39], s63 offen sc1
 v_exp_f32 v118, v118
 v_exp_f32 v119, v119
 v_cvt_pk_bf16_f32 v178, v116, v117
 v_exp_f32 v120, v120
 v_mfma_f32_32x32x16_bf16 v[144:159], v[220:223], v[100:103], v[144:159]
 v_exp_f32 v121, v121
 v_cvt_pk_bf16_f32 v179, v118, v119
 v_exp_f32 v122, v122
 v_exp_f32 v123, v123
 v_mfma_f32_32x32x16_bf16 v[160:175], v[220:223], v[108:111], v[160:175]
 buffer_load_dwordx4 a[164:167], v14, s[36:39], s64 offen sc1
 v_cvt_pk_bf16_f32 v180, v120, v121
 v_exp_f32 v124, v124
 v_exp_f32 v125, v125
 v_mfma_f32_32x32x16_bf16 a[16:31], a[184:187], a[180:183], a[16:31]
 v_cvt_pk_bf16_f32 v181, v122, v123
 v_exp_f32 v126, v126
 v_exp_f32 v127, v127
 v_cvt_pk_bf16_f32 v182, v124, v125
 v_exp_f32 v128, v128
 v_mfma_f32_32x32x16_bf16 v[64:79], v[232:235], v[192:195], v[64:79]
 buffer_load_dwordx4 a[168:171], v14, s[36:39], s65 offen sc1
 v_exp_f32 v129, v129
 v_cvt_pk_bf16_f32 v183, v126, v127
 v_exp_f32 v130, v130
 v_exp_f32 v131, v131
 v_mfma_f32_32x32x16_bf16 v[80:95], v[232:235], v[200:203], v[80:95]
 v_cvt_pk_bf16_f32 v184, v128, v129
 v_exp_f32 v132, v132
 v_exp_f32 v133, v133
 v_mfma_f32_32x32x16_bf16 a[32:47], a[188:191], a[176:179], a[32:47]
 buffer_load_dwordx4 a[172:175], v14, s[36:39], s65 offen offset:1024 sc1
 s_add_u32 s65, s65, 18432
 v_cvt_pk_bf16_f32 v185, v130, v131
 v_exp_f32 v134, v134
 v_exp_f32 v135, v135
 v_cvt_pk_bf16_f32 v186, v132, v133
 v_exp_f32 v136, v136
 v_mfma_f32_32x32x16_bf16 v[64:79], v[236:239], v[196:199], v[64:79]
 v_exp_f32 v137, v137
 v_cvt_pk_bf16_f32 v187, v134, v135
 v_exp_f32 v138, v138
 v_mfma_f32_32x32x16_bf16 v[80:95], v[236:239], v[204:207], v[80:95]
 v_exp_f32 v139, v139
 v_cvt_pk_bf16_f32 v188, v136, v137
 v_exp_f32 v140, v140
 v_exp_f32 v141, v141
 v_mfma_f32_32x32x16_bf16 a[48:63], a[188:191], a[180:183], a[48:63]
 buffer_load_dwordx4 a[176:179], v14, s[36:39], s63 offen offset:1024 sc1
 v_cvt_pk_bf16_f32 v189, v138, v139
 v_exp_f32 v142, v142
 v_exp_f32 v143, v143
 v_cvt_pk_bf16_f32 v190, v140, v141
 s_waitcnt lgkmcnt(0)
 v_cvt_pk_bf16_f32 v191, v142, v143
 v_mfma_f32_32x32x16_bf16 v[112:127], v[208:211], v[96:99], v[32:47]
 ds_read_b128 v[216:219], v10 offset:3072
 ds_read_b32 v220, v11 offset:384
 v_exp_f32 v144, v144
 v_exp_f32 v145, v145
 v_exp_f32 v146, v146
 v_exp_f32 v147, v147
 v_mfma_f32_32x32x16_bf16 v[128:143], v[208:211], v[104:107], v[48:63]
 ds_read_b128 v[232:235], v12 offset:1280
 ds_read_b128 v[236:239], v12 offset:1920
 buffer_load_dwordx4 a[180:183], v14, s[36:39], s64 offen offset:1024 sc1
 v_cvt_pk_bf16_f32 v192, v144, v145
 v_exp_f32 v148, v148
 v_exp_f32 v149, v149
 v_cvt_pk_bf16_f32 v193, v146, v147
 s_waitcnt vmcnt(31)
 v_mfma_f32_32x32x16_bf16 a[0:15], a[200:203], a[192:195], a[0:15]
 v_exp_f32 v150, v150
 v_exp_f32 v151, v151
 v_cvt_pk_bf16_f32 v194, v148, v149
 v_exp_f32 v152, v152
 v_mfma_f32_32x32x16_bf16 v[112:127], v[212:215], v[100:103], v[112:127]
 buffer_load_dwordx4 a[184:187], v14, s[36:39], s65 offen sc1
 v_exp_f32 v153, v153
 v_cvt_pk_bf16_f32 v195, v150, v151
 v_exp_f32 v154, v154
 v_exp_f32 v155, v155
 v_mfma_f32_32x32x16_bf16 v[128:143], v[212:215], v[108:111], v[128:143]
 v_cvt_pk_bf16_f32 v196, v152, v153
 v_exp_f32 v156, v156
 v_exp_f32 v157, v157
 v_mfma_f32_32x32x16_bf16 a[16:31], a[200:203], a[196:199], a[16:31]
 buffer_load_dwordx4 a[188:191], v14, s[36:39], s65 offen offset:1024 sc1
 s_add_u32 s65, s65, 18432
 v_cvt_pk_bf16_f32 v197, v154, v155
 v_exp_f32 v158, v158
 v_exp_f32 v159, v159
 v_cvt_pk_bf16_f32 v198, v156, v157
 v_exp_f32 v160, v160
 v_mfma_f32_32x32x16_bf16 v[64:79], v[224:227], v[176:179], v[64:79]
 v_exp_f32 v161, v161
 v_cvt_pk_bf16_f32 v199, v158, v159
 v_exp_f32 v162, v162
 v_exp_f32 v163, v163
 v_mfma_f32_32x32x16_bf16 v[80:95], v[224:227], v[184:187], v[80:95]
 v_cvt_pk_bf16_f32 v200, v160, v161
 v_exp_f32 v164, v164
 v_exp_f32 v165, v165
 v_mfma_f32_32x32x16_bf16 a[32:47], a[204:207], a[192:195], a[32:47]
 v_cvt_pk_bf16_f32 v201, v162, v163
 v_exp_f32 v166, v166
 v_exp_f32 v167, v167
 v_cvt_pk_bf16_f32 v202, v164, v165
 v_exp_f32 v168, v168
 v_mfma_f32_32x32x16_bf16 v[64:79], v[228:231], v[180:183], v[64:79]
 v_exp_f32 v169, v169
 v_cvt_pk_bf16_f32 v203, v166, v167
 v_exp_f32 v170, v170
 v_mfma_f32_32x32x16_bf16 v[80:95], v[228:231], v[188:191], v[80:95]
 v_exp_f32 v171, v171
 v_cvt_pk_bf16_f32 v204, v168, v169
 v_exp_f32 v172, v172
 v_exp_f32 v173, v173
 v_mfma_f32_32x32x16_bf16 a[48:63], a[204:207], a[196:199], a[48:63]
 buffer_load_dwordx4 a[192:195], v14, s[36:39], s63 offen offset:2048 sc1
 v_cvt_pk_bf16_f32 v205, v170, v171
 v_exp_f32 v174, v174
 v_exp_f32 v175, v175
 v_cvt_pk_bf16_f32 v206, v172, v173
 s_waitcnt lgkmcnt(0)
 v_cvt_pk_bf16_f32 v207, v174, v175
 v_mfma_f32_32x32x16_bf16 v[144:159], v[216:219], v[96:99], v[32:47]
 ds_read_b128 v[208:211], v10 offset:4096
 ds_read_b32 v212, v11 offset:512
 v_exp_f32 v112, v112
 v_exp_f32 v113, v113
 v_exp_f32 v114, v114
 v_exp_f32 v115, v115
 v_mfma_f32_32x32x16_bf16 v[160:175], v[216:219], v[104:107], v[48:63]
 ds_read_b128 v[224:227], v12 offset:2560
 ds_read_b128 v[228:231], v12 offset:3200
 buffer_load_dwordx4 a[196:199], v14, s[36:39], s64 offen offset:2048 sc1
 v_cvt_pk_bf16_f32 v176, v112, v113
 v_exp_f32 v116, v116
 v_exp_f32 v117, v117
 v_cvt_pk_bf16_f32 v177, v114, v115
 s_waitcnt vmcnt(31)
 v_mfma_f32_32x32x16_bf16 a[0:15], a[216:219], a[208:211], a[0:15]
 v_exp_f32 v118, v118
 v_exp_f32 v119, v119
 v_cvt_pk_bf16_f32 v178, v116, v117
 v_exp_f32 v120, v120
 v_mfma_f32_32x32x16_bf16 v[144:159], v[220:223], v[100:103], v[144:159]
 buffer_load_dwordx4 a[200:203], v14, s[36:39], s65 offen sc1
 v_exp_f32 v121, v121
 v_cvt_pk_bf16_f32 v179, v118, v119
 v_exp_f32 v122, v122
 v_exp_f32 v123, v123
 v_mfma_f32_32x32x16_bf16 v[160:175], v[220:223], v[108:111], v[160:175]
 v_cvt_pk_bf16_f32 v180, v120, v121
 v_exp_f32 v124, v124
 v_exp_f32 v125, v125
 v_mfma_f32_32x32x16_bf16 a[16:31], a[216:219], a[212:215], a[16:31]
 buffer_load_dwordx4 a[204:207], v14, s[36:39], s65 offen offset:1024 sc1
 s_add_u32 s65, s65, 18432
 v_cvt_pk_bf16_f32 v181, v122, v123
 v_exp_f32 v126, v126
 v_exp_f32 v127, v127
 v_cvt_pk_bf16_f32 v182, v124, v125
 v_exp_f32 v128, v128
 v_mfma_f32_32x32x16_bf16 v[64:79], v[232:235], v[192:195], v[64:79]
 v_exp_f32 v129, v129
 v_cvt_pk_bf16_f32 v183, v126, v127
 v_exp_f32 v130, v130
 v_exp_f32 v131, v131
 v_mfma_f32_32x32x16_bf16 v[80:95], v[232:235], v[200:203], v[80:95]
 s_lshl_b32 s52, s30, 2
 s_add_u32 s52, s52, s28
 s_mul_i32 s52, s52, 5248
 s_add_u32 s52, s52, 69730304
 v_lshlrev_b32 v245, 7, v1
 buffer_load_dword v244, v245, s[36:39], s52 offen
 v_cvt_pk_bf16_f32 v184, v128, v129
 v_exp_f32 v132, v132
 v_exp_f32 v133, v133
 v_mfma_f32_32x32x16_bf16 a[32:47], a[220:223], a[208:211], a[32:47]
 v_cvt_pk_bf16_f32 v185, v130, v131
 v_exp_f32 v134, v134
 v_exp_f32 v135, v135
 v_cvt_pk_bf16_f32 v186, v132, v133
 v_exp_f32 v136, v136
 v_mfma_f32_32x32x16_bf16 v[64:79], v[236:239], v[196:199], v[64:79]
 v_exp_f32 v137, v137
 v_cvt_pk_bf16_f32 v187, v134, v135
 v_exp_f32 v138, v138
 v_mfma_f32_32x32x16_bf16 v[80:95], v[236:239], v[204:207], v[80:95]
 v_exp_f32 v139, v139
 v_cvt_pk_bf16_f32 v188, v136, v137
 v_exp_f32 v140, v140
 v_exp_f32 v141, v141
 v_mfma_f32_32x32x16_bf16 a[48:63], a[220:223], a[212:215], a[48:63]
 buffer_load_dwordx4 a[208:211], v14, s[36:39], s63 offen offset:3072 sc1
 s_add_u32 s63, s63, 4096
 v_cvt_pk_bf16_f32 v189, v138, v139
 v_exp_f32 v142, v142
 v_exp_f32 v143, v143
 v_cvt_pk_bf16_f32 v190, v140, v141
 s_waitcnt lgkmcnt(0)
 v_cvt_pk_bf16_f32 v191, v142, v143
 v_mfma_f32_32x32x16_bf16 v[112:127], v[208:211], v[96:99], v[32:47]
 ds_read_b128 v[216:219], v10 offset:5120
 ds_read_b32 v220, v11 offset:640
 v_exp_f32 v144, v144
 v_exp_f32 v145, v145
 v_exp_f32 v146, v146
 v_exp_f32 v147, v147
 v_mfma_f32_32x32x16_bf16 v[128:143], v[208:211], v[104:107], v[48:63]
 ds_read_b128 v[232:235], v12 offset:3840
 ds_read_b128 v[236:239], v12 offset:4480
 buffer_load_dwordx4 a[212:215], v14, s[36:39], s64 offen offset:3072 sc1
 s_add_u32 s64, s64, 4096
 v_cvt_pk_bf16_f32 v192, v144, v145
 v_exp_f32 v148, v148
 v_exp_f32 v149, v149
 v_cvt_pk_bf16_f32 v193, v146, v147
 s_waitcnt vmcnt(32)
 v_mfma_f32_32x32x16_bf16 a[0:15], a[104:107], a[96:99], a[0:15]
 v_exp_f32 v150, v150
 v_exp_f32 v151, v151
 v_cvt_pk_bf16_f32 v194, v148, v149
 v_exp_f32 v152, v152
 v_mfma_f32_32x32x16_bf16 v[112:127], v[212:215], v[100:103], v[112:127]
 buffer_load_dwordx4 a[216:219], v14, s[36:39], s65 offen sc1
 v_exp_f32 v153, v153
 v_cvt_pk_bf16_f32 v195, v150, v151
 v_exp_f32 v154, v154
 v_exp_f32 v155, v155
 v_mfma_f32_32x32x16_bf16 v[128:143], v[212:215], v[108:111], v[128:143]
 v_cvt_pk_bf16_f32 v196, v152, v153
 v_exp_f32 v156, v156
 v_exp_f32 v157, v157
 v_mfma_f32_32x32x16_bf16 a[16:31], a[104:107], a[100:103], a[16:31]
 buffer_load_dwordx4 a[220:223], v14, s[36:39], s65 offen offset:1024 sc1
 s_add_u32 s65, s65, 18432
 v_cvt_pk_bf16_f32 v197, v154, v155
 v_exp_f32 v158, v158
 v_exp_f32 v159, v159
 v_cvt_pk_bf16_f32 v198, v156, v157
 v_exp_f32 v160, v160
 v_mfma_f32_32x32x16_bf16 v[64:79], v[224:227], v[176:179], v[64:79]
 v_exp_f32 v161, v161
 v_cvt_pk_bf16_f32 v199, v158, v159
 v_exp_f32 v162, v162
 v_exp_f32 v163, v163
 v_mfma_f32_32x32x16_bf16 v[80:95], v[224:227], v[184:187], v[80:95]
 v_cvt_pk_bf16_f32 v200, v160, v161
 v_exp_f32 v164, v164
 v_exp_f32 v165, v165
 v_mfma_f32_32x32x16_bf16 a[32:47], a[108:111], a[96:99], a[32:47]
 v_cvt_pk_bf16_f32 v201, v162, v163
 v_exp_f32 v166, v166
 v_exp_f32 v167, v167
 v_cvt_pk_bf16_f32 v202, v164, v165
 v_exp_f32 v168, v168
 v_mfma_f32_32x32x16_bf16 v[64:79], v[228:231], v[180:183], v[64:79]
 v_exp_f32 v169, v169
 v_cvt_pk_bf16_f32 v203, v166, v167
 v_exp_f32 v170, v170
 v_mfma_f32_32x32x16_bf16 v[80:95], v[228:231], v[188:191], v[80:95]
 v_exp_f32 v171, v171
 v_cvt_pk_bf16_f32 v204, v168, v169
 v_exp_f32 v172, v172
 v_exp_f32 v173, v173
 v_mfma_f32_32x32x16_bf16 a[48:63], a[108:111], a[100:103], a[48:63]
 buffer_load_dwordx4 a[96:99], v14, s[36:39], s63 offen sc1
 v_cvt_pk_bf16_f32 v205, v170, v171
 v_exp_f32 v174, v174
 v_exp_f32 v175, v175
 v_cvt_pk_bf16_f32 v206, v172, v173
 s_waitcnt lgkmcnt(0)
 v_cvt_pk_bf16_f32 v207, v174, v175
 v_mfma_f32_32x32x16_bf16 v[144:159], v[216:219], v[96:99], v[32:47]
 ds_read_b128 v[208:211], v10 offset:6144
 ds_read_b32 v212, v11 offset:768
 v_exp_f32 v112, v112
 v_exp_f32 v113, v113
 v_exp_f32 v114, v114
 v_exp_f32 v115, v115
 v_mfma_f32_32x32x16_bf16 v[160:175], v[216:219], v[104:107], v[48:63]
 ds_read_b128 v[224:227], v12 offset:5120
 ds_read_b128 v[228:231], v12 offset:5760
 buffer_load_dwordx4 a[100:103], v14, s[36:39], s64 offen sc1
 v_cvt_pk_bf16_f32 v176, v112, v113
 v_exp_f32 v116, v116
 v_exp_f32 v117, v117
 v_cvt_pk_bf16_f32 v177, v114, v115
 s_waitcnt vmcnt(32)
 v_mfma_f32_32x32x16_bf16 a[0:15], a[120:123], a[112:115], a[0:15]
 v_exp_f32 v118, v118
 v_exp_f32 v119, v119
 v_cvt_pk_bf16_f32 v178, v116, v117
 v_exp_f32 v120, v120
 v_mfma_f32_32x32x16_bf16 v[144:159], v[220:223], v[100:103], v[144:159]
 buffer_load_dwordx4 a[104:107], v14, s[36:39], s65 offen sc1
 v_exp_f32 v121, v121
 v_cvt_pk_bf16_f32 v179, v118, v119
 v_exp_f32 v122, v122
 v_exp_f32 v123, v123
 v_mfma_f32_32x32x16_bf16 v[160:175], v[220:223], v[108:111], v[160:175]
 v_cvt_pk_bf16_f32 v180, v120, v121
 v_exp_f32 v124, v124
 v_exp_f32 v125, v125
 v_mfma_f32_32x32x16_bf16 a[16:31], a[120:123], a[116:119], a[16:31]
 buffer_load_dwordx4 a[108:111], v14, s[36:39], s65 offen offset:1024 sc1
 s_add_u32 s65, s65, 18432
 v_cvt_pk_bf16_f32 v181, v122, v123
 v_exp_f32 v126, v126
 v_exp_f32 v127, v127
 v_cvt_pk_bf16_f32 v182, v124, v125
 v_exp_f32 v128, v128
 v_mfma_f32_32x32x16_bf16 v[64:79], v[232:235], v[192:195], v[64:79]
 v_exp_f32 v129, v129
 v_cvt_pk_bf16_f32 v183, v126, v127
 v_exp_f32 v130, v130
 v_exp_f32 v131, v131
 v_mfma_f32_32x32x16_bf16 v[80:95], v[232:235], v[200:203], v[80:95]
 v_cvt_pk_bf16_f32 v184, v128, v129
 v_exp_f32 v132, v132
 v_exp_f32 v133, v133
 v_mfma_f32_32x32x16_bf16 a[32:47], a[124:127], a[112:115], a[32:47]
 v_cvt_pk_bf16_f32 v185, v130, v131
 v_exp_f32 v134, v134
 v_exp_f32 v135, v135
 v_cvt_pk_bf16_f32 v186, v132, v133
 v_exp_f32 v136, v136
 v_mfma_f32_32x32x16_bf16 v[64:79], v[236:239], v[196:199], v[64:79]
 v_exp_f32 v137, v137
 v_cvt_pk_bf16_f32 v187, v134, v135
 v_exp_f32 v138, v138
 v_mfma_f32_32x32x16_bf16 v[80:95], v[236:239], v[204:207], v[80:95]
 v_exp_f32 v139, v139
 v_cvt_pk_bf16_f32 v188, v136, v137
 v_exp_f32 v140, v140
 v_exp_f32 v141, v141
 v_mfma_f32_32x32x16_bf16 a[48:63], a[124:127], a[116:119], a[48:63]
 buffer_load_dwordx4 a[112:115], v14, s[36:39], s63 offen offset:1024 sc1
 v_cvt_pk_bf16_f32 v189, v138, v139
 v_exp_f32 v142, v142
 v_exp_f32 v143, v143
 v_cvt_pk_bf16_f32 v190, v140, v141
 s_waitcnt lgkmcnt(0)
 v_cvt_pk_bf16_f32 v191, v142, v143
 v_mfma_f32_32x32x16_bf16 v[112:127], v[208:211], v[96:99], v[32:47]
 ds_read_b128 v[216:219], v10 offset:7168
 ds_read_b32 v220, v11 offset:896
 v_exp_f32 v144, v144
 v_exp_f32 v145, v145
 v_exp_f32 v146, v146
 v_exp_f32 v147, v147
 v_mfma_f32_32x32x16_bf16 v[128:143], v[208:211], v[104:107], v[48:63]
 ds_read_b128 v[232:235], v12 offset:6400
 ds_read_b128 v[236:239], v12 offset:7040
 s_add_u32 s57, s57, 20480
 s_cmp_eq_u32 s57, 61440
 s_cselect_b32 s57, 0, s57
 buffer_load_dwordx4 a[116:119], v14, s[36:39], s64 offen offset:1024 sc1
 v_cvt_pk_bf16_f32 v192, v144, v145
 v_exp_f32 v148, v148
 v_exp_f32 v149, v149
 v_cvt_pk_bf16_f32 v193, v146, v147
 s_waitcnt vmcnt(32)
 v_mfma_f32_32x32x16_bf16 a[0:15], a[136:139], a[128:131], a[0:15]
 v_exp_f32 v150, v150
 v_exp_f32 v151, v151
 v_cvt_pk_bf16_f32 v194, v148, v149
 v_exp_f32 v152, v152
 v_mfma_f32_32x32x16_bf16 v[112:127], v[212:215], v[100:103], v[112:127]
 buffer_load_dwordx4 a[120:123], v14, s[36:39], s65 offen sc1
 v_exp_f32 v153, v153
 v_cvt_pk_bf16_f32 v195, v150, v151
 v_exp_f32 v154, v154
 v_exp_f32 v155, v155
 v_mfma_f32_32x32x16_bf16 v[128:143], v[212:215], v[108:111], v[128:143]
 v_cvt_pk_bf16_f32 v196, v152, v153
 v_exp_f32 v156, v156
 v_exp_f32 v157, v157
 v_mfma_f32_32x32x16_bf16 a[16:31], a[136:139], a[132:135], a[16:31]
 buffer_load_dwordx4 a[124:127], v14, s[36:39], s65 offen offset:1024 sc1
 s_add_u32 s65, s65, 18432
 v_cvt_pk_bf16_f32 v197, v154, v155
 v_exp_f32 v158, v158
 v_exp_f32 v159, v159
 v_cvt_pk_bf16_f32 v198, v156, v157
 v_exp_f32 v160, v160
 v_mfma_f32_32x32x16_bf16 v[64:79], v[224:227], v[176:179], v[64:79]
 v_exp_f32 v161, v161
 v_cvt_pk_bf16_f32 v199, v158, v159
 v_exp_f32 v162, v162
 v_exp_f32 v163, v163
 v_mfma_f32_32x32x16_bf16 v[80:95], v[224:227], v[184:187], v[80:95]
 v_cvt_pk_bf16_f32 v200, v160, v161
 v_exp_f32 v164, v164
 v_exp_f32 v165, v165
 v_mfma_f32_32x32x16_bf16 a[32:47], a[140:143], a[128:131], a[32:47]
 v_cvt_pk_bf16_f32 v201, v162, v163
 v_exp_f32 v166, v166
 v_exp_f32 v167, v167
 v_cvt_pk_bf16_f32 v202, v164, v165
 v_exp_f32 v168, v168
 v_mfma_f32_32x32x16_bf16 v[64:79], v[228:231], v[180:183], v[64:79]
 v_exp_f32 v169, v169
 v_cvt_pk_bf16_f32 v203, v166, v167
 v_exp_f32 v170, v170
 v_mfma_f32_32x32x16_bf16 v[80:95], v[228:231], v[188:191], v[80:95]
 v_exp_f32 v171, v171
 v_cvt_pk_bf16_f32 v204, v168, v169
 v_exp_f32 v172, v172
 v_exp_f32 v173, v173
 v_mfma_f32_32x32x16_bf16 a[48:63], a[140:143], a[132:135], a[48:63]
 buffer_load_dwordx4 a[128:131], v14, s[36:39], s63 offen offset:2048 sc1
 v_cvt_pk_bf16_f32 v205, v170, v171
 v_exp_f32 v174, v174
 v_exp_f32 v175, v175
 v_cvt_pk_bf16_f32 v206, v172, v173
 v_add_u32 v10, s57, v14
 v_add_u32 v11, s57, v20
 v_add_u32 v253, s57, v252
 s_waitcnt lgkmcnt(0)
 v_cvt_pk_bf16_f32 v207, v174, v175
 v_mfma_f32_32x32x16_bf16 v[144:159], v[216:219], v[96:99], v[32:47]
 s_waitcnt vmcnt(26)
 ds_write_b128 v253, v[248:251]
 s_waitcnt lgkmcnt(0)
 s_barrier
 ds_read_b128 v[208:211], v10
 ds_read_b32 v212, v11
 v_exp_f32 v112, v112
 v_exp_f32 v113, v113
 v_exp_f32 v114, v114
 v_exp_f32 v115, v115
 v_mfma_f32_32x32x16_bf16 v[160:175], v[216:219], v[104:107], v[48:63]
 ds_read_b128 v[224:227], v12 offset:7680
 ds_read_b128 v[228:231], v12 offset:8320
 buffer_load_dwordx4 a[132:135], v14, s[36:39], s64 offen offset:2048 sc1
 v_cvt_pk_bf16_f32 v176, v112, v113
 v_exp_f32 v116, v116
 v_exp_f32 v117, v117
 v_cvt_pk_bf16_f32 v177, v114, v115
 s_waitcnt vmcnt(30)
 v_mfma_f32_32x32x16_bf16 a[0:15], a[152:155], a[144:147], a[0:15]
 v_exp_f32 v118, v118
 v_exp_f32 v119, v119
 v_cvt_pk_bf16_f32 v178, v116, v117
 v_exp_f32 v120, v120
 v_mfma_f32_32x32x16_bf16 v[144:159], v[220:223], v[100:103], v[144:159]
 buffer_load_dwordx4 a[136:139], v14, s[36:39], s65 offen sc1
 v_exp_f32 v121, v121
 v_cvt_pk_bf16_f32 v179, v118, v119
 v_exp_f32 v122, v122
 v_exp_f32 v123, v123
 v_mfma_f32_32x32x16_bf16 v[160:175], v[220:223], v[108:111], v[160:175]
 v_cvt_pk_bf16_f32 v180, v120, v121
 v_exp_f32 v124, v124
 v_exp_f32 v125, v125
 v_mfma_f32_32x32x16_bf16 a[16:31], a[152:155], a[148:151], a[16:31]
 buffer_load_dwordx4 a[140:143], v14, s[36:39], s65 offen offset:1024 sc1
 s_add_u32 s65, s65, 18432
 v_cvt_pk_bf16_f32 v181, v122, v123
 v_exp_f32 v126, v126
 v_exp_f32 v127, v127
 v_cvt_pk_bf16_f32 v182, v124, v125
 v_exp_f32 v128, v128
 v_mfma_f32_32x32x16_bf16 v[64:79], v[232:235], v[192:195], v[64:79]
 v_exp_f32 v129, v129
 v_cvt_pk_bf16_f32 v183, v126, v127
 v_exp_f32 v130, v130
 v_exp_f32 v131, v131
 v_mfma_f32_32x32x16_bf16 v[80:95], v[232:235], v[200:203], v[80:95]
 v_cvt_pk_bf16_f32 v184, v128, v129
 v_exp_f32 v132, v132
 v_exp_f32 v133, v133
 v_mfma_f32_32x32x16_bf16 a[32:47], a[156:159], a[144:147], a[32:47]
 v_cvt_pk_bf16_f32 v185, v130, v131
 v_exp_f32 v134, v134
 v_exp_f32 v135, v135
 v_cvt_pk_bf16_f32 v186, v132, v133
 v_exp_f32 v136, v136
 v_mfma_f32_32x32x16_bf16 v[64:79], v[236:239], v[196:199], v[64:79]
 v_exp_f32 v137, v137
 v_cvt_pk_bf16_f32 v187, v134, v135
 v_exp_f32 v138, v138
 v_mfma_f32_32x32x16_bf16 v[80:95], v[236:239], v[204:207], v[80:95]
 v_exp_f32 v139, v139
 v_cvt_pk_bf16_f32 v188, v136, v137
 v_exp_f32 v140, v140
 v_exp_f32 v141, v141
 v_mfma_f32_32x32x16_bf16 a[48:63], a[156:159], a[148:151], a[48:63]
 buffer_load_dwordx4 a[144:147], v14, s[36:39], s63 offen offset:3072 sc1
 s_add_u32 s63, s63, 4096
 v_cvt_pk_bf16_f32 v189, v138, v139
 v_exp_f32 v142, v142
 v_exp_f32 v143, v143
 v_cvt_pk_bf16_f32 v190, v140, v141
 s_waitcnt lgkmcnt(0)
 v_cvt_pk_bf16_f32 v191, v142, v143
 v_mfma_f32_32x32x16_bf16 v[112:127], v[208:211], v[96:99], v[32:47]
 ds_read_b128 v[216:219], v10 offset:1024
 ds_read_b32 v220, v11 offset:128
 v_exp_f32 v144, v144
 v_exp_f32 v145, v145
 v_exp_f32 v146, v146
 v_exp_f32 v147, v147
 v_mfma_f32_32x32x16_bf16 v[128:143], v[208:211], v[104:107], v[48:63]
 ds_read_b128 v[232:235], v12 offset:8960
 ds_read_b128 v[236:239], v12 offset:9600
 buffer_load_dwordx4 a[148:151], v14, s[36:39], s64 offen offset:3072 sc1
 s_add_u32 s64, s64, 4096
 v_cvt_pk_bf16_f32 v192, v144, v145
 v_exp_f32 v148, v148
 v_exp_f32 v149, v149
 v_cvt_pk_bf16_f32 v193, v146, v147
 s_waitcnt vmcnt(27)
 v_mfma_f32_32x32x16_bf16 a[0:15], a[168:171], a[160:163], a[0:15]
 v_exp_f32 v150, v150
 v_exp_f32 v151, v151
 v_cvt_pk_bf16_f32 v194, v148, v149
 v_exp_f32 v152, v152
 v_mfma_f32_32x32x16_bf16 v[112:127], v[212:215], v[100:103], v[112:127]
 buffer_load_dwordx4 a[152:155], v14, s[36:39], s65 offen sc1
 v_exp_f32 v153, v153
 v_cvt_pk_bf16_f32 v195, v150, v151
 v_exp_f32 v154, v154
 v_exp_f32 v155, v155
 v_mfma_f32_32x32x16_bf16 v[128:143], v[212:215], v[108:111], v[128:143]
 v_cvt_pk_bf16_f32 v196, v152, v153
 v_exp_f32 v156, v156
 v_exp_f32 v157, v157
 v_mfma_f32_32x32x16_bf16 a[16:31], a[168:171], a[164:167], a[16:31]
 buffer_load_dwordx4 a[156:159], v14, s[36:39], s65 offen offset:1024 sc1
 s_add_u32 s65, s65, 18432
 v_cvt_pk_bf16_f32 v197, v154, v155
 v_exp_f32 v158, v158
 v_exp_f32 v159, v159
 v_cvt_pk_bf16_f32 v198, v156, v157
 v_exp_f32 v160, v160
 v_mfma_f32_32x32x16_bf16 v[64:79], v[224:227], v[176:179], v[64:79]
 v_exp_f32 v161, v161
 v_cvt_pk_bf16_f32 v199, v158, v159
 v_exp_f32 v162, v162
 v_exp_f32 v163, v163
 v_mfma_f32_32x32x16_bf16 v[80:95], v[224:227], v[184:187], v[80:95]
 v_cvt_pk_bf16_f32 v200, v160, v161
 v_exp_f32 v164, v164
 v_exp_f32 v165, v165
 v_mfma_f32_32x32x16_bf16 a[32:47], a[172:175], a[160:163], a[32:47]
 v_cvt_pk_bf16_f32 v201, v162, v163
 v_exp_f32 v166, v166
 v_exp_f32 v167, v167
 v_cvt_pk_bf16_f32 v202, v164, v165
 v_exp_f32 v168, v168
 v_mfma_f32_32x32x16_bf16 v[64:79], v[228:231], v[180:183], v[64:79]
 v_exp_f32 v169, v169
 v_cvt_pk_bf16_f32 v203, v166, v167
 v_exp_f32 v170, v170
 v_mfma_f32_32x32x16_bf16 v[80:95], v[228:231], v[188:191], v[80:95]
 v_exp_f32 v171, v171
 v_cvt_pk_bf16_f32 v204, v168, v169
 v_exp_f32 v172, v172
 v_exp_f32 v173, v173
 v_mfma_f32_32x32x16_bf16 a[48:63], a[172:175], a[164:167], a[48:63]
 buffer_load_dwordx4 a[160:163], v14, s[36:39], s63 offen sc1
 v_cvt_pk_bf16_f32 v205, v170, v171
 v_exp_f32 v174, v174
 v_exp_f32 v175, v175
 v_cvt_pk_bf16_f32 v206, v172, v173
 v_add_u32 v12, s57, v21
 s_waitcnt lgkmcnt(0)
 v_cvt_pk_bf16_f32 v207, v174, v175
 v_mfma_f32_32x32x16_bf16 v[144:159], v[216:219], v[96:99], v[32:47]
 ds_read_b128 v[208:211], v10 offset:2048
 ds_read_b32 v212, v11 offset:256
 v_exp_f32 v112, v112
 v_exp_f32 v113, v113
 v_exp_f32 v114, v114
 v_exp_f32 v115, v115
 v_mfma_f32_32x32x16_bf16 v[160:175], v[216:219], v[104:107], v[48:63]
 ds_read_b128 v[224:227], v12
 ds_read_b128 v[228:231], v12 offset:640
 buffer_load_dwordx4 a[164:167], v14, s[36:39], s64 offen sc1
 v_cvt_pk_bf16_f32 v176, v112, v113
 v_exp_f32 v116, v116
 v_exp_f32 v117, v117
 v_cvt_pk_bf16_f32 v177, v114, v115
 s_waitcnt vmcnt(27)
 v_mfma_f32_32x32x16_bf16 a[0:15], a[184:187], a[176:179], a[0:15]
 v_exp_f32 v118, v118
 v_exp_f32 v119, v119
 v_cvt_pk_bf16_f32 v178, v116, v117
 v_exp_f32 v120, v120
 v_mfma_f32_32x32x16_bf16 v[144:159], v[220:223], v[100:103], v[144:159]
 buffer_load_dwordx4 a[168:171], v14, s[36:39], s65 offen sc1
 v_exp_f32 v121, v121
 v_cvt_pk_bf16_f32 v179, v118, v119
 v_exp_f32 v122, v122
 v_exp_f32 v123, v123
 v_mfma_f32_32x32x16_bf16 v[160:175], v[220:223], v[108:111], v[160:175]
 v_cvt_pk_bf16_f32 v180, v120, v121
 v_exp_f32 v124, v124
 v_exp_f32 v125, v125
 v_mfma_f32_32x32x16_bf16 a[16:31], a[184:187], a[180:183], a[16:31]
 buffer_load_dwordx4 a[172:175], v14, s[36:39], s65 offen offset:1024 sc1
 s_add_u32 s65, s65, 18432
 v_cvt_pk_bf16_f32 v181, v122, v123
 v_exp_f32 v126, v126
 v_exp_f32 v127, v127
 v_cvt_pk_bf16_f32 v182, v124, v125
 v_exp_f32 v128, v128
 v_mfma_f32_32x32x16_bf16 v[64:79], v[232:235], v[192:195], v[64:79]
 v_exp_f32 v129, v129
 v_cvt_pk_bf16_f32 v183, v126, v127
 v_exp_f32 v130, v130
 v_exp_f32 v131, v131
 v_mfma_f32_32x32x16_bf16 v[80:95], v[232:235], v[200:203], v[80:95]
 v_cvt_pk_bf16_f32 v184, v128, v129
 v_exp_f32 v132, v132
 v_exp_f32 v133, v133
 v_mfma_f32_32x32x16_bf16 a[32:47], a[188:191], a[176:179], a[32:47]
 v_cvt_pk_bf16_f32 v185, v130, v131
 v_exp_f32 v134, v134
 v_exp_f32 v135, v135
 v_cvt_pk_bf16_f32 v186, v132, v133
 v_exp_f32 v136, v136
 v_mfma_f32_32x32x16_bf16 v[64:79], v[236:239], v[196:199], v[64:79]
 v_exp_f32 v137, v137
 v_cvt_pk_bf16_f32 v187, v134, v135
 v_exp_f32 v138, v138
 v_mfma_f32_32x32x16_bf16 v[80:95], v[236:239], v[204:207], v[80:95]
 v_exp_f32 v139, v139
 v_cvt_pk_bf16_f32 v188, v136, v137
 v_exp_f32 v140, v140
 v_exp_f32 v141, v141
 v_mfma_f32_32x32x16_bf16 a[48:63], a[188:191], a[180:183], a[48:63]
 buffer_load_dwordx4 a[176:179], v14, s[36:39], s63 offen offset:1024 sc1
 v_cvt_pk_bf16_f32 v189, v138, v139
 v_exp_f32 v142, v142
 v_exp_f32 v143, v143
 v_cvt_pk_bf16_f32 v190, v140, v141
 s_waitcnt lgkmcnt(0)
 v_cvt_pk_bf16_f32 v191, v142, v143
 v_mfma_f32_32x32x16_bf16 v[112:127], v[208:211], v[96:99], v[32:47]
 ds_read_b128 v[216:219], v10 offset:3072
 ds_read_b32 v220, v11 offset:384
 v_exp_f32 v144, v144
 v_exp_f32 v145, v145
 v_exp_f32 v146, v146
 v_exp_f32 v147, v147
 v_mfma_f32_32x32x16_bf16 v[128:143], v[208:211], v[104:107], v[48:63]
 ds_read_b128 v[232:235], v12 offset:1280
 ds_read_b128 v[236:239], v12 offset:1920
 buffer_load_dwordx4 a[180:183], v14, s[36:39], s64 offen offset:1024 sc1
 v_cvt_pk_bf16_f32 v192, v144, v145
 v_exp_f32 v148, v148
 v_exp_f32 v149, v149
 v_cvt_pk_bf16_f32 v193, v146, v147
 s_waitcnt vmcnt(27)
 v_mfma_f32_32x32x16_bf16 a[0:15], a[200:203], a[192:195], a[0:15]
 v_exp_f32 v150, v150
 v_exp_f32 v151, v151
 v_cvt_pk_bf16_f32 v194, v148, v149
 v_exp_f32 v152, v152
 v_mfma_f32_32x32x16_bf16 v[112:127], v[212:215], v[100:103], v[112:127]
 buffer_load_dwordx4 a[184:187], v14, s[36:39], s65 offen sc1
 v_exp_f32 v153, v153
 v_cvt_pk_bf16_f32 v195, v150, v151
 v_exp_f32 v154, v154
 v_exp_f32 v155, v155
 v_mfma_f32_32x32x16_bf16 v[128:143], v[212:215], v[108:111], v[128:143]
 v_cvt_pk_bf16_f32 v196, v152, v153
 v_exp_f32 v156, v156
 v_exp_f32 v157, v157
 v_mfma_f32_32x32x16_bf16 a[16:31], a[200:203], a[196:199], a[16:31]
 buffer_load_dwordx4 a[188:191], v14, s[36:39], s65 offen offset:1024 sc1
 s_add_u32 s65, s65, 18432
 v_cvt_pk_bf16_f32 v197, v154, v155
 v_exp_f32 v158, v158
 v_exp_f32 v159, v159
 v_cvt_pk_bf16_f32 v198, v156, v157
 v_exp_f32 v160, v160
 v_mfma_f32_32x32x16_bf16 v[64:79], v[224:227], v[176:179], v[64:79]
 v_exp_f32 v161, v161
 v_cvt_pk_bf16_f32 v199, v158, v159
 v_exp_f32 v162, v162
 v_exp_f32 v163, v163
 v_mfma_f32_32x32x16_bf16 v[80:95], v[224:227], v[184:187], v[80:95]
 v_cvt_pk_bf16_f32 v200, v160, v161
 v_exp_f32 v164, v164
 v_exp_f32 v165, v165
 v_mfma_f32_32x32x16_bf16 a[32:47], a[204:207], a[192:195], a[32:47]
 v_cvt_pk_bf16_f32 v201, v162, v163
 v_exp_f32 v166, v166
 v_exp_f32 v167, v167
 v_cvt_pk_bf16_f32 v202, v164, v165
 v_exp_f32 v168, v168
 v_mfma_f32_32x32x16_bf16 v[64:79], v[228:231], v[180:183], v[64:79]
 v_exp_f32 v169, v169
 v_cvt_pk_bf16_f32 v203, v166, v167
 v_exp_f32 v170, v170
 v_mfma_f32_32x32x16_bf16 v[80:95], v[228:231], v[188:191], v[80:95]
 v_exp_f32 v171, v171
 v_cvt_pk_bf16_f32 v204, v168, v169
 v_exp_f32 v172, v172
 v_exp_f32 v173, v173
 v_mfma_f32_32x32x16_bf16 a[48:63], a[204:207], a[196:199], a[48:63]
 buffer_load_dwordx4 a[192:195], v14, s[36:39], s63 offen offset:2048 sc1
 v_cvt_pk_bf16_f32 v205, v170, v171
 v_exp_f32 v174, v174
 v_exp_f32 v175, v175
 v_cvt_pk_bf16_f32 v206, v172, v173
 s_waitcnt lgkmcnt(0)
 v_cvt_pk_bf16_f32 v207, v174, v175
 v_mfma_f32_32x32x16_bf16 v[144:159], v[216:219], v[96:99], v[32:47]
 ds_read_b128 v[208:211], v10 offset:4096
 ds_read_b32 v212, v11 offset:512
 v_exp_f32 v112, v112
 v_exp_f32 v113, v113
 v_exp_f32 v114, v114
 v_exp_f32 v115, v115
 v_mfma_f32_32x32x16_bf16 v[160:175], v[216:219], v[104:107], v[48:63]
 ds_read_b128 v[224:227], v12 offset:2560
 ds_read_b128 v[228:231], v12 offset:3200
 buffer_load_dwordx4 a[196:199], v14, s[36:39], s64 offen offset:2048 sc1
 v_cvt_pk_bf16_f32 v176, v112, v113
 v_exp_f32 v116, v116
 v_exp_f32 v117, v117
 v_cvt_pk_bf16_f32 v177, v114, v115
 s_waitcnt vmcnt(26)
 v_mfma_f32_32x32x16_bf16 a[0:15], a[216:219], a[208:211], a[0:15]
 v_exp_f32 v118, v118
 v_exp_f32 v119, v119
 v_cvt_pk_bf16_f32 v178, v116, v117
 v_exp_f32 v120, v120
 v_mfma_f32_32x32x16_bf16 v[144:159], v[220:223], v[100:103], v[144:159]
 buffer_load_dwordx4 a[200:203], v14, s[36:39], s65 offen sc1
 v_exp_f32 v121, v121
 v_cvt_pk_bf16_f32 v179, v118, v119
 v_exp_f32 v122, v122
 v_exp_f32 v123, v123
 v_mfma_f32_32x32x16_bf16 v[160:175], v[220:223], v[108:111], v[160:175]
 v_cvt_pk_bf16_f32 v180, v120, v121
 v_exp_f32 v124, v124
 v_exp_f32 v125, v125
 v_mfma_f32_32x32x16_bf16 a[16:31], a[216:219], a[212:215], a[16:31]
 buffer_load_dwordx4 a[204:207], v14, s[36:39], s65 offen offset:1024 sc1
 s_add_u32 s65, s65, 18432
 v_cvt_pk_bf16_f32 v181, v122, v123
 v_exp_f32 v126, v126
 v_exp_f32 v127, v127
 v_cvt_pk_bf16_f32 v182, v124, v125
 v_exp_f32 v128, v128
 v_mfma_f32_32x32x16_bf16 v[64:79], v[232:235], v[192:195], v[64:79]
 v_exp_f32 v129, v129
 v_cvt_pk_bf16_f32 v183, v126, v127
 v_exp_f32 v130, v130
 v_exp_f32 v131, v131
 v_mfma_f32_32x32x16_bf16 v[80:95], v[232:235], v[200:203], v[80:95]
 v_cvt_pk_bf16_f32 v184, v128, v129
 v_exp_f32 v132, v132
 v_exp_f32 v133, v133
 v_mfma_f32_32x32x16_bf16 a[32:47], a[220:223], a[208:211], a[32:47]
 v_cvt_pk_bf16_f32 v185, v130, v131
 v_exp_f32 v134, v134
 v_exp_f32 v135, v135
 v_cvt_pk_bf16_f32 v186, v132, v133
 v_exp_f32 v136, v136
 v_mfma_f32_32x32x16_bf16 v[64:79], v[236:239], v[196:199], v[64:79]
 v_exp_f32 v137, v137
 v_cvt_pk_bf16_f32 v187, v134, v135
 v_exp_f32 v138, v138
 v_mfma_f32_32x32x16_bf16 v[80:95], v[236:239], v[204:207], v[80:95]
 v_exp_f32 v139, v139
 v_cvt_pk_bf16_f32 v188, v136, v137
 v_exp_f32 v140, v140
 v_exp_f32 v141, v141
 v_mfma_f32_32x32x16_bf16 a[48:63], a[220:223], a[212:215], a[48:63]
 buffer_load_dwordx4 a[208:211], v14, s[36:39], s63 offen offset:3072 sc1
 s_add_u32 s63, s63, 4096
 v_cvt_pk_bf16_f32 v189, v138, v139
 v_exp_f32 v142, v142
 v_exp_f32 v143, v143
 v_cvt_pk_bf16_f32 v190, v140, v141
 s_waitcnt lgkmcnt(0)
 v_cvt_pk_bf16_f32 v191, v142, v143
 v_mfma_f32_32x32x16_bf16 v[112:127], v[208:211], v[96:99], v[32:47]
 ds_read_b128 v[216:219], v10 offset:5120
 ds_read_b32 v220, v11 offset:640
 v_exp_f32 v144, v144
 v_exp_f32 v145, v145
 v_exp_f32 v146, v146
 v_exp_f32 v147, v147
 v_mfma_f32_32x32x16_bf16 v[128:143], v[208:211], v[104:107], v[48:63]
 ds_read_b128 v[232:235], v12 offset:3840
 ds_read_b128 v[236:239], v12 offset:4480
 buffer_load_dwordx4 a[212:215], v14, s[36:39], s64 offen offset:3072 sc1
 s_add_u32 s64, s64, 4096
 v_cvt_pk_bf16_f32 v192, v144, v145
 v_exp_f32 v148, v148
 v_exp_f32 v149, v149
 v_cvt_pk_bf16_f32 v193, v146, v147
 s_waitcnt vmcnt(26)
 v_mfma_f32_32x32x16_bf16 a[0:15], a[104:107], a[96:99], a[0:15]
 v_exp_f32 v150, v150
 v_exp_f32 v151, v151
 v_cvt_pk_bf16_f32 v194, v148, v149
 v_exp_f32 v152, v152
 v_mfma_f32_32x32x16_bf16 v[112:127], v[212:215], v[100:103], v[112:127]
 buffer_load_dwordx4 a[216:219], v14, s[36:39], s65 offen sc1
 v_exp_f32 v153, v153
 v_cvt_pk_bf16_f32 v195, v150, v151
 v_exp_f32 v154, v154
 v_exp_f32 v155, v155
 v_mfma_f32_32x32x16_bf16 v[128:143], v[212:215], v[108:111], v[128:143]
 v_cvt_pk_bf16_f32 v196, v152, v153
 v_exp_f32 v156, v156
 v_exp_f32 v157, v157
 v_mfma_f32_32x32x16_bf16 a[16:31], a[104:107], a[100:103], a[16:31]
 buffer_load_dwordx4 a[220:223], v14, s[36:39], s65 offen offset:1024 sc1
 s_add_u32 s65, s65, 18432
 v_cvt_pk_bf16_f32 v197, v154, v155
 v_exp_f32 v158, v158
 v_exp_f32 v159, v159
 v_cvt_pk_bf16_f32 v198, v156, v157
 v_exp_f32 v160, v160
 v_mfma_f32_32x32x16_bf16 v[64:79], v[224:227], v[176:179], v[64:79]
 v_exp_f32 v161, v161
 v_cvt_pk_bf16_f32 v199, v158, v159
 v_exp_f32 v162, v162
 v_exp_f32 v163, v163
 v_mfma_f32_32x32x16_bf16 v[80:95], v[224:227], v[184:187], v[80:95]
 v_cvt_pk_bf16_f32 v200, v160, v161
 v_exp_f32 v164, v164
 v_exp_f32 v165, v165
 v_mfma_f32_32x32x16_bf16 a[32:47], a[108:111], a[96:99], a[32:47]
 v_cvt_pk_bf16_f32 v201, v162, v163
 v_exp_f32 v166, v166
 v_exp_f32 v167, v167
 v_cvt_pk_bf16_f32 v202, v164, v165
 v_exp_f32 v168, v168
 v_mfma_f32_32x32x16_bf16 v[64:79], v[228:231], v[180:183], v[64:79]
 v_exp_f32 v169, v169
 v_cvt_pk_bf16_f32 v203, v166, v167
 v_exp_f32 v170, v170
 v_mfma_f32_32x32x16_bf16 v[80:95], v[228:231], v[188:191], v[80:95]
 v_exp_f32 v171, v171
 v_cvt_pk_bf16_f32 v204, v168, v169
 v_exp_f32 v172, v172
 v_exp_f32 v173, v173
 v_mfma_f32_32x32x16_bf16 a[48:63], a[108:111], a[100:103], a[48:63]
 buffer_load_dwordx4 a[96:99], v14, s[36:39], s63 offen sc1
 v_cvt_pk_bf16_f32 v205, v170, v171
 v_exp_f32 v174, v174
 v_exp_f32 v175, v175
 v_cvt_pk_bf16_f32 v206, v172, v173
 s_waitcnt lgkmcnt(0)
 v_cvt_pk_bf16_f32 v207, v174, v175
 v_mfma_f32_32x32x16_bf16 v[144:159], v[216:219], v[96:99], v[32:47]
 ds_read_b128 v[208:211], v10 offset:6144
 ds_read_b32 v212, v11 offset:768
 v_exp_f32 v112, v112
 v_exp_f32 v113, v113
 v_exp_f32 v114, v114
 v_exp_f32 v115, v115
 v_mfma_f32_32x32x16_bf16 v[160:175], v[216:219], v[104:107], v[48:63]
 ds_read_b128 v[224:227], v12 offset:5120
 ds_read_b128 v[228:231], v12 offset:5760
 buffer_load_dwordx4 a[100:103], v14, s[36:39], s64 offen sc1
 v_cvt_pk_bf16_f32 v176, v112, v113
 v_exp_f32 v116, v116
 v_exp_f32 v117, v117
 v_cvt_pk_bf16_f32 v177, v114, v115
 s_waitcnt vmcnt(26)
 v_mfma_f32_32x32x16_bf16 a[0:15], a[120:123], a[112:115], a[0:15]
 v_exp_f32 v118, v118
 v_exp_f32 v119, v119
 v_cvt_pk_bf16_f32 v178, v116, v117
 v_exp_f32 v120, v120
 v_mfma_f32_32x32x16_bf16 v[144:159], v[220:223], v[100:103], v[144:159]
 buffer_load_dwordx4 a[104:107], v14, s[36:39], s65 offen sc1
 v_exp_f32 v121, v121
 v_cvt_pk_bf16_f32 v179, v118, v119
 v_exp_f32 v122, v122
 v_exp_f32 v123, v123
 v_mfma_f32_32x32x16_bf16 v[160:175], v[220:223], v[108:111], v[160:175]
 v_cvt_pk_bf16_f32 v180, v120, v121
 v_exp_f32 v124, v124
 v_exp_f32 v125, v125
 v_mfma_f32_32x32x16_bf16 a[16:31], a[120:123], a[116:119], a[16:31]
 buffer_load_dwordx4 a[108:111], v14, s[36:39], s65 offen offset:1024 sc1
 s_add_u32 s65, s65, 18432
 v_cvt_pk_bf16_f32 v181, v122, v123
 v_exp_f32 v126, v126
 v_exp_f32 v127, v127
 v_cvt_pk_bf16_f32 v182, v124, v125
 v_exp_f32 v128, v128
 v_mfma_f32_32x32x16_bf16 v[64:79], v[232:235], v[192:195], v[64:79]
 v_exp_f32 v129, v129
 v_cvt_pk_bf16_f32 v183, v126, v127
 v_exp_f32 v130, v130
 v_exp_f32 v131, v131
 v_mfma_f32_32x32x16_bf16 v[80:95], v[232:235], v[200:203], v[80:95]
 v_cvt_pk_bf16_f32 v184, v128, v129
 v_exp_f32 v132, v132
 v_exp_f32 v133, v133
 v_mfma_f32_32x32x16_bf16 a[32:47], a[124:127], a[112:115], a[32:47]
 v_cvt_pk_bf16_f32 v185, v130, v131
 v_exp_f32 v134, v134
 v_exp_f32 v135, v135
 v_cvt_pk_bf16_f32 v186, v132, v133
 v_exp_f32 v136, v136
 v_mfma_f32_32x32x16_bf16 v[64:79], v[236:239], v[196:199], v[64:79]
 v_exp_f32 v137, v137
 v_cvt_pk_bf16_f32 v187, v134, v135
 v_exp_f32 v138, v138
 v_mfma_f32_32x32x16_bf16 v[80:95], v[236:239], v[204:207], v[80:95]
 v_exp_f32 v139, v139
 v_cvt_pk_bf16_f32 v188, v136, v137
 v_exp_f32 v140, v140
 v_exp_f32 v141, v141
 v_mfma_f32_32x32x16_bf16 a[48:63], a[124:127], a[116:119], a[48:63]
 buffer_load_dwordx4 a[112:115], v14, s[36:39], s63 offen offset:1024 sc1
 v_cvt_pk_bf16_f32 v189, v138, v139
 v_exp_f32 v142, v142
 v_exp_f32 v143, v143
 v_cvt_pk_bf16_f32 v190, v140, v141
 s_waitcnt lgkmcnt(0)
 v_cvt_pk_bf16_f32 v191, v142, v143
 v_mfma_f32_32x32x16_bf16 v[112:127], v[208:211], v[96:99], v[32:47]
 ds_read_b128 v[216:219], v10 offset:7168
 ds_read_b32 v220, v11 offset:896
 v_exp_f32 v144, v144
 v_exp_f32 v145, v145
 v_exp_f32 v146, v146
 v_exp_f32 v147, v147
 v_mfma_f32_32x32x16_bf16 v[128:143], v[208:211], v[104:107], v[48:63]
 ds_read_b128 v[232:235], v12 offset:6400
 ds_read_b128 v[236:239], v12 offset:7040
 buffer_load_dwordx4 a[116:119], v14, s[36:39], s64 offen offset:1024 sc1
 v_cvt_pk_bf16_f32 v192, v144, v145
 v_exp_f32 v148, v148
 v_exp_f32 v149, v149
 v_cvt_pk_bf16_f32 v193, v146, v147
 s_waitcnt vmcnt(26)
 v_mfma_f32_32x32x16_bf16 a[0:15], a[136:139], a[128:131], a[0:15]
 v_exp_f32 v150, v150
 v_exp_f32 v151, v151
 v_cvt_pk_bf16_f32 v194, v148, v149
 v_exp_f32 v152, v152
 v_mfma_f32_32x32x16_bf16 v[112:127], v[212:215], v[100:103], v[112:127]
 buffer_load_dwordx4 a[120:123], v14, s[36:39], s65 offen sc1
 v_exp_f32 v153, v153
 v_cvt_pk_bf16_f32 v195, v150, v151
 v_exp_f32 v154, v154
 v_exp_f32 v155, v155
 v_mfma_f32_32x32x16_bf16 v[128:143], v[212:215], v[108:111], v[128:143]
 v_cvt_pk_bf16_f32 v196, v152, v153
 v_exp_f32 v156, v156
 v_exp_f32 v157, v157
 v_mfma_f32_32x32x16_bf16 a[16:31], a[136:139], a[132:135], a[16:31]
 buffer_load_dwordx4 a[124:127], v14, s[36:39], s65 offen offset:1024 sc1
 s_add_u32 s65, s65, 18432
 v_cvt_pk_bf16_f32 v197, v154, v155
 v_exp_f32 v158, v158
 v_exp_f32 v159, v159
 v_cvt_pk_bf16_f32 v198, v156, v157
 v_exp_f32 v160, v160
 v_mfma_f32_32x32x16_bf16 v[64:79], v[224:227], v[176:179], v[64:79]
 v_exp_f32 v161, v161
 v_cvt_pk_bf16_f32 v199, v158, v159
 v_exp_f32 v162, v162
 v_exp_f32 v163, v163
 v_mfma_f32_32x32x16_bf16 v[80:95], v[224:227], v[184:187], v[80:95]
 v_cvt_pk_bf16_f32 v200, v160, v161
 v_exp_f32 v164, v164
 v_exp_f32 v165, v165
 v_mfma_f32_32x32x16_bf16 a[32:47], a[140:143], a[128:131], a[32:47]
 v_cvt_pk_bf16_f32 v201, v162, v163
 v_exp_f32 v166, v166
 v_exp_f32 v167, v167
 v_cvt_pk_bf16_f32 v202, v164, v165
 v_exp_f32 v168, v168
 v_mfma_f32_32x32x16_bf16 v[64:79], v[228:231], v[180:183], v[64:79]
 v_exp_f32 v169, v169
 v_cvt_pk_bf16_f32 v203, v166, v167
 v_exp_f32 v170, v170
 v_mfma_f32_32x32x16_bf16 v[80:95], v[228:231], v[188:191], v[80:95]
 v_exp_f32 v171, v171
 v_cvt_pk_bf16_f32 v204, v168, v169
 v_exp_f32 v172, v172
 v_exp_f32 v173, v173
 v_mfma_f32_32x32x16_bf16 a[48:63], a[140:143], a[132:135], a[48:63]
 buffer_load_dwordx4 a[128:131], v14, s[36:39], s63 offen offset:2048 sc1
 v_cvt_pk_bf16_f32 v205, v170, v171
 v_exp_f32 v174, v174
 v_exp_f32 v175, v175
 v_cvt_pk_bf16_f32 v206, v172, v173
 s_waitcnt lgkmcnt(0)
 v_cvt_pk_bf16_f32 v207, v174, v175
 v_mfma_f32_32x32x16_bf16 v[144:159], v[216:219], v[96:99], v[32:47]
 ds_read_b128 v[224:227], v12 offset:7680
 ds_read_b128 v[228:231], v12 offset:8320
 v_exp_f32 v112, v112
 v_exp_f32 v113, v113
 v_exp_f32 v114, v114
 v_exp_f32 v115, v115
 v_mfma_f32_32x32x16_bf16 v[160:175], v[216:219], v[104:107], v[48:63]
 buffer_load_dwordx4 a[132:135], v14, s[36:39], s64 offen offset:2048 sc1
 v_cvt_pk_bf16_f32 v176, v112, v113
 v_exp_f32 v116, v116
 v_exp_f32 v117, v117
 v_cvt_pk_bf16_f32 v177, v114, v115
 s_waitcnt vmcnt(26)
 v_mfma_f32_32x32x16_bf16 a[0:15], a[152:155], a[144:147], a[0:15]
 v_exp_f32 v118, v118
 v_exp_f32 v119, v119
 v_cvt_pk_bf16_f32 v178, v116, v117
 v_exp_f32 v120, v120
 v_mfma_f32_32x32x16_bf16 v[144:159], v[220:223], v[100:103], v[144:159]
 buffer_load_dwordx4 a[136:139], v14, s[36:39], s65 offen sc1
 v_exp_f32 v121, v121
 v_cvt_pk_bf16_f32 v179, v118, v119
 v_exp_f32 v122, v122
 v_exp_f32 v123, v123
 v_mfma_f32_32x32x16_bf16 v[160:175], v[220:223], v[108:111], v[160:175]
 v_cvt_pk_bf16_f32 v180, v120, v121
 v_exp_f32 v124, v124
 v_exp_f32 v125, v125
 v_mfma_f32_32x32x16_bf16 a[16:31], a[152:155], a[148:151], a[16:31]
 buffer_load_dwordx4 a[140:143], v14, s[36:39], s65 offen offset:1024 sc1
 s_add_u32 s65, s65, 18432
 v_cvt_pk_bf16_f32 v181, v122, v123
 v_exp_f32 v126, v126
 v_exp_f32 v127, v127
 v_cvt_pk_bf16_f32 v182, v124, v125
 v_exp_f32 v128, v128
 v_mfma_f32_32x32x16_bf16 v[64:79], v[232:235], v[192:195], v[64:79]
 v_exp_f32 v129, v129
 v_cvt_pk_bf16_f32 v183, v126, v127
 v_exp_f32 v130, v130
 v_exp_f32 v131, v131
 v_mfma_f32_32x32x16_bf16 v[80:95], v[232:235], v[200:203], v[80:95]
 v_cvt_pk_bf16_f32 v184, v128, v129
 v_exp_f32 v132, v132
 v_exp_f32 v133, v133
 v_mfma_f32_32x32x16_bf16 a[32:47], a[156:159], a[144:147], a[32:47]
 v_cvt_pk_bf16_f32 v185, v130, v131
 v_exp_f32 v134, v134
 v_exp_f32 v135, v135
 v_cvt_pk_bf16_f32 v186, v132, v133
 v_exp_f32 v136, v136
 v_mfma_f32_32x32x16_bf16 v[64:79], v[236:239], v[196:199], v[64:79]
 v_exp_f32 v137, v137
 v_cvt_pk_bf16_f32 v187, v134, v135
 v_exp_f32 v138, v138
 v_mfma_f32_32x32x16_bf16 v[80:95], v[236:239], v[204:207], v[80:95]
 v_exp_f32 v139, v139
 v_cvt_pk_bf16_f32 v188, v136, v137
 v_exp_f32 v140, v140
 v_exp_f32 v141, v141
 v_mfma_f32_32x32x16_bf16 a[48:63], a[156:159], a[148:151], a[48:63]
 buffer_load_dwordx4 a[144:147], v14, s[36:39], s63 offen offset:3072 sc1
 s_add_u32 s63, s63, 4096
 v_cvt_pk_bf16_f32 v189, v138, v139
 v_exp_f32 v142, v142
 v_exp_f32 v143, v143
 v_cvt_pk_bf16_f32 v190, v140, v141
 s_waitcnt lgkmcnt(0)
 v_cvt_pk_bf16_f32 v191, v142, v143
 v_mfma_f32_32x32x16_bf16 v[64:79], v[224:227], v[176:179], v[64:79]
 ds_read_b128 v[232:235], v12 offset:8960
 ds_read_b128 v[236:239], v12 offset:9600
 v_exp_f32 v144, v144
 v_exp_f32 v145, v145
 v_exp_f32 v146, v146
 v_exp_f32 v147, v147
 v_cvt_pk_bf16_f32 v192, v144, v145
 v_exp_f32 v148, v148
 s_waitcnt vmcnt(25)
 v_mfma_f32_32x32x16_bf16 a[0:15], a[168:171], a[160:163], a[0:15]
 buffer_load_dwordx4 a[148:151], v14, s[36:39], s64 offen offset:3072 sc1
 s_add_u32 s64, s64, 4096
 v_exp_f32 v149, v149
 v_cvt_pk_bf16_f32 v193, v146, v147
 v_exp_f32 v150, v150
 v_exp_f32 v151, v151
 v_cvt_pk_bf16_f32 v194, v148, v149
 v_exp_f32 v152, v152
 v_mfma_f32_32x32x16_bf16 v[80:95], v[224:227], v[184:187], v[80:95]
 buffer_load_dwordx4 a[152:155], v14, s[36:39], s65 offen sc1
 v_exp_f32 v153, v153
 v_cvt_pk_bf16_f32 v195, v150, v151
 v_exp_f32 v154, v154
 v_exp_f32 v155, v155
 v_cvt_pk_bf16_f32 v196, v152, v153
 v_exp_f32 v156, v156
 v_mfma_f32_32x32x16_bf16 a[16:31], a[168:171], a[164:167], a[16:31]
 buffer_load_dwordx4 a[156:159], v14, s[36:39], s65 offen offset:1024 sc1
 s_add_u32 s65, s65, 18432
 v_exp_f32 v157, v157
 v_cvt_pk_bf16_f32 v197, v154, v155
 v_exp_f32 v158, v158
 v_exp_f32 v159, v159
 v_cvt_pk_bf16_f32 v198, v156, v157
 v_exp_f32 v160, v160
 v_mfma_f32_32x32x16_bf16 v[64:79], v[228:231], v[180:183], v[64:79]
 v_exp_f32 v161, v161
 v_cvt_pk_bf16_f32 v199, v158, v159
 v_exp_f32 v162, v162
 v_exp_f32 v163, v163
 v_cvt_pk_bf16_f32 v200, v160, v161
 v_exp_f32 v164, v164
 v_mfma_f32_32x32x16_bf16 a[32:47], a[172:175], a[160:163], a[32:47]
 v_exp_f32 v165, v165
 v_cvt_pk_bf16_f32 v201, v162, v163
 v_exp_f32 v166, v166
 v_exp_f32 v167, v167
 v_cvt_pk_bf16_f32 v202, v164, v165
 v_exp_f32 v168, v168
 v_mfma_f32_32x32x16_bf16 v[80:95], v[228:231], v[188:191], v[80:95]
 v_exp_f32 v169, v169
 v_cvt_pk_bf16_f32 v203, v166, v167
 v_exp_f32 v170, v170
 v_exp_f32 v171, v171
 v_cvt_pk_bf16_f32 v204, v168, v169
 v_exp_f32 v172, v172
 v_mfma_f32_32x32x16_bf16 a[48:63], a[172:175], a[164:167], a[48:63]
 buffer_load_dwordx4 a[160:163], v14, s[36:39], s63 offen sc1
 v_exp_f32 v173, v173
 v_cvt_pk_bf16_f32 v205, v170, v171
 v_exp_f32 v174, v174
 v_exp_f32 v175, v175
 v_cvt_pk_bf16_f32 v206, v172, v173
 s_waitcnt lgkmcnt(0)
 v_cvt_pk_bf16_f32 v207, v174, v175
 v_mfma_f32_32x32x16_bf16 v[64:79], v[232:235], v[192:195], v[64:79]
 buffer_load_dwordx4 a[164:167], v14, s[36:39], s64 offen sc1
 v_mfma_f32_32x32x16_bf16 v[80:95], v[232:235], v[200:203], v[80:95]
 buffer_load_dwordx4 a[168:171], v14, s[36:39], s65 offen sc1
 v_mfma_f32_32x32x16_bf16 v[64:79], v[236:239], v[196:199], v[64:79]
 buffer_load_dwordx4 a[172:175], v14, s[36:39], s65 offen offset:1024 sc1
 s_add_u32 s65, s65, 18432
 v_mfma_f32_32x32x16_bf16 v[80:95], v[236:239], v[204:207], v[80:95]
 s_nop 10
 v_mov_b32 v16, v74
 v_mov_b32 v8, v74
 v_mov_b32 v17, v90
 v_mov_b32 v9, v90
 s_nop 1
 v_permlane32_swap_b32 v16, v8
 v_permlane32_swap_b32 v17, v9
 s_nop 1
 s_mov_b32 s52, 0x4e800000
 v_cmp_nge_f32 vcc, s52, v16
 v_cmp_nge_f32 s[70:71], s52, v17
 s_mov_b32 s66, 2
 s_or_b64 vcc, vcc, s[70:71]
 s_cbranch_vccnz L_a_slow
L_a_epi_d:
 v_rcp_f32 v16, v16
 v_rcp_f32 v17, v17
 s_mul_i32 s52, s59, 36864
 s_add_u32 s52, s52, 61865984
 s_lshl_b32 s53, s31, 10
 s_add_u32 s54, s52, s53
 s_lshr_b32 s53, s31, 3
 s_add_u32 s53, s53, 32
 s_lshl_b32 s53, s53, 10
 s_add_u32 s55, s52, s53
 s_bfe_u32 s53, s31, 65538
 s_lshl_b32 s53, s53, 9
 s_add_u32 s55, s55, s53
 s_and_b32 s53, s31, 3
 s_lshl_b32 s53, s53, 2
 s_add_u32 s55, s55, s53
 v_lshlrev_b32 v4, 4, v2
 v_lshlrev_b32 v5, 31, v3
 v_or_b32 v5, v5, v4
 v_mul_f32 v64, v64, v16
 v_mul_f32 v65, v65, v16
 v_mul_f32 v66, v66, v16
 v_mul_f32 v67, v67, v16
 v_mul_f32 v68, v68, v16
 v_mul_f32 v69, v69, v16
 v_mul_f32 v70, v70, v16
 v_mul_f32 v71, v71, v16
 v_mul_f32 v72, v72, v16
 v_mul_f32 v73, v73, v16
 v_cvt_pk_bf16_f32 v64, v64, v65
 v_cvt_pk_bf16_f32 v65, v66, v67
 v_cvt_pk_bf16_f32 v66, v68, v69
 v_cvt_pk_bf16_f32 v67, v70, v71
 v_cvt_pk_bf16_f32 v68, v72, v73
 buffer_store_dwordx4 v[64:67], v14, s[36:39], s54 offen sc1
 buffer_store_dword v68, v5, s[36:39], s55 offen sc1
 s_add_u32 s54, s54, 36864
 s_add_u32 s55, s55, 36864
 v_mul_f32 v80, v80, v17
 v_mul_f32 v81, v81, v17
 v_mul_f32 v82, v82, v17
 v_mul_f32 v83, v83, v17
 v_mul_f32 v84, v84, v17
 v_mul_f32 v85, v85, v17
 v_mul_f32 v86, v86, v17
 v_mul_f32 v87, v87, v17
 v_mul_f32 v88, v88, v17
 v_mul_f32 v89, v89, v17
 v_cvt_pk_bf16_f32 v80, v80, v81
 v_cvt_pk_bf16_f32 v81, v82, v83
 v_cvt_pk_bf16_f32 v82, v84, v85
 v_cvt_pk_bf16_f32 v83, v86, v87
 v_cvt_pk_bf16_f32 v84, v88, v89
 buffer_store_dwordx4 v[80:83], v14, s[36:39], s54 offen sc1
 buffer_store_dword v84, v5, s[36:39], s55 offen sc1
 v_mov_b32 v8, s69
 v_mov_b32 v9, 1
 s_cmp_ge_u32 s68, 6
 s_cbranch_scc1 L_tail_d3
 s_lshl_b32 s34, s68, 1
 s_lshr_b32 s52, s28, 1
 s_mul_i32 s60, s52, 331776
 s_lshl_b32 s53, s34, 10
 s_add_u32 s60, s60, s53
 s_add_u32 s60, s60, 69730304
 s_waitcnt vmcnt(32)
 v_mfma_f32_32x32x16_bf16 a[0:15], a[184:187], a[176:179], a[0:15]
 v_mfma_f32_32x32x16_bf16 a[16:31], a[184:187], a[180:183], a[16:31]
 v_mfma_f32_32x32x16_bf16 a[32:47], a[188:191], a[176:179], a[32:47]
 v_mfma_f32_32x32x16_bf16 a[48:63], a[188:191], a[180:183], a[48:63]
 s_waitcnt vmcnt(28)
 v_mfma_f32_32x32x16_bf16 a[0:15], a[200:203], a[192:195], a[0:15]
 buffer_load_dwordx4 a[176:179], v14, s[36:39], s63 offen offset:1024 sc1
 v_mfma_f32_32x32x16_bf16 a[16:31], a[200:203], a[196:199], a[16:31]
 buffer_load_dwordx4 a[180:183], v14, s[36:39], s64 offen offset:1024 sc1
 v_mfma_f32_32x32x16_bf16 a[32:47], a[204:207], a[192:195], a[32:47]
 buffer_load_dwordx4 a[184:187], v14, s[36:39], s65 offen sc1
 v_mfma_f32_32x32x16_bf16 a[48:63], a[204:207], a[196:199], a[48:63]
 buffer_load_dwordx4 a[188:191], v14, s[36:39], s65 offen offset:1024 sc1
 s_add_u32 s65, s65, 18432
 s_waitcnt vmcnt(28)
 v_mfma_f32_32x32x16_bf16 a[0:15], a[216:219], a[208:211], a[0:15]
 buffer_load_dwordx4 a[192:195], v14, s[36:39], s63 offen offset:2048 sc1
 v_mfma_f32_32x32x16_bf16 a[16:31], a[216:219], a[212:215], a[16:31]
 buffer_load_dwordx4 a[196:199], v14, s[36:39], s64 offen offset:2048 sc1
 v_mfma_f32_32x32x16_bf16 a[32:47], a[220:223], a[208:211], a[32:47]
 buffer_load_dwordx4 a[200:203], v14, s[36:39], s65 offen sc1
 v_mfma_f32_32x32x16_bf16 a[48:63], a[220:223], a[212:215], a[48:63]
 buffer_load_dwordx4 a[204:207], v14, s[36:39], s65 offen offset:1024 sc1
 s_add_u32 s65, s65, 18432
 s_waitcnt vmcnt(28)
 v_mfma_f32_32x32x16_bf16 a[0:15], a[104:107], a[96:99], a[0:15]
 buffer_load_dwordx4 a[208:211], v14, s[36:39], s63 offen offset:3072 sc1
 s_add_u32 s63, s63, 4096
 v_mfma_f32_32x32x16_bf16 a[16:31], a[104:107], a[100:103], a[16:31]
 buffer_load_dwordx4 a[212:215], v14, s[36:39], s64 offen offset:3072 sc1
 s_add_u32 s64, s64, 4096
 v_mfma_f32_32x32x16_bf16 a[32:47], a[108:111], a[96:99], a[32:47]
 buffer_load_dwordx4 a[216:219], v14, s[36:39], s65 offen sc1
 v_mfma_f32_32x32x16_bf16 a[48:63], a[108:111], a[100:103], a[48:63]
 buffer_load_dwordx4 a[220:223], v14, s[36:39], s65 offen offset:1024 sc1
 s_add_u32 s65, s65, 18432
 s_waitcnt vmcnt(28)
 v_mfma_f32_32x32x16_bf16 a[0:15], a[120:123], a[112:115], a[0:15]
 v_mfma_f32_32x32x16_bf16 a[16:31], a[120:123], a[116:119], a[16:31]
 buffer_load_dwordx4 v[32:35], v14, s[36:39], s60 offen sc1
 v_mfma_f32_32x32x16_bf16 a[32:47], a[124:127], a[112:115], a[32:47]
 v_mfma_f32_32x32x16_bf16 a[48:63], a[124:127], a[116:119], a[48:63]
 buffer_load_dwordx4 v[36:39], v14, s[36:39], s60 offen offset:1024 sc1
 s_add_u32 s60, s60, 18432
 s_waitcnt vmcnt(26)
 s_waitcnt vmcnt(14)
 s_barrier
 s_mov_b64 exec, 1
 buffer_store_dword v9, v8, s[36:39], s67 offen offset:1024 sc1
 s_mov_b64 exec, -1
 v_mfma_f32_32x32x16_bf16 a[0:15], a[136:139], a[128:131], a[0:15]
 v_mfma_f32_32x32x16_bf16 a[16:31], a[136:139], a[132:135], a[16:31]
 buffer_load_dwordx4 v[40:43], v14, s[36:39], s60 offen sc1
 v_mfma_f32_32x32x16_bf16 a[32:47], a[140:143], a[128:131], a[32:47]
 v_mfma_f32_32x32x16_bf16 a[48:63], a[140:143], a[132:135], a[48:63]
 buffer_load_dwordx4 v[44:47], v14, s[36:39], s60 offen offset:1024 sc1
 s_add_u32 s60, s60, 18432
 s_waitcnt vmcnt(25)
 v_mfma_f32_32x32x16_bf16 a[0:15], a[152:155], a[144:147], a[0:15]
 v_mfma_f32_32x32x16_bf16 a[16:31], a[152:155], a[148:151], a[16:31]
 buffer_load_dwordx4 v[48:51], v14, s[36:39], s60 offen sc1
 v_mfma_f32_32x32x16_bf16 a[32:47], a[156:159], a[144:147], a[32:47]
 v_mfma_f32_32x32x16_bf16 a[48:63], a[156:159], a[148:151], a[48:63]
 buffer_load_dwordx4 v[52:55], v14, s[36:39], s60 offen offset:1024 sc1
 s_add_u32 s60, s60, 18432
 s_waitcnt vmcnt(23)
 v_mfma_f32_32x32x16_bf16 a[0:15], a[168:171], a[160:163], a[0:15]
 v_mfma_f32_32x32x16_bf16 a[16:31], a[168:171], a[164:167], a[16:31]
 buffer_load_dwordx4 v[56:59], v14, s[36:39], s60 offen sc1
 v_mfma_f32_32x32x16_bf16 a[32:47], a[172:175], a[160:163], a[32:47]
 v_mfma_f32_32x32x16_bf16 a[48:63], a[172:175], a[164:167], a[48:63]
 buffer_load_dwordx4 v[60:63], v14, s[36:39], s60 offen offset:1024 sc1
 s_add_u32 s60, s60, 18432
 s_waitcnt vmcnt(17)
 v_mfma_f32_32x32x16_bf16 a[0:15], a[184:187], a[176:179], a[0:15]
 v_mfma_f32_32x32x16_bf16 a[16:31], a[184:187], a[180:183], a[16:31]
 buffer_load_dwordx4 v[64:67], v14, s[36:39], s60 offen sc1
 v_mfma_f32_32x32x16_bf16 a[32:47], a[188:191], a[176:179], a[32:47]
 v_mfma_f32_32x32x16_bf16 a[48:63], a[188:191], a[180:183], a[48:63]
 buffer_load_dwordx4 v[68:71], v14, s[36:39], s60 offen offset:1024 sc1
 s_add_u32 s60, s60, 18432
 s_waitcnt vmcnt(15)
 v_mfma_f32_32x32x16_bf16 a[0:15], a[200:203], a[192:195], a[0:15]
 v_mfma_f32_32x32x16_bf16 a[16:31], a[200:203], a[196:199], a[16:31]
 buffer_load_dwordx4 v[72:75], v14, s[36:39], s60 offen sc1
 v_mfma_f32_32x32x16_bf16 a[32:47], a[204:207], a[192:195], a[32:47]
 v_mfma_f32_32x32x16_bf16 a[48:63], a[204:207], a[196:199], a[48:63]
 buffer_load_dwordx4 v[76:79], v14, s[36:39], s60 offen offset:1024 sc1
 s_add_u32 s60, s60, 18432
 s_waitcnt vmcnt(13)
 v_mfma_f32_32x32x16_bf16 a[0:15], a[216:219], a[208:211], a[0:15]
 v_mfma_f32_32x32x16_bf16 a[16:31], a[216:219], a[212:215], a[16:31]
 buffer_load_dwordx4 v[80:83], v14, s[36:39], s60 offen sc1
 v_mfma_f32_32x32x16_bf16 a[32:47], a[220:223], a[208:211], a[32:47]
 v_mfma_f32_32x32x16_bf16 a[48:63], a[220:223], a[212:215], a[48:63]
 buffer_load_dwordx4 v[84:87], v14, s[36:39], s60 offen offset:1024 sc1
 s_add_u32 s60, s60, 18432
 s_nop 3
 s_lshl_b32 s52, s28, 12
 s_add_u32 s52, s52, 61440
 v_add_u32 v6, s52, v14
 v_add_u32 v7, 65536, v6
 ds_write_b128 v6, a[0:3]
 buffer_load_dwordx4 v[88:91], v14, s[36:39], s60 offen sc1
 ds_write_b128 v6, a[4:7] offset:1024
 buffer_load_dwordx4 v[92:95], v14, s[36:39], s60 offen offset:1024 sc1
 s_add_u32 s60, s60, 18432
 ds_write_b128 v6, a[8:11] offset:2048
 buffer_load_dwordx4 v[96:99], v14, s[36:39], s60 offen sc1
 ds_write_b128 v6, a[12:15] offset:3072
 buffer_load_dwordx4 v[100:103], v14, s[36:39], s60 offen offset:1024 sc1
 s_add_u32 s60, s60, 18432
 ds_write_b128 v6, a[16:19] offset:16384
 buffer_load_dwordx4 v[104:107], v14, s[36:39], s60 offen sc1
 ds_write_b128 v6, a[20:23] offset:17408
 buffer_load_dwordx4 v[108:111], v14, s[36:39], s60 offen offset:1024 sc1
 s_add_u32 s60, s60, 18432
 ds_write_b128 v6, a[24:27] offset:18432
 buffer_load_dwordx4 a[224:227], v14, s[36:39], s60 offen sc1
 ds_write_b128 v6, a[28:31] offset:19456
 buffer_load_dwordx4 a[228:231], v14, s[36:39], s60 offen offset:1024 sc1
 s_add_u32 s60, s60, 18432
 ds_write_b128 v6, a[32:35] offset:32768
 buffer_load_dwordx4 a[232:235], v14, s[36:39], s60 offen sc1
 ds_write_b128 v6, a[36:39] offset:33792
 buffer_load_dwordx4 a[236:239], v14, s[36:39], s60 offen offset:1024 sc1
 s_add_u32 s60, s60, 18432
 ds_write_b128 v6, a[40:43] offset:34816
 buffer_load_dwordx4 a[240:243], v14, s[36:39], s60 offen sc1
 ds_write_b128 v6, a[44:47] offset:35840
 buffer_load_dwordx4 a[244:247], v14, s[36:39], s60 offen offset:1024 sc1
 s_add_u32 s60, s60, 18432
 ds_write_b128 v6, a[48:51] offset:49152
 buffer_load_dwordx4 a[248:251], v14, s[36:39], s60 offen sc1
 ds_write_b128 v6, a[52:55] offset:50176
 buffer_load_dwordx4 a[252:255], v14, s[36:39], s60 offen offset:1024 sc1
 s_add_u32 s60, s60, 18432
 ds_write_b128 v6, a[56:59] offset:51200
 buffer_load_dwordx4 a[96:99], v14, s[36:39], s60 offen sc1
 ds_write_b128 v6, a[60:63] offset:52224
 buffer_load_dwordx4 a[100:103], v14, s[36:39], s60 offen offset:1024 sc1
 s_add_u32 s60, s60, 18432
 buffer_load_dwordx4 a[104:107], v14, s[36:39], s60 offen sc1
 buffer_load_dwordx4 a[108:111], v14, s[36:39], s60 offen offset:1024 sc1
 s_add_u32 s60, s60, 18432
 buffer_load_dwordx4 a[112:115], v14, s[36:39], s60 offen sc1
 buffer_load_dwordx4 a[116:119], v14, s[36:39], s60 offen offset:1024 sc1
 s_add_u32 s60, s60, 18432
 buffer_load_dwordx4 a[120:123], v14, s[36:39], s60 offen sc1
 buffer_load_dwordx4 a[124:127], v14, s[36:39], s60 offen offset:1024 sc1
 s_add_u32 s60, s60, 18432
 s_and_b32 s52, s28, 1
 s_lshr_b32 s53, s28, 1
 s_lshl_b32 s54, s52, 14
 s_lshl_b32 s55, s53, 11
 s_add_u32 s54, s54, s55
 s_add_u32 s54, s54, 61440
 v_add_u32 v6, s54, v14
 v_add_u32 v7, 65536, v6
 s_add_u32 s52, s52, s61
 s_mul_i32 s52, s52, 73728
 s_lshl_b32 s53, s53, 5
 s_add_u32 s52, s52, s53
 s_lshl_b32 s53, s62, 6
 s_add_u32 s54, s52, s53
 v_mul_u32_u24 v4, 2304, v2
 v_lshl_add_u32 v4, v3, 4, v4
 buffer_load_dwordx4 v[240:243], v14, s[36:39], s67 offen offset:1024 sc1
 s_waitcnt lgkmcnt(0)
 s_barrier
 ds_read_b128 v[200:203], v6
 ds_read_b128 v[204:207], v6 offset:1024
 ds_read_b128 v[208:211], v6 offset:4096
 ds_read_b128 v[212:215], v6 offset:5120
 ds_read_b128 v[216:219], v6 offset:8192
 ds_read_b128 v[220:223], v6 offset:9216
 ds_read_b128 v[224:227], v6 offset:12288
 ds_read_b128 v[228:231], v6 offset:13312
 ds_read_b128 v[112:115], v6 offset:32768
 ds_read_b128 v[116:119], v6 offset:33792
 ds_read_b128 v[120:123], v6 offset:36864
 ds_read_b128 v[124:127], v6 offset:37888
 ds_read_b128 v[128:131], v6 offset:40960
 ds_read_b128 v[132:135], v6 offset:41984
 ds_read_b128 v[136:139], v6 offset:45056
 ds_read_b128 v[140:143], v6 offset:46080
 s_waitcnt lgkmcnt(8)
 v_pk_add_f32 v[200:201], v[200:201], v[208:209]
 v_pk_add_f32 v[216:217], v[216:217], v[224:225]
 v_pk_add_f32 v[202:203], v[202:203], v[210:211]
 v_pk_add_f32 v[218:219], v[218:219], v[226:227]
 v_pk_add_f32 v[204:205], v[204:205], v[212:213]
 v_pk_add_f32 v[220:221], v[220:221], v[228:229]
 v_pk_add_f32 v[206:207], v[206:207], v[214:215]
 v_pk_add_f32 v[222:223], v[222:223], v[230:231]
 v_pk_add_f32 v[200:201], v[200:201], v[216:217]
 v_pk_add_f32 v[202:203], v[202:203], v[218:219]
 v_pk_add_f32 v[204:205], v[204:205], v[220:221]
 v_pk_add_f32 v[206:207], v[206:207], v[222:223]
 v_cvt_pk_bf16_f32 v232, v200, v201
 v_cvt_pk_bf16_f32 v233, v202, v203
 v_cvt_pk_bf16_f32 v234, v204, v205
 v_cvt_pk_bf16_f32 v235, v206, v207
 s_nop 1
 v_permlane32_swap_b32 v232, v234
 v_permlane32_swap_b32 v233, v235
 buffer_store_dwordx4 v[232:235], v4, s[40:43], s54 offen offset:1152
 s_waitcnt lgkmcnt(0)
 v_pk_add_f32 v[112:113], v[112:113], v[120:121]
 v_pk_add_f32 v[128:129], v[128:129], v[136:137]
 v_pk_add_f32 v[114:115], v[114:115], v[122:123]
 v_pk_add_f32 v[130:131], v[130:131], v[138:139]
 v_pk_add_f32 v[116:117], v[116:117], v[124:125]
 v_pk_add_f32 v[132:133], v[132:133], v[140:141]
 v_pk_add_f32 v[118:119], v[118:119], v[126:127]
 v_pk_add_f32 v[134:135], v[134:135], v[142:143]
 v_pk_add_f32 v[112:113], v[112:113], v[128:129]
 v_pk_add_f32 v[114:115], v[114:115], v[130:131]
 v_pk_add_f32 v[116:117], v[116:117], v[132:133]
 v_pk_add_f32 v[118:119], v[118:119], v[134:135]
 v_cvt_pk_bf16_f32 v236, v112, v113
 v_cvt_pk_bf16_f32 v237, v114, v115
 v_cvt_pk_bf16_f32 v238, v116, v117
 v_cvt_pk_bf16_f32 v239, v118, v119
 s_nop 1
 v_permlane32_swap_b32 v236, v238
 v_permlane32_swap_b32 v237, v239
 buffer_store_dwordx4 v[236:239], v4, s[40:43], s54 offen offset:1216
 s_and_b32 s52, s28, 1
 s_add_u32 s52, s52, s61
 s_mul_i32 s63, s52, 36864
 s_lshr_b32 s53, s28, 1
 s_mul_i32 s53, s53, 18432
 s_add_u32 s63, s63, s53
 s_add_u32 s63, s63, 61865984
 s_waitcnt vmcnt(2)
 v_and_b32 v240, v240, v241
 v_and_b32 v242, v242, v243
 v_and_b32 v240, v240, v242
 v_cmp_ne_u32 vcc, 1, v240
 s_cmp_lg_u64 vcc, 0
 s_cbranch_scc1 L_faspin_d2
L_faok_d2:
 buffer_load_dwordx4 v[112:115], v14, s[36:39], s63 offen sc1
 buffer_load_dwordx4 v[116:119], v14, s[36:39], s63 offen offset:1024 sc1
 buffer_load_dwordx4 v[120:123], v14, s[36:39], s63 offen offset:2048 sc1
 buffer_load_dwordx4 v[124:127], v14, s[36:39], s63 offen offset:3072 sc1
 s_add_u32 s63, s63, 4096
 buffer_load_dwordx4 v[128:131], v14, s[36:39], s63 offen sc1
 buffer_load_dwordx4 v[132:135], v14, s[36:39], s63 offen offset:1024 sc1
 buffer_load_dwordx4 v[136:139], v14, s[36:39], s63 offen offset:2048 sc1
 buffer_load_dwordx4 v[140:143], v14, s[36:39], s63 offen offset:3072 sc1
 s_add_u32 s63, s63, 4096
 buffer_load_dwordx4 v[144:147], v14, s[36:39], s63 offen sc1
 buffer_load_dwordx4 v[148:151], v14, s[36:39], s63 offen offset:1024 sc1
 buffer_load_dwordx4 v[152:155], v14, s[36:39], s63 offen offset:2048 sc1
 buffer_load_dwordx4 v[156:159], v14, s[36:39], s63 offen offset:3072 sc1
 s_add_u32 s63, s63, 4096
 buffer_load_dwordx4 v[160:163], v14, s[36:39], s63 offen sc1
 buffer_load_dwordx4 v[164:167], v14, s[36:39], s63 offen offset:1024 sc1
 buffer_load_dwordx4 v[168:171], v14, s[36:39], s63 offen offset:2048 sc1
 buffer_load_dwordx4 v[172:175], v14, s[36:39], s63 offen offset:3072 sc1
 s_add_u32 s63, s63, 4096
 buffer_load_dwordx4 v[176:179], v14, s[36:39], s63 offen sc1
 buffer_load_dwordx4 v[180:183], v14, s[36:39], s63 offen offset:1024 sc1
 s_lshl_b32 s54, s28, 13
 v_add_u32 v6, s54, v14
 s_xor_b32 s54, s54, 16384
 v_add_u32 v7, s54, v14
 s_mul_i32 s52, s52, 73728
 s_lshr_b32 s53, s28, 1
 s_lshl_b32 s53, s53, 5
 s_add_u32 s52, s52, s53
 s_lshl_b32 s53, s34, 6
 s_add_u32 s54, s52, s53
 s_waitcnt vmcnt(16)
 v_mfma_f32_32x32x16_bf16 v[184:199], v[32:35], v[112:115], 0
 v_mfma_f32_32x32x16_bf16 v[200:215], v[36:39], v[112:115], 0
 v_mfma_f32_32x32x16_bf16 v[184:199], v[40:43], v[116:119], v[184:199]
 v_mfma_f32_32x32x16_bf16 v[200:215], v[44:47], v[116:119], v[200:215]
 s_waitcnt vmcnt(14)
 v_mfma_f32_32x32x16_bf16 v[184:199], v[48:51], v[120:123], v[184:199]
 v_mfma_f32_32x32x16_bf16 v[200:215], v[52:55], v[120:123], v[200:215]
 v_mfma_f32_32x32x16_bf16 v[184:199], v[56:59], v[124:127], v[184:199]
 v_mfma_f32_32x32x16_bf16 v[200:215], v[60:63], v[124:127], v[200:215]
 s_waitcnt vmcnt(12)
 v_mfma_f32_32x32x16_bf16 v[184:199], v[64:67], v[128:131], v[184:199]
 v_mfma_f32_32x32x16_bf16 v[200:215], v[68:71], v[128:131], v[200:215]
 v_mfma_f32_32x32x16_bf16 v[184:199], v[72:75], v[132:135], v[184:199]
 v_mfma_f32_32x32x16_bf16 v[200:215], v[76:79], v[132:135], v[200:215]
 s_waitcnt vmcnt(10)
 v_mfma_f32_32x32x16_bf16 v[184:199], v[80:83], v[136:139], v[184:199]
 v_mfma_f32_32x32x16_bf16 v[200:215], v[84:87], v[136:139], v[200:215]
 v_mfma_f32_32x32x16_bf16 v[184:199], v[88:91], v[140:143], v[184:199]
 v_mfma_f32_32x32x16_bf16 v[200:215], v[92:95], v[140:143], v[200:215]
 s_waitcnt vmcnt(8)
 v_mfma_f32_32x32x16_bf16 v[184:199], v[96:99], v[144:147], v[184:199]
 v_mfma_f32_32x32x16_bf16 v[200:215], v[100:103], v[144:147], v[200:215]
 v_mfma_f32_32x32x16_bf16 v[184:199], v[104:107], v[148:151], v[184:199]
 v_mfma_f32_32x32x16_bf16 v[200:215], v[108:111], v[148:151], v[200:215]
 s_waitcnt vmcnt(6)
 v_mfma_f32_32x32x16_bf16 v[184:199], a[224:227], v[152:155], v[184:199]
 v_mfma_f32_32x32x16_bf16 v[200:215], a[228:231], v[152:155], v[200:215]
 v_mfma_f32_32x32x16_bf16 v[184:199], a[232:235], v[156:159], v[184:199]
 v_mfma_f32_32x32x16_bf16 v[200:215], a[236:239], v[156:159], v[200:215]
 s_waitcnt vmcnt(4)
 v_mfma_f32_32x32x16_bf16 v[184:199], a[240:243], v[160:163], v[184:199]
 v_mfma_f32_32x32x16_bf16 v[200:215], a[244:247], v[160:163], v[200:215]
 v_mfma_f32_32x32x16_bf16 v[184:199], a[248:251], v[164:167], v[184:199]
 v_mfma_f32_32x32x16_bf16 v[200:215], a[252:255], v[164:167], v[200:215]
 s_waitcnt vmcnt(2)
 v_mfma_f32_32x32x16_bf16 v[184:199], a[96:99], v[168:171], v[184:199]
 v_mfma_f32_32x32x16_bf16 v[200:215], a[100:103], v[168:171], v[200:215]
 v_mfma_f32_32x32x16_bf16 v[184:199], a[104:107], v[172:175], v[184:199]
 v_mfma_f32_32x32x16_bf16 v[200:215], a[108:111], v[172:175], v[200:215]
 s_waitcnt vmcnt(0)
 v_mfma_f32_32x32x16_bf16 v[184:199], a[112:115], v[176:179], v[184:199]
 v_mfma_f32_32x32x16_bf16 v[200:215], a[116:119], v[176:179], v[200:215]
 v_mfma_f32_32x32x16_bf16 v[184:199], a[120:123], v[180:183], v[184:199]
 v_mfma_f32_32x32x16_bf16 v[200:215], a[124:127], v[180:183], v[200:215]
 s_cmp_ge_u32 s28, 2
 s_nop 9
 s_cbranch_scc1 L_x1_d2
 ds_write_b128 v6, v[192:195]
 ds_write_b128 v6, v[196:199] offset:1024
 ds_write_b128 v6, v[208:211] offset:2048
 ds_write_b128 v6, v[212:215] offset:3072
 s_waitcnt lgkmcnt(0)
 s_barrier
 ds_read_b128 v[112:115], v7
 ds_read_b128 v[116:119], v7 offset:1024
 ds_read_b128 v[120:123], v7 offset:2048
 ds_read_b128 v[124:127], v7 offset:3072
 s_waitcnt lgkmcnt(2)
 v_pk_add_f32 v[184:185], v[184:185], v[112:113]
 v_pk_add_f32 v[186:187], v[186:187], v[114:115]
 v_pk_add_f32 v[188:189], v[188:189], v[116:117]
 v_pk_add_f32 v[190:191], v[190:191], v[118:119]
 v_cvt_pk_bf16_f32 v144, v184, v185
 v_cvt_pk_bf16_f32 v145, v186, v187
 v_cvt_pk_bf16_f32 v146, v188, v189
 v_cvt_pk_bf16_f32 v147, v190, v191
 s_nop 1
 v_permlane32_swap_b32 v144, v146
 v_permlane32_swap_b32 v145, v147
 buffer_store_dwordx4 v[144:147], v4, s[40:43], s54 offen
 s_waitcnt lgkmcnt(0)
 v_pk_add_f32 v[200:201], v[200:201], v[120:121]
 v_pk_add_f32 v[202:203], v[202:203], v[122:123]
 v_pk_add_f32 v[204:205], v[204:205], v[124:125]
 v_pk_add_f32 v[206:207], v[206:207], v[126:127]
 v_cvt_pk_bf16_f32 v148, v200, v201
 v_cvt_pk_bf16_f32 v149, v202, v203
 v_cvt_pk_bf16_f32 v150, v204, v205
 v_cvt_pk_bf16_f32 v151, v206, v207
 s_nop 1
 v_permlane32_swap_b32 v148, v150
 v_permlane32_swap_b32 v149, v151
 buffer_store_dwordx4 v[148:151], v4, s[40:43], s54 offen offset:64
 s_branch L_fin
L_x1_d2:
 ds_write_b128 v6, v[184:187]
 ds_write_b128 v6, v[188:191] offset:1024
 ds_write_b128 v6, v[200:203] offset:2048
 ds_write_b128 v6, v[204:207] offset:3072
 s_waitcnt lgkmcnt(0)
 s_barrier
 ds_read_b128 v[112:115], v7
 ds_read_b128 v[116:119], v7 offset:1024
 ds_read_b128 v[120:123], v7 offset:2048
 ds_read_b128 v[124:127], v7 offset:3072
 s_waitcnt lgkmcnt(2)
 v_pk_add_f32 v[192:193], v[192:193], v[112:113]
 v_pk_add_f32 v[194:195], v[194:195], v[114:115]
 v_pk_add_f32 v[196:197], v[196:197], v[116:117]
 v_pk_add_f32 v[198:199], v[198:199], v[118:119]
 v_cvt_pk_bf16_f32 v144, v192, v193
 v_cvt_pk_bf16_f32 v145, v194, v195
 v_cvt_pk_bf16_f32 v146, v196, v197
 v_cvt_pk_bf16_f32 v147, v198, v199
 s_nop 1
 v_permlane32_swap_b32 v144, v146
 v_permlane32_swap_b32 v145, v147
 buffer_store_dwordx4 v[144:147], v4, s[40:43], s54 offen
 s_waitcnt lgkmcnt(0)
 v_pk_add_f32 v[208:209], v[208:209], v[120:121]
 v_pk_add_f32 v[210:211], v[210:211], v[122:123]
 v_pk_add_f32 v[212:213], v[212:213], v[124:125]
 v_pk_add_f32 v[214:215], v[214:215], v[126:127]
 v_cvt_pk_bf16_f32 v148, v208, v209
 v_cvt_pk_bf16_f32 v149, v210, v211
 v_cvt_pk_bf16_f32 v150, v212, v213
 v_cvt_pk_bf16_f32 v151, v214, v215
 s_nop 1
 v_permlane32_swap_b32 v148, v150
 v_permlane32_swap_b32 v149, v151
 buffer_store_dwordx4 v[148:151], v4, s[40:43], s54 offen offset:64
 s_branch L_fin
L_tail_d3:
 s_mul_i32 s34, s68, 3
 s_sub_u32 s34, s34, 6
 s_lshr_b32 s52, s28, 1
 s_mul_i32 s60, s52, 331776
 s_lshl_b32 s53, s34, 10
 s_add_u32 s60, s60, s53
 s_add_u32 s60, s60, 69730304
 s_waitcnt vmcnt(32)
 v_mfma_f32_32x32x16_bf16 a[0:15], a[184:187], a[176:179], a[0:15]
 v_mfma_f32_32x32x16_bf16 a[16:31], a[184:187], a[180:183], a[16:31]
 v_mfma_f32_32x32x16_bf16 a[32:47], a[188:191], a[176:179], a[32:47]
 v_mfma_f32_32x32x16_bf16 a[48:63], a[188:191], a[180:183], a[48:63]
 s_waitcnt vmcnt(28)
 v_mfma_f32_32x32x16_bf16 a[0:15], a[200:203], a[192:195], a[0:15]
 buffer_load_dwordx4 a[176:179], v14, s[36:39], s63 offen offset:1024 sc1
 v_mfma_f32_32x32x16_bf16 a[16:31], a[200:203], a[196:199], a[16:31]
 buffer_load_dwordx4 a[180:183], v14, s[36:39], s64 offen offset:1024 sc1
 v_mfma_f32_32x32x16_bf16 a[32:47], a[204:207], a[192:195], a[32:47]
 buffer_load_dwordx4 a[184:187], v14, s[36:39], s65 offen sc1
 v_mfma_f32_32x32x16_bf16 a[48:63], a[204:207], a[196:199], a[48:63]
 buffer_load_dwordx4 a[188:191], v14, s[36:39], s65 offen offset:1024 sc1
 s_add_u32 s65, s65, 18432
 s_waitcnt vmcnt(28)
 v_mfma_f32_32x32x16_bf16 a[0:15], a[216:219], a[208:211], a[0:15]
 buffer_load_dwordx4 a[192:195], v14, s[36:39], s63 offen offset:2048 sc1
 v_mfma_f32_32x32x16_bf16 a[16:31], a[216:219], a[212:215], a[16:31]
 buffer_load_dwordx4 a[196:199], v14, s[36:39], s64 offen offset:2048 sc1
 v_mfma_f32_32x32x16_bf16 a[32:47], a[220:223], a[208:211], a[32:47]
 buffer_load_dwordx4 a[200:203], v14, s[36:39], s65 offen sc1
 v_mfma_f32_32x32x16_bf16 a[48:63], a[220:223], a[212:215], a[48:63]
 buffer_load_dwordx4 a[204:207], v14, s[36:39], s65 offen offset:1024 sc1
 s_add_u32 s65, s65, 18432
 s_waitcnt vmcnt(28)
 v_mfma_f32_32x32x16_bf16 a[0:15], a[104:107], a[96:99], a[0:15]
 buffer_load_dwordx4 a[208:211], v14, s[36:39], s63 offen offset:3072 sc1
 s_add_u32 s63, s63, 4096
 v_mfma_f32_32x32x16_bf16 a[16:31], a[104:107], a[100:103], a[16:31]
 buffer_load_dwordx4 a[212:215], v14, s[36:39], s64 offen offset:3072 sc1
 s_add_u32 s64, s64, 4096
 v_mfma_f32_32x32x16_bf16 a[32:47], a[108:111], a[96:99], a[32:47]
 buffer_load_dwordx4 a[216:219], v14, s[36:39], s65 offen sc1
 v_mfma_f32_32x32x16_bf16 a[48:63], a[108:111], a[100:103], a[48:63]
 buffer_load_dwordx4 a[220:223], v14, s[36:39], s65 offen offset:1024 sc1
 s_add_u32 s65, s65, 18432
 s_waitcnt vmcnt(28)
 v_mfma_f32_32x32x16_bf16 a[0:15], a[120:123], a[112:115], a[0:15]
 v_mfma_f32_32x32x16_bf16 a[16:31], a[120:123], a[116:119], a[16:31]
 buffer_load_dwordx4 v[32:35], v14, s[36:39], s60 offen sc1
 v_mfma_f32_32x32x16_bf16 a[32:47], a[124:127], a[112:115], a[32:47]
 v_mfma_f32_32x32x16_bf16 a[48:63], a[124:127], a[116:119], a[48:63]
 buffer_load_dwordx4 v[36:39], v14, s[36:39], s60 offen offset:1024 sc1
 s_waitcnt vmcnt(26)
 s_waitcnt vmcnt(14)
 s_barrier
 s_mov_b64 exec, 1
 buffer_store_dword v9, v8, s[36:39], s67 offen offset:1024 sc1
 s_mov_b64 exec, -1
 v_mfma_f32_32x32x16_bf16 a[0:15], a[136:139], a[128:131], a[0:15]
 v_mfma_f32_32x32x16_bf16 a[16:31], a[136:139], a[132:135], a[16:31]
 buffer_load_dwordx4 v[40:43], v14, s[36:39], s60 offen offset:2048 sc1
 s_add_u32 s60, s60, 18432
 v_mfma_f32_32x32x16_bf16 a[32:47], a[140:143], a[128:131], a[32:47]
 v_mfma_f32_32x32x16_bf16 a[48:63], a[140:143], a[132:135], a[48:63]
 buffer_load_dwordx4 v[44:47], v14, s[36:39], s60 offen sc1
 s_waitcnt vmcnt(25)
 v_mfma_f32_32x32x16_bf16 a[0:15], a[152:155], a[144:147], a[0:15]
 v_mfma_f32_32x32x16_bf16 a[16:31], a[152:155], a[148:151], a[16:31]
 buffer_load_dwordx4 v[48:51], v14, s[36:39], s60 offen offset:1024 sc1
 v_mfma_f32_32x32x16_bf16 a[32:47], a[156:159], a[144:147], a[32:47]
 v_mfma_f32_32x32x16_bf16 a[48:63], a[156:159], a[148:151], a[48:63]
 buffer_load_dwordx4 v[52:55], v14, s[36:39], s60 offen offset:2048 sc1
 s_add_u32 s60, s60, 18432
 s_waitcnt vmcnt(23)
 v_mfma_f32_32x32x16_bf16 a[0:15], a[168:171], a[160:163], a[0:15]
 v_mfma_f32_32x32x16_bf16 a[16:31], a[168:171], a[164:167], a[16:31]
 buffer_load_dwordx4 v[56:59], v14, s[36:39], s60 offen sc1
 v_mfma_f32_32x32x16_bf16 a[32:47], a[172:175], a[160:163], a[32:47]
 v_mfma_f32_32x32x16_bf16 a[48:63], a[172:175], a[164:167], a[48:63]
 buffer_load_dwordx4 v[60:63], v14, s[36:39], s60 offen offset:1024 sc1
 s_waitcnt vmcnt(17)
 v_mfma_f32_32x32x16_bf16 a[0:15], a[184:187], a[176:179], a[0:15]
 v_mfma_f32_32x32x16_bf16 a[16:31], a[184:187], a[180:183], a[16:31]
 buffer_load_dwordx4 v[64:67], v14, s[36:39], s60 offen offset:2048 sc1
 s_add_u32 s60, s60, 18432
 v_mfma_f32_32x32x16_bf16 a[32:47], a[188:191], a[176:179], a[32:47]
 v_mfma_f32_32x32x16_bf16 a[48:63], a[188:191], a[180:183], a[48:63]
 buffer_load_dwordx4 v[68:71], v14, s[36:39], s60 offen sc1
 s_waitcnt vmcnt(15)
 v_mfma_f32_32x32x16_bf16 a[0:15], a[200:203], a[192:195], a[0:15]
 v_mfma_f32_32x32x16_bf16 a[16:31], a[200:203], a[196:199], a[16:31]
 buffer_load_dwordx4 v[72:75], v14, s[36:39], s60 offen offset:1024 sc1
 v_mfma_f32_32x32x16_bf16 a[32:47], a[204:207], a[192:195], a[32:47]
 v_mfma_f32_32x32x16_bf16 a[48:63], a[204:207], a[196:199], a[48:63]
 buffer_load_dwordx4 v[76:79], v14, s[36:39], s60 offen offset:2048 sc1
 s_add_u32 s60, s60, 18432
 s_waitcnt vmcnt(13)
 v_mfma_f32_32x32x16_bf16 a[0:15], a[216:219], a[208:211], a[0:15]
 v_mfma_f32_32x32x16_bf16 a[16:31], a[216:219], a[212:215], a[16:31]
 buffer_load_dwordx4 v[80:83], v14, s[36:39], s60 offen sc1
 v_mfma_f32_32x32x16_bf16 a[32:47], a[220:223], a[208:211], a[32:47]
 v_mfma_f32_32x32x16_bf16 a[48:63], a[220:223], a[212:215], a[48:63]
 buffer_load_dwordx4 v[84:87], v14, s[36:39], s60 offen offset:1024 sc1
 s_nop 3
 s_lshl_b32 s52, s28, 12
 s_add_u32 s52, s52, 61440
 v_add_u32 v6, s52, v14
 v_add_u32 v7, 65536, v6
 ds_write_b128 v6, a[0:3]
 buffer_load_dwordx4 v[88:91], v14, s[36:39], s60 offen offset:2048 sc1
 s_add_u32 s60, s60, 18432
 ds_write_b128 v6, a[4:7] offset:1024
 buffer_load_dwordx4 v[92:95], v14, s[36:39], s60 offen sc1
 ds_write_b128 v6, a[8:11] offset:2048
 buffer_load_dwordx4 v[96:99], v14, s[36:39], s60 offen offset:1024 sc1
 ds_write_b128 v6, a[12:15] offset:3072
 buffer_load_dwordx4 v[100:103], v14, s[36:39], s60 offen offset:2048 sc1
 s_add_u32 s60, s60, 18432
 ds_write_b128 v6, a[16:19] offset:16384
 buffer_load_dwordx4 v[104:107], v14, s[36:39], s60 offen sc1
 ds_write_b128 v6, a[20:23] offset:17408
 buffer_load_dwordx4 v[108:111], v14, s[36:39], s60 offen offset:1024 sc1
 ds_write_b128 v6, a[24:27] offset:18432
 buffer_load_dwordx4 a[224:227], v14, s[36:39], s60 offen offset:2048 sc1
 s_add_u32 s60, s60, 18432
 ds_write_b128 v6, a[28:31] offset:19456
 buffer_load_dwordx4 a[228:231], v14, s[36:39], s60 offen sc1
 ds_write_b128 v6, a[32:35] offset:32768
 buffer_load_dwordx4 a[232:235], v14, s[36:39], s60 offen offset:1024 sc1
 ds_write_b128 v6, a[36:39] offset:33792
 buffer_load_dwordx4 a[236:239], v14, s[36:39], s60 offen offset:2048 sc1
 s_add_u32 s60, s60, 18432
 ds_write_b128 v6, a[40:43] offset:34816
 buffer_load_dwordx4 a[240:243], v14, s[36:39], s60 offen sc1
 ds_write_b128 v6, a[44:47] offset:35840
 buffer_load_dwordx4 a[244:247], v14, s[36:39], s60 offen offset:1024 sc1
 ds_write_b128 v6, a[48:51] offset:49152
 buffer_load_dwordx4 a[248:251], v14, s[36:39], s60 offen offset:2048 sc1
 s_add_u32 s60, s60, 18432
 ds_write_b128 v6, a[52:55] offset:50176
 buffer_load_dwordx4 a[252:255], v14, s[36:39], s60 offen sc1
 ds_write_b128 v6, a[56:59] offset:51200
 buffer_load_dwordx4 a[96:99], v14, s[36:39], s60 offen offset:1024 sc1
 ds_write_b128 v6, a[60:63] offset:52224
 buffer_load_dwordx4 a[100:103], v14, s[36:39], s60 offen offset:2048 sc1
 s_add_u32 s60, s60, 18432
 buffer_load_dwordx4 a[104:107], v14, s[36:39], s60 offen sc1
 buffer_load_dwordx4 a[108:111], v14, s[36:39], s60 offen offset:1024 sc1
 buffer_load_dwordx4 a[112:115], v14, s[36:39], s60 offen offset:2048 sc1
 s_add_u32 s60, s60, 18432
 buffer_load_dwordx4 a[116:119], v14, s[36:39], s60 offen sc1
 buffer_load_dwordx4 a[120:123], v14, s[36:39], s60 offen offset:1024 sc1
 buffer_load_dwordx4 a[124:127], v14, s[36:39], s60 offen offset:2048 sc1
 s_add_u32 s60, s60, 18432
 buffer_load_dwordx4 a[128:131], v14, s[36:39], s60 offen sc1
 buffer_load_dwordx4 a[132:135], v14, s[36:39], s60 offen offset:1024 sc1
 buffer_load_dwordx4 a[136:139], v14, s[36:39], s60 offen offset:2048 sc1
 s_add_u32 s60, s60, 18432
 buffer_load_dwordx4 a[140:143], v14, s[36:39], s60 offen sc1
 buffer_load_dwordx4 a[144:147], v14, s[36:39], s60 offen offset:1024 sc1
 buffer_load_dwordx4 a[148:151], v14, s[36:39], s60 offen offset:2048 sc1
 s_add_u32 s60, s60, 18432
 buffer_load_dwordx4 a[152:155], v14, s[36:39], s60 offen sc1
 buffer_load_dwordx4 a[156:159], v14, s[36:39], s60 offen offset:1024 sc1
 buffer_load_dwordx4 a[160:163], v14, s[36:39], s60 offen offset:2048 sc1
 s_add_u32 s60, s60, 18432
 buffer_load_dwordx4 a[164:167], v14, s[36:39], s60 offen sc1
 buffer_load_dwordx4 a[168:171], v14, s[36:39], s60 offen offset:1024 sc1
 buffer_load_dwordx4 a[172:175], v14, s[36:39], s60 offen offset:2048 sc1
 s_add_u32 s60, s60, 18432
 buffer_load_dwordx4 a[176:179], v14, s[36:39], s60 offen sc1
 buffer_load_dwordx4 a[180:183], v14, s[36:39], s60 offen offset:1024 sc1
 buffer_load_dwordx4 a[184:187], v14, s[36:39], s60 offen offset:2048 sc1
 s_add_u32 s60, s60, 18432
 buffer_load_dwordx4 a[188:191], v14, s[36:39], s60 offen sc1
 buffer_load_dwordx4 a[192:195], v14, s[36:39], s60 offen offset:1024 sc1
 buffer_load_dwordx4 a[196:199], v14, s[36:39], s60 offen offset:2048 sc1
 s_add_u32 s60, s60, 18432
 s_and_b32 s52, s28, 1
 s_lshr_b32 s53, s28, 1
 s_lshl_b32 s54, s52, 14
 s_lshl_b32 s55, s53, 11
 s_add_u32 s54, s54, s55
 s_add_u32 s54, s54, 61440
 v_add_u32 v6, s54, v14
 v_add_u32 v7, 65536, v6
 s_add_u32 s52, s52, s61
 s_mul_i32 s52, s52, 73728
 s_lshl_b32 s53, s53, 5
 s_add_u32 s52, s52, s53
 s_lshl_b32 s53, s62, 6
 s_add_u32 s54, s52, s53
 v_mul_u32_u24 v4, 2304, v2
 v_lshl_add_u32 v4, v3, 4, v4
 buffer_load_dwordx4 v[240:243], v14, s[36:39], s67 offen offset:1024 sc1
 s_waitcnt lgkmcnt(0)
 s_barrier
 ds_read_b128 v[200:203], v6
 ds_read_b128 v[204:207], v6 offset:1024
 ds_read_b128 v[208:211], v6 offset:4096
 ds_read_b128 v[212:215], v6 offset:5120
 ds_read_b128 v[216:219], v6 offset:8192
 ds_read_b128 v[220:223], v6 offset:9216
 ds_read_b128 v[224:227], v6 offset:12288
 ds_read_b128 v[228:231], v6 offset:13312
 ds_read_b128 v[112:115], v6 offset:32768
 ds_read_b128 v[116:119], v6 offset:33792
 ds_read_b128 v[120:123], v6 offset:36864
 ds_read_b128 v[124:127], v6 offset:37888
 ds_read_b128 v[128:131], v6 offset:40960
 ds_read_b128 v[132:135], v6 offset:41984
 ds_read_b128 v[136:139], v6 offset:45056
 ds_read_b128 v[140:143], v6 offset:46080
 s_waitcnt lgkmcnt(8)
 v_pk_add_f32 v[200:201], v[200:201], v[208:209]
 v_pk_add_f32 v[216:217], v[216:217], v[224:225]
 v_pk_add_f32 v[202:203], v[202:203], v[210:211]
 v_pk_add_f32 v[218:219], v[218:219], v[226:227]
 v_pk_add_f32 v[204:205], v[204:205], v[212:213]
 v_pk_add_f32 v[220:221], v[220:221], v[228:229]
 v_pk_add_f32 v[206:207], v[206:207], v[214:215]
 v_pk_add_f32 v[222:223], v[222:223], v[230:231]
 v_pk_add_f32 v[200:201], v[200:201], v[216:217]
 v_pk_add_f32 v[202:203], v[202:203], v[218:219]
 v_pk_add_f32 v[204:205], v[204:205], v[220:221]
 v_pk_add_f32 v[206:207], v[206:207], v[222:223]
 v_cvt_pk_bf16_f32 v232, v200, v201
 v_cvt_pk_bf16_f32 v233, v202, v203
 v_cvt_pk_bf16_f32 v234, v204, v205
 v_cvt_pk_bf16_f32 v235, v206, v207
 s_nop 1
 v_permlane32_swap_b32 v232, v234
 v_permlane32_swap_b32 v233, v235
 buffer_store_dwordx4 v[232:235], v4, s[40:43], s54 offen offset:1152
 s_waitcnt lgkmcnt(0)
 v_pk_add_f32 v[112:113], v[112:113], v[120:121]
 v_pk_add_f32 v[128:129], v[128:129], v[136:137]
 v_pk_add_f32 v[114:115], v[114:115], v[122:123]
 v_pk_add_f32 v[130:131], v[130:131], v[138:139]
 v_pk_add_f32 v[116:117], v[116:117], v[124:125]
 v_pk_add_f32 v[132:133], v[132:133], v[140:141]
 v_pk_add_f32 v[118:119], v[118:119], v[126:127]
 v_pk_add_f32 v[134:135], v[134:135], v[142:143]
 v_pk_add_f32 v[112:113], v[112:113], v[128:129]
 v_pk_add_f32 v[114:115], v[114:115], v[130:131]
 v_pk_add_f32 v[116:117], v[116:117], v[132:133]
 v_pk_add_f32 v[118:119], v[118:119], v[134:135]
 v_cvt_pk_bf16_f32 v236, v112, v113
 v_cvt_pk_bf16_f32 v237, v114, v115
 v_cvt_pk_bf16_f32 v238, v116, v117
 v_cvt_pk_bf16_f32 v239, v118, v119
 s_nop 1
 v_permlane32_swap_b32 v236, v238
 v_permlane32_swap_b32 v237, v239
 buffer_store_dwordx4 v[236:239], v4, s[40:43], s54 offen offset:1216
 s_and_b32 s52, s28, 1
 s_add_u32 s52, s52, s61
 s_mul_i32 s63, s52, 36864
 s_lshr_b32 s53, s28, 1
 s_mul_i32 s53, s53, 18432
 s_add_u32 s63, s63, s53
 s_add_u32 s63, s63, 61865984
 s_waitcnt vmcnt(2)
 v_and_b32 v240, v240, v241
 v_and_b32 v242, v242, v243
 v_and_b32 v240, v240, v242
 v_cmp_ne_u32 vcc, 1, v240
 s_cmp_lg_u64 vcc, 0
 s_cbranch_scc1 L_faspin_d3
L_faok_d3:
 buffer_load_dwordx4 v[112:115], v14, s[36:39], s63 offen sc1
 buffer_load_dwordx4 v[116:119], v14, s[36:39], s63 offen offset:1024 sc1
 buffer_load_dwordx4 v[120:123], v14, s[36:39], s63 offen offset:2048 sc1
 buffer_load_dwordx4 v[124:127], v14, s[36:39], s63 offen offset:3072 sc1
 s_add_u32 s63, s63, 4096
 buffer_load_dwordx4 v[128:131], v14, s[36:39], s63 offen sc1
 buffer_load_dwordx4 v[132:135], v14, s[36:39], s63 offen offset:1024 sc1
 buffer_load_dwordx4 v[136:139], v14, s[36:39], s63 offen offset:2048 sc1
 buffer_load_dwordx4 v[140:143], v14, s[36:39], s63 offen offset:3072 sc1
 s_add_u32 s63, s63, 4096
 buffer_load_dwordx4 v[144:147], v14, s[36:39], s63 offen sc1
 buffer_load_dwordx4 v[148:151], v14, s[36:39], s63 offen offset:1024 sc1
 buffer_load_dwordx4 v[152:155], v14, s[36:39], s63 offen offset:2048 sc1
 buffer_load_dwordx4 v[156:159], v14, s[36:39], s63 offen offset:3072 sc1
 s_add_u32 s63, s63, 4096
 buffer_load_dwordx4 v[160:163], v14, s[36:39], s63 offen sc1
 buffer_load_dwordx4 v[164:167], v14, s[36:39], s63 offen offset:1024 sc1
 buffer_load_dwordx4 v[168:171], v14, s[36:39], s63 offen offset:2048 sc1
 buffer_load_dwordx4 v[172:175], v14, s[36:39], s63 offen offset:3072 sc1
 s_add_u32 s63, s63, 4096
 buffer_load_dwordx4 v[176:179], v14, s[36:39], s63 offen sc1
 buffer_load_dwordx4 v[180:183], v14, s[36:39], s63 offen offset:1024 sc1
 s_lshl_b32 s54, s28, 13
 v_add_u32 v6, s54, v14
 s_xor_b32 s54, s54, 16384
 v_add_u32 v7, s54, v14
 s_mul_i32 s52, s52, 73728
 s_lshr_b32 s53, s28, 1
 s_lshl_b32 s53, s53, 5
 s_add_u32 s52, s52, s53
 s_lshl_b32 s53, s34, 6
 s_add_u32 s54, s52, s53
 s_waitcnt vmcnt(16)
 v_mfma_f32_32x32x16_bf16 v[184:199], v[32:35], v[112:115], 0
 v_mfma_f32_32x32x16_bf16 v[200:215], v[36:39], v[112:115], 0
 v_mfma_f32_32x32x16_bf16 v[216:231], v[40:43], v[112:115], 0
 v_mfma_f32_32x32x16_bf16 v[184:199], v[44:47], v[116:119], v[184:199]
 v_mfma_f32_32x32x16_bf16 v[200:215], v[48:51], v[116:119], v[200:215]
 v_mfma_f32_32x32x16_bf16 v[216:231], v[52:55], v[116:119], v[216:231]
 s_waitcnt vmcnt(14)
 v_mfma_f32_32x32x16_bf16 v[184:199], v[56:59], v[120:123], v[184:199]
 v_mfma_f32_32x32x16_bf16 v[200:215], v[60:63], v[120:123], v[200:215]
 v_mfma_f32_32x32x16_bf16 v[216:231], v[64:67], v[120:123], v[216:231]
 v_mfma_f32_32x32x16_bf16 v[184:199], v[68:71], v[124:127], v[184:199]
 v_mfma_f32_32x32x16_bf16 v[200:215], v[72:75], v[124:127], v[200:215]
 v_mfma_f32_32x32x16_bf16 v[216:231], v[76:79], v[124:127], v[216:231]
 s_waitcnt vmcnt(12)
 v_mfma_f32_32x32x16_bf16 v[184:199], v[80:83], v[128:131], v[184:199]
 v_mfma_f32_32x32x16_bf16 v[200:215], v[84:87], v[128:131], v[200:215]
 v_mfma_f32_32x32x16_bf16 v[216:231], v[88:91], v[128:131], v[216:231]
 v_mfma_f32_32x32x16_bf16 v[184:199], v[92:95], v[132:135], v[184:199]
 v_mfma_f32_32x32x16_bf16 v[200:215], v[96:99], v[132:135], v[200:215]
 v_mfma_f32_32x32x16_bf16 v[216:231], v[100:103], v[132:135], v[216:231]
 s_waitcnt vmcnt(10)
 v_mfma_f32_32x32x16_bf16 v[184:199], v[104:107], v[136:139], v[184:199]
 v_mfma_f32_32x32x16_bf16 v[200:215], v[108:111], v[136:139], v[200:215]
 v_mfma_f32_32x32x16_bf16 v[216:231], a[224:227], v[136:139], v[216:231]
 v_mfma_f32_32x32x16_bf16 v[184:199], a[228:231], v[140:143], v[184:199]
 v_mfma_f32_32x32x16_bf16 v[200:215], a[232:235], v[140:143], v[200:215]
 v_mfma_f32_32x32x16_bf16 v[216:231], a[236:239], v[140:143], v[216:231]
 s_waitcnt vmcnt(8)
 v_mfma_f32_32x32x16_bf16 v[184:199], a[240:243], v[144:147], v[184:199]
 v_mfma_f32_32x32x16_bf16 v[200:215], a[244:247], v[144:147], v[200:215]
 v_mfma_f32_32x32x16_bf16 v[216:231], a[248:251], v[144:147], v[216:231]
 v_mfma_f32_32x32x16_bf16 v[184:199], a[252:255], v[148:151], v[184:199]
 v_mfma_f32_32x32x16_bf16 v[200:215], a[96:99], v[148:151], v[200:215]
 v_mfma_f32_32x32x16_bf16 v[216:231], a[100:103], v[148:151], v[216:231]
 s_waitcnt vmcnt(6)
 v_mfma_f32_32x32x16_bf16 v[184:199], a[104:107], v[152:155], v[184:199]
 v_mfma_f32_32x32x16_bf16 v[200:215], a[108:111], v[152:155], v[200:215]
 v_mfma_f32_32x32x16_bf16 v[216:231], a[112:115], v[152:155], v[216:231]
 v_mfma_f32_32x32x16_bf16 v[184:199], a[116:119], v[156:159], v[184:199]
 v_mfma_f32_32x32x16_bf16 v[200:215], a[120:123], v[156:159], v[200:215]
 v_mfma_f32_32x32x16_bf16 v[216:231], a[124:127], v[156:159], v[216:231]
 s_waitcnt vmcnt(4)
 v_mfma_f32_32x32x16_bf16 v[184:199], a[128:131], v[160:163], v[184:199]
 v_mfma_f32_32x32x16_bf16 v[200:215], a[132:135], v[160:163], v[200:215]
 v_mfma_f32_32x32x16_bf16 v[216:231], a[136:139], v[160:163], v[216:231]
 v_mfma_f32_32x32x16_bf16 v[184:199], a[140:143], v[164:167], v[184:199]
 v_mfma_f32_32x32x16_bf16 v[200:215], a[144:147], v[164:167], v[200:215]
 v_mfma_f32_32x32x16_bf16 v[216:231], a[148:151], v[164:167], v[216:231]
 s_waitcnt vmcnt(2)
 v_mfma_f32_32x32x16_bf16 v[184:199], a[152:155], v[168:171], v[184:199]
 v_mfma_f32_32x32x16_bf16 v[200:215], a[156:159], v[168:171], v[200:215]
 v_mfma_f32_32x32x16_bf16 v[216:231], a[160:163], v[168:171], v[216:231]
 v_mfma_f32_32x32x16_bf16 v[184:199], a[164:167], v[172:175], v[184:199]
 v_mfma_f32_32x32x16_bf16 v[200:215], a[168:171], v[172:175], v[200:215]
 v_mfma_f32_32x32x16_bf16 v[216:231], a[172:175], v[172:175], v[216:231]
 s_waitcnt vmcnt(0)
 v_mfma_f32_32x32x16_bf16 v[184:199], a[176:179], v[176:179], v[184:199]
 v_mfma_f32_32x32x16_bf16 v[200:215], a[180:183], v[176:179], v[200:215]
 v_mfma_f32_32x32x16_bf16 v[216:231], a[184:187], v[176:179], v[216:231]
 v_mfma_f32_32x32x16_bf16 v[184:199], a[188:191], v[180:183], v[184:199]
 v_mfma_f32_32x32x16_bf16 v[200:215], a[192:195], v[180:183], v[200:215]
 v_mfma_f32_32x32x16_bf16 v[216:231], a[196:199], v[180:183], v[216:231]
 s_cmp_ge_u32 s28, 2
 s_nop 9
 s_cbranch_scc1 L_x1_d3
 ds_write_b128 v6, v[192:195]
 ds_write_b128 v6, v[196:199] offset:1024
 ds_write_b128 v6, v[208:211] offset:2048
 ds_write_b128 v6, v[212:215] offset:3072
 ds_write_b128 v6, v[224:227] offset:4096
 ds_write_b128 v6, v[228:231] offset:5120
 s_waitcnt lgkmcnt(0)
 s_barrier
 ds_read_b128 v[112:115], v7
 ds_read_b128 v[116:119], v7 offset:1024
 ds_read_b128 v[120:123], v7 offset:2048
 ds_read_b128 v[124:127], v7 offset:3072
 ds_read_b128 v[128:131], v7 offset:4096
 ds_read_b128 v[132:135], v7 offset:5120
 s_waitcnt lgkmcnt(4)
 v_pk_add_f32 v[184:185], v[184:185], v[112:113]
 v_pk_add_f32 v[186:187], v[186:187], v[114:115]
 v_pk_add_f32 v[188:189], v[188:189], v[116:117]
 v_pk_add_f32 v[190:191], v[190:191], v[118:119]
 v_cvt_pk_bf16_f32 v144, v184, v185
 v_cvt_pk_bf16_f32 v145, v186, v187
 v_cvt_pk_bf16_f32 v146, v188, v189
 v_cvt_pk_bf16_f32 v147, v190, v191
 s_nop 1
 v_permlane32_swap_b32 v144, v146
 v_permlane32_swap_b32 v145, v147
 buffer_store_dwordx4 v[144:147], v4, s[40:43], s54 offen
 s_waitcnt lgkmcnt(2)
 v_pk_add_f32 v[200:201], v[200:201], v[120:121]
 v_pk_add_f32 v[202:203], v[202:203], v[122:123]
 v_pk_add_f32 v[204:205], v[204:205], v[124:125]
 v_pk_add_f32 v[206:207], v[206:207], v[126:127]
 v_cvt_pk_bf16_f32 v148, v200, v201
 v_cvt_pk_bf16_f32 v149, v202, v203
 v_cvt_pk_bf16_f32 v150, v204, v205
 v_cvt_pk_bf16_f32 v151, v206, v207
 s_nop 1
 v_permlane32_swap_b32 v148, v150
 v_permlane32_swap_b32 v149, v151
 buffer_store_dwordx4 v[148:151], v4, s[40:43], s54 offen offset:64
 s_waitcnt lgkmcnt(0)
 v_pk_add_f32 v[216:217], v[216:217], v[128:129]
 v_pk_add_f32 v[218:219], v[218:219], v[130:131]
 v_pk_add_f32 v[220:221], v[220:221], v[132:133]
 v_pk_add_f32 v[222:223], v[222:223], v[134:135]
 v_cvt_pk_bf16_f32 v152, v216, v217
 v_cvt_pk_bf16_f32 v153, v218, v219
 v_cvt_pk_bf16_f32 v154, v220, v221
 v_cvt_pk_bf16_f32 v155, v222, v223
 s_nop 1
 v_permlane32_swap_b32 v152, v154
 v_permlane32_swap_b32 v153, v155
 buffer_store_dwordx4 v[152:155], v4, s[40:43], s54 offen offset:128
 s_branch L_fin
L_x1_d3:
 ds_write_b128 v6, v[184:187]
 ds_write_b128 v6, v[188:191] offset:1024
 ds_write_b128 v6, v[200:203] offset:2048
 ds_write_b128 v6, v[204:207] offset:3072
 ds_write_b128 v6, v[216:219] offset:4096
 ds_write_b128 v6, v[220:223] offset:5120
 s_waitcnt lgkmcnt(0)
 s_barrier
 ds_read_b128 v[112:115], v7
 ds_read_b128 v[116:119], v7 offset:1024
 ds_read_b128 v[120:123], v7 offset:2048
 ds_read_b128 v[124:127], v7 offset:3072
 ds_read_b128 v[128:131], v7 offset:4096
 ds_read_b128 v[132:135], v7 offset:5120
 s_waitcnt lgkmcnt(4)
 v_pk_add_f32 v[192:193], v[192:193], v[112:113]
 v_pk_add_f32 v[194:195], v[194:195], v[114:115]
 v_pk_add_f32 v[196:197], v[196:197], v[116:117]
 v_pk_add_f32 v[198:199], v[198:199], v[118:119]
 v_cvt_pk_bf16_f32 v144, v192, v193
 v_cvt_pk_bf16_f32 v145, v194, v195
 v_cvt_pk_bf16_f32 v146, v196, v197
 v_cvt_pk_bf16_f32 v147, v198, v199
 s_nop 1
 v_permlane32_swap_b32 v144, v146
 v_permlane32_swap_b32 v145, v147
 buffer_store_dwordx4 v[144:147], v4, s[40:43], s54 offen
 s_waitcnt lgkmcnt(2)
 v_pk_add_f32 v[208:209], v[208:209], v[120:121]
 v_pk_add_f32 v[210:211], v[210:211], v[122:123]
 v_pk_add_f32 v[212:213], v[212:213], v[124:125]
 v_pk_add_f32 v[214:215], v[214:215], v[126:127]
 v_cvt_pk_bf16_f32 v148, v208, v209
 v_cvt_pk_bf16_f32 v149, v210, v211
 v_cvt_pk_bf16_f32 v150, v212, v213
 v_cvt_pk_bf16_f32 v151, v214, v215
 s_nop 1
 v_permlane32_swap_b32 v148, v150
 v_permlane32_swap_b32 v149, v151
 buffer_store_dwordx4 v[148:151], v4, s[40:43], s54 offen offset:64
 s_waitcnt lgkmcnt(0)
 v_pk_add_f32 v[224:225], v[224:225], v[128:129]
 v_pk_add_f32 v[226:227], v[226:227], v[130:131]
 v_pk_add_f32 v[228:229], v[228:229], v[132:133]
 v_pk_add_f32 v[230:231], v[230:231], v[134:135]
 v_cvt_pk_bf16_f32 v152, v224, v225
 v_cvt_pk_bf16_f32 v153, v226, v227
 v_cvt_pk_bf16_f32 v154, v228, v229
 v_cvt_pk_bf16_f32 v155, v230, v231
 s_nop 1
 v_permlane32_swap_b32 v152, v154
 v_permlane32_swap_b32 v153, v155
 buffer_store_dwordx4 v[152:155], v4, s[40:43], s54 offen offset:128
L_fin:
L_end:
 s_endpgm
L_b_slow:
 s_nop 15
 s_mov_b32 s70, s32
 s_lshl_b32 s70, s70, 2
 s_add_u32 s71, s70, s28
 s_add_u32 s71, s71, 1
 s_lshl_b32 s70, s70, 5
 v_mov_b32 v20, 0
 v_mov_b32 v21, 0xf149f2ca
 s_mov_b32 s61, s63
 s_mov_b32 s60, s70
 s_mov_b32 s62, s71
L_b_sl00:
 s_add_u32 s53, s61, 0
 buffer_load_dwordx4 a[128:131], v14, s[36:39], s53 offen sc1
 s_add_u32 s53, s61, 1024
 buffer_load_dwordx4 a[132:135], v14, s[36:39], s53 offen sc1
 s_add_u32 s53, s61, 2048
 buffer_load_dwordx4 a[136:139], v14, s[36:39], s53 offen sc1
 s_add_u32 s53, s61, 3072
 buffer_load_dwordx4 a[140:143], v14, s[36:39], s53 offen sc1
 s_add_u32 s53, s61, 4096
 buffer_load_dwordx4 a[144:147], v14, s[36:39], s53 offen sc1
 s_add_u32 s53, s61, 5120
 buffer_load_dwordx4 a[148:151], v14, s[36:39], s53 offen sc1
 s_add_u32 s53, s61, 6144
 buffer_load_dwordx4 a[152:155], v14, s[36:39], s53 offen sc1
 s_add_u32 s53, s61, 7168
 buffer_load_dwordx4 a[156:159], v14, s[36:39], s53 offen sc1
 s_sub_u32 s52, s60, 0
 v_add_u32 v23, s52, v22
 v_cmp_gt_i32 s[64:65], 0, v23
 v_cmp_gt_i32 s[66:67], 1, v23
 v_cmp_gt_i32 s[68:69], 2, v23
 v_cmp_gt_i32 s[54:55], 3, v23
 v_cndmask_b32 v32, v20, v25, s[64:65]
 v_cmp_gt_i32 s[64:65], 8, v23
 v_cndmask_b32 v33, v20, v25, s[66:67]
 v_cmp_gt_i32 s[66:67], 9, v23
 v_cndmask_b32 v34, v20, v25, s[68:69]
 v_cmp_gt_i32 s[68:69], 10, v23
 v_cndmask_b32 v35, v20, v25, s[54:55]
 v_cmp_gt_i32 s[54:55], 11, v23
 v_cndmask_b32 v36, v20, v25, s[64:65]
 v_cmp_gt_i32 s[64:65], 16, v23
 v_cndmask_b32 v37, v20, v25, s[66:67]
 v_cmp_gt_i32 s[66:67], 17, v23
 v_cndmask_b32 v38, v20, v25, s[68:69]
 v_cmp_gt_i32 s[68:69], 18, v23
 v_cndmask_b32 v39, v20, v25, s[54:55]
 v_cmp_gt_i32 s[54:55], 19, v23
 v_cndmask_b32 v40, v20, v25, s[64:65]
 v_cmp_gt_i32 s[64:65], 24, v23
 v_cndmask_b32 v41, v20, v25, s[66:67]
 v_cmp_gt_i32 s[66:67], 25, v23
 v_cndmask_b32 v42, v20, v25, s[68:69]
 v_cmp_gt_i32 s[68:69], 26, v23
 v_cndmask_b32 v43, v20, v25, s[54:55]
 v_cmp_gt_i32 s[54:55], 27, v23
 v_cndmask_b32 v44, v20, v25, s[64:65]
 v_cndmask_b32 v45, v20, v25, s[66:67]
 v_cndmask_b32 v46, v20, v25, s[68:69]
 v_cndmask_b32 v47, v20, v25, s[54:55]
 s_waitcnt vmcnt(0)
 s_nop 0
 v_mfma_f32_32x32x16_bf16 v[64:79], a[128:131], v[192:195], v[32:47]
 v_mfma_f32_32x32x16_bf16 v[64:79], a[132:135], v[196:199], v[64:79]
 v_mfma_f32_32x32x16_bf16 v[64:79], a[136:139], v[200:203], v[64:79]
 v_mfma_f32_32x32x16_bf16 v[64:79], a[140:143], v[204:207], v[64:79]
 v_mfma_f32_32x32x16_bf16 v[64:79], a[144:147], v[208:211], v[64:79]
 v_mfma_f32_32x32x16_bf16 v[64:79], a[148:151], v[212:215], v[64:79]
 v_mfma_f32_32x32x16_bf16 v[64:79], a[152:155], v[216:219], v[64:79]
 v_mfma_f32_32x32x16_bf16 v[64:79], a[156:159], v[220:223], v[64:79]
 s_nop 15
 v_max_f32 v21, v21, v64
 v_max_f32 v21, v21, v65
 v_max_f32 v21, v21, v66
 v_max_f32 v21, v21, v67
 v_max_f32 v21, v21, v68
 v_max_f32 v21, v21, v69
 v_max_f32 v21, v21, v70
 v_max_f32 v21, v21, v71
 v_max_f32 v21, v21, v72
 v_max_f32 v21, v21, v73
 v_max_f32 v21, v21, v74
 v_max_f32 v21, v21, v75
 v_max_f32 v21, v21, v76
 v_max_f32 v21, v21, v77
 v_max_f32 v21, v21, v78
 v_max_f32 v21, v21, v79
 s_add_u32 s61, s61, 8192
 s_sub_u32 s60, s60, 32
 s_sub_u32 s62, s62, 1
 s_cmp_lg_u32 s62, 0
 s_cbranch_scc1 L_b_sl00
 v_mov_b32 v8, v21
 s_nop 1
 v_permlane32_swap_b32 v21, v8
 s_nop 1
 v_max_f32 v21, v21, v8
 v_sub_f32 v20, 0, v21
 v_mov_b32 v17, 0
 v_accvgpr_write_b32 a0, 0
 v_accvgpr_write_b32 a1, 0
 v_accvgpr_write_b32 a2, 0
 v_accvgpr_write_b32 a3, 0
 v_accvgpr_write_b32 a4, 0
 v_accvgpr_write_b32 a5, 0
 v_accvgpr_write_b32 a6, 0
 v_accvgpr_write_b32 a7, 0
 v_accvgpr_write_b32 a8, 0
 v_accvgpr_write_b32 a9, 0
 v_accvgpr_write_b32 a10, 0
 v_accvgpr_write_b32 a11, 0
 v_accvgpr_write_b32 a12, 0
 v_accvgpr_write_b32 a13, 0
 v_accvgpr_write_b32 a14, 0
 v_accvgpr_write_b32 a15, 0
 v_accvgpr_write_b32 a16, 0
 v_accvgpr_write_b32 a17, 0
 v_accvgpr_write_b32 a18, 0
 v_accvgpr_write_b32 a19, 0
 v_accvgpr_write_b32 a20, 0
 v_accvgpr_write_b32 a21, 0
 v_accvgpr_write_b32 a22, 0
 v_accvgpr_write_b32 a23, 0
 v_accvgpr_write_b32 a24, 0
 v_accvgpr_write_b32 a25, 0
 v_accvgpr_write_b32 a26, 0
 v_accvgpr_write_b32 a27, 0
 v_accvgpr_write_b32 a28, 0
 v_accvgpr_write_b32 a29, 0
 v_accvgpr_write_b32 a30, 0
 v_accvgpr_write_b32 a31, 0
 v_accvgpr_write_b32 a32, 0
 v_accvgpr_write_b32 a33, 0
 v_accvgpr_write_b32 a34, 0
 v_accvgpr_write_b32 a35, 0
 v_accvgpr_write_b32 a36, 0
 v_accvgpr_write_b32 a37, 0
 v_accvgpr_write_b32 a38, 0
 v_accvgpr_write_b32 a39, 0
 v_accvgpr_write_b32 a40, 0
 v_accvgpr_write_b32 a41, 0
 v_accvgpr_write_b32 a42, 0
 v_accvgpr_write_b32 a43, 0
 v_accvgpr_write_b32 a44, 0
 v_accvgpr_write_b32 a45, 0
 v_accvgpr_write_b32 a46, 0
 v_accvgpr_write_b32 a47, 0
 v_accvgpr_write_b32 a48, 0
 v_accvgpr_write_b32 a49, 0
 v_accvgpr_write_b32 a50, 0
 v_accvgpr_write_b32 a51, 0
 v_accvgpr_write_b32 a52, 0
 v_accvgpr_write_b32 a53, 0
 v_accvgpr_write_b32 a54, 0
 v_accvgpr_write_b32 a55, 0
 v_accvgpr_write_b32 a56, 0
 v_accvgpr_write_b32 a57, 0
 v_accvgpr_write_b32 a58, 0
 v_accvgpr_write_b32 a59, 0
 v_accvgpr_write_b32 a60, 0
 v_accvgpr_write_b32 a61, 0
 v_accvgpr_write_b32 a62, 0
 v_accvgpr_write_b32 a63, 0
 s_mov_b32 s61, s63
 s_mov_b32 s60, s70
 s_mov_b32 s62, s71
L_b_sl01:
 s_add_u32 s53, s61, 0
 buffer_load_dwordx4 a[128:131], v14, s[36:39], s53 offen sc1
 s_add_u32 s53, s61, 1024
 buffer_load_dwordx4 a[132:135], v14, s[36:39], s53 offen sc1
 s_add_u32 s53, s61, 2048
 buffer_load_dwordx4 a[136:139], v14, s[36:39], s53 offen sc1
 s_add_u32 s53, s61, 3072
 buffer_load_dwordx4 a[140:143], v14, s[36:39], s53 offen sc1
 s_add_u32 s53, s61, 4096
 buffer_load_dwordx4 a[144:147], v14, s[36:39], s53 offen sc1
 s_add_u32 s53, s61, 5120
 buffer_load_dwordx4 a[148:151], v14, s[36:39], s53 offen sc1
 s_add_u32 s53, s61, 6144
 buffer_load_dwordx4 a[152:155], v14, s[36:39], s53 offen sc1
 s_add_u32 s53, s61, 7168
 buffer_load_dwordx4 a[156:159], v14, s[36:39], s53 offen sc1
 s_add_u32 s53, s61, 16777216
 buffer_load_dwordx4 a[160:163], v14, s[36:39], s53 offen sc1
 s_add_u32 s53, s61, 16778240
 buffer_load_dwordx4 a[164:167], v14, s[36:39], s53 offen sc1
 s_add_u32 s53, s61, 16779264
 buffer_load_dwordx4 a[168:171], v14, s[36:39], s53 offen sc1
 s_add_u32 s53, s61, 16780288
 buffer_load_dwordx4 a[172:175], v14, s[36:39], s53 offen sc1
 s_add_u32 s53, s61, 16781312
 buffer_load_dwordx4 a[176:179], v14, s[36:39], s53 offen sc1
 s_add_u32 s53, s61, 16782336
 buffer_load_dwordx4 a[180:183], v14, s[36:39], s53 offen sc1
 s_add_u32 s53, s61, 16783360
 buffer_load_dwordx4 a[184:187], v14, s[36:39], s53 offen sc1
 s_add_u32 s53, s61, 16784384
 buffer_load_dwordx4 a[188:191], v14, s[36:39], s53 offen sc1
 s_sub_u32 s52, s60, 0
 v_add_u32 v23, s52, v22
 v_cmp_gt_i32 s[64:65], 0, v23
 v_cmp_gt_i32 s[66:67], 1, v23
 v_cmp_gt_i32 s[68:69], 2, v23
 v_cmp_gt_i32 s[54:55], 3, v23
 v_cndmask_b32 v32, v20, v25, s[64:65]
 v_cmp_gt_i32 s[64:65], 8, v23
 v_cndmask_b32 v33, v20, v25, s[66:67]
 v_cmp_gt_i32 s[66:67], 9, v23
 v_cndmask_b32 v34, v20, v25, s[68:69]
 v_cmp_gt_i32 s[68:69], 10, v23
 v_cndmask_b32 v35, v20, v25, s[54:55]
 v_cmp_gt_i32 s[54:55], 11, v23
 v_cndmask_b32 v36, v20, v25, s[64:65]
 v_cmp_gt_i32 s[64:65], 16, v23
 v_cndmask_b32 v37, v20, v25, s[66:67]
 v_cmp_gt_i32 s[66:67], 17, v23
 v_cndmask_b32 v38, v20, v25, s[68:69]
 v_cmp_gt_i32 s[68:69], 18, v23
 v_cndmask_b32 v39, v20, v25, s[54:55]
 v_cmp_gt_i32 s[54:55], 19, v23
 v_cndmask_b32 v40, v20, v25, s[64:65]
 v_cmp_gt_i32 s[64:65], 24, v23
 v_cndmask_b32 v41, v20, v25, s[66:67]
 v_cmp_gt_i32 s[66:67], 25, v23
 v_cndmask_b32 v42, v20, v25, s[68:69]
 v_cmp_gt_i32 s[68:69], 26, v23
 v_cndmask_b32 v43, v20, v25, s[54:55]
 v_cmp_gt_i32 s[54:55], 27, v23
 v_cndmask_b32 v44, v20, v25, s[64:65]
 v_cndmask_b32 v45, v20, v25, s[66:67]
 v_cndmask_b32 v46, v20, v25, s[68:69]
 v_cndmask_b32 v47, v20, v25, s[54:55]
 s_waitcnt vmcnt(0)
 s_nop 0
 v_mfma_f32_32x32x16_bf16 v[64:79], a[128:131], v[192:195], v[32:47]
 v_mfma_f32_32x32x16_bf16 v[64:79], a[132:135], v[196:199], v[64:79]
 v_mfma_f32_32x32x16_bf16 v[64:79], a[136:139], v[200:203], v[64:79]
 v_mfma_f32_32x32x16_bf16 v[64:79], a[140:143], v[204:207], v[64:79]
 v_mfma_f32_32x32x16_bf16 v[64:79], a[144:147], v[208:211], v[64:79]
 v_mfma_f32_32x32x16_bf16 v[64:79], a[148:151], v[212:215], v[64:79]
 v_mfma_f32_32x32x16_bf16 v[64:79], a[152:155], v[216:219], v[64:79]
 v_mfma_f32_32x32x16_bf16 v[64:79], a[156:159], v[220:223], v[64:79]
 s_nop 15
 v_exp_f32 v64, v64
 v_exp_f32 v65, v65
 v_exp_f32 v66, v66
 v_exp_f32 v67, v67
 v_exp_f32 v68, v68
 v_exp_f32 v69, v69
 v_exp_f32 v70, v70
 v_exp_f32 v71, v71
 v_exp_f32 v72, v72
 v_exp_f32 v73, v73
 v_exp_f32 v74, v74
 v_exp_f32 v75, v75
 v_exp_f32 v76, v76
 v_exp_f32 v77, v77
 v_exp_f32 v78, v78
 v_exp_f32 v79, v79
 s_nop 0
 v_add_f32 v17, v17, v64
 v_add_f32 v17, v17, v65
 v_add_f32 v17, v17, v66
 v_add_f32 v17, v17, v67
 v_add_f32 v17, v17, v68
 v_add_f32 v17, v17, v69
 v_add_f32 v17, v17, v70
 v_add_f32 v17, v17, v71
 v_add_f32 v17, v17, v72
 v_add_f32 v17, v17, v73
 v_add_f32 v17, v17, v74
 v_add_f32 v17, v17, v75
 v_add_f32 v17, v17, v76
 v_add_f32 v17, v17, v77
 v_add_f32 v17, v17, v78
 v_add_f32 v17, v17, v79
 v_cvt_pk_bf16_f32 v128, v64, v65
 v_cvt_pk_bf16_f32 v129, v66, v67
 v_cvt_pk_bf16_f32 v130, v68, v69
 v_cvt_pk_bf16_f32 v131, v70, v71
 v_cvt_pk_bf16_f32 v132, v72, v73
 v_cvt_pk_bf16_f32 v133, v74, v75
 v_cvt_pk_bf16_f32 v134, v76, v77
 v_cvt_pk_bf16_f32 v135, v78, v79
 s_nop 1
 v_mfma_f32_32x32x16_bf16 a[0:15], a[160:163], v[128:131], a[0:15]
 v_mfma_f32_32x32x16_bf16 a[16:31], a[164:167], v[128:131], a[16:31]
 v_mfma_f32_32x32x16_bf16 a[32:47], a[168:171], v[128:131], a[32:47]
 v_mfma_f32_32x32x16_bf16 a[48:63], a[172:175], v[128:131], a[48:63]
 v_mfma_f32_32x32x16_bf16 a[0:15], a[176:179], v[132:135], a[0:15]
 v_mfma_f32_32x32x16_bf16 a[16:31], a[180:183], v[132:135], a[16:31]
 v_mfma_f32_32x32x16_bf16 a[32:47], a[184:187], v[132:135], a[32:47]
 v_mfma_f32_32x32x16_bf16 a[48:63], a[188:191], v[132:135], a[48:63]
 s_nop 15
 s_add_u32 s61, s61, 8192
 s_sub_u32 s60, s60, 32
 s_sub_u32 s62, s62, 1
 s_cmp_lg_u32 s62, 0
 s_cbranch_scc1 L_b_sl01
 v_mov_b32 v8, v17
 s_nop 1
 v_permlane32_swap_b32 v17, v8
 s_nop 1
 v_add_f32 v17, v17, v8
 s_sub_u32 s70, 15, s32
 s_lshl_b32 s70, s70, 2
 s_add_u32 s71, s70, s28
 s_add_u32 s71, s71, 1
 s_lshl_b32 s70, s70, 5
 v_mov_b32 v20, 0
 v_mov_b32 v21, 0xf149f2ca
 s_mov_b32 s61, s63
 s_mov_b32 s60, s70
 s_mov_b32 s62, s71
L_b_sl10:
 s_add_u32 s53, s61, 0
 buffer_load_dwordx4 a[128:131], v14, s[36:39], s53 offen sc1
 s_add_u32 s53, s61, 1024
 buffer_load_dwordx4 a[132:135], v14, s[36:39], s53 offen sc1
 s_add_u32 s53, s61, 2048
 buffer_load_dwordx4 a[136:139], v14, s[36:39], s53 offen sc1
 s_add_u32 s53, s61, 3072
 buffer_load_dwordx4 a[140:143], v14, s[36:39], s53 offen sc1
 s_add_u32 s53, s61, 4096
 buffer_load_dwordx4 a[144:147], v14, s[36:39], s53 offen sc1
 s_add_u32 s53, s61, 5120
 buffer_load_dwordx4 a[148:151], v14, s[36:39], s53 offen sc1
 s_add_u32 s53, s61, 6144
 buffer_load_dwordx4 a[152:155], v14, s[36:39], s53 offen sc1
 s_add_u32 s53, s61, 7168
 buffer_load_dwordx4 a[156:159], v14, s[36:39], s53 offen sc1
 s_sub_u32 s52, s60, 0
 v_add_u32 v23, s52, v22
 v_cmp_gt_i32 s[64:65], 0, v23
 v_cmp_gt_i32 s[66:67], 1, v23
 v_cmp_gt_i32 s[68:69], 2, v23
 v_cmp_gt_i32 s[54:55], 3, v23
 v_cndmask_b32 v32, v20, v25, s[64:65]
 v_cmp_gt_i32 s[64:65], 8, v23
 v_cndmask_b32 v33, v20, v25, s[66:67]
 v_cmp_gt_i32 s[66:67], 9, v23
 v_cndmask_b32 v34, v20, v25, s[68:69]
 v_cmp_gt_i32 s[68:69], 10, v23
 v_cndmask_b32 v35, v20, v25, s[54:55]
 v_cmp_gt_i32 s[54:55], 11, v23
 v_cndmask_b32 v36, v20, v25, s[64:65]
 v_cmp_gt_i32 s[64:65], 16, v23
 v_cndmask_b32 v37, v20, v25, s[66:67]
 v_cmp_gt_i32 s[66:67], 17, v23
 v_cndmask_b32 v38, v20, v25, s[68:69]
 v_cmp_gt_i32 s[68:69], 18, v23
 v_cndmask_b32 v39, v20, v25, s[54:55]
 v_cmp_gt_i32 s[54:55], 19, v23
 v_cndmask_b32 v40, v20, v25, s[64:65]
 v_cmp_gt_i32 s[64:65], 24, v23
 v_cndmask_b32 v41, v20, v25, s[66:67]
 v_cmp_gt_i32 s[66:67], 25, v23
 v_cndmask_b32 v42, v20, v25, s[68:69]
 v_cmp_gt_i32 s[68:69], 26, v23
 v_cndmask_b32 v43, v20, v25, s[54:55]
 v_cmp_gt_i32 s[54:55], 27, v23
 v_cndmask_b32 v44, v20, v25, s[64:65]
 v_cndmask_b32 v45, v20, v25, s[66:67]
 v_cndmask_b32 v46, v20, v25, s[68:69]
 v_cndmask_b32 v47, v20, v25, s[54:55]
 s_waitcnt vmcnt(0)
 s_nop 0
 v_mfma_f32_32x32x16_bf16 v[64:79], a[128:131], v[224:227], v[32:47]
 v_mfma_f32_32x32x16_bf16 v[64:79], a[132:135], v[228:231], v[64:79]
 v_mfma_f32_32x32x16_bf16 v[64:79], a[136:139], v[232:235], v[64:79]
 v_mfma_f32_32x32x16_bf16 v[64:79], a[140:143], v[236:239], v[64:79]
 v_mfma_f32_32x32x16_bf16 v[64:79], a[144:147], v[240:243], v[64:79]
 v_mfma_f32_32x32x16_bf16 v[64:79], a[148:151], v[244:247], v[64:79]
 v_mfma_f32_32x32x16_bf16 v[64:79], a[152:155], v[248:251], v[64:79]
 v_mfma_f32_32x32x16_bf16 v[64:79], a[156:159], v[252:255], v[64:79]
 s_nop 15
 v_max_f32 v21, v21, v64
 v_max_f32 v21, v21, v65
 v_max_f32 v21, v21, v66
 v_max_f32 v21, v21, v67
 v_max_f32 v21, v21, v68
 v_max_f32 v21, v21, v69
 v_max_f32 v21, v21, v70
 v_max_f32 v21, v21, v71
 v_max_f32 v21, v21, v72
 v_max_f32 v21, v21, v73
 v_max_f32 v21, v21, v74
 v_max_f32 v21, v21, v75
 v_max_f32 v21, v21, v76
 v_max_f32 v21, v21, v77
 v_max_f32 v21, v21, v78
 v_max_f32 v21, v21, v79
 s_add_u32 s61, s61, 8192
 s_sub_u32 s60, s60, 32
 s_sub_u32 s62, s62, 1
 s_cmp_lg_u32 s62, 0
 s_cbranch_scc1 L_b_sl10
 v_mov_b32 v8, v21
 s_nop 1
 v_permlane32_swap_b32 v21, v8
 s_nop 1
 v_max_f32 v21, v21, v8
 v_sub_f32 v20, 0, v21
 v_mov_b32 v18, 0
 v_accvgpr_write_b32 a64, 0
 v_accvgpr_write_b32 a65, 0
 v_accvgpr_write_b32 a66, 0
 v_accvgpr_write_b32 a67, 0
 v_accvgpr_write_b32 a68, 0
 v_accvgpr_write_b32 a69, 0
 v_accvgpr_write_b32 a70, 0
 v_accvgpr_write_b32 a71, 0
 v_accvgpr_write_b32 a72, 0
 v_accvgpr_write_b32 a73, 0
 v_accvgpr_write_b32 a74, 0
 v_accvgpr_write_b32 a75, 0
 v_accvgpr_write_b32 a76, 0
 v_accvgpr_write_b32 a77, 0
 v_accvgpr_write_b32 a78, 0
 v_accvgpr_write_b32 a79, 0
 v_accvgpr_write_b32 a80, 0
 v_accvgpr_write_b32 a81, 0
 v_accvgpr_write_b32 a82, 0
 v_accvgpr_write_b32 a83, 0
 v_accvgpr_write_b32 a84, 0
 v_accvgpr_write_b32 a85, 0
 v_accvgpr_write_b32 a86, 0
 v_accvgpr_write_b32 a87, 0
 v_accvgpr_write_b32 a88, 0
 v_accvgpr_write_b32 a89, 0
 v_accvgpr_write_b32 a90, 0
 v_accvgpr_write_b32 a91, 0
 v_accvgpr_write_b32 a92, 0
 v_accvgpr_write_b32 a93, 0
 v_accvgpr_write_b32 a94, 0
 v_accvgpr_write_b32 a95, 0
 v_accvgpr_write_b32 a96, 0
 v_accvgpr_write_b32 a97, 0
 v_accvgpr_write_b32 a98, 0
 v_accvgpr_write_b32 a99, 0
 v_accvgpr_write_b32 a100, 0
 v_accvgpr_write_b32 a101, 0
 v_accvgpr_write_b32 a102, 0
 v_accvgpr_write_b32 a103, 0
 v_accvgpr_write_b32 a104, 0
 v_accvgpr_write_b32 a105, 0
 v_accvgpr_write_b32 a106, 0
 v_accvgpr_write_b32 a107, 0
 v_accvgpr_write_b32 a108, 0
 v_accvgpr_write_b32 a109, 0
 v_accvgpr_write_b32 a110, 0
 v_accvgpr_write_b32 a111, 0
 v_accvgpr_write_b32 a112, 0
 v_accvgpr_write_b32 a113, 0
 v_accvgpr_write_b32 a114, 0
 v_accvgpr_write_b32 a115, 0
 v_accvgpr_write_b32 a116, 0
 v_accvgpr_write_b32 a117, 0
 v_accvgpr_write_b32 a118, 0
 v_accvgpr_write_b32 a119, 0
 v_accvgpr_write_b32 a120, 0
 v_accvgpr_write_b32 a121, 0
 v_accvgpr_write_b32 a122, 0
 v_accvgpr_write_b32 a123, 0
 v_accvgpr_write_b32 a124, 0
 v_accvgpr_write_b32 a125, 0
 v_accvgpr_write_b32 a126, 0
 v_accvgpr_write_b32 a127, 0
 s_mov_b32 s61, s63
 s_mov_b32 s60, s70
 s_mov_b32 s62, s71
L_b_sl11:
 s_add_u32 s53, s61, 0
 buffer_load_dwordx4 a[128:131], v14, s[36:39], s53 offen sc1
 s_add_u32 s53, s61, 1024
 buffer_load_dwordx4 a[132:135], v14, s[36:39], s53 offen sc1
 s_add_u32 s53, s61, 2048
 buffer_load_dwordx4 a[136:139], v14, s[36:39], s53 offen sc1
 s_add_u32 s53, s61, 3072
 buffer_load_dwordx4 a[140:143], v14, s[36:39], s53 offen sc1
 s_add_u32 s53, s61, 4096
 buffer_load_dwordx4 a[144:147], v14, s[36:39], s53 offen sc1
 s_add_u32 s53, s61, 5120
 buffer_load_dwordx4 a[148:151], v14, s[36:39], s53 offen sc1
 s_add_u32 s53, s61, 6144
 buffer_load_dwordx4 a[152:155], v14, s[36:39], s53 offen sc1
 s_add_u32 s53, s61, 7168
 buffer_load_dwordx4 a[156:159], v14, s[36:39], s53 offen sc1
 s_add_u32 s53, s61, 16777216
 buffer_load_dwordx4 a[160:163], v14, s[36:39], s53 offen sc1
 s_add_u32 s53, s61, 16778240
 buffer_load_dwordx4 a[164:167], v14, s[36:39], s53 offen sc1
 s_add_u32 s53, s61, 16779264
 buffer_load_dwordx4 a[168:171], v14, s[36:39], s53 offen sc1
 s_add_u32 s53, s61, 16780288
 buffer_load_dwordx4 a[172:175], v14, s[36:39], s53 offen sc1
 s_add_u32 s53, s61, 16781312
 buffer_load_dwordx4 a[176:179], v14, s[36:39], s53 offen sc1
 s_add_u32 s53, s61, 16782336
 buffer_load_dwordx4 a[180:183], v14, s[36:39], s53 offen sc1
 s_add_u32 s53, s61, 16783360
 buffer_load_dwordx4 a[184:187], v14, s[36:39], s53 offen sc1
 s_add_u32 s53, s61, 16784384
 buffer_load_dwordx4 a[188:191], v14, s[36:39], s53 offen sc1
 s_sub_u32 s52, s60, 0
 v_add_u32 v23, s52, v22
 v_cmp_gt_i32 s[64:65], 0, v23
 v_cmp_gt_i32 s[66:67], 1, v23
 v_cmp_gt_i32 s[68:69], 2, v23
 v_cmp_gt_i32 s[54:55], 3, v23
 v_cndmask_b32 v32, v20, v25, s[64:65]
 v_cmp_gt_i32 s[64:65], 8, v23
 v_cndmask_b32 v33, v20, v25, s[66:67]
 v_cmp_gt_i32 s[66:67], 9, v23
 v_cndmask_b32 v34, v20, v25, s[68:69]
 v_cmp_gt_i32 s[68:69], 10, v23
 v_cndmask_b32 v35, v20, v25, s[54:55]
 v_cmp_gt_i32 s[54:55], 11, v23
 v_cndmask_b32 v36, v20, v25, s[64:65]
 v_cmp_gt_i32 s[64:65], 16, v23
 v_cndmask_b32 v37, v20, v25, s[66:67]
 v_cmp_gt_i32 s[66:67], 17, v23
 v_cndmask_b32 v38, v20, v25, s[68:69]
 v_cmp_gt_i32 s[68:69], 18, v23
 v_cndmask_b32 v39, v20, v25, s[54:55]
 v_cmp_gt_i32 s[54:55], 19, v23
 v_cndmask_b32 v40, v20, v25, s[64:65]
 v_cmp_gt_i32 s[64:65], 24, v23
 v_cndmask_b32 v41, v20, v25, s[66:67]
 v_cmp_gt_i32 s[66:67], 25, v23
 v_cndmask_b32 v42, v20, v25, s[68:69]
 v_cmp_gt_i32 s[68:69], 26, v23
 v_cndmask_b32 v43, v20, v25, s[54:55]
 v_cmp_gt_i32 s[54:55], 27, v23
 v_cndmask_b32 v44, v20, v25, s[64:65]
 v_cndmask_b32 v45, v20, v25, s[66:67]
 v_cndmask_b32 v46, v20, v25, s[68:69]
 v_cndmask_b32 v47, v20, v25, s[54:55]
 s_waitcnt vmcnt(0)
 s_nop 0
 v_mfma_f32_32x32x16_bf16 v[64:79], a[128:131], v[224:227], v[32:47]
 v_mfma_f32_32x32x16_bf16 v[64:79], a[132:135], v[228:231], v[64:79]
 v_mfma_f32_32x32x16_bf16 v[64:79], a[136:139], v[232:235], v[64:79]
 v_mfma_f32_32x32x16_bf16 v[64:79], a[140:143], v[236:239], v[64:79]
 v_mfma_f32_32x32x16_bf16 v[64:79], a[144:147], v[240:243], v[64:79]
 v_mfma_f32_32x32x16_bf16 v[64:79], a[148:151], v[244:247], v[64:79]
 v_mfma_f32_32x32x16_bf16 v[64:79], a[152:155], v[248:251], v[64:79]
 v_mfma_f32_32x32x16_bf16 v[64:79], a[156:159], v[252:255], v[64:79]
 s_nop 15
 v_exp_f32 v64, v64
 v_exp_f32 v65, v65
 v_exp_f32 v66, v66
 v_exp_f32 v67, v67
 v_exp_f32 v68, v68
 v_exp_f32 v69, v69
 v_exp_f32 v70, v70
 v_exp_f32 v71, v71
 v_exp_f32 v72, v72
 v_exp_f32 v73, v73
 v_exp_f32 v74, v74
 v_exp_f32 v75, v75
 v_exp_f32 v76, v76
 v_exp_f32 v77, v77
 v_exp_f32 v78, v78
 v_exp_f32 v79, v79
 s_nop 0
 v_add_f32 v18, v18, v64
 v_add_f32 v18, v18, v65
 v_add_f32 v18, v18, v66
 v_add_f32 v18, v18, v67
 v_add_f32 v18, v18, v68
 v_add_f32 v18, v18, v69
 v_add_f32 v18, v18, v70
 v_add_f32 v18, v18, v71
 v_add_f32 v18, v18, v72
 v_add_f32 v18, v18, v73
 v_add_f32 v18, v18, v74
 v_add_f32 v18, v18, v75
 v_add_f32 v18, v18, v76
 v_add_f32 v18, v18, v77
 v_add_f32 v18, v18, v78
 v_add_f32 v18, v18, v79
 v_cvt_pk_bf16_f32 v128, v64, v65
 v_cvt_pk_bf16_f32 v129, v66, v67
 v_cvt_pk_bf16_f32 v130, v68, v69
 v_cvt_pk_bf16_f32 v131, v70, v71
 v_cvt_pk_bf16_f32 v132, v72, v73
 v_cvt_pk_bf16_f32 v133, v74, v75
 v_cvt_pk_bf16_f32 v134, v76, v77
 v_cvt_pk_bf16_f32 v135, v78, v79
 s_nop 1
 v_mfma_f32_32x32x16_bf16 a[64:79], a[160:163], v[128:131], a[64:79]
 v_mfma_f32_32x32x16_bf16 a[80:95], a[164:167], v[128:131], a[80:95]
 v_mfma_f32_32x32x16_bf16 a[96:111], a[168:171], v[128:131], a[96:111]
 v_mfma_f32_32x32x16_bf16 a[112:127], a[172:175], v[128:131], a[112:127]
 v_mfma_f32_32x32x16_bf16 a[64:79], a[176:179], v[132:135], a[64:79]
 v_mfma_f32_32x32x16_bf16 a[80:95], a[180:183], v[132:135], a[80:95]
 v_mfma_f32_32x32x16_bf16 a[96:111], a[184:187], v[132:135], a[96:111]
 v_mfma_f32_32x32x16_bf16 a[112:127], a[188:191], v[132:135], a[112:127]
 s_nop 15
 s_add_u32 s61, s61, 8192
 s_sub_u32 s60, s60, 32
 s_sub_u32 s62, s62, 1
 s_cmp_lg_u32 s62, 0
 s_cbranch_scc1 L_b_sl11
 v_mov_b32 v8, v18
 s_nop 1
 v_permlane32_swap_b32 v18, v8
 s_nop 1
 v_add_f32 v18, v18, v8
 v_rcp_f32 v9, v17
 s_lshl_b32 s53, s31, 13
 s_add_u32 s53, s53, 34603008
 s_lshl_b32 s52, s32, 2
 s_add_u32 s52, s52, s28
 s_lshl_b32 s52, s52, 18
 s_add_u32 s52, s52, s53
 s_add_u32 s53, s52, 4096
 v_mov_b32 v8, v9
 v_accvgpr_read_b32 v160, a0
 v_accvgpr_read_b32 v161, a1
 v_accvgpr_read_b32 v162, a2
 v_accvgpr_read_b32 v163, a3
 v_accvgpr_read_b32 v164, a4
 v_accvgpr_read_b32 v165, a5
 v_accvgpr_read_b32 v166, a6
 v_accvgpr_read_b32 v167, a7
 v_pk_mul_f32 v[160:161], v[160:161], v[8:9]
 v_pk_mul_f32 v[162:163], v[162:163], v[8:9]
 v_pk_mul_f32 v[164:165], v[164:165], v[8:9]
 v_pk_mul_f32 v[166:167], v[166:167], v[8:9]
 v_cvt_pk_bf16_f32 v168, v160, v161
 v_cvt_pk_bf16_f32 v169, v162, v163
 v_cvt_pk_bf16_f32 v170, v164, v165
 v_cvt_pk_bf16_f32 v171, v166, v167
 buffer_store_dwordx4 v[168:171], v14, s[36:39], s52 offen sc1
 v_accvgpr_read_b32 v160, a8
 v_accvgpr_read_b32 v161, a9
 v_accvgpr_read_b32 v162, a10
 v_accvgpr_read_b32 v163, a11
 v_accvgpr_read_b32 v164, a12
 v_accvgpr_read_b32 v165, a13
 v_accvgpr_read_b32 v166, a14
 v_accvgpr_read_b32 v167, a15
 v_pk_mul_f32 v[160:161], v[160:161], v[8:9]
 v_pk_mul_f32 v[162:163], v[162:163], v[8:9]
 v_pk_mul_f32 v[164:165], v[164:165], v[8:9]
 v_pk_mul_f32 v[166:167], v[166:167], v[8:9]
 v_cvt_pk_bf16_f32 v172, v160, v161
 v_cvt_pk_bf16_f32 v173, v162, v163
 v_cvt_pk_bf16_f32 v174, v164, v165
 v_cvt_pk_bf16_f32 v175, v166, v167
 buffer_store_dwordx4 v[172:175], v14, s[36:39], s52 offen offset:1024 sc1
 v_accvgpr_read_b32 v160, a16
 v_accvgpr_read_b32 v161, a17
 v_accvgpr_read_b32 v162, a18
 v_accvgpr_read_b32 v163, a19
 v_accvgpr_read_b32 v164, a20
 v_accvgpr_read_b32 v165, a21
 v_accvgpr_read_b32 v166, a22
 v_accvgpr_read_b32 v167, a23
 v_pk_mul_f32 v[160:161], v[160:161], v[8:9]
 v_pk_mul_f32 v[162:163], v[162:163], v[8:9]
 v_pk_mul_f32 v[164:165], v[164:165], v[8:9]
 v_pk_mul_f32 v[166:167], v[166:167], v[8:9]
 v_cvt_pk_bf16_f32 v168, v160, v161
 v_cvt_pk_bf16_f32 v169, v162, v163
 v_cvt_pk_bf16_f32 v170, v164, v165
 v_cvt_pk_bf16_f32 v171, v166, v167
 buffer_store_dwordx4 v[168:171], v14, s[36:39], s52 offen offset:2048 sc1
 v_accvgpr_read_b32 v160, a24
 v_accvgpr_read_b32 v161, a25
 v_accvgpr_read_b32 v162, a26
 v_accvgpr_read_b32 v163, a27
 v_accvgpr_read_b32 v164, a28
 v_accvgpr_read_b32 v165, a29
 v_accvgpr_read_b32 v166, a30
 v_accvgpr_read_b32 v167, a31
 v_pk_mul_f32 v[160:161], v[160:161], v[8:9]
 v_pk_mul_f32 v[162:163], v[162:163], v[8:9]
 v_pk_mul_f32 v[164:165], v[164:165], v[8:9]
 v_pk_mul_f32 v[166:167], v[166:167], v[8:9]
 v_cvt_pk_bf16_f32 v172, v160, v161
 v_cvt_pk_bf16_f32 v173, v162, v163
 v_cvt_pk_bf16_f32 v174, v164, v165
 v_cvt_pk_bf16_f32 v175, v166, v167
 buffer_store_dwordx4 v[172:175], v14, s[36:39], s52 offen offset:3072 sc1
 v_accvgpr_read_b32 v160, a32
 v_accvgpr_read_b32 v161, a33
 v_accvgpr_read_b32 v162, a34
 v_accvgpr_read_b32 v163, a35
 v_accvgpr_read_b32 v164, a36
 v_accvgpr_read_b32 v165, a37
 v_accvgpr_read_b32 v166, a38
 v_accvgpr_read_b32 v167, a39
 v_pk_mul_f32 v[160:161], v[160:161], v[8:9]
 v_pk_mul_f32 v[162:163], v[162:163], v[8:9]
 v_pk_mul_f32 v[164:165], v[164:165], v[8:9]
 v_pk_mul_f32 v[166:167], v[166:167], v[8:9]
 v_cvt_pk_bf16_f32 v168, v160, v161
 v_cvt_pk_bf16_f32 v169, v162, v163
 v_cvt_pk_bf16_f32 v170, v164, v165
 v_cvt_pk_bf16_f32 v171, v166, v167
 buffer_store_dwordx4 v[168:171], v14, s[36:39], s53 offen sc1
 v_accvgpr_read_b32 v160, a40
 v_accvgpr_read_b32 v161, a41
 v_accvgpr_read_b32 v162, a42
 v_accvgpr_read_b32 v163, a43
 v_accvgpr_read_b32 v164, a44
 v_accvgpr_read_b32 v165, a45
 v_accvgpr_read_b32 v166, a46
 v_accvgpr_read_b32 v167, a47
 v_pk_mul_f32 v[160:161], v[160:161], v[8:9]
 v_pk_mul_f32 v[162:163], v[162:163], v[8:9]
 v_pk_mul_f32 v[164:165], v[164:165], v[8:9]
 v_pk_mul_f32 v[166:167], v[166:167], v[8:9]
 v_cvt_pk_bf16_f32 v172, v160, v161
 v_cvt_pk_bf16_f32 v173, v162, v163
 v_cvt_pk_bf16_f32 v174, v164, v165
 v_cvt_pk_bf16_f32 v175, v166, v167
 buffer_store_dwordx4 v[172:175], v14, s[36:39], s53 offen offset:1024 sc1
 v_accvgpr_read_b32 v160, a48
 v_accvgpr_read_b32 v161, a49
 v_accvgpr_read_b32 v162, a50
 v_accvgpr_read_b32 v163, a51
 v_accvgpr_read_b32 v164, a52
 v_accvgpr_read_b32 v165, a53
 v_accvgpr_read_b32 v166, a54
 v_accvgpr_read_b32 v167, a55
 v_pk_mul_f32 v[160:161], v[160:161], v[8:9]
 v_pk_mul_f32 v[162:163], v[162:163], v[8:9]
 v_pk_mul_f32 v[164:165], v[164:165], v[8:9]
 v_pk_mul_f32 v[166:167], v[166:167], v[8:9]
 v_cvt_pk_bf16_f32 v168, v160, v161
 v_cvt_pk_bf16_f32 v169, v162, v163
 v_cvt_pk_bf16_f32 v170, v164, v165
 v_cvt_pk_bf16_f32 v171, v166, v167
 buffer_store_dwordx4 v[168:171], v14, s[36:39], s53 offen offset:2048 sc1
 v_accvgpr_read_b32 v160, a56
 v_accvgpr_read_b32 v161, a57
 v_accvgpr_read_b32 v162, a58
 v_accvgpr_read_b32 v163, a59
 v_accvgpr_read_b32 v164, a60
 v_accvgpr_read_b32 v165, a61
 v_accvgpr_read_b32 v166, a62
 v_accvgpr_read_b32 v167, a63
 v_pk_mul_f32 v[160:161], v[160:161], v[8:9]
 v_pk_mul_f32 v[162:163], v[162:163], v[8:9]
 v_pk_mul_f32 v[164:165], v[164:165], v[8:9]
 v_pk_mul_f32 v[166:167], v[166:167], v[8:9]
 v_cvt_pk_bf16_f32 v172, v160, v161
 v_cvt_pk_bf16_f32 v173, v162, v163
 v_cvt_pk_bf16_f32 v174, v164, v165
 v_cvt_pk_bf16_f32 v175, v166, v167
 buffer_store_dwordx4 v[172:175], v14, s[36:39], s53 offen offset:3072 sc1
 s_branch L_b_epi
L_kvspin_FT:
 s_mov_b32 s55, 0x40000
L_kvspin_FT_l:
 s_sleep 2
 s_lshl_b32 s64, s31, 2
 v_mov_b32 v31, s64
 buffer_load_dword v31, v31, s[72:75], 0 offen offset:128 sc1
 s_waitcnt vmcnt(0)
 v_readfirstlane_b32 s64, v31
 s_cmp_lt_u32 s64, 8
 s_cbranch_scc0 L_kvok_FT
 s_sub_u32 s55, s55, 1
 s_cmp_lg_u32 s55, 0
 s_cbranch_scc1 L_kvspin_FT_l
 s_branch L_kvok_FT
L_kvspin_TF:
 s_mov_b32 s55, 0x40000
L_kvspin_TF_l:
 s_sleep 2
 s_lshl_b32 s64, s31, 2
 v_mov_b32 v31, s64
 buffer_load_dword v31, v31, s[72:75], 0 offen offset:128 sc1
 s_waitcnt vmcnt(0)
 v_readfirstlane_b32 s64, v31
 s_cmp_lt_u32 s64, 8
 s_cbranch_scc0 L_kvok_TF
 s_sub_u32 s55, s55, 1
 s_cmp_lg_u32 s55, 0
 s_cbranch_scc1 L_kvspin_TF_l
 s_branch L_kvok_TF
L_s2spin:
 s_mov_b32 s53, 0x40000
L_s2spin_l:
 s_sleep 2
 v_mov_b32 v28, 0
 buffer_load_dword v28, v28, s[72:75], 0 offen sc1
 s_waitcnt vmcnt(0)
 v_readfirstlane_b32 s52, v28
 s_cmp_lt_u32 s52, 256
 s_cbranch_scc0 L_s2ok
 s_sub_u32 s53, s53, 1
 s_cmp_lg_u32 s53, 0
 s_cbranch_scc1 L_s2spin_l
 s_branch L_s2ok
L_fbspin:
 s_mov_b32 s53, 0x40000
L_fbspin_l:
 s_sleep 2
 buffer_load_dwordx4 v[240:243], v14, s[36:39], s67 offen sc1
 s_waitcnt vmcnt(0)
 v_and_b32 v240, v240, v241
 v_and_b32 v242, v242, v243
 v_and_b32 v240, v240, v242
 v_cmp_ne_u32 vcc, 1, v240
 s_cmp_lg_u64 vcc, 0
 s_cbranch_scc0 L_fbok
 s_sub_u32 s53, s53, 1
 s_cmp_lg_u32 s53, 0
 s_cbranch_scc1 L_fbspin_l
 s_branch L_fbok
L_faspin_t2:
 s_mov_b32 s53, 0x40000
L_faspin_t2_l:
 s_sleep 2
 buffer_load_dwordx4 v[240:243], v14, s[36:39], s67 offen offset:1024 sc1
 s_waitcnt vmcnt(0)
 v_and_b32 v240, v240, v241
 v_and_b32 v242, v242, v243
 v_and_b32 v240, v240, v242
 v_cmp_ne_u32 vcc, 1, v240
 s_cmp_lg_u64 vcc, 0
 s_cbranch_scc0 L_faok_t2
 s_sub_u32 s53, s53, 1
 s_cmp_lg_u32 s53, 0
 s_cbranch_scc1 L_faspin_t2_l
 s_branch L_faok_t2
L_faspin_d2:
 s_mov_b32 s53, 0x40000
L_faspin_d2_l:
 s_sleep 2
 buffer_load_dwordx4 v[240:243], v14, s[36:39], s67 offen offset:1024 sc1
 s_waitcnt vmcnt(0)
 v_and_b32 v240, v240, v241
 v_and_b32 v242, v242, v243
 v_and_b32 v240, v240, v242
 v_cmp_ne_u32 vcc, 1, v240
 s_cmp_lg_u64 vcc, 0
 s_cbranch_scc0 L_faok_d2
 s_sub_u32 s53, s53, 1
 s_cmp_lg_u32 s53, 0
 s_cbranch_scc1 L_faspin_d2_l
 s_branch L_faok_d2
L_faspin_d3:
 s_mov_b32 s53, 0x40000
L_faspin_d3_l:
 s_sleep 2
 buffer_load_dwordx4 v[240:243], v14, s[36:39], s67 offen offset:1024 sc1
 s_waitcnt vmcnt(0)
 v_and_b32 v240, v240, v241
 v_and_b32 v242, v242, v243
 v_and_b32 v240, v240, v242
 v_cmp_ne_u32 vcc, 1, v240
 s_cmp_lg_u64 vcc, 0
 s_cbranch_scc0 L_faok_d3
 s_sub_u32 s53, s53, 1
 s_cmp_lg_u32 s53, 0
 s_cbranch_scc1 L_faspin_d3_l
 s_branch L_faok_d3
L_a_slow:
 s_waitcnt vmcnt(0)
 v_mov_b32 v16, 0xf149f2ca
 v_mov_b32 v32, 0
 v_mov_b32 v33, 0
 v_mov_b32 v34, 0
 v_mov_b32 v35, 0
 v_mov_b32 v36, 0
 v_mov_b32 v37, 0
 v_mov_b32 v38, 0
 v_mov_b32 v39, 0
 v_mov_b32 v40, 0
 v_mov_b32 v41, 0
 v_mov_b32 v42, 0
 v_mov_b32 v43, 0
 v_mov_b32 v44, 0
 v_mov_b32 v45, 0
 v_mov_b32 v46, 0
 v_mov_b32 v47, 0
 v_mov_b32 v17, 0xf149f2ca
 v_mov_b32 v48, 0
 v_mov_b32 v49, 0
 v_mov_b32 v50, 0
 v_mov_b32 v51, 0
 v_mov_b32 v52, 0
 v_mov_b32 v53, 0
 v_mov_b32 v54, 0
 v_mov_b32 v55, 0
 v_mov_b32 v56, 0
 v_mov_b32 v57, 0
 v_mov_b32 v58, 0
 v_mov_b32 v59, 0
 v_mov_b32 v60, 0
 v_mov_b32 v61, 0
 v_mov_b32 v62, 0
 v_mov_b32 v63, 0
 s_mov_b32 s52, 0
L_a_sl0:
 s_lshr_b32 s53, s52, 3
 s_mul_i32 s53, s53, 20480
 s_mul_i32 s54, s31, 163840
 s_add_u32 s53, s53, s54
 s_add_u32 s53, s53, 52428800
 s_and_b32 s54, s52, 7
 s_lshl_b32 s55, s54, 10
 s_add_u32 s55, s55, s53
 buffer_load_dwordx4 v[208:211], v14, s[36:39], s55 offen sc1
 s_lshl_b32 s55, s54, 7
 s_add_u32 s55, s55, s53
 buffer_load_dword v212, v20, s[36:39], s55 offen sc1
 s_mul_i32 s55, s54, 1280
 s_add_u32 s55, s55, s53
 buffer_load_dwordx4 v[224:227], v21, s[36:39], s55 offen sc1
 buffer_load_dwordx4 v[228:231], v21, s[36:39], s55 offen offset:640 sc1
 v_cmp_eq_u32 vcc, 18, v2
 v_mov_b32 v6, 0x3f803f80
 s_waitcnt vmcnt(0)
 v_cndmask_b32 v6, 0, v6, vcc
 v_cmp_gt_u32 vcc, 18, v2
 s_nop 1
 v_cndmask_b32 v224, v6, v224, vcc
 v_cndmask_b32 v225, v6, v225, vcc
 v_cndmask_b32 v226, v6, v226, vcc
 v_cndmask_b32 v227, v6, v227, vcc
 v_cndmask_b32 v228, v6, v228, vcc
 v_cndmask_b32 v229, v6, v229, vcc
 v_cndmask_b32 v230, v6, v230, vcc
 v_cndmask_b32 v231, v6, v231, vcc
 v_mfma_f32_32x32x16_bf16 v[112:127], v[208:211], v[96:99], v[32:47]
 v_mfma_f32_32x32x16_bf16 v[128:143], v[208:211], v[104:107], v[48:63]
 v_mfma_f32_32x32x16_bf16 v[112:127], v[212:215], v[100:103], v[112:127]
 v_mfma_f32_32x32x16_bf16 v[128:143], v[212:215], v[108:111], v[128:143]
 s_nop 15
 v_max_f32 v16, v16, v112
 v_max_f32 v16, v16, v113
 v_max_f32 v16, v16, v114
 v_max_f32 v16, v16, v115
 v_max_f32 v16, v16, v116
 v_max_f32 v16, v16, v117
 v_max_f32 v16, v16, v118
 v_max_f32 v16, v16, v119
 v_max_f32 v16, v16, v120
 v_max_f32 v16, v16, v121
 v_max_f32 v16, v16, v122
 v_max_f32 v16, v16, v123
 v_max_f32 v16, v16, v124
 v_max_f32 v16, v16, v125
 v_max_f32 v16, v16, v126
 v_max_f32 v16, v16, v127
 v_max_f32 v17, v17, v128
 v_max_f32 v17, v17, v129
 v_max_f32 v17, v17, v130
 v_max_f32 v17, v17, v131
 v_max_f32 v17, v17, v132
 v_max_f32 v17, v17, v133
 v_max_f32 v17, v17, v134
 v_max_f32 v17, v17, v135
 v_max_f32 v17, v17, v136
 v_max_f32 v17, v17, v137
 v_max_f32 v17, v17, v138
 v_max_f32 v17, v17, v139
 v_max_f32 v17, v17, v140
 v_max_f32 v17, v17, v141
 v_max_f32 v17, v17, v142
 v_max_f32 v17, v17, v143
 s_add_u32 s52, s52, 1
 s_cmp_lt_u32 s52, 64
 s_cbranch_scc1 L_a_sl0
 v_mov_b32 v8, v16
 v_mov_b32 v9, v17
 s_nop 1
 v_permlane32_swap_b32 v16, v8
 v_permlane32_swap_b32 v17, v9
 s_nop 1
 v_max_f32 v16, v16, v8
 v_max_f32 v17, v17, v9
 v_sub_f32 v32, 0, v16
 v_mov_b32 v64, 0
 v_sub_f32 v33, 0, v16
 v_mov_b32 v65, 0
 v_sub_f32 v34, 0, v16
 v_mov_b32 v66, 0
 v_sub_f32 v35, 0, v16
 v_mov_b32 v67, 0
 v_sub_f32 v36, 0, v16
 v_mov_b32 v68, 0
 v_sub_f32 v37, 0, v16
 v_mov_b32 v69, 0
 v_sub_f32 v38, 0, v16
 v_mov_b32 v70, 0
 v_sub_f32 v39, 0, v16
 v_mov_b32 v71, 0
 v_sub_f32 v40, 0, v16
 v_mov_b32 v72, 0
 v_sub_f32 v41, 0, v16
 v_mov_b32 v73, 0
 v_sub_f32 v42, 0, v16
 v_mov_b32 v74, 0
 v_sub_f32 v43, 0, v16
 v_mov_b32 v75, 0
 v_sub_f32 v44, 0, v16
 v_mov_b32 v76, 0
 v_sub_f32 v45, 0, v16
 v_mov_b32 v77, 0
 v_sub_f32 v46, 0, v16
 v_mov_b32 v78, 0
 v_sub_f32 v47, 0, v16
 v_mov_b32 v79, 0
 v_sub_f32 v48, 0, v17
 v_mov_b32 v80, 0
 v_sub_f32 v49, 0, v17
 v_mov_b32 v81, 0
 v_sub_f32 v50, 0, v17
 v_mov_b32 v82, 0
 v_sub_f32 v51, 0, v17
 v_mov_b32 v83, 0
 v_sub_f32 v52, 0, v17
 v_mov_b32 v84, 0
 v_sub_f32 v53, 0, v17
 v_mov_b32 v85, 0
 v_sub_f32 v54, 0, v17
 v_mov_b32 v86, 0
 v_sub_f32 v55, 0, v17
 v_mov_b32 v87, 0
 v_sub_f32 v56, 0, v17
 v_mov_b32 v88, 0
 v_sub_f32 v57, 0, v17
 v_mov_b32 v89, 0
 v_sub_f32 v58, 0, v17
 v_mov_b32 v90, 0
 v_sub_f32 v59, 0, v17
 v_mov_b32 v91, 0
 v_sub_f32 v60, 0, v17
 v_mov_b32 v92, 0
 v_sub_f32 v61, 0, v17
 v_mov_b32 v93, 0
 v_sub_f32 v62, 0, v17
 v_mov_b32 v94, 0
 v_sub_f32 v63, 0, v17
 v_mov_b32 v95, 0
 s_mov_b32 s52, 0
L_a_sl1:
 s_lshr_b32 s53, s52, 3
 s_mul_i32 s53, s53, 20480
 s_mul_i32 s54, s31, 163840
 s_add_u32 s53, s53, s54
 s_add_u32 s53, s53, 52428800
 s_and_b32 s54, s52, 7
 s_lshl_b32 s55, s54, 10
 s_add_u32 s55, s55, s53
 buffer_load_dwordx4 v[208:211], v14, s[36:39], s55 offen sc1
 s_lshl_b32 s55, s54, 7
 s_add_u32 s55, s55, s53
 buffer_load_dword v212, v20, s[36:39], s55 offen sc1
 s_mul_i32 s55, s54, 1280
 s_add_u32 s55, s55, s53
 buffer_load_dwordx4 v[224:227], v21, s[36:39], s55 offen sc1
 buffer_load_dwordx4 v[228:231], v21, s[36:39], s55 offen offset:640 sc1
 v_cmp_eq_u32 vcc, 18, v2
 v_mov_b32 v6, 0x3f803f80
 s_waitcnt vmcnt(0)
 v_cndmask_b32 v6, 0, v6, vcc
 v_cmp_gt_u32 vcc, 18, v2
 s_nop 1
 v_cndmask_b32 v224, v6, v224, vcc
 v_cndmask_b32 v225, v6, v225, vcc
 v_cndmask_b32 v226, v6, v226, vcc
 v_cndmask_b32 v227, v6, v227, vcc
 v_cndmask_b32 v228, v6, v228, vcc
 v_cndmask_b32 v229, v6, v229, vcc
 v_cndmask_b32 v230, v6, v230, vcc
 v_cndmask_b32 v231, v6, v231, vcc
 v_mfma_f32_32x32x16_bf16 v[112:127], v[208:211], v[96:99], v[32:47]
 v_mfma_f32_32x32x16_bf16 v[128:143], v[208:211], v[104:107], v[48:63]
 v_mfma_f32_32x32x16_bf16 v[112:127], v[212:215], v[100:103], v[112:127]
 v_mfma_f32_32x32x16_bf16 v[128:143], v[212:215], v[108:111], v[128:143]
 s_nop 15
 v_exp_f32 v112, v112
 v_exp_f32 v113, v113
 v_exp_f32 v114, v114
 v_exp_f32 v115, v115
 v_exp_f32 v116, v116
 v_exp_f32 v117, v117
 v_exp_f32 v118, v118
 v_exp_f32 v119, v119
 v_exp_f32 v120, v120
 v_exp_f32 v121, v121
 v_exp_f32 v122, v122
 v_exp_f32 v123, v123
 v_exp_f32 v124, v124
 v_exp_f32 v125, v125
 v_exp_f32 v126, v126
 v_exp_f32 v127, v127
 s_nop 0
 v_cvt_pk_bf16_f32 v176, v112, v113
 v_cvt_pk_bf16_f32 v177, v114, v115
 v_cvt_pk_bf16_f32 v178, v116, v117
 v_cvt_pk_bf16_f32 v179, v118, v119
 v_cvt_pk_bf16_f32 v180, v120, v121
 v_cvt_pk_bf16_f32 v181, v122, v123
 v_cvt_pk_bf16_f32 v182, v124, v125
 v_cvt_pk_bf16_f32 v183, v126, v127
 v_exp_f32 v128, v128
 v_exp_f32 v129, v129
 v_exp_f32 v130, v130
 v_exp_f32 v131, v131
 v_exp_f32 v132, v132
 v_exp_f32 v133, v133
 v_exp_f32 v134, v134
 v_exp_f32 v135, v135
 v_exp_f32 v136, v136
 v_exp_f32 v137, v137
 v_exp_f32 v138, v138
 v_exp_f32 v139, v139
 v_exp_f32 v140, v140
 v_exp_f32 v141, v141
 v_exp_f32 v142, v142
 v_exp_f32 v143, v143
 s_nop 0
 v_cvt_pk_bf16_f32 v184, v128, v129
 v_cvt_pk_bf16_f32 v185, v130, v131
 v_cvt_pk_bf16_f32 v186, v132, v133
 v_cvt_pk_bf16_f32 v187, v134, v135
 v_cvt_pk_bf16_f32 v188, v136, v137
 v_cvt_pk_bf16_f32 v189, v138, v139
 v_cvt_pk_bf16_f32 v190, v140, v141
 v_cvt_pk_bf16_f32 v191, v142, v143
 s_nop 1
 v_mfma_f32_32x32x16_bf16 v[64:79], v[224:227], v[176:179], v[64:79]
 v_mfma_f32_32x32x16_bf16 v[80:95], v[224:227], v[184:187], v[80:95]
 v_mfma_f32_32x32x16_bf16 v[64:79], v[228:231], v[180:183], v[64:79]
 v_mfma_f32_32x32x16_bf16 v[80:95], v[228:231], v[188:191], v[80:95]
 s_nop 15
 s_add_u32 s52, s52, 1
 s_cmp_lt_u32 s52, 64
 s_cbranch_scc1 L_a_sl1
 v_mov_b32 v16, v74
 v_mov_b32 v8, v74
 v_mov_b32 v17, v90
 v_mov_b32 v9, v90
 s_nop 1
 v_permlane32_swap_b32 v16, v8
 v_permlane32_swap_b32 v17, v9
 s_nop 1
 s_cmp_eq_u32 s66, 3
 s_cbranch_scc1 L_a_epi_t
 s_branch L_a_epi_d
L_code_end:
.section .rodata,"a"
.p2align 6
.amdhsa_kernel concat_heads__softmax_full_mha__compressed_kv_cla__prompt_kernel
  .amdhsa_next_free_vgpr 512
  .amdhsa_next_free_sgpr 102
  .amdhsa_accum_offset 256
  .amdhsa_group_segment_fixed_size 0
  .amdhsa_kernarg_size 96
  .amdhsa_user_sgpr_count 2
  .amdhsa_user_sgpr_kernarg_segment_ptr 1
  .amdhsa_system_sgpr_workgroup_id_x 1
  .amdhsa_float_denorm_mode_32 3
.end_amdhsa_kernel
```
